```python
import torch

def _softmax(x, axis=-1):
    return torch.softmax(x, dim=axis)
def _gelu(x):
    return torch.nn.functional.gelu(x, approximate="tanh")
def _silu(x):
    return torch.nn.functional.silu(x)
def _sigmoid(x):
    return torch.sigmoid(x)
def _layernorm(x, axis=-1, eps=1e-5):
    m = x.mean(dim=axis, keepdim=True)
    v = x.var(dim=axis, keepdim=True, unbiased=False)
    return (x - m) / torch.sqrt(v + eps)
def _scatter_add(tgt, idx, src, axis=0):
    return tgt.clone().index_add_(axis, idx, src)
def _segment_sum(src, seg, n):
    out = torch.zeros((n,) + src.shape[1:], dtype=src.dtype)
    return out.index_add_(0, seg, src)
def _pad(x, pw):
    flat = tuple(v for pair in reversed(pw) for v in pair)
    return torch.nn.functional.pad(x, flat)

kernel_name = 'concat_heads__mha_block_cached__mha_block_cached__near_ridge'

def setup_inputs():

    _w = (lambda a: (lambda t: t.to(torch.bfloat16) if t.is_floating_point() else t)(torch.as_tensor(a)))
    def _A_setup():
        B, Sq, D = 8, 144, 640
        H, Sk, Dh = 32, 512, 128
        return {
            "x": _w((lambda *s: torch.randn(*s, dtype=torch.bfloat16) * 0.8)(B, Sq, D)),
            "k_cache": _w((lambda *s: torch.randn(*s, dtype=torch.bfloat16) * 0.8)(B, H, Sk, Dh)),
            "v_cache": _w((lambda *s: torch.randn(*s, dtype=torch.bfloat16) * 0.05)(B, H, Sk, Dh)),
            "wq": _w((lambda *s: torch.randn(*s, dtype=torch.bfloat16) * 0.8)(D, H * Dh) * (D ** -0.5)),
            "wo": _w((lambda *s: torch.randn(*s, dtype=torch.bfloat16) * 0.05)(H * Dh, D) * ((H * Dh) ** -0.5)),
        }
    _A_in = _A_setup()

    def _B_setup():
        B, Sq, D = 8, 144, 640
        H, Sk, Dh = 32, 512, 128
        return {
            "x": _w((lambda *s: torch.randn(*s, dtype=torch.bfloat16) * 0.8)(B, Sq, D)),
            "k_cache": _w((lambda *s: torch.randn(*s, dtype=torch.bfloat16) * 0.8)(B, H, Sk, Dh)),
            "v_cache": _w((lambda *s: torch.randn(*s, dtype=torch.bfloat16) * 0.05)(B, H, Sk, Dh)),
            "wq": _w((lambda *s: torch.randn(*s, dtype=torch.bfloat16) * 0.8)(D, H * Dh) * (D ** -0.5)),
            "wo": _w((lambda *s: torch.randn(*s, dtype=torch.bfloat16) * 0.05)(H * Dh, D) * ((H * Dh) ** -0.5)),
        }
    _B_in = _B_setup()

    return {
        "A_x": _A_in["x"],
        "A_k_cache": _A_in["k_cache"],
        "A_v_cache": _A_in["v_cache"],
        "A_wq": _A_in["wq"],
        "A_wo": _A_in["wo"],
        "B_x": _B_in["x"],
        "B_k_cache": _B_in["k_cache"],
        "B_v_cache": _B_in["v_cache"],
        "B_wq": _B_in["wq"],
        "B_wo": _B_in["wo"],
    }

def reference(A_x, A_k_cache, A_v_cache, A_wq, A_wo, B_x, B_k_cache, B_v_cache, B_wq, B_wo):
    def _A_ref(x, k_cache, v_cache, wq, wo):
        B, Sq, D = x.shape
        H, Dh = 32, 128
        q = (lambda x, *d: x.permute(*d))((x @ wq).reshape(B, Sq, H, Dh), 0, 2, 1, 3)
        scores = torch.einsum("bhqd,bhkd->bhqk", q, k_cache) * (Dh ** -0.5)
        p = _softmax(scores, axis=-1)
        o = torch.einsum("bhqk,bhkd->bhqd", p, v_cache)
        return (lambda x, *d: x.permute(*d))(o, 0, 2, 1, 3).reshape(B, Sq, H * Dh) @ wo

    def _B_ref(x, k_cache, v_cache, wq, wo):
        B, Sq, D = x.shape
        H, Dh = 32, 128
        q = (lambda x, *d: x.permute(*d))((x @ wq).reshape(B, Sq, H, Dh), 0, 2, 1, 3)
        scores = torch.einsum("bhqd,bhkd->bhqk", q, k_cache) * (Dh ** -0.5)
        p = _softmax(scores, axis=-1)
        o = torch.einsum("bhqk,bhkd->bhqd", p, v_cache)
        return (lambda x, *d: x.permute(*d))(o, 0, 2, 1, 3).reshape(B, Sq, H * Dh) @ wo

    a = _A_ref(A_x, A_k_cache, A_v_cache, A_wq, A_wo)
    b = _B_ref(B_x, B_k_cache, B_v_cache, B_wq, B_wo)
    return torch.concatenate([a, b], axis=-1)
```

```asm
; @launch grid=(496,1,1) block=(512,1,1) lds=163840
.amdgcn_target "amdgcn-amd-amdhsa--gfx950"
.text
.globl concat_heads__mha_block_cached__mha_block_cached__near_ridge_kernel
.p2align 8
.type concat_heads__mha_block_cached__mha_block_cached__near_ridge_kernel,@function
concat_heads__mha_block_cached__mha_block_cached__near_ridge_kernel:

s_cmp_ge_u32 s2, 496
s_cbranch_scc1 K1_end
s_cmp_ge_u32 s2, 256
s_cbranch_scc0 K1_entry
s_branch G_entry
K1_entry:
s_load_dwordx4 s[40:43], s[0:1], 0
s_load_dwordx4 s[44:47], s[0:1], 16
s_load_dwordx4 s[48:51], s[0:1], 40
s_load_dwordx4 s[52:55], s[0:1], 56
s_load_dwordx2 s[56:57], s[0:1], 96
s_load_dwordx2 s[82:83], s[0:1], 88
s_load_dwordx2 s[88:89], s[0:1], 32
s_load_dwordx2 s[90:91], s[0:1], 72
v_lshrrev_b32 v1, 6, v0
v_and_b32 v0, 63, v0
v_readfirstlane_b32 s63, v1
s_and_b32 s58, s2, 7
s_lshr_b32 s59, s2, 3
s_lshr_b32 s60, s58, 2
s_lshr_b32 s84, s63, 2
s_lshl_b32 s36, s84, 1
s_add_u32 s24, s63, s36
s_and_b32 s24, s24, 3
s_mul_i32 s99, s84, 69632
s_and_b32 s61, s58, 3
s_lshl_b32 s61, s61, 3
s_lshl_b32 s36, s84, 2
s_add_u32 s61, s61, s36
s_and_b32 s85, s59, 3
s_add_u32 s61, s61, s85
s_lshr_b32 s62, s59, 2
v_lshrrev_b32 v2, 4, v0
v_and_b32 v5, 15, v0
v_lshlrev_b32 v6, 4, v5
v_and_b32 v3, 1, v2
v_lshlrev_b32 v3, 15, v3
v_lshrrev_b32 v4, 5, v0
v_lshlrev_b32 v4, 17, v4
v_add3_u32 v14, v3, v4, v6
v_lshrrev_b32 v3, 3, v0
v_mul_u32_u24 v15, 1280, v3
s_and_b32 s36, s63, 1
s_lshl_b32 s36, s36, 2
v_add_u32 v3, s36, v2
v_and_b32 v4, 7, v0
v_xor_b32 v3, v3, v4
v_lshl_add_u32 v15, v3, 4, v15
v_lshrrev_b32 v3, 1, v5
v_xor_b32 v3, v3, v2
v_lshlrev_b32 v3, 4, v3
v_lshl_add_u32 v18, v5, 7, v3
v_xor_b32 v19, 64, v18
v_lshrrev_b32 v7, 2, v0
v_and_b32 v7, 3, v7
v_and_b32 v8, 1, v2
v_lshl_add_u32 v9, v8, 2, v7
v_mul_u32_u24 v16, 1088, v9
v_lshl_add_u32 v16, v8, 3, v16
v_lshrrev_b32 v3, 1, v2
v_lshl_add_u32 v16, v3, 9, v16
v_and_b32 v4, 3, v0
v_lshl_add_u32 v16, v4, 4, v16
s_lshl_b32 s36, s24, 6
s_add_u32 s36, s36, s99
v_add_u32 v16, s36, v16
v_mul_u32_u24 v11, 1056, v9
v_lshl_add_u32 v11, v3, 8, v11
v_lshl_add_u32 v11, v4, 3, v11
v_add_u32 v11, s99, v11
v_lshrrev_b32 v3, 2, v5
v_mul_u32_u24 v10, 1088, v3
v_and_b32 v3, 3, v5
v_lshl_add_u32 v10, v3, 8, v10
v_xor_b32 v3, v3, v2
v_lshl_add_u32 v10, v3, 4, v10
v_add_u32 v10, s99, v10
v_xor_b32 v3, v5, v2
v_lshlrev_b32 v3, 4, v3
v_lshl_add_u32 v12, v2, 8, v3
v_lshl_add_u32 v13, v2, 11, v6
s_mov_b32 s34, 0x3e0293ee
s_mov_b32 s35, s34
s_mov_b32 s3, 0x41000000
s_and_b32 s36, s24, 1
s_lshl_b32 s36, s36, 1
s_lshr_b32 s37, s24, 1
s_lshl_b32 s25, s37, 3
s_add_u32 s25, s25, s36
s_lshl_b32 s25, s25, 13
s_mul_i32 s26, s24, 2176
s_lshl_b32 s37, s37, 3
s_add_u32 s26, s26, s37
s_add_u32 s26, s26, s99
s_mul_i32 s27, s24, 2176
s_add_u32 s27, s27, s99
s_mul_i32 s28, s24, 2112
s_add_u32 s28, s28, s99
s_lshl_b32 s29, s24, 11
s_lshl_b32 s33, s24, 9
s_mul_i32 s30, s63, 10240
s_lshl_b32 s31, s63, 10
s_lshl_b32 s37, s24, 18
s_mul_i32 s84, s62, 184320
s_lshl_b32 s85, s61, 8
s_waitcnt lgkmcnt(0)
s_cmp_eq_u32 s60, 0
s_cselect_b32 s4, s40, s48
s_cselect_b32 s5, s41, s49
s_cselect_b32 s12, s42, s50
s_cselect_b32 s13, s43, s51
s_cselect_b32 s16, s44, s52
s_cselect_b32 s17, s45, s53
s_cselect_b32 s8, s46, s54
s_cselect_b32 s9, s47, s55
s_cselect_b32 s88, s88, s90
s_cselect_b32 s89, s89, s91
s_add_u32 s4, s4, s84
s_addc_u32 s5, s5, 0
s_mov_b32 s6, 184320
s_mov_b32 s7, 0x20000
s_add_u32 s8, s8, s85
s_addc_u32 s9, s9, 0
s_sub_u32 s10, 5242880, s85
s_mov_b32 s11, 0x20000
s_cmp_ge_u32 s63, 2
s_cbranch_scc1 XS_1
s_add_u32 m0, s31, 157696
s_add_u32 s36, s30, 163840
buffer_load_dwordx4 v15, s[4:7], s36 offen  lds
XS_1:
s_add_u32 m0, s31, 52224
s_add_u32 s36, s30, 0
buffer_load_dwordx4 v15, s[4:7], s36 offen  lds
s_add_u32 m0, s31, 60416
s_add_u32 s36, s30, 81920
buffer_load_dwordx4 v15, s[4:7], s36 offen  lds
s_add_u32 m0, s26, 34816
s_add_u32 s36, s25, 0
buffer_load_dwordx4 v14, s[8:11], s36 offen  lds
s_add_u32 m0, s26, 35904
s_add_u32 s36, s25, 8192
buffer_load_dwordx4 v14, s[8:11], s36 offen  lds
s_add_u32 m0, s26, 43520
s_add_u32 s36, s25, 262144
buffer_load_dwordx4 v14, s[8:11], s36 offen  lds
s_add_u32 m0, s26, 44608
s_add_u32 s36, s25, 270336
buffer_load_dwordx4 v14, s[8:11], s36 offen  lds
s_cmp_ge_u32 s63, 2
s_cbranch_scc1 XS_2
s_add_u32 m0, s31, 159744
s_add_u32 s36, s30, 163968
buffer_load_dwordx4 v15, s[4:7], s36 offen  lds
XS_2:
s_add_u32 m0, s31, 121856
s_add_u32 s36, s30, 128
buffer_load_dwordx4 v15, s[4:7], s36 offen  lds
s_add_u32 m0, s31, 130048
s_add_u32 s36, s30, 82048
buffer_load_dwordx4 v15, s[4:7], s36 offen  lds
s_add_u32 m0, s26, 0
s_add_u32 s36, s25, 524288
buffer_load_dwordx4 v14, s[8:11], s36 offen  lds
s_add_u32 m0, s26, 1088
s_add_u32 s36, s25, 532480
buffer_load_dwordx4 v14, s[8:11], s36 offen  lds
s_add_u32 m0, s26, 8704
s_add_u32 s36, s25, 786432
buffer_load_dwordx4 v14, s[8:11], s36 offen  lds
s_add_u32 m0, s26, 9792
s_add_u32 s36, s25, 794624
buffer_load_dwordx4 v14, s[8:11], s36 offen  lds
s_mov_b32 s44, s82
s_mov_b32 s45, s83
s_and_b32 s36, s58, 3
s_lshl_b32 s36, s36, 5
s_add_u32 s36, s36, s59
s_mul_i32 s36, s36, 40960
s_add_u32 s88, s88, s36
s_addc_u32 s89, s89, 0
s_mov_b32 s90, 40960
s_mov_b32 s91, 0x20000
s_lshl_b32 s36, s62, 5
s_add_u32 s36, s36, s61
s_lshl_b32 s36, s36, 17
s_add_u32 s12, s12, s36
s_addc_u32 s13, s13, 0
s_mov_b32 s14, 131072
s_mov_b32 s15, 0x20000
s_add_u32 s16, s16, s36
s_addc_u32 s17, s17, 0
s_mov_b32 s18, 131072
s_mov_b32 s19, 0x20000
s_mul_i32 s36, s60, 9437184
s_mul_i32 s40, s62, 1179648
s_add_u32 s36, s36, s40
s_lshl_b32 s40, s61, 12
s_add_u32 s36, s36, s40
s_add_u32 s20, s56, s36
s_addc_u32 s21, s57, 0
s_sub_u32 s22, 1179648, s40
s_mov_b32 s23, 0x20000
s_cmp_lg_u32 s2, 0
s_cbranch_scc1 PN_3
s_cmp_lg_u32 s63, 0
s_cbranch_scc1 PN_3
s_memrealtime s[46:47]
s_waitcnt lgkmcnt(0)
s_or_b32 s46, s46, 1
s_mov_b64 s[42:43], exec
s_mov_b64 exec, 1
v_mov_b32 v2, s46
v_mov_b32 v3, 0
global_store_dword v3, v2, s[44:45] sc1
s_mov_b64 exec, s[42:43]
PN_3:
v_add_u32 v180, 52224, v18
v_add_u32 v181, 52224, v19
v_add_u32 v182, 121856, v18
v_add_u32 v183, 121856, v19
v_add_u32 v184, 139264, v18
v_add_u32 v185, 139264, v19
v_add_u32 v186, 157696, v18
v_add_u32 v187, 157696, v19
s_waitcnt vmcnt(6)
s_barrier
ds_read_b64_tr_b16 v[164:165], v16 offset:34816
ds_read_b64_tr_b16 v[166:167], v16 offset:35072
ds_read_b64_tr_b16 v[168:169], v16 offset:34824
ds_read_b64_tr_b16 v[170:171], v16 offset:35080
ds_read_b128 v[92:95], v180 offset:0
ds_read_b128 v[96:99], v180 offset:2048
ds_read_b128 v[100:103], v180 offset:4096
ds_read_b128 v[104:107], v180 offset:6144
ds_read_b128 v[108:111], v180 offset:8192
ds_read_b128 v[112:115], v180 offset:10240
ds_read_b128 v[116:119], v180 offset:12288
ds_read_b128 v[120:123], v180 offset:14336
ds_read_b128 v[124:127], v186 offset:0
s_waitcnt lgkmcnt(0)
v_mfma_f32_16x16x32_bf16 v[20:23], v[164:167], v[92:95], 0
s_cmp_ge_u32 s63, 2
s_cbranch_scc1 XS_4
s_add_u32 m0, s31, 155648
s_add_u32 s36, s30, 164096
buffer_load_dwordx4 v15, s[4:7], s36 offen  lds
XS_4:
ds_read_b64_tr_b16 v[172:173], v16 offset:43520
v_mfma_f32_16x16x32_bf16 v[24:27], v[164:167], v[96:99], 0
ds_read_b64_tr_b16 v[174:175], v16 offset:43776
v_mfma_f32_16x16x32_bf16 v[28:31], v[164:167], v[100:103], 0
s_add_u32 m0, s31, 139264
s_add_u32 s36, s30, 256
buffer_load_dwordx4 v15, s[4:7], s36 offen  lds
v_mfma_f32_16x16x32_bf16 v[32:35], v[164:167], v[104:107], 0
ds_read_b64_tr_b16 v[176:177], v16 offset:43528
v_mfma_f32_16x16x32_bf16 v[36:39], v[164:167], v[108:111], 0
ds_read_b64_tr_b16 v[178:179], v16 offset:43784
v_mfma_f32_16x16x32_bf16 v[40:43], v[164:167], v[112:115], 0
s_add_u32 m0, s31, 147456
s_add_u32 s36, s30, 82176
buffer_load_dwordx4 v15, s[4:7], s36 offen  lds
v_mfma_f32_16x16x32_bf16 v[44:47], v[164:167], v[116:119], 0
ds_read_b128 v[128:131], v181 offset:0
v_mfma_f32_16x16x32_bf16 v[48:51], v[164:167], v[120:123], 0
ds_read_b128 v[132:135], v181 offset:2048
v_mfma_f32_16x16x32_bf16 v[52:55], v[164:167], v[124:127], 0
s_add_u32 m0, s26, 17408
s_add_u32 s36, s25, 1048576
buffer_load_dwordx4 v14, s[8:11], s36 offen  lds
v_mfma_f32_16x16x32_bf16 v[56:59], v[168:171], v[92:95], 0
ds_read_b128 v[136:139], v181 offset:4096
ds_read_b128 v[140:143], v181 offset:6144
v_mfma_f32_16x16x32_bf16 v[60:63], v[168:171], v[96:99], 0
s_add_u32 m0, s26, 18496
s_add_u32 s36, s25, 1056768
buffer_load_dwordx4 v14, s[8:11], s36 offen  lds
v_mfma_f32_16x16x32_bf16 v[64:67], v[168:171], v[100:103], 0
ds_read_b128 v[144:147], v181 offset:8192
v_mfma_f32_16x16x32_bf16 v[68:71], v[168:171], v[104:107], 0
ds_read_b128 v[148:151], v181 offset:10240
v_mfma_f32_16x16x32_bf16 v[72:75], v[168:171], v[108:111], 0
s_add_u32 m0, s26, 26112
s_add_u32 s36, s25, 1310720
buffer_load_dwordx4 v14, s[8:11], s36 offen  lds
v_mfma_f32_16x16x32_bf16 v[76:79], v[168:171], v[112:115], 0
ds_read_b128 v[152:155], v181 offset:12288
v_mfma_f32_16x16x32_bf16 v[80:83], v[168:171], v[116:119], 0
ds_read_b128 v[156:159], v181 offset:14336
v_mfma_f32_16x16x32_bf16 v[84:87], v[168:171], v[120:123], 0
s_add_u32 m0, s26, 27200
s_add_u32 s36, s25, 1318912
buffer_load_dwordx4 v14, s[8:11], s36 offen  lds
v_mfma_f32_16x16x32_bf16 v[88:91], v[168:171], v[124:127], 0
ds_read_b128 v[160:163], v187 offset:0
s_waitcnt vmcnt(6) lgkmcnt(0)
s_barrier
v_mfma_f32_16x16x32_bf16 v[20:23], v[172:175], v[128:131], v[20:23]
s_cmp_ge_u32 s63, 2
s_cbranch_scc1 XS_5
s_add_u32 m0, s31, 157696
s_add_u32 s36, s30, 164224
buffer_load_dwordx4 v15, s[4:7], s36 offen  lds
XS_5:
ds_read_b64_tr_b16 v[164:165], v16 offset:0
v_mfma_f32_16x16x32_bf16 v[24:27], v[172:175], v[132:135], v[24:27]
ds_read_b64_tr_b16 v[166:167], v16 offset:256
v_mfma_f32_16x16x32_bf16 v[28:31], v[172:175], v[136:139], v[28:31]
s_add_u32 m0, s31, 52224
s_add_u32 s36, s30, 384
buffer_load_dwordx4 v15, s[4:7], s36 offen  lds
v_mfma_f32_16x16x32_bf16 v[32:35], v[172:175], v[140:143], v[32:35]
ds_read_b64_tr_b16 v[168:169], v16 offset:8
v_mfma_f32_16x16x32_bf16 v[36:39], v[172:175], v[144:147], v[36:39]
ds_read_b64_tr_b16 v[170:171], v16 offset:264
v_mfma_f32_16x16x32_bf16 v[40:43], v[172:175], v[148:151], v[40:43]
s_add_u32 m0, s31, 60416
s_add_u32 s36, s30, 82304
buffer_load_dwordx4 v15, s[4:7], s36 offen  lds
v_mfma_f32_16x16x32_bf16 v[44:47], v[172:175], v[152:155], v[44:47]
ds_read_b128 v[92:95], v182 offset:0
v_mfma_f32_16x16x32_bf16 v[48:51], v[172:175], v[156:159], v[48:51]
ds_read_b128 v[96:99], v182 offset:2048
v_mfma_f32_16x16x32_bf16 v[52:55], v[172:175], v[160:163], v[52:55]
s_add_u32 m0, s26, 34816
s_add_u32 s36, s25, 1572864
buffer_load_dwordx4 v14, s[8:11], s36 offen  lds
v_mfma_f32_16x16x32_bf16 v[56:59], v[176:179], v[128:131], v[56:59]
ds_read_b128 v[100:103], v182 offset:4096
ds_read_b128 v[104:107], v182 offset:6144
v_mfma_f32_16x16x32_bf16 v[60:63], v[176:179], v[132:135], v[60:63]
s_add_u32 m0, s26, 35904
s_add_u32 s36, s25, 1581056
buffer_load_dwordx4 v14, s[8:11], s36 offen  lds
v_mfma_f32_16x16x32_bf16 v[64:67], v[176:179], v[136:139], v[64:67]
ds_read_b128 v[108:111], v182 offset:8192
v_mfma_f32_16x16x32_bf16 v[68:71], v[176:179], v[140:143], v[68:71]
ds_read_b128 v[112:115], v182 offset:10240
v_mfma_f32_16x16x32_bf16 v[72:75], v[176:179], v[144:147], v[72:75]
s_add_u32 m0, s26, 43520
s_add_u32 s36, s25, 1835008
buffer_load_dwordx4 v14, s[8:11], s36 offen  lds
v_mfma_f32_16x16x32_bf16 v[76:79], v[176:179], v[148:151], v[76:79]
ds_read_b128 v[116:119], v182 offset:12288
v_mfma_f32_16x16x32_bf16 v[80:83], v[176:179], v[152:155], v[80:83]
ds_read_b128 v[120:123], v182 offset:14336
v_mfma_f32_16x16x32_bf16 v[84:87], v[176:179], v[156:159], v[84:87]
s_add_u32 m0, s26, 44608
s_add_u32 s36, s25, 1843200
buffer_load_dwordx4 v14, s[8:11], s36 offen  lds
v_mfma_f32_16x16x32_bf16 v[88:91], v[176:179], v[160:163], v[88:91]
ds_read_b128 v[124:127], v186 offset:2048
s_waitcnt lgkmcnt(0)
v_mfma_f32_16x16x32_bf16 v[20:23], v[164:167], v[92:95], v[20:23]
ds_read_b64_tr_b16 v[172:173], v16 offset:8704
v_mfma_f32_16x16x32_bf16 v[24:27], v[164:167], v[96:99], v[24:27]
ds_read_b64_tr_b16 v[174:175], v16 offset:8960
v_mfma_f32_16x16x32_bf16 v[28:31], v[164:167], v[100:103], v[28:31]
ds_read_b64_tr_b16 v[176:177], v16 offset:8712
v_mfma_f32_16x16x32_bf16 v[32:35], v[164:167], v[104:107], v[32:35]
v_mfma_f32_16x16x32_bf16 v[36:39], v[164:167], v[108:111], v[36:39]
ds_read_b64_tr_b16 v[178:179], v16 offset:8968
v_mfma_f32_16x16x32_bf16 v[40:43], v[164:167], v[112:115], v[40:43]
ds_read_b128 v[128:131], v183 offset:0
v_mfma_f32_16x16x32_bf16 v[44:47], v[164:167], v[116:119], v[44:47]
ds_read_b128 v[132:135], v183 offset:2048
v_mfma_f32_16x16x32_bf16 v[48:51], v[164:167], v[120:123], v[48:51]
v_mfma_f32_16x16x32_bf16 v[52:55], v[164:167], v[124:127], v[52:55]
ds_read_b128 v[136:139], v183 offset:4096
v_mfma_f32_16x16x32_bf16 v[56:59], v[168:171], v[92:95], v[56:59]
ds_read_b128 v[140:143], v183 offset:6144
v_mfma_f32_16x16x32_bf16 v[60:63], v[168:171], v[96:99], v[60:63]
v_mfma_f32_16x16x32_bf16 v[64:67], v[168:171], v[100:103], v[64:67]
ds_read_b128 v[144:147], v183 offset:8192
v_mfma_f32_16x16x32_bf16 v[68:71], v[168:171], v[104:107], v[68:71]
ds_read_b128 v[148:151], v183 offset:10240
v_mfma_f32_16x16x32_bf16 v[72:75], v[168:171], v[108:111], v[72:75]
ds_read_b128 v[152:155], v183 offset:12288
v_mfma_f32_16x16x32_bf16 v[76:79], v[168:171], v[112:115], v[76:79]
v_mfma_f32_16x16x32_bf16 v[80:83], v[168:171], v[116:119], v[80:83]
ds_read_b128 v[156:159], v183 offset:14336
v_mfma_f32_16x16x32_bf16 v[84:87], v[168:171], v[120:123], v[84:87]
ds_read_b128 v[160:163], v187 offset:2048
v_mfma_f32_16x16x32_bf16 v[88:91], v[168:171], v[124:127], v[88:91]
s_waitcnt vmcnt(6) lgkmcnt(0)
s_barrier
v_mfma_f32_16x16x32_bf16 v[20:23], v[172:175], v[128:131], v[20:23]
s_cmp_ge_u32 s63, 2
s_cbranch_scc1 XS_6
s_add_u32 m0, s31, 159744
s_add_u32 s36, s30, 164352
buffer_load_dwordx4 v15, s[4:7], s36 offen  lds
XS_6:
ds_read_b64_tr_b16 v[164:165], v16 offset:17408
v_mfma_f32_16x16x32_bf16 v[24:27], v[172:175], v[132:135], v[24:27]
ds_read_b64_tr_b16 v[166:167], v16 offset:17664
v_mfma_f32_16x16x32_bf16 v[28:31], v[172:175], v[136:139], v[28:31]
s_add_u32 m0, s31, 121856
s_add_u32 s36, s30, 512
buffer_load_dwordx4 v15, s[4:7], s36 offen  lds
v_mfma_f32_16x16x32_bf16 v[32:35], v[172:175], v[140:143], v[32:35]
ds_read_b64_tr_b16 v[168:169], v16 offset:17416
v_mfma_f32_16x16x32_bf16 v[36:39], v[172:175], v[144:147], v[36:39]
ds_read_b64_tr_b16 v[170:171], v16 offset:17672
v_mfma_f32_16x16x32_bf16 v[40:43], v[172:175], v[148:151], v[40:43]
s_add_u32 m0, s31, 130048
s_add_u32 s36, s30, 82432
buffer_load_dwordx4 v15, s[4:7], s36 offen  lds
v_mfma_f32_16x16x32_bf16 v[44:47], v[172:175], v[152:155], v[44:47]
ds_read_b128 v[92:95], v184 offset:0
v_mfma_f32_16x16x32_bf16 v[48:51], v[172:175], v[156:159], v[48:51]
ds_read_b128 v[96:99], v184 offset:2048
v_mfma_f32_16x16x32_bf16 v[52:55], v[172:175], v[160:163], v[52:55]
s_add_u32 m0, s26, 0
s_add_u32 s36, s25, 2097152
buffer_load_dwordx4 v14, s[8:11], s36 offen  lds
v_mfma_f32_16x16x32_bf16 v[56:59], v[176:179], v[128:131], v[56:59]
ds_read_b128 v[100:103], v184 offset:4096
ds_read_b128 v[104:107], v184 offset:6144
v_mfma_f32_16x16x32_bf16 v[60:63], v[176:179], v[132:135], v[60:63]
s_add_u32 m0, s26, 1088
s_add_u32 s36, s25, 2105344
buffer_load_dwordx4 v14, s[8:11], s36 offen  lds
v_mfma_f32_16x16x32_bf16 v[64:67], v[176:179], v[136:139], v[64:67]
ds_read_b128 v[108:111], v184 offset:8192
v_mfma_f32_16x16x32_bf16 v[68:71], v[176:179], v[140:143], v[68:71]
ds_read_b128 v[112:115], v184 offset:10240
v_mfma_f32_16x16x32_bf16 v[72:75], v[176:179], v[144:147], v[72:75]
s_add_u32 m0, s26, 8704
s_add_u32 s36, s25, 2359296
buffer_load_dwordx4 v14, s[8:11], s36 offen  lds
v_mfma_f32_16x16x32_bf16 v[76:79], v[176:179], v[148:151], v[76:79]
ds_read_b128 v[116:119], v184 offset:12288
v_mfma_f32_16x16x32_bf16 v[80:83], v[176:179], v[152:155], v[80:83]
ds_read_b128 v[120:123], v184 offset:14336
v_mfma_f32_16x16x32_bf16 v[84:87], v[176:179], v[156:159], v[84:87]
s_add_u32 m0, s26, 9792
s_add_u32 s36, s25, 2367488
buffer_load_dwordx4 v14, s[8:11], s36 offen  lds
v_mfma_f32_16x16x32_bf16 v[88:91], v[176:179], v[160:163], v[88:91]
ds_read_b128 v[124:127], v184 offset:16384
s_waitcnt lgkmcnt(0)
v_mfma_f32_16x16x32_bf16 v[20:23], v[164:167], v[92:95], v[20:23]
ds_read_b64_tr_b16 v[172:173], v16 offset:26112
v_mfma_f32_16x16x32_bf16 v[24:27], v[164:167], v[96:99], v[24:27]
ds_read_b64_tr_b16 v[174:175], v16 offset:26368
v_mfma_f32_16x16x32_bf16 v[28:31], v[164:167], v[100:103], v[28:31]
ds_read_b64_tr_b16 v[176:177], v16 offset:26120
v_mfma_f32_16x16x32_bf16 v[32:35], v[164:167], v[104:107], v[32:35]
v_mfma_f32_16x16x32_bf16 v[36:39], v[164:167], v[108:111], v[36:39]
ds_read_b64_tr_b16 v[178:179], v16 offset:26376
v_mfma_f32_16x16x32_bf16 v[40:43], v[164:167], v[112:115], v[40:43]
ds_read_b128 v[128:131], v185 offset:0
v_mfma_f32_16x16x32_bf16 v[44:47], v[164:167], v[116:119], v[44:47]
ds_read_b128 v[132:135], v185 offset:2048
v_mfma_f32_16x16x32_bf16 v[48:51], v[164:167], v[120:123], v[48:51]
v_mfma_f32_16x16x32_bf16 v[52:55], v[164:167], v[124:127], v[52:55]
ds_read_b128 v[136:139], v185 offset:4096
v_mfma_f32_16x16x32_bf16 v[56:59], v[168:171], v[92:95], v[56:59]
ds_read_b128 v[140:143], v185 offset:6144
v_mfma_f32_16x16x32_bf16 v[60:63], v[168:171], v[96:99], v[60:63]
v_mfma_f32_16x16x32_bf16 v[64:67], v[168:171], v[100:103], v[64:67]
ds_read_b128 v[144:147], v185 offset:8192
v_mfma_f32_16x16x32_bf16 v[68:71], v[168:171], v[104:107], v[68:71]
ds_read_b128 v[148:151], v185 offset:10240
v_mfma_f32_16x16x32_bf16 v[72:75], v[168:171], v[108:111], v[72:75]
ds_read_b128 v[152:155], v185 offset:12288
v_mfma_f32_16x16x32_bf16 v[76:79], v[168:171], v[112:115], v[76:79]
v_mfma_f32_16x16x32_bf16 v[80:83], v[168:171], v[116:119], v[80:83]
ds_read_b128 v[156:159], v185 offset:14336
v_mfma_f32_16x16x32_bf16 v[84:87], v[168:171], v[120:123], v[84:87]
ds_read_b128 v[160:163], v185 offset:16384
v_mfma_f32_16x16x32_bf16 v[88:91], v[168:171], v[124:127], v[88:91]
s_waitcnt vmcnt(6) lgkmcnt(0)
s_barrier
v_mfma_f32_16x16x32_bf16 v[20:23], v[172:175], v[128:131], v[20:23]
s_cmp_ge_u32 s63, 2
s_cbranch_scc1 XS_7
s_add_u32 m0, s31, 155648
s_add_u32 s36, s30, 164480
buffer_load_dwordx4 v15, s[4:7], s36 offen  lds
XS_7:
ds_read_b64_tr_b16 v[164:165], v16 offset:34816
v_mfma_f32_16x16x32_bf16 v[24:27], v[172:175], v[132:135], v[24:27]
ds_read_b64_tr_b16 v[166:167], v16 offset:35072
v_mfma_f32_16x16x32_bf16 v[28:31], v[172:175], v[136:139], v[28:31]
s_add_u32 m0, s31, 139264
s_add_u32 s36, s30, 640
buffer_load_dwordx4 v15, s[4:7], s36 offen  lds
v_mfma_f32_16x16x32_bf16 v[32:35], v[172:175], v[140:143], v[32:35]
ds_read_b64_tr_b16 v[168:169], v16 offset:34824
v_mfma_f32_16x16x32_bf16 v[36:39], v[172:175], v[144:147], v[36:39]
ds_read_b64_tr_b16 v[170:171], v16 offset:35080
v_mfma_f32_16x16x32_bf16 v[40:43], v[172:175], v[148:151], v[40:43]
s_add_u32 m0, s31, 147456
s_add_u32 s36, s30, 82560
buffer_load_dwordx4 v15, s[4:7], s36 offen  lds
v_mfma_f32_16x16x32_bf16 v[44:47], v[172:175], v[152:155], v[44:47]
ds_read_b128 v[92:95], v180 offset:0
v_mfma_f32_16x16x32_bf16 v[48:51], v[172:175], v[156:159], v[48:51]
ds_read_b128 v[96:99], v180 offset:2048
v_mfma_f32_16x16x32_bf16 v[52:55], v[172:175], v[160:163], v[52:55]
s_add_u32 m0, s26, 17408
s_add_u32 s36, s25, 2621440
buffer_load_dwordx4 v14, s[8:11], s36 offen  lds
v_mfma_f32_16x16x32_bf16 v[56:59], v[176:179], v[128:131], v[56:59]
ds_read_b128 v[100:103], v180 offset:4096
ds_read_b128 v[104:107], v180 offset:6144
v_mfma_f32_16x16x32_bf16 v[60:63], v[176:179], v[132:135], v[60:63]
s_add_u32 m0, s26, 18496
s_add_u32 s36, s25, 2629632
buffer_load_dwordx4 v14, s[8:11], s36 offen  lds
v_mfma_f32_16x16x32_bf16 v[64:67], v[176:179], v[136:139], v[64:67]
ds_read_b128 v[108:111], v180 offset:8192
v_mfma_f32_16x16x32_bf16 v[68:71], v[176:179], v[140:143], v[68:71]
ds_read_b128 v[112:115], v180 offset:10240
v_mfma_f32_16x16x32_bf16 v[72:75], v[176:179], v[144:147], v[72:75]
s_add_u32 m0, s26, 26112
s_add_u32 s36, s25, 2883584
buffer_load_dwordx4 v14, s[8:11], s36 offen  lds
v_mfma_f32_16x16x32_bf16 v[76:79], v[176:179], v[148:151], v[76:79]
ds_read_b128 v[116:119], v180 offset:12288
v_mfma_f32_16x16x32_bf16 v[80:83], v[176:179], v[152:155], v[80:83]
ds_read_b128 v[120:123], v180 offset:14336
v_mfma_f32_16x16x32_bf16 v[84:87], v[176:179], v[156:159], v[84:87]
s_add_u32 m0, s26, 27200
s_add_u32 s36, s25, 2891776
buffer_load_dwordx4 v14, s[8:11], s36 offen  lds
v_mfma_f32_16x16x32_bf16 v[88:91], v[176:179], v[160:163], v[88:91]
ds_read_b128 v[124:127], v186 offset:0
s_waitcnt lgkmcnt(0)
v_mfma_f32_16x16x32_bf16 v[20:23], v[164:167], v[92:95], v[20:23]
ds_read_b64_tr_b16 v[172:173], v16 offset:43520
v_mfma_f32_16x16x32_bf16 v[24:27], v[164:167], v[96:99], v[24:27]
ds_read_b64_tr_b16 v[174:175], v16 offset:43776
v_mfma_f32_16x16x32_bf16 v[28:31], v[164:167], v[100:103], v[28:31]
ds_read_b64_tr_b16 v[176:177], v16 offset:43528
v_mfma_f32_16x16x32_bf16 v[32:35], v[164:167], v[104:107], v[32:35]
v_mfma_f32_16x16x32_bf16 v[36:39], v[164:167], v[108:111], v[36:39]
ds_read_b64_tr_b16 v[178:179], v16 offset:43784
v_mfma_f32_16x16x32_bf16 v[40:43], v[164:167], v[112:115], v[40:43]
ds_read_b128 v[128:131], v181 offset:0
v_mfma_f32_16x16x32_bf16 v[44:47], v[164:167], v[116:119], v[44:47]
ds_read_b128 v[132:135], v181 offset:2048
v_mfma_f32_16x16x32_bf16 v[48:51], v[164:167], v[120:123], v[48:51]
v_mfma_f32_16x16x32_bf16 v[52:55], v[164:167], v[124:127], v[52:55]
ds_read_b128 v[136:139], v181 offset:4096
v_mfma_f32_16x16x32_bf16 v[56:59], v[168:171], v[92:95], v[56:59]
ds_read_b128 v[140:143], v181 offset:6144
v_mfma_f32_16x16x32_bf16 v[60:63], v[168:171], v[96:99], v[60:63]
v_mfma_f32_16x16x32_bf16 v[64:67], v[168:171], v[100:103], v[64:67]
ds_read_b128 v[144:147], v181 offset:8192
v_mfma_f32_16x16x32_bf16 v[68:71], v[168:171], v[104:107], v[68:71]
ds_read_b128 v[148:151], v181 offset:10240
v_mfma_f32_16x16x32_bf16 v[72:75], v[168:171], v[108:111], v[72:75]
ds_read_b128 v[152:155], v181 offset:12288
v_mfma_f32_16x16x32_bf16 v[76:79], v[168:171], v[112:115], v[76:79]
v_mfma_f32_16x16x32_bf16 v[80:83], v[168:171], v[116:119], v[80:83]
ds_read_b128 v[156:159], v181 offset:14336
v_mfma_f32_16x16x32_bf16 v[84:87], v[168:171], v[120:123], v[84:87]
ds_read_b128 v[160:163], v187 offset:0
v_mfma_f32_16x16x32_bf16 v[88:91], v[168:171], v[124:127], v[88:91]
s_waitcnt vmcnt(6) lgkmcnt(0)
s_barrier
v_mfma_f32_16x16x32_bf16 v[20:23], v[172:175], v[128:131], v[20:23]
s_cmp_ge_u32 s63, 2
s_cbranch_scc1 XS_8
s_add_u32 m0, s31, 157696
s_add_u32 s36, s30, 164608
buffer_load_dwordx4 v15, s[4:7], s36 offen  lds
XS_8:
ds_read_b64_tr_b16 v[164:165], v16 offset:0
v_mfma_f32_16x16x32_bf16 v[24:27], v[172:175], v[132:135], v[24:27]
ds_read_b64_tr_b16 v[166:167], v16 offset:256
v_mfma_f32_16x16x32_bf16 v[28:31], v[172:175], v[136:139], v[28:31]
s_add_u32 m0, s31, 52224
s_add_u32 s36, s30, 768
buffer_load_dwordx4 v15, s[4:7], s36 offen  lds
v_mfma_f32_16x16x32_bf16 v[32:35], v[172:175], v[140:143], v[32:35]
ds_read_b64_tr_b16 v[168:169], v16 offset:8
v_mfma_f32_16x16x32_bf16 v[36:39], v[172:175], v[144:147], v[36:39]
ds_read_b64_tr_b16 v[170:171], v16 offset:264
v_mfma_f32_16x16x32_bf16 v[40:43], v[172:175], v[148:151], v[40:43]
s_add_u32 m0, s31, 60416
s_add_u32 s36, s30, 82688
buffer_load_dwordx4 v15, s[4:7], s36 offen  lds
v_mfma_f32_16x16x32_bf16 v[44:47], v[172:175], v[152:155], v[44:47]
ds_read_b128 v[92:95], v182 offset:0
v_mfma_f32_16x16x32_bf16 v[48:51], v[172:175], v[156:159], v[48:51]
ds_read_b128 v[96:99], v182 offset:2048
v_mfma_f32_16x16x32_bf16 v[52:55], v[172:175], v[160:163], v[52:55]
s_add_u32 m0, s26, 34816
s_add_u32 s36, s25, 3145728
buffer_load_dwordx4 v14, s[8:11], s36 offen  lds
v_mfma_f32_16x16x32_bf16 v[56:59], v[176:179], v[128:131], v[56:59]
ds_read_b128 v[100:103], v182 offset:4096
ds_read_b128 v[104:107], v182 offset:6144
v_mfma_f32_16x16x32_bf16 v[60:63], v[176:179], v[132:135], v[60:63]
s_add_u32 m0, s26, 35904
s_add_u32 s36, s25, 3153920
buffer_load_dwordx4 v14, s[8:11], s36 offen  lds
v_mfma_f32_16x16x32_bf16 v[64:67], v[176:179], v[136:139], v[64:67]
ds_read_b128 v[108:111], v182 offset:8192
v_mfma_f32_16x16x32_bf16 v[68:71], v[176:179], v[140:143], v[68:71]
ds_read_b128 v[112:115], v182 offset:10240
v_mfma_f32_16x16x32_bf16 v[72:75], v[176:179], v[144:147], v[72:75]
s_add_u32 m0, s26, 43520
s_add_u32 s36, s25, 3407872
buffer_load_dwordx4 v14, s[8:11], s36 offen  lds
v_mfma_f32_16x16x32_bf16 v[76:79], v[176:179], v[148:151], v[76:79]
ds_read_b128 v[116:119], v182 offset:12288
v_mfma_f32_16x16x32_bf16 v[80:83], v[176:179], v[152:155], v[80:83]
ds_read_b128 v[120:123], v182 offset:14336
v_mfma_f32_16x16x32_bf16 v[84:87], v[176:179], v[156:159], v[84:87]
s_add_u32 m0, s26, 44608
s_add_u32 s36, s25, 3416064
buffer_load_dwordx4 v14, s[8:11], s36 offen  lds
v_mfma_f32_16x16x32_bf16 v[88:91], v[176:179], v[160:163], v[88:91]
ds_read_b128 v[124:127], v186 offset:2048
s_waitcnt lgkmcnt(0)
v_mfma_f32_16x16x32_bf16 v[20:23], v[164:167], v[92:95], v[20:23]
ds_read_b64_tr_b16 v[172:173], v16 offset:8704
v_mfma_f32_16x16x32_bf16 v[24:27], v[164:167], v[96:99], v[24:27]
ds_read_b64_tr_b16 v[174:175], v16 offset:8960
v_mfma_f32_16x16x32_bf16 v[28:31], v[164:167], v[100:103], v[28:31]
ds_read_b64_tr_b16 v[176:177], v16 offset:8712
v_mfma_f32_16x16x32_bf16 v[32:35], v[164:167], v[104:107], v[32:35]
v_mfma_f32_16x16x32_bf16 v[36:39], v[164:167], v[108:111], v[36:39]
ds_read_b64_tr_b16 v[178:179], v16 offset:8968
v_mfma_f32_16x16x32_bf16 v[40:43], v[164:167], v[112:115], v[40:43]
ds_read_b128 v[128:131], v183 offset:0
v_mfma_f32_16x16x32_bf16 v[44:47], v[164:167], v[116:119], v[44:47]
ds_read_b128 v[132:135], v183 offset:2048
v_mfma_f32_16x16x32_bf16 v[48:51], v[164:167], v[120:123], v[48:51]
v_mfma_f32_16x16x32_bf16 v[52:55], v[164:167], v[124:127], v[52:55]
ds_read_b128 v[136:139], v183 offset:4096
v_mfma_f32_16x16x32_bf16 v[56:59], v[168:171], v[92:95], v[56:59]
ds_read_b128 v[140:143], v183 offset:6144
v_mfma_f32_16x16x32_bf16 v[60:63], v[168:171], v[96:99], v[60:63]
v_mfma_f32_16x16x32_bf16 v[64:67], v[168:171], v[100:103], v[64:67]
ds_read_b128 v[144:147], v183 offset:8192
v_mfma_f32_16x16x32_bf16 v[68:71], v[168:171], v[104:107], v[68:71]
ds_read_b128 v[148:151], v183 offset:10240
v_mfma_f32_16x16x32_bf16 v[72:75], v[168:171], v[108:111], v[72:75]
ds_read_b128 v[152:155], v183 offset:12288
v_mfma_f32_16x16x32_bf16 v[76:79], v[168:171], v[112:115], v[76:79]
v_mfma_f32_16x16x32_bf16 v[80:83], v[168:171], v[116:119], v[80:83]
ds_read_b128 v[156:159], v183 offset:14336
v_mfma_f32_16x16x32_bf16 v[84:87], v[168:171], v[120:123], v[84:87]
ds_read_b128 v[160:163], v187 offset:2048
v_mfma_f32_16x16x32_bf16 v[88:91], v[168:171], v[124:127], v[88:91]
s_waitcnt vmcnt(6) lgkmcnt(0)
s_barrier
v_mfma_f32_16x16x32_bf16 v[20:23], v[172:175], v[128:131], v[20:23]
s_cmp_ge_u32 s63, 2
s_cbranch_scc1 XS_9
s_add_u32 m0, s31, 159744
s_add_u32 s36, s30, 164736
buffer_load_dwordx4 v15, s[4:7], s36 offen  lds
XS_9:
ds_read_b64_tr_b16 v[164:165], v16 offset:17408
v_mfma_f32_16x16x32_bf16 v[24:27], v[172:175], v[132:135], v[24:27]
ds_read_b64_tr_b16 v[166:167], v16 offset:17664
v_mfma_f32_16x16x32_bf16 v[28:31], v[172:175], v[136:139], v[28:31]
s_add_u32 m0, s31, 121856
s_add_u32 s36, s30, 896
buffer_load_dwordx4 v15, s[4:7], s36 offen  lds
v_mfma_f32_16x16x32_bf16 v[32:35], v[172:175], v[140:143], v[32:35]
ds_read_b64_tr_b16 v[168:169], v16 offset:17416
v_mfma_f32_16x16x32_bf16 v[36:39], v[172:175], v[144:147], v[36:39]
ds_read_b64_tr_b16 v[170:171], v16 offset:17672
v_mfma_f32_16x16x32_bf16 v[40:43], v[172:175], v[148:151], v[40:43]
s_add_u32 m0, s31, 130048
s_add_u32 s36, s30, 82816
buffer_load_dwordx4 v15, s[4:7], s36 offen  lds
v_mfma_f32_16x16x32_bf16 v[44:47], v[172:175], v[152:155], v[44:47]
ds_read_b128 v[92:95], v184 offset:0
v_mfma_f32_16x16x32_bf16 v[48:51], v[172:175], v[156:159], v[48:51]
ds_read_b128 v[96:99], v184 offset:2048
v_mfma_f32_16x16x32_bf16 v[52:55], v[172:175], v[160:163], v[52:55]
s_add_u32 m0, s26, 0
s_add_u32 s36, s25, 3670016
buffer_load_dwordx4 v14, s[8:11], s36 offen  lds
v_mfma_f32_16x16x32_bf16 v[56:59], v[176:179], v[128:131], v[56:59]
ds_read_b128 v[100:103], v184 offset:4096
ds_read_b128 v[104:107], v184 offset:6144
v_mfma_f32_16x16x32_bf16 v[60:63], v[176:179], v[132:135], v[60:63]
s_add_u32 m0, s26, 1088
s_add_u32 s36, s25, 3678208
buffer_load_dwordx4 v14, s[8:11], s36 offen  lds
v_mfma_f32_16x16x32_bf16 v[64:67], v[176:179], v[136:139], v[64:67]
ds_read_b128 v[108:111], v184 offset:8192
v_mfma_f32_16x16x32_bf16 v[68:71], v[176:179], v[140:143], v[68:71]
ds_read_b128 v[112:115], v184 offset:10240
v_mfma_f32_16x16x32_bf16 v[72:75], v[176:179], v[144:147], v[72:75]
s_add_u32 m0, s26, 8704
s_add_u32 s36, s25, 3932160
buffer_load_dwordx4 v14, s[8:11], s36 offen  lds
v_mfma_f32_16x16x32_bf16 v[76:79], v[176:179], v[148:151], v[76:79]
ds_read_b128 v[116:119], v184 offset:12288
v_mfma_f32_16x16x32_bf16 v[80:83], v[176:179], v[152:155], v[80:83]
ds_read_b128 v[120:123], v184 offset:14336
v_mfma_f32_16x16x32_bf16 v[84:87], v[176:179], v[156:159], v[84:87]
s_add_u32 m0, s26, 9792
s_add_u32 s36, s25, 3940352
buffer_load_dwordx4 v14, s[8:11], s36 offen  lds
v_mfma_f32_16x16x32_bf16 v[88:91], v[176:179], v[160:163], v[88:91]
ds_read_b128 v[124:127], v184 offset:16384
s_waitcnt lgkmcnt(0)
v_mfma_f32_16x16x32_bf16 v[20:23], v[164:167], v[92:95], v[20:23]
ds_read_b64_tr_b16 v[172:173], v16 offset:26112
v_mfma_f32_16x16x32_bf16 v[24:27], v[164:167], v[96:99], v[24:27]
ds_read_b64_tr_b16 v[174:175], v16 offset:26368
v_mfma_f32_16x16x32_bf16 v[28:31], v[164:167], v[100:103], v[28:31]
ds_read_b64_tr_b16 v[176:177], v16 offset:26120
v_mfma_f32_16x16x32_bf16 v[32:35], v[164:167], v[104:107], v[32:35]
v_mfma_f32_16x16x32_bf16 v[36:39], v[164:167], v[108:111], v[36:39]
ds_read_b64_tr_b16 v[178:179], v16 offset:26376
v_mfma_f32_16x16x32_bf16 v[40:43], v[164:167], v[112:115], v[40:43]
ds_read_b128 v[128:131], v185 offset:0
v_mfma_f32_16x16x32_bf16 v[44:47], v[164:167], v[116:119], v[44:47]
ds_read_b128 v[132:135], v185 offset:2048
v_mfma_f32_16x16x32_bf16 v[48:51], v[164:167], v[120:123], v[48:51]
v_mfma_f32_16x16x32_bf16 v[52:55], v[164:167], v[124:127], v[52:55]
ds_read_b128 v[136:139], v185 offset:4096
v_mfma_f32_16x16x32_bf16 v[56:59], v[168:171], v[92:95], v[56:59]
ds_read_b128 v[140:143], v185 offset:6144
v_mfma_f32_16x16x32_bf16 v[60:63], v[168:171], v[96:99], v[60:63]
v_mfma_f32_16x16x32_bf16 v[64:67], v[168:171], v[100:103], v[64:67]
ds_read_b128 v[144:147], v185 offset:8192
v_mfma_f32_16x16x32_bf16 v[68:71], v[168:171], v[104:107], v[68:71]
ds_read_b128 v[148:151], v185 offset:10240
v_mfma_f32_16x16x32_bf16 v[72:75], v[168:171], v[108:111], v[72:75]
ds_read_b128 v[152:155], v185 offset:12288
v_mfma_f32_16x16x32_bf16 v[76:79], v[168:171], v[112:115], v[76:79]
v_mfma_f32_16x16x32_bf16 v[80:83], v[168:171], v[116:119], v[80:83]
ds_read_b128 v[156:159], v185 offset:14336
v_mfma_f32_16x16x32_bf16 v[84:87], v[168:171], v[120:123], v[84:87]
ds_read_b128 v[160:163], v185 offset:16384
v_mfma_f32_16x16x32_bf16 v[88:91], v[168:171], v[124:127], v[88:91]
s_waitcnt vmcnt(6) lgkmcnt(0)
s_barrier
v_mfma_f32_16x16x32_bf16 v[20:23], v[172:175], v[128:131], v[20:23]
s_cmp_ge_u32 s63, 2
s_cbranch_scc1 XS_10
s_add_u32 m0, s31, 155648
s_add_u32 s36, s30, 164864
buffer_load_dwordx4 v15, s[4:7], s36 offen  lds
XS_10:
ds_read_b64_tr_b16 v[164:165], v16 offset:34816
v_mfma_f32_16x16x32_bf16 v[24:27], v[172:175], v[132:135], v[24:27]
ds_read_b64_tr_b16 v[166:167], v16 offset:35072
v_mfma_f32_16x16x32_bf16 v[28:31], v[172:175], v[136:139], v[28:31]
s_add_u32 m0, s31, 139264
s_add_u32 s36, s30, 1024
buffer_load_dwordx4 v15, s[4:7], s36 offen  lds
v_mfma_f32_16x16x32_bf16 v[32:35], v[172:175], v[140:143], v[32:35]
ds_read_b64_tr_b16 v[168:169], v16 offset:34824
v_mfma_f32_16x16x32_bf16 v[36:39], v[172:175], v[144:147], v[36:39]
ds_read_b64_tr_b16 v[170:171], v16 offset:35080
v_mfma_f32_16x16x32_bf16 v[40:43], v[172:175], v[148:151], v[40:43]
s_add_u32 m0, s31, 147456
s_add_u32 s36, s30, 82944
buffer_load_dwordx4 v15, s[4:7], s36 offen  lds
v_mfma_f32_16x16x32_bf16 v[44:47], v[172:175], v[152:155], v[44:47]
ds_read_b128 v[92:95], v180 offset:0
v_mfma_f32_16x16x32_bf16 v[48:51], v[172:175], v[156:159], v[48:51]
ds_read_b128 v[96:99], v180 offset:2048
v_mfma_f32_16x16x32_bf16 v[52:55], v[172:175], v[160:163], v[52:55]
s_add_u32 m0, s26, 17408
s_add_u32 s36, s25, 4194304
buffer_load_dwordx4 v14, s[8:11], s36 offen  lds
v_mfma_f32_16x16x32_bf16 v[56:59], v[176:179], v[128:131], v[56:59]
ds_read_b128 v[100:103], v180 offset:4096
ds_read_b128 v[104:107], v180 offset:6144
v_mfma_f32_16x16x32_bf16 v[60:63], v[176:179], v[132:135], v[60:63]
s_add_u32 m0, s26, 18496
s_add_u32 s36, s25, 4202496
buffer_load_dwordx4 v14, s[8:11], s36 offen  lds
v_mfma_f32_16x16x32_bf16 v[64:67], v[176:179], v[136:139], v[64:67]
ds_read_b128 v[108:111], v180 offset:8192
v_mfma_f32_16x16x32_bf16 v[68:71], v[176:179], v[140:143], v[68:71]
ds_read_b128 v[112:115], v180 offset:10240
v_mfma_f32_16x16x32_bf16 v[72:75], v[176:179], v[144:147], v[72:75]
s_add_u32 m0, s26, 26112
s_add_u32 s36, s25, 4456448
buffer_load_dwordx4 v14, s[8:11], s36 offen  lds
v_mfma_f32_16x16x32_bf16 v[76:79], v[176:179], v[148:151], v[76:79]
ds_read_b128 v[116:119], v180 offset:12288
v_mfma_f32_16x16x32_bf16 v[80:83], v[176:179], v[152:155], v[80:83]
ds_read_b128 v[120:123], v180 offset:14336
v_mfma_f32_16x16x32_bf16 v[84:87], v[176:179], v[156:159], v[84:87]
s_add_u32 m0, s26, 27200
s_add_u32 s36, s25, 4464640
buffer_load_dwordx4 v14, s[8:11], s36 offen  lds
v_mfma_f32_16x16x32_bf16 v[88:91], v[176:179], v[160:163], v[88:91]
ds_read_b128 v[124:127], v186 offset:0
s_waitcnt lgkmcnt(0)
v_mfma_f32_16x16x32_bf16 v[20:23], v[164:167], v[92:95], v[20:23]
ds_read_b64_tr_b16 v[172:173], v16 offset:43520
v_mfma_f32_16x16x32_bf16 v[24:27], v[164:167], v[96:99], v[24:27]
ds_read_b64_tr_b16 v[174:175], v16 offset:43776
v_mfma_f32_16x16x32_bf16 v[28:31], v[164:167], v[100:103], v[28:31]
ds_read_b64_tr_b16 v[176:177], v16 offset:43528
v_mfma_f32_16x16x32_bf16 v[32:35], v[164:167], v[104:107], v[32:35]
v_mfma_f32_16x16x32_bf16 v[36:39], v[164:167], v[108:111], v[36:39]
ds_read_b64_tr_b16 v[178:179], v16 offset:43784
v_mfma_f32_16x16x32_bf16 v[40:43], v[164:167], v[112:115], v[40:43]
ds_read_b128 v[128:131], v181 offset:0
v_mfma_f32_16x16x32_bf16 v[44:47], v[164:167], v[116:119], v[44:47]
ds_read_b128 v[132:135], v181 offset:2048
v_mfma_f32_16x16x32_bf16 v[48:51], v[164:167], v[120:123], v[48:51]
v_mfma_f32_16x16x32_bf16 v[52:55], v[164:167], v[124:127], v[52:55]
ds_read_b128 v[136:139], v181 offset:4096
v_mfma_f32_16x16x32_bf16 v[56:59], v[168:171], v[92:95], v[56:59]
ds_read_b128 v[140:143], v181 offset:6144
v_mfma_f32_16x16x32_bf16 v[60:63], v[168:171], v[96:99], v[60:63]
v_mfma_f32_16x16x32_bf16 v[64:67], v[168:171], v[100:103], v[64:67]
ds_read_b128 v[144:147], v181 offset:8192
v_mfma_f32_16x16x32_bf16 v[68:71], v[168:171], v[104:107], v[68:71]
ds_read_b128 v[148:151], v181 offset:10240
v_mfma_f32_16x16x32_bf16 v[72:75], v[168:171], v[108:111], v[72:75]
ds_read_b128 v[152:155], v181 offset:12288
v_mfma_f32_16x16x32_bf16 v[76:79], v[168:171], v[112:115], v[76:79]
v_mfma_f32_16x16x32_bf16 v[80:83], v[168:171], v[116:119], v[80:83]
ds_read_b128 v[156:159], v181 offset:14336
v_mfma_f32_16x16x32_bf16 v[84:87], v[168:171], v[120:123], v[84:87]
ds_read_b128 v[160:163], v187 offset:0
v_mfma_f32_16x16x32_bf16 v[88:91], v[168:171], v[124:127], v[88:91]
s_waitcnt vmcnt(6) lgkmcnt(0)
s_barrier
v_mfma_f32_16x16x32_bf16 v[20:23], v[172:175], v[128:131], v[20:23]
s_cmp_ge_u32 s63, 2
s_cbranch_scc1 XS_11
s_add_u32 m0, s31, 157696
s_add_u32 s36, s30, 164992
buffer_load_dwordx4 v15, s[4:7], s36 offen  lds
XS_11:
ds_read_b64_tr_b16 v[164:165], v16 offset:0
v_mfma_f32_16x16x32_bf16 v[24:27], v[172:175], v[132:135], v[24:27]
ds_read_b64_tr_b16 v[166:167], v16 offset:256
v_mfma_f32_16x16x32_bf16 v[28:31], v[172:175], v[136:139], v[28:31]
s_add_u32 m0, s31, 52224
s_add_u32 s36, s30, 1152
buffer_load_dwordx4 v15, s[4:7], s36 offen  lds
v_mfma_f32_16x16x32_bf16 v[32:35], v[172:175], v[140:143], v[32:35]
ds_read_b64_tr_b16 v[168:169], v16 offset:8
v_mfma_f32_16x16x32_bf16 v[36:39], v[172:175], v[144:147], v[36:39]
ds_read_b64_tr_b16 v[170:171], v16 offset:264
v_mfma_f32_16x16x32_bf16 v[40:43], v[172:175], v[148:151], v[40:43]
s_add_u32 m0, s31, 60416
s_add_u32 s36, s30, 83072
buffer_load_dwordx4 v15, s[4:7], s36 offen  lds
v_mfma_f32_16x16x32_bf16 v[44:47], v[172:175], v[152:155], v[44:47]
ds_read_b128 v[92:95], v182 offset:0
v_mfma_f32_16x16x32_bf16 v[48:51], v[172:175], v[156:159], v[48:51]
ds_read_b128 v[96:99], v182 offset:2048
v_mfma_f32_16x16x32_bf16 v[52:55], v[172:175], v[160:163], v[52:55]
s_add_u32 m0, s26, 34816
s_add_u32 s36, s25, 4718592
buffer_load_dwordx4 v14, s[8:11], s36 offen  lds
v_mfma_f32_16x16x32_bf16 v[56:59], v[176:179], v[128:131], v[56:59]
ds_read_b128 v[100:103], v182 offset:4096
ds_read_b128 v[104:107], v182 offset:6144
v_mfma_f32_16x16x32_bf16 v[60:63], v[176:179], v[132:135], v[60:63]
s_add_u32 m0, s26, 35904
s_add_u32 s36, s25, 4726784
buffer_load_dwordx4 v14, s[8:11], s36 offen  lds
v_mfma_f32_16x16x32_bf16 v[64:67], v[176:179], v[136:139], v[64:67]
ds_read_b128 v[108:111], v182 offset:8192
v_mfma_f32_16x16x32_bf16 v[68:71], v[176:179], v[140:143], v[68:71]
ds_read_b128 v[112:115], v182 offset:10240
v_mfma_f32_16x16x32_bf16 v[72:75], v[176:179], v[144:147], v[72:75]
s_add_u32 m0, s26, 43520
s_add_u32 s36, s25, 4980736
buffer_load_dwordx4 v14, s[8:11], s36 offen  lds
v_mfma_f32_16x16x32_bf16 v[76:79], v[176:179], v[148:151], v[76:79]
ds_read_b128 v[116:119], v182 offset:12288
v_mfma_f32_16x16x32_bf16 v[80:83], v[176:179], v[152:155], v[80:83]
ds_read_b128 v[120:123], v182 offset:14336
v_mfma_f32_16x16x32_bf16 v[84:87], v[176:179], v[156:159], v[84:87]
s_add_u32 m0, s26, 44608
s_add_u32 s36, s25, 4988928
buffer_load_dwordx4 v14, s[8:11], s36 offen  lds
v_mfma_f32_16x16x32_bf16 v[88:91], v[176:179], v[160:163], v[88:91]
ds_read_b128 v[124:127], v186 offset:2048
s_waitcnt lgkmcnt(0)
v_mfma_f32_16x16x32_bf16 v[20:23], v[164:167], v[92:95], v[20:23]
ds_read_b64_tr_b16 v[172:173], v16 offset:8704
v_mfma_f32_16x16x32_bf16 v[24:27], v[164:167], v[96:99], v[24:27]
ds_read_b64_tr_b16 v[174:175], v16 offset:8960
v_mfma_f32_16x16x32_bf16 v[28:31], v[164:167], v[100:103], v[28:31]
ds_read_b64_tr_b16 v[176:177], v16 offset:8712
v_mfma_f32_16x16x32_bf16 v[32:35], v[164:167], v[104:107], v[32:35]
v_mfma_f32_16x16x32_bf16 v[36:39], v[164:167], v[108:111], v[36:39]
ds_read_b64_tr_b16 v[178:179], v16 offset:8968
v_mfma_f32_16x16x32_bf16 v[40:43], v[164:167], v[112:115], v[40:43]
ds_read_b128 v[128:131], v183 offset:0
v_mfma_f32_16x16x32_bf16 v[44:47], v[164:167], v[116:119], v[44:47]
ds_read_b128 v[132:135], v183 offset:2048
v_mfma_f32_16x16x32_bf16 v[48:51], v[164:167], v[120:123], v[48:51]
v_mfma_f32_16x16x32_bf16 v[52:55], v[164:167], v[124:127], v[52:55]
ds_read_b128 v[136:139], v183 offset:4096
v_mfma_f32_16x16x32_bf16 v[56:59], v[168:171], v[92:95], v[56:59]
ds_read_b128 v[140:143], v183 offset:6144
v_mfma_f32_16x16x32_bf16 v[60:63], v[168:171], v[96:99], v[60:63]
v_mfma_f32_16x16x32_bf16 v[64:67], v[168:171], v[100:103], v[64:67]
ds_read_b128 v[144:147], v183 offset:8192
v_mfma_f32_16x16x32_bf16 v[68:71], v[168:171], v[104:107], v[68:71]
ds_read_b128 v[148:151], v183 offset:10240
v_mfma_f32_16x16x32_bf16 v[72:75], v[168:171], v[108:111], v[72:75]
ds_read_b128 v[152:155], v183 offset:12288
v_mfma_f32_16x16x32_bf16 v[76:79], v[168:171], v[112:115], v[76:79]
v_mfma_f32_16x16x32_bf16 v[80:83], v[168:171], v[116:119], v[80:83]
ds_read_b128 v[156:159], v183 offset:14336
v_mfma_f32_16x16x32_bf16 v[84:87], v[168:171], v[120:123], v[84:87]
ds_read_b128 v[160:163], v187 offset:2048
v_mfma_f32_16x16x32_bf16 v[88:91], v[168:171], v[124:127], v[88:91]
s_waitcnt vmcnt(6) lgkmcnt(0)
s_barrier
v_mfma_f32_16x16x32_bf16 v[20:23], v[172:175], v[128:131], v[20:23]
s_add_u32 m0, s27, 0
s_add_u32 s36, s29, 0
buffer_load_dwordx4 v12, s[12:15], s36 offen nt lds
v_mfma_f32_16x16x32_bf16 v[24:27], v[172:175], v[132:135], v[24:27]
ds_read_b64_tr_b16 v[164:165], v16 offset:17408
v_mfma_f32_16x16x32_bf16 v[28:31], v[172:175], v[136:139], v[28:31]
ds_read_b64_tr_b16 v[166:167], v16 offset:17664
v_mfma_f32_16x16x32_bf16 v[32:35], v[172:175], v[140:143], v[32:35]
s_add_u32 m0, s27, 1088
s_add_u32 s36, s29, 1024
buffer_load_dwordx4 v12, s[12:15], s36 offen nt lds
v_mfma_f32_16x16x32_bf16 v[36:39], v[172:175], v[144:147], v[36:39]
ds_read_b64_tr_b16 v[168:169], v16 offset:17416
v_mfma_f32_16x16x32_bf16 v[40:43], v[172:175], v[148:151], v[40:43]
ds_read_b64_tr_b16 v[170:171], v16 offset:17672
v_mfma_f32_16x16x32_bf16 v[44:47], v[172:175], v[152:155], v[44:47]
s_add_u32 m0, s27, 8704
s_add_u32 s36, s29, 8192
buffer_load_dwordx4 v12, s[12:15], s36 offen nt lds
v_mfma_f32_16x16x32_bf16 v[48:51], v[172:175], v[156:159], v[48:51]
ds_read_b128 v[92:95], v184 offset:0
v_mfma_f32_16x16x32_bf16 v[52:55], v[172:175], v[160:163], v[52:55]
ds_read_b128 v[96:99], v184 offset:2048
v_mfma_f32_16x16x32_bf16 v[56:59], v[176:179], v[128:131], v[56:59]
s_add_u32 m0, s27, 9792
s_add_u32 s36, s29, 9216
buffer_load_dwordx4 v12, s[12:15], s36 offen nt lds
v_mfma_f32_16x16x32_bf16 v[60:63], v[176:179], v[132:135], v[60:63]
ds_read_b128 v[100:103], v184 offset:4096
v_mfma_f32_16x16x32_bf16 v[64:67], v[176:179], v[136:139], v[64:67]
ds_read_b128 v[104:107], v184 offset:6144
v_mfma_f32_16x16x32_bf16 v[68:71], v[176:179], v[140:143], v[68:71]
ds_read_b128 v[108:111], v184 offset:8192
v_mfma_f32_16x16x32_bf16 v[72:75], v[176:179], v[144:147], v[72:75]
ds_read_b128 v[112:115], v184 offset:10240
v_mfma_f32_16x16x32_bf16 v[76:79], v[176:179], v[148:151], v[76:79]
ds_read_b128 v[116:119], v184 offset:12288
v_mfma_f32_16x16x32_bf16 v[80:83], v[176:179], v[152:155], v[80:83]
ds_read_b128 v[120:123], v184 offset:14336
v_mfma_f32_16x16x32_bf16 v[84:87], v[176:179], v[156:159], v[84:87]
ds_read_b128 v[124:127], v184 offset:16384
v_mfma_f32_16x16x32_bf16 v[88:91], v[176:179], v[160:163], v[88:91]
s_waitcnt lgkmcnt(0)
v_mfma_f32_16x16x32_bf16 v[20:23], v[164:167], v[92:95], v[20:23]
ds_read_b64_tr_b16 v[172:173], v16 offset:26112
v_mfma_f32_16x16x32_bf16 v[24:27], v[164:167], v[96:99], v[24:27]
ds_read_b64_tr_b16 v[174:175], v16 offset:26368
v_mfma_f32_16x16x32_bf16 v[28:31], v[164:167], v[100:103], v[28:31]
ds_read_b64_tr_b16 v[176:177], v16 offset:26120
v_mfma_f32_16x16x32_bf16 v[32:35], v[164:167], v[104:107], v[32:35]
v_mfma_f32_16x16x32_bf16 v[36:39], v[164:167], v[108:111], v[36:39]
ds_read_b64_tr_b16 v[178:179], v16 offset:26376
v_mfma_f32_16x16x32_bf16 v[40:43], v[164:167], v[112:115], v[40:43]
ds_read_b128 v[128:131], v185 offset:0
v_mfma_f32_16x16x32_bf16 v[44:47], v[164:167], v[116:119], v[44:47]
ds_read_b128 v[132:135], v185 offset:2048
v_mfma_f32_16x16x32_bf16 v[48:51], v[164:167], v[120:123], v[48:51]
v_mfma_f32_16x16x32_bf16 v[52:55], v[164:167], v[124:127], v[52:55]
ds_read_b128 v[136:139], v185 offset:4096
v_mfma_f32_16x16x32_bf16 v[56:59], v[168:171], v[92:95], v[56:59]
ds_read_b128 v[140:143], v185 offset:6144
v_mfma_f32_16x16x32_bf16 v[60:63], v[168:171], v[96:99], v[60:63]
v_mfma_f32_16x16x32_bf16 v[64:67], v[168:171], v[100:103], v[64:67]
ds_read_b128 v[144:147], v185 offset:8192
v_mfma_f32_16x16x32_bf16 v[68:71], v[168:171], v[104:107], v[68:71]
ds_read_b128 v[148:151], v185 offset:10240
v_mfma_f32_16x16x32_bf16 v[72:75], v[168:171], v[108:111], v[72:75]
ds_read_b128 v[152:155], v185 offset:12288
v_mfma_f32_16x16x32_bf16 v[76:79], v[168:171], v[112:115], v[76:79]
v_mfma_f32_16x16x32_bf16 v[80:83], v[168:171], v[116:119], v[80:83]
ds_read_b128 v[156:159], v185 offset:14336
v_mfma_f32_16x16x32_bf16 v[84:87], v[168:171], v[120:123], v[84:87]
ds_read_b128 v[160:163], v185 offset:16384
v_mfma_f32_16x16x32_bf16 v[88:91], v[168:171], v[124:127], v[88:91]
s_waitcnt vmcnt(4) lgkmcnt(0)
s_barrier
v_mfma_f32_16x16x32_bf16 v[20:23], v[172:175], v[128:131], v[20:23]
s_add_u32 m0, s28, 17408
s_add_u32 s36, s33, 0
buffer_load_dwordx4 v13, s[16:19], s36 offen nt lds
v_mfma_f32_16x16x32_bf16 v[24:27], v[172:175], v[132:135], v[24:27]
ds_read_b64_tr_b16 v[164:165], v16 offset:34816
v_mfma_f32_16x16x32_bf16 v[28:31], v[172:175], v[136:139], v[28:31]
ds_read_b64_tr_b16 v[166:167], v16 offset:35072
v_mfma_f32_16x16x32_bf16 v[32:35], v[172:175], v[140:143], v[32:35]
s_add_u32 m0, s28, 18464
s_add_u32 s36, s33, 256
buffer_load_dwordx4 v13, s[16:19], s36 offen nt lds
v_mfma_f32_16x16x32_bf16 v[36:39], v[172:175], v[144:147], v[36:39]
ds_read_b64_tr_b16 v[168:169], v16 offset:34824
v_mfma_f32_16x16x32_bf16 v[40:43], v[172:175], v[148:151], v[40:43]
ds_read_b64_tr_b16 v[170:171], v16 offset:35080
v_mfma_f32_16x16x32_bf16 v[44:47], v[172:175], v[152:155], v[44:47]
s_add_u32 m0, s28, 25856
s_add_u32 s36, s33, 8192
buffer_load_dwordx4 v13, s[16:19], s36 offen nt lds
v_mfma_f32_16x16x32_bf16 v[48:51], v[172:175], v[156:159], v[48:51]
ds_read_b128 v[92:95], v180 offset:0
v_mfma_f32_16x16x32_bf16 v[52:55], v[172:175], v[160:163], v[52:55]
ds_read_b128 v[96:99], v180 offset:2048
v_mfma_f32_16x16x32_bf16 v[56:59], v[176:179], v[128:131], v[56:59]
s_add_u32 m0, s28, 26912
s_add_u32 s36, s33, 8448
buffer_load_dwordx4 v13, s[16:19], s36 offen nt lds
v_mfma_f32_16x16x32_bf16 v[60:63], v[176:179], v[132:135], v[60:63]
ds_read_b128 v[100:103], v180 offset:4096
v_mfma_f32_16x16x32_bf16 v[64:67], v[176:179], v[136:139], v[64:67]
ds_read_b128 v[104:107], v180 offset:6144
v_mfma_f32_16x16x32_bf16 v[68:71], v[176:179], v[140:143], v[68:71]
ds_read_b128 v[108:111], v180 offset:8192
v_mfma_f32_16x16x32_bf16 v[72:75], v[176:179], v[144:147], v[72:75]
ds_read_b128 v[112:115], v180 offset:10240
v_mfma_f32_16x16x32_bf16 v[76:79], v[176:179], v[148:151], v[76:79]
ds_read_b128 v[116:119], v180 offset:12288
v_mfma_f32_16x16x32_bf16 v[80:83], v[176:179], v[152:155], v[80:83]
ds_read_b128 v[120:123], v180 offset:14336
v_mfma_f32_16x16x32_bf16 v[84:87], v[176:179], v[156:159], v[84:87]
ds_read_b128 v[124:127], v186 offset:0
v_mfma_f32_16x16x32_bf16 v[88:91], v[176:179], v[160:163], v[88:91]
s_waitcnt lgkmcnt(0)
v_mfma_f32_16x16x32_bf16 v[20:23], v[164:167], v[92:95], v[20:23]
ds_read_b64_tr_b16 v[172:173], v16 offset:43520
v_mfma_f32_16x16x32_bf16 v[24:27], v[164:167], v[96:99], v[24:27]
ds_read_b64_tr_b16 v[174:175], v16 offset:43776
v_mfma_f32_16x16x32_bf16 v[28:31], v[164:167], v[100:103], v[28:31]
ds_read_b64_tr_b16 v[176:177], v16 offset:43528
v_mfma_f32_16x16x32_bf16 v[32:35], v[164:167], v[104:107], v[32:35]
v_mfma_f32_16x16x32_bf16 v[36:39], v[164:167], v[108:111], v[36:39]
ds_read_b64_tr_b16 v[178:179], v16 offset:43784
v_mfma_f32_16x16x32_bf16 v[40:43], v[164:167], v[112:115], v[40:43]
ds_read_b128 v[128:131], v181 offset:0
v_mfma_f32_16x16x32_bf16 v[44:47], v[164:167], v[116:119], v[44:47]
ds_read_b128 v[132:135], v181 offset:2048
v_mfma_f32_16x16x32_bf16 v[48:51], v[164:167], v[120:123], v[48:51]
v_mfma_f32_16x16x32_bf16 v[52:55], v[164:167], v[124:127], v[52:55]
ds_read_b128 v[136:139], v181 offset:4096
v_mfma_f32_16x16x32_bf16 v[56:59], v[168:171], v[92:95], v[56:59]
ds_read_b128 v[140:143], v181 offset:6144
v_mfma_f32_16x16x32_bf16 v[60:63], v[168:171], v[96:99], v[60:63]
v_mfma_f32_16x16x32_bf16 v[64:67], v[168:171], v[100:103], v[64:67]
ds_read_b128 v[144:147], v181 offset:8192
v_mfma_f32_16x16x32_bf16 v[68:71], v[168:171], v[104:107], v[68:71]
ds_read_b128 v[148:151], v181 offset:10240
v_mfma_f32_16x16x32_bf16 v[72:75], v[168:171], v[108:111], v[72:75]
ds_read_b128 v[152:155], v181 offset:12288
v_mfma_f32_16x16x32_bf16 v[76:79], v[168:171], v[112:115], v[76:79]
v_mfma_f32_16x16x32_bf16 v[80:83], v[168:171], v[116:119], v[80:83]
ds_read_b128 v[156:159], v181 offset:14336
v_mfma_f32_16x16x32_bf16 v[84:87], v[168:171], v[120:123], v[84:87]
ds_read_b128 v[160:163], v187 offset:0
v_mfma_f32_16x16x32_bf16 v[88:91], v[168:171], v[124:127], v[88:91]
s_waitcnt lgkmcnt(0)
s_barrier
v_mfma_f32_16x16x32_bf16 v[20:23], v[172:175], v[128:131], v[20:23]
v_mfma_f32_16x16x32_bf16 v[24:27], v[172:175], v[132:135], v[24:27]
v_mfma_f32_16x16x32_bf16 v[28:31], v[172:175], v[136:139], v[28:31]
v_mfma_f32_16x16x32_bf16 v[32:35], v[172:175], v[140:143], v[32:35]
v_mfma_f32_16x16x32_bf16 v[36:39], v[172:175], v[144:147], v[36:39]
v_mfma_f32_16x16x32_bf16 v[40:43], v[172:175], v[148:151], v[40:43]
v_mfma_f32_16x16x32_bf16 v[44:47], v[172:175], v[152:155], v[44:47]
v_mfma_f32_16x16x32_bf16 v[48:51], v[172:175], v[156:159], v[48:51]
v_mfma_f32_16x16x32_bf16 v[52:55], v[172:175], v[160:163], v[52:55]
v_mfma_f32_16x16x32_bf16 v[56:59], v[176:179], v[128:131], v[56:59]
v_mfma_f32_16x16x32_bf16 v[60:63], v[176:179], v[132:135], v[60:63]
v_mfma_f32_16x16x32_bf16 v[64:67], v[176:179], v[136:139], v[64:67]
v_mfma_f32_16x16x32_bf16 v[68:71], v[176:179], v[140:143], v[68:71]
v_mfma_f32_16x16x32_bf16 v[72:75], v[176:179], v[144:147], v[72:75]
v_mfma_f32_16x16x32_bf16 v[76:79], v[176:179], v[148:151], v[76:79]
v_mfma_f32_16x16x32_bf16 v[80:83], v[176:179], v[152:155], v[80:83]
v_mfma_f32_16x16x32_bf16 v[84:87], v[176:179], v[156:159], v[84:87]
v_mfma_f32_16x16x32_bf16 v[88:91], v[176:179], v[160:163], v[88:91]
s_nop 15
v_lshlrev_b32 v2, 4, v0
s_lshl_b32 s36, s24, 10
s_add_u32 s36, s36, s99
v_add_u32 v2, s36, v2
s_lshl_b32 s40, s24, 10
s_lshr_b32 s41, s63, 2
s_lshl_b32 s41, s41, 12
s_add_u32 s40, s40, s41
s_add_u32 s40, s40, 139264
v_lshlrev_b32 v3, 4, v0
v_add_u32 v3, s40, v3
v_pk_mul_f32 v[20:21], v[20:21], s[34:35]
v_pk_mul_f32 v[22:23], v[22:23], s[34:35]
v_pk_mul_f32 v[56:57], v[56:57], s[34:35]
v_pk_mul_f32 v[58:59], v[58:59], s[34:35]
v_cvt_pk_bf16_f32 v92, v20, v21
v_cvt_pk_bf16_f32 v93, v22, v23
v_cvt_pk_bf16_f32 v94, v56, v57
v_cvt_pk_bf16_f32 v95, v58, v59
ds_write_b128 v2, v[92:95] offset:34816
v_pk_mul_f32 v[24:25], v[24:25], s[34:35]
v_pk_mul_f32 v[26:27], v[26:27], s[34:35]
v_pk_mul_f32 v[60:61], v[60:61], s[34:35]
v_pk_mul_f32 v[62:63], v[62:63], s[34:35]
v_cvt_pk_bf16_f32 v96, v24, v25
v_cvt_pk_bf16_f32 v97, v26, v27
v_cvt_pk_bf16_f32 v98, v60, v61
v_cvt_pk_bf16_f32 v99, v62, v63
ds_write_b128 v2, v[96:99] offset:38912
v_pk_mul_f32 v[28:29], v[28:29], s[34:35]
v_pk_mul_f32 v[30:31], v[30:31], s[34:35]
v_pk_mul_f32 v[64:65], v[64:65], s[34:35]
v_pk_mul_f32 v[66:67], v[66:67], s[34:35]
v_cvt_pk_bf16_f32 v100, v28, v29
v_cvt_pk_bf16_f32 v101, v30, v31
v_cvt_pk_bf16_f32 v102, v64, v65
v_cvt_pk_bf16_f32 v103, v66, v67
ds_write_b128 v2, v[100:103] offset:43008
v_pk_mul_f32 v[32:33], v[32:33], s[34:35]
v_pk_mul_f32 v[34:35], v[34:35], s[34:35]
v_pk_mul_f32 v[68:69], v[68:69], s[34:35]
v_pk_mul_f32 v[70:71], v[70:71], s[34:35]
v_cvt_pk_bf16_f32 v104, v32, v33
v_cvt_pk_bf16_f32 v105, v34, v35
v_cvt_pk_bf16_f32 v106, v68, v69
v_cvt_pk_bf16_f32 v107, v70, v71
ds_write_b128 v2, v[104:107] offset:47104
v_pk_mul_f32 v[36:37], v[36:37], s[34:35]
v_pk_mul_f32 v[38:39], v[38:39], s[34:35]
v_pk_mul_f32 v[72:73], v[72:73], s[34:35]
v_pk_mul_f32 v[74:75], v[74:75], s[34:35]
v_cvt_pk_bf16_f32 v108, v36, v37
v_cvt_pk_bf16_f32 v109, v38, v39
v_cvt_pk_bf16_f32 v110, v72, v73
v_cvt_pk_bf16_f32 v111, v74, v75
ds_write_b128 v2, v[108:111] offset:51200
v_pk_mul_f32 v[40:41], v[40:41], s[34:35]
v_pk_mul_f32 v[42:43], v[42:43], s[34:35]
v_pk_mul_f32 v[76:77], v[76:77], s[34:35]
v_pk_mul_f32 v[78:79], v[78:79], s[34:35]
v_cvt_pk_bf16_f32 v112, v40, v41
v_cvt_pk_bf16_f32 v113, v42, v43
v_cvt_pk_bf16_f32 v114, v76, v77
v_cvt_pk_bf16_f32 v115, v78, v79
ds_write_b128 v2, v[112:115] offset:55296
v_pk_mul_f32 v[44:45], v[44:45], s[34:35]
v_pk_mul_f32 v[46:47], v[46:47], s[34:35]
v_pk_mul_f32 v[80:81], v[80:81], s[34:35]
v_pk_mul_f32 v[82:83], v[82:83], s[34:35]
v_cvt_pk_bf16_f32 v116, v44, v45
v_cvt_pk_bf16_f32 v117, v46, v47
v_cvt_pk_bf16_f32 v118, v80, v81
v_cvt_pk_bf16_f32 v119, v82, v83
ds_write_b128 v2, v[116:119] offset:59392
v_pk_mul_f32 v[48:49], v[48:49], s[34:35]
v_pk_mul_f32 v[50:51], v[50:51], s[34:35]
v_pk_mul_f32 v[84:85], v[84:85], s[34:35]
v_pk_mul_f32 v[86:87], v[86:87], s[34:35]
v_cvt_pk_bf16_f32 v120, v48, v49
v_cvt_pk_bf16_f32 v121, v50, v51
v_cvt_pk_bf16_f32 v122, v84, v85
v_cvt_pk_bf16_f32 v123, v86, v87
ds_write_b128 v2, v[120:123] offset:63488
v_pk_mul_f32 v[52:53], v[52:53], s[34:35]
v_pk_mul_f32 v[54:55], v[54:55], s[34:35]
v_pk_mul_f32 v[88:89], v[88:89], s[34:35]
v_pk_mul_f32 v[90:91], v[90:91], s[34:35]
v_cvt_pk_bf16_f32 v124, v52, v53
v_cvt_pk_bf16_f32 v125, v54, v55
v_cvt_pk_bf16_f32 v126, v88, v89
v_cvt_pk_bf16_f32 v127, v90, v91
ds_write_b128 v3, v[124:127]
s_waitcnt lgkmcnt(0)
s_barrier
s_cmp_lt_u32 s63, 4
s_cbranch_scc1 GP_12
s_setprio 1
GP_12:
s_cmp_eq_u32 s24, 3
s_cbranch_scc1 K1_w3
v_lshlrev_b32 v2, 4, v0
s_lshl_b32 s36, s24, 13
s_add_u32 s36, s36, s99
v_add_u32 v2, s36, v2
s_lshr_b32 s41, s63, 2
s_lshl_b32 s41, s41, 12
s_add_u32 s41, s41, 139264
v_lshlrev_b32 v3, 4, v0
v_add_u32 v3, s41, v3
ds_read_b128 v[128:131], v2 offset:34816
ds_read_b128 v[132:135], v2 offset:35840
ds_read_b128 v[136:139], v2 offset:36864
ds_read_b128 v[140:143], v2 offset:37888
ds_read_b128 v[144:147], v2 offset:38912
ds_read_b128 v[148:151], v2 offset:39936
ds_read_b128 v[152:155], v2 offset:40960
ds_read_b128 v[156:159], v2 offset:41984
v_mov_b32 v16, 0x3f803f80
v_mov_b32 v17, 0x3f803f80
v_mov_b32 v18, 0x3f803f80
v_mov_b32 v19, 0x3f803f80
s_waitcnt vmcnt(2) lgkmcnt(0)
s_barrier
ds_read_b128 v[224:227], v10 offset:0
ds_read_b128 v[228:231], v10 offset:64
ds_read_b128 v[232:235], v10 offset:128
ds_read_b128 v[236:239], v10 offset:192
ds_read_b128 v[240:243], v10 offset:4352
ds_read_b128 v[244:247], v10 offset:4416
ds_read_b128 v[248:251], v10 offset:4480
ds_read_b128 v[252:255], v10 offset:4544
s_waitcnt lgkmcnt(4)
v_mfma_f32_16x16x32_bf16 v[176:179], v[224:227], v[128:131], 0
s_add_u32 m0, s27, 34816
s_add_u32 s36, s29, 16384
buffer_load_dwordx4 v12, s[12:15], s36 offen nt lds
v_mfma_f32_16x16x32_bf16 v[176:179], v[228:231], v[132:135], v[176:179]
v_mfma_f32_16x16x32_bf16 v[176:179], v[232:235], v[136:139], v[176:179]
s_add_u32 m0, s27, 35904
s_add_u32 s36, s29, 17408
buffer_load_dwordx4 v12, s[12:15], s36 offen nt lds
v_mfma_f32_16x16x32_bf16 v[176:179], v[236:239], v[140:143], v[176:179]
v_mfma_f32_16x16x32_bf16 v[180:183], v[224:227], v[144:147], 0
s_add_u32 m0, s27, 43520
s_add_u32 s36, s29, 24576
buffer_load_dwordx4 v12, s[12:15], s36 offen nt lds
v_mfma_f32_16x16x32_bf16 v[180:183], v[228:231], v[148:151], v[180:183]
v_mfma_f32_16x16x32_bf16 v[180:183], v[232:235], v[152:155], v[180:183]
s_add_u32 m0, s27, 44608
s_add_u32 s36, s29, 25600
buffer_load_dwordx4 v12, s[12:15], s36 offen nt lds
v_mfma_f32_16x16x32_bf16 v[180:183], v[236:239], v[156:159], v[180:183]
s_waitcnt lgkmcnt(0)
v_mfma_f32_16x16x32_bf16 v[184:187], v[240:243], v[128:131], 0
s_add_u32 m0, s28, 52224
s_add_u32 s36, s33, 16384
buffer_load_dwordx4 v13, s[16:19], s36 offen nt lds
v_mfma_f32_16x16x32_bf16 v[184:187], v[244:247], v[132:135], v[184:187]
v_mfma_f32_16x16x32_bf16 v[184:187], v[248:251], v[136:139], v[184:187]
s_add_u32 m0, s28, 53280
s_add_u32 s36, s33, 16640
buffer_load_dwordx4 v13, s[16:19], s36 offen nt lds
v_mfma_f32_16x16x32_bf16 v[184:187], v[252:255], v[140:143], v[184:187]
v_mfma_f32_16x16x32_bf16 v[188:191], v[240:243], v[144:147], 0
s_add_u32 m0, s28, 60672
s_add_u32 s36, s33, 24576
buffer_load_dwordx4 v13, s[16:19], s36 offen nt lds
v_mfma_f32_16x16x32_bf16 v[188:191], v[244:247], v[148:151], v[188:191]
v_mfma_f32_16x16x32_bf16 v[188:191], v[248:251], v[152:155], v[188:191]
s_add_u32 m0, s28, 61728
s_add_u32 s36, s33, 24832
buffer_load_dwordx4 v13, s[16:19], s36 offen nt lds
v_mfma_f32_16x16x32_bf16 v[188:191], v[252:255], v[156:159], v[188:191]
ds_read_b128 v[224:227], v10 offset:8704
ds_read_b128 v[228:231], v10 offset:8768
ds_read_b128 v[232:235], v10 offset:8832
ds_read_b128 v[236:239], v10 offset:8896
ds_read_b128 v[240:243], v10 offset:13056
ds_read_b128 v[244:247], v10 offset:13120
ds_read_b128 v[248:251], v10 offset:13184
ds_read_b128 v[252:255], v10 offset:13248
s_nop 7
v_max3_f32 v2, v176, v177, v178
v_max3_f32 v2, v2, v179, v184
v_max3_f32 v2, v2, v185, v186
v_max_f32 v2, v2, v187
v_mov_b32 v3, v2
s_nop 1
v_permlane32_swap_b32 v2, v3
s_nop 1
v_max_f32 v2, v2, v3
v_mov_b32 v3, v2
s_nop 1
v_permlane16_swap_b32 v2, v3
s_nop 1
v_max_f32 v2, v2, v3
v_sub_f32 v176, v176, v2
v_sub_f32 v177, v177, v2
v_sub_f32 v178, v178, v2
v_sub_f32 v179, v179, v2
v_sub_f32 v184, v184, v2
v_sub_f32 v185, v185, v2
v_sub_f32 v186, v186, v2
v_sub_f32 v187, v187, v2
v_sub_f32 v212, 0, v2
v_sub_f32 v213, 0, v2
v_sub_f32 v214, 0, v2
v_sub_f32 v215, 0, v2
v_max3_f32 v2, v180, v181, v182
v_max3_f32 v2, v2, v183, v188
v_max3_f32 v2, v2, v189, v190
v_max_f32 v2, v2, v191
v_mov_b32 v3, v2
s_nop 1
v_permlane32_swap_b32 v2, v3
s_nop 1
v_max_f32 v2, v2, v3
v_mov_b32 v3, v2
s_nop 1
v_permlane16_swap_b32 v2, v3
s_nop 1
v_max_f32 v2, v2, v3
v_sub_f32 v180, v180, v2
v_sub_f32 v181, v181, v2
v_sub_f32 v182, v182, v2
v_sub_f32 v183, v183, v2
v_sub_f32 v188, v188, v2
v_sub_f32 v189, v189, v2
v_sub_f32 v190, v190, v2
v_sub_f32 v191, v191, v2
v_sub_f32 v216, 0, v2
v_sub_f32 v217, 0, v2
v_sub_f32 v218, 0, v2
v_sub_f32 v219, 0, v2
v_exp_f32 v176, v176
v_exp_f32 v177, v177
v_exp_f32 v178, v178
v_exp_f32 v179, v179
v_exp_f32 v184, v184
v_exp_f32 v185, v185
v_exp_f32 v186, v186
v_exp_f32 v187, v187
v_exp_f32 v180, v180
v_exp_f32 v181, v181
v_exp_f32 v182, v182
v_exp_f32 v183, v183
v_exp_f32 v188, v188
v_exp_f32 v189, v189
v_exp_f32 v190, v190
v_exp_f32 v191, v191
v_cvt_pk_bf16_f32 v200, v176, v177
v_cvt_pk_bf16_f32 v201, v178, v179
v_cvt_pk_bf16_f32 v202, v184, v185
v_cvt_pk_bf16_f32 v203, v186, v187
v_cvt_pk_bf16_f32 v204, v180, v181
v_cvt_pk_bf16_f32 v205, v182, v183
v_cvt_pk_bf16_f32 v206, v188, v189
v_cvt_pk_bf16_f32 v207, v190, v191
s_waitcnt lgkmcnt(7)
v_mfma_f32_16x16x32_bf16 v[176:179], v[224:227], v[128:131], v[212:215]
v_mfma_f32_16x16x32_bf16 v[180:183], v[224:227], v[144:147], v[216:219]
s_waitcnt lgkmcnt(6)
v_mfma_f32_16x16x32_bf16 v[176:179], v[228:231], v[132:135], v[176:179]
ds_read_b64_tr_b16 v[224:225], v11 offset:17408
v_mfma_f32_16x16x32_bf16 v[180:183], v[228:231], v[148:151], v[180:183]
ds_read_b64_tr_b16 v[226:227], v11 offset:17920
s_waitcnt lgkmcnt(7)
v_mfma_f32_16x16x32_bf16 v[176:179], v[232:235], v[136:139], v[176:179]
ds_read_b64_tr_b16 v[228:229], v11 offset:17440
v_mfma_f32_16x16x32_bf16 v[180:183], v[232:235], v[152:155], v[180:183]
ds_read_b64_tr_b16 v[230:231], v11 offset:17952
s_waitcnt lgkmcnt(8)
v_mfma_f32_16x16x32_bf16 v[176:179], v[236:239], v[140:143], v[176:179]
ds_read_b64_tr_b16 v[232:233], v11 offset:17472
v_mfma_f32_16x16x32_bf16 v[180:183], v[236:239], v[156:159], v[180:183]
ds_read_b64_tr_b16 v[234:235], v11 offset:17984
s_waitcnt lgkmcnt(9)
v_mfma_f32_16x16x32_bf16 v[184:187], v[240:243], v[128:131], v[212:215]
ds_read_b64_tr_b16 v[236:237], v11 offset:17504
v_mfma_f32_16x16x32_bf16 v[188:191], v[240:243], v[144:147], v[216:219]
ds_read_b64_tr_b16 v[238:239], v11 offset:18016
s_waitcnt lgkmcnt(10)
v_mfma_f32_16x16x32_bf16 v[184:187], v[244:247], v[132:135], v[184:187]
ds_read_b64_tr_b16 v[240:241], v11 offset:17536
v_mfma_f32_16x16x32_bf16 v[188:191], v[244:247], v[148:151], v[188:191]
ds_read_b64_tr_b16 v[242:243], v11 offset:18048
s_waitcnt lgkmcnt(11)
v_mfma_f32_16x16x32_bf16 v[184:187], v[248:251], v[136:139], v[184:187]
ds_read_b64_tr_b16 v[244:245], v11 offset:17568
ds_read_b64_tr_b16 v[246:247], v11 offset:18080
v_mfma_f32_16x16x32_bf16 v[188:191], v[248:251], v[152:155], v[188:191]
v_max3_f32 v2, v176, v177, v178
v_max_f32 v2, v2, v179
s_waitcnt lgkmcnt(12)
v_mfma_f32_16x16x32_bf16 v[184:187], v[252:255], v[140:143], v[184:187]
ds_read_b64_tr_b16 v[248:249], v11 offset:17600
ds_read_b64_tr_b16 v[250:251], v11 offset:18112
v_mfma_f32_16x16x32_bf16 v[188:191], v[252:255], v[156:159], v[188:191]
v_max3_f32 v2, v2, v180, v181
v_max3_f32 v2, v2, v182, v183
ds_read_b64_tr_b16 v[252:253], v11 offset:17632
ds_read_b64_tr_b16 v[254:255], v11 offset:18144
s_nop 5
v_max3_f32 v2, v2, v184, v185
v_max3_f32 v2, v2, v186, v187
v_max3_f32 v2, v2, v188, v189
v_max3_f32 v2, v2, v190, v191
v_cmp_lt_f32 vcc, s3, v2
s_cbranch_vccnz W2_R1
s_waitcnt lgkmcnt(14)
v_mfma_f32_16x16x32_bf16 v[20:23], v[224:227], v[200:203], 0
v_exp_f32 v176, v176
s_waitcnt lgkmcnt(12)
v_mfma_f32_16x16x32_bf16 v[28:31], v[228:231], v[200:203], 0
v_exp_f32 v177, v177
s_waitcnt lgkmcnt(10)
v_mfma_f32_16x16x32_bf16 v[36:39], v[232:235], v[200:203], 0
v_exp_f32 v178, v178
s_waitcnt lgkmcnt(8)
v_mfma_f32_16x16x32_bf16 v[44:47], v[236:239], v[200:203], 0
v_exp_f32 v179, v179
s_waitcnt lgkmcnt(6)
v_mfma_f32_16x16x32_bf16 v[52:55], v[240:243], v[200:203], 0
v_exp_f32 v184, v184
s_waitcnt lgkmcnt(4)
v_mfma_f32_16x16x32_bf16 v[60:63], v[244:247], v[200:203], 0
v_exp_f32 v185, v185
s_waitcnt lgkmcnt(2)
v_mfma_f32_16x16x32_bf16 v[68:71], v[248:251], v[200:203], 0
v_exp_f32 v186, v186
s_waitcnt lgkmcnt(0)
v_mfma_f32_16x16x32_bf16 v[76:79], v[252:255], v[200:203], 0
v_exp_f32 v187, v187
v_mfma_f32_16x16x32_bf16 v[84:87], v[16:19], v[200:203], 0
s_waitcnt vmcnt(6)
s_barrier
v_mfma_f32_16x16x32_bf16 v[24:27], v[224:227], v[204:207], 0
v_exp_f32 v180, v180
v_cvt_pk_bf16_f32 v200, v176, v177
s_add_u32 m0, s27, 0
s_add_u32 s36, s29, 32768
buffer_load_dwordx4 v12, s[12:15], s36 offen nt lds
ds_read_b128 v[224:227], v10 offset:34816
v_mfma_f32_16x16x32_bf16 v[32:35], v[228:231], v[204:207], 0
v_exp_f32 v181, v181
v_cvt_pk_bf16_f32 v201, v178, v179
s_add_u32 m0, s27, 1088
s_add_u32 s36, s29, 33792
buffer_load_dwordx4 v12, s[12:15], s36 offen nt lds
ds_read_b128 v[228:231], v10 offset:34880
v_mfma_f32_16x16x32_bf16 v[40:43], v[232:235], v[204:207], 0
v_exp_f32 v182, v182
v_cvt_pk_bf16_f32 v202, v184, v185
s_add_u32 m0, s27, 8704
s_add_u32 s36, s29, 40960
buffer_load_dwordx4 v12, s[12:15], s36 offen nt lds
ds_read_b128 v[232:235], v10 offset:34944
v_mfma_f32_16x16x32_bf16 v[48:51], v[236:239], v[204:207], 0
v_exp_f32 v183, v183
v_cvt_pk_bf16_f32 v203, v186, v187
s_add_u32 m0, s27, 9792
s_add_u32 s36, s29, 41984
buffer_load_dwordx4 v12, s[12:15], s36 offen nt lds
ds_read_b128 v[236:239], v10 offset:35008
v_mfma_f32_16x16x32_bf16 v[56:59], v[240:243], v[204:207], 0
v_exp_f32 v188, v188
s_add_u32 m0, s28, 17408
s_add_u32 s36, s33, 32768
buffer_load_dwordx4 v13, s[16:19], s36 offen nt lds
v_exp_f32 v189, v189
ds_read_b128 v[240:243], v10 offset:39168
v_mfma_f32_16x16x32_bf16 v[64:67], v[244:247], v[204:207], 0
s_add_u32 m0, s28, 18464
s_add_u32 s36, s33, 33024
buffer_load_dwordx4 v13, s[16:19], s36 offen nt lds
v_exp_f32 v190, v190
v_mov_b32 v8, 0
global_load_dword v7, v8, s[44:45] sc1
ds_read_b128 v[244:247], v10 offset:39232
v_mfma_f32_16x16x32_bf16 v[72:75], v[248:251], v[204:207], 0
v_exp_f32 v191, v191
ds_read_b128 v[248:251], v10 offset:39296
v_mfma_f32_16x16x32_bf16 v[80:83], v[252:255], v[204:207], 0
ds_read_b128 v[252:255], v10 offset:39360
v_mfma_f32_16x16x32_bf16 v[88:91], v[16:19], v[204:207], 0
s_nop 0
v_cvt_pk_bf16_f32 v204, v180, v181
v_cvt_pk_bf16_f32 v205, v182, v183
v_cvt_pk_bf16_f32 v206, v188, v189
v_cvt_pk_bf16_f32 v207, v190, v191
W2_R1_back:
s_waitcnt lgkmcnt(7)
v_mfma_f32_16x16x32_bf16 v[176:179], v[224:227], v[128:131], v[212:215]
v_mfma_f32_16x16x32_bf16 v[180:183], v[224:227], v[144:147], v[216:219]
s_waitcnt lgkmcnt(6)
v_mfma_f32_16x16x32_bf16 v[176:179], v[228:231], v[132:135], v[176:179]
ds_read_b64_tr_b16 v[224:225], v11 offset:25856
v_mfma_f32_16x16x32_bf16 v[180:183], v[228:231], v[148:151], v[180:183]
ds_read_b64_tr_b16 v[226:227], v11 offset:26368
s_waitcnt lgkmcnt(7)
v_mfma_f32_16x16x32_bf16 v[176:179], v[232:235], v[136:139], v[176:179]
ds_read_b64_tr_b16 v[228:229], v11 offset:25888
v_mfma_f32_16x16x32_bf16 v[180:183], v[232:235], v[152:155], v[180:183]
ds_read_b64_tr_b16 v[230:231], v11 offset:26400
s_waitcnt lgkmcnt(8)
v_mfma_f32_16x16x32_bf16 v[176:179], v[236:239], v[140:143], v[176:179]
ds_read_b64_tr_b16 v[232:233], v11 offset:25920
v_mfma_f32_16x16x32_bf16 v[180:183], v[236:239], v[156:159], v[180:183]
ds_read_b64_tr_b16 v[234:235], v11 offset:26432
s_waitcnt lgkmcnt(9)
v_mfma_f32_16x16x32_bf16 v[184:187], v[240:243], v[128:131], v[212:215]
ds_read_b64_tr_b16 v[236:237], v11 offset:25952
v_mfma_f32_16x16x32_bf16 v[188:191], v[240:243], v[144:147], v[216:219]
ds_read_b64_tr_b16 v[238:239], v11 offset:26464
s_waitcnt lgkmcnt(10)
v_mfma_f32_16x16x32_bf16 v[184:187], v[244:247], v[132:135], v[184:187]
ds_read_b64_tr_b16 v[240:241], v11 offset:25984
v_mfma_f32_16x16x32_bf16 v[188:191], v[244:247], v[148:151], v[188:191]
ds_read_b64_tr_b16 v[242:243], v11 offset:26496
s_waitcnt lgkmcnt(11)
v_mfma_f32_16x16x32_bf16 v[184:187], v[248:251], v[136:139], v[184:187]
ds_read_b64_tr_b16 v[244:245], v11 offset:26016
ds_read_b64_tr_b16 v[246:247], v11 offset:26528
v_mfma_f32_16x16x32_bf16 v[188:191], v[248:251], v[152:155], v[188:191]
v_max3_f32 v2, v176, v177, v178
v_max_f32 v2, v2, v179
s_waitcnt lgkmcnt(12)
v_mfma_f32_16x16x32_bf16 v[184:187], v[252:255], v[140:143], v[184:187]
ds_read_b64_tr_b16 v[248:249], v11 offset:26048
ds_read_b64_tr_b16 v[250:251], v11 offset:26560
v_mfma_f32_16x16x32_bf16 v[188:191], v[252:255], v[156:159], v[188:191]
v_max3_f32 v2, v2, v180, v181
v_max3_f32 v2, v2, v182, v183
ds_read_b64_tr_b16 v[252:253], v11 offset:26080
ds_read_b64_tr_b16 v[254:255], v11 offset:26592
s_nop 5
v_max3_f32 v2, v2, v184, v185
v_max3_f32 v2, v2, v186, v187
v_max3_f32 v2, v2, v188, v189
v_max3_f32 v2, v2, v190, v191
v_cmp_lt_f32 vcc, s3, v2
s_cbranch_vccnz W2_R2
s_waitcnt lgkmcnt(14)
v_mfma_f32_16x16x32_bf16 v[20:23], v[224:227], v[200:203], v[20:23]
v_exp_f32 v176, v176
s_waitcnt lgkmcnt(12)
v_mfma_f32_16x16x32_bf16 v[28:31], v[228:231], v[200:203], v[28:31]
v_exp_f32 v177, v177
s_waitcnt lgkmcnt(10)
v_mfma_f32_16x16x32_bf16 v[36:39], v[232:235], v[200:203], v[36:39]
v_exp_f32 v178, v178
s_waitcnt lgkmcnt(8)
v_mfma_f32_16x16x32_bf16 v[44:47], v[236:239], v[200:203], v[44:47]
v_exp_f32 v179, v179
s_waitcnt lgkmcnt(6)
v_mfma_f32_16x16x32_bf16 v[52:55], v[240:243], v[200:203], v[52:55]
v_exp_f32 v184, v184
s_waitcnt lgkmcnt(4)
v_mfma_f32_16x16x32_bf16 v[60:63], v[244:247], v[200:203], v[60:63]
v_exp_f32 v185, v185
s_waitcnt lgkmcnt(2)
v_mfma_f32_16x16x32_bf16 v[68:71], v[248:251], v[200:203], v[68:71]
v_exp_f32 v186, v186
s_waitcnt lgkmcnt(0)
v_mfma_f32_16x16x32_bf16 v[76:79], v[252:255], v[200:203], v[76:79]
v_exp_f32 v187, v187
v_mfma_f32_16x16x32_bf16 v[84:87], v[16:19], v[200:203], v[84:87]
s_waitcnt vmcnt(9)
s_barrier
v_mfma_f32_16x16x32_bf16 v[24:27], v[224:227], v[204:207], v[24:27]
v_exp_f32 v180, v180
v_cvt_pk_bf16_f32 v200, v176, v177
ds_read_b128 v[224:227], v10 offset:43520
v_mfma_f32_16x16x32_bf16 v[32:35], v[228:231], v[204:207], v[32:35]
s_add_u32 m0, s27, 34816
s_add_u32 s36, s29, 49152
buffer_load_dwordx4 v12, s[12:15], s36 offen nt lds
v_exp_f32 v181, v181
ds_read_b128 v[228:231], v10 offset:43584
v_mfma_f32_16x16x32_bf16 v[40:43], v[232:235], v[204:207], v[40:43]
v_cvt_pk_bf16_f32 v201, v178, v179
s_add_u32 m0, s27, 35904
s_add_u32 s36, s29, 50176
buffer_load_dwordx4 v12, s[12:15], s36 offen nt lds
ds_read_b128 v[232:235], v10 offset:43648
v_mfma_f32_16x16x32_bf16 v[48:51], v[236:239], v[204:207], v[48:51]
v_exp_f32 v182, v182
v_cvt_pk_bf16_f32 v202, v184, v185
ds_read_b128 v[236:239], v10 offset:43712
v_mfma_f32_16x16x32_bf16 v[56:59], v[240:243], v[204:207], v[56:59]
s_add_u32 m0, s28, 25856
s_add_u32 s36, s33, 40960
buffer_load_dwordx4 v13, s[16:19], s36 offen nt lds
v_exp_f32 v183, v183
ds_read_b128 v[240:243], v10 offset:47872
v_mfma_f32_16x16x32_bf16 v[64:67], v[244:247], v[204:207], v[64:67]
v_cvt_pk_bf16_f32 v203, v186, v187
s_add_u32 m0, s28, 26912
s_add_u32 s36, s33, 41216
buffer_load_dwordx4 v13, s[16:19], s36 offen nt lds
ds_read_b128 v[244:247], v10 offset:47936
v_mfma_f32_16x16x32_bf16 v[72:75], v[248:251], v[204:207], v[72:75]
v_exp_f32 v188, v188
v_exp_f32 v189, v189
ds_read_b128 v[248:251], v10 offset:48000
v_mfma_f32_16x16x32_bf16 v[80:83], v[252:255], v[204:207], v[80:83]
v_exp_f32 v190, v190
v_exp_f32 v191, v191
ds_read_b128 v[252:255], v10 offset:48064
v_mfma_f32_16x16x32_bf16 v[88:91], v[16:19], v[204:207], v[88:91]
s_nop 0
v_cvt_pk_bf16_f32 v204, v180, v181
v_cvt_pk_bf16_f32 v205, v182, v183
v_cvt_pk_bf16_f32 v206, v188, v189
v_cvt_pk_bf16_f32 v207, v190, v191
W2_R2_back:
s_waitcnt lgkmcnt(7)
v_mfma_f32_16x16x32_bf16 v[176:179], v[224:227], v[128:131], v[212:215]
v_mfma_f32_16x16x32_bf16 v[180:183], v[224:227], v[144:147], v[216:219]
s_waitcnt lgkmcnt(6)
v_mfma_f32_16x16x32_bf16 v[176:179], v[228:231], v[132:135], v[176:179]
ds_read_b64_tr_b16 v[224:225], v11 offset:52224
v_mfma_f32_16x16x32_bf16 v[180:183], v[228:231], v[148:151], v[180:183]
ds_read_b64_tr_b16 v[226:227], v11 offset:52736
s_waitcnt lgkmcnt(7)
v_mfma_f32_16x16x32_bf16 v[176:179], v[232:235], v[136:139], v[176:179]
ds_read_b64_tr_b16 v[228:229], v11 offset:52256
v_mfma_f32_16x16x32_bf16 v[180:183], v[232:235], v[152:155], v[180:183]
ds_read_b64_tr_b16 v[230:231], v11 offset:52768
s_waitcnt lgkmcnt(8)
v_mfma_f32_16x16x32_bf16 v[176:179], v[236:239], v[140:143], v[176:179]
ds_read_b64_tr_b16 v[232:233], v11 offset:52288
v_mfma_f32_16x16x32_bf16 v[180:183], v[236:239], v[156:159], v[180:183]
ds_read_b64_tr_b16 v[234:235], v11 offset:52800
s_waitcnt lgkmcnt(9)
v_mfma_f32_16x16x32_bf16 v[184:187], v[240:243], v[128:131], v[212:215]
ds_read_b64_tr_b16 v[236:237], v11 offset:52320
v_mfma_f32_16x16x32_bf16 v[188:191], v[240:243], v[144:147], v[216:219]
ds_read_b64_tr_b16 v[238:239], v11 offset:52832
s_waitcnt lgkmcnt(10)
v_mfma_f32_16x16x32_bf16 v[184:187], v[244:247], v[132:135], v[184:187]
ds_read_b64_tr_b16 v[240:241], v11 offset:52352
v_mfma_f32_16x16x32_bf16 v[188:191], v[244:247], v[148:151], v[188:191]
ds_read_b64_tr_b16 v[242:243], v11 offset:52864
s_waitcnt lgkmcnt(11)
v_mfma_f32_16x16x32_bf16 v[184:187], v[248:251], v[136:139], v[184:187]
ds_read_b64_tr_b16 v[244:245], v11 offset:52384
ds_read_b64_tr_b16 v[246:247], v11 offset:52896
v_mfma_f32_16x16x32_bf16 v[188:191], v[248:251], v[152:155], v[188:191]
v_max3_f32 v2, v176, v177, v178
v_max_f32 v2, v2, v179
s_waitcnt lgkmcnt(12)
v_mfma_f32_16x16x32_bf16 v[184:187], v[252:255], v[140:143], v[184:187]
ds_read_b64_tr_b16 v[248:249], v11 offset:52416
ds_read_b64_tr_b16 v[250:251], v11 offset:52928
v_mfma_f32_16x16x32_bf16 v[188:191], v[252:255], v[156:159], v[188:191]
v_max3_f32 v2, v2, v180, v181
v_max3_f32 v2, v2, v182, v183
ds_read_b64_tr_b16 v[252:253], v11 offset:52448
ds_read_b64_tr_b16 v[254:255], v11 offset:52960
s_nop 5
v_max3_f32 v2, v2, v184, v185
v_max3_f32 v2, v2, v186, v187
v_max3_f32 v2, v2, v188, v189
v_max3_f32 v2, v2, v190, v191
v_cmp_lt_f32 vcc, s3, v2
s_cbranch_vccnz W2_R3
s_waitcnt lgkmcnt(14)
v_mfma_f32_16x16x32_bf16 v[20:23], v[224:227], v[200:203], v[20:23]
v_exp_f32 v176, v176
s_waitcnt lgkmcnt(12)
v_mfma_f32_16x16x32_bf16 v[28:31], v[228:231], v[200:203], v[28:31]
v_exp_f32 v177, v177
s_waitcnt lgkmcnt(10)
v_mfma_f32_16x16x32_bf16 v[36:39], v[232:235], v[200:203], v[36:39]
v_exp_f32 v178, v178
s_waitcnt lgkmcnt(8)
v_mfma_f32_16x16x32_bf16 v[44:47], v[236:239], v[200:203], v[44:47]
v_exp_f32 v179, v179
s_waitcnt lgkmcnt(6)
v_mfma_f32_16x16x32_bf16 v[52:55], v[240:243], v[200:203], v[52:55]
v_exp_f32 v184, v184
s_waitcnt lgkmcnt(4)
v_mfma_f32_16x16x32_bf16 v[60:63], v[244:247], v[200:203], v[60:63]
v_exp_f32 v185, v185
s_waitcnt lgkmcnt(2)
v_mfma_f32_16x16x32_bf16 v[68:71], v[248:251], v[200:203], v[68:71]
v_exp_f32 v186, v186
s_waitcnt lgkmcnt(0)
v_mfma_f32_16x16x32_bf16 v[76:79], v[252:255], v[200:203], v[76:79]
v_exp_f32 v187, v187
v_mfma_f32_16x16x32_bf16 v[84:87], v[16:19], v[200:203], v[84:87]
s_waitcnt vmcnt(9)
s_barrier
v_mfma_f32_16x16x32_bf16 v[24:27], v[224:227], v[204:207], v[24:27]
v_exp_f32 v180, v180
v_cvt_pk_bf16_f32 v200, v176, v177
ds_read_b128 v[224:227], v10 offset:0
v_mfma_f32_16x16x32_bf16 v[32:35], v[228:231], v[204:207], v[32:35]
s_add_u32 m0, s27, 43520
s_add_u32 s36, s29, 57344
buffer_load_dwordx4 v12, s[12:15], s36 offen nt lds
v_exp_f32 v181, v181
ds_read_b128 v[228:231], v10 offset:64
v_mfma_f32_16x16x32_bf16 v[40:43], v[232:235], v[204:207], v[40:43]
v_cvt_pk_bf16_f32 v201, v178, v179
s_add_u32 m0, s27, 44608
s_add_u32 s36, s29, 58368
buffer_load_dwordx4 v12, s[12:15], s36 offen nt lds
ds_read_b128 v[232:235], v10 offset:128
v_mfma_f32_16x16x32_bf16 v[48:51], v[236:239], v[204:207], v[48:51]
v_exp_f32 v182, v182
v_cvt_pk_bf16_f32 v202, v184, v185
ds_read_b128 v[236:239], v10 offset:192
v_mfma_f32_16x16x32_bf16 v[56:59], v[240:243], v[204:207], v[56:59]
s_add_u32 m0, s28, 52224
s_add_u32 s36, s33, 49152
buffer_load_dwordx4 v13, s[16:19], s36 offen nt lds
v_exp_f32 v183, v183
ds_read_b128 v[240:243], v10 offset:4352
v_mfma_f32_16x16x32_bf16 v[64:67], v[244:247], v[204:207], v[64:67]
v_cvt_pk_bf16_f32 v203, v186, v187
s_add_u32 m0, s28, 53280
s_add_u32 s36, s33, 49408
buffer_load_dwordx4 v13, s[16:19], s36 offen nt lds
ds_read_b128 v[244:247], v10 offset:4416
v_mfma_f32_16x16x32_bf16 v[72:75], v[248:251], v[204:207], v[72:75]
v_exp_f32 v188, v188
v_exp_f32 v189, v189
ds_read_b128 v[248:251], v10 offset:4480
v_mfma_f32_16x16x32_bf16 v[80:83], v[252:255], v[204:207], v[80:83]
v_exp_f32 v190, v190
v_exp_f32 v191, v191
ds_read_b128 v[252:255], v10 offset:4544
v_mfma_f32_16x16x32_bf16 v[88:91], v[16:19], v[204:207], v[88:91]
s_nop 0
v_cvt_pk_bf16_f32 v204, v180, v181
v_cvt_pk_bf16_f32 v205, v182, v183
v_cvt_pk_bf16_f32 v206, v188, v189
v_cvt_pk_bf16_f32 v207, v190, v191
W2_R3_back:
s_waitcnt lgkmcnt(7)
v_mfma_f32_16x16x32_bf16 v[176:179], v[224:227], v[128:131], v[212:215]
v_mfma_f32_16x16x32_bf16 v[180:183], v[224:227], v[144:147], v[216:219]
s_waitcnt lgkmcnt(6)
v_mfma_f32_16x16x32_bf16 v[176:179], v[228:231], v[132:135], v[176:179]
ds_read_b64_tr_b16 v[224:225], v11 offset:60672
v_mfma_f32_16x16x32_bf16 v[180:183], v[228:231], v[148:151], v[180:183]
ds_read_b64_tr_b16 v[226:227], v11 offset:61184
s_waitcnt lgkmcnt(7)
v_mfma_f32_16x16x32_bf16 v[176:179], v[232:235], v[136:139], v[176:179]
ds_read_b64_tr_b16 v[228:229], v11 offset:60704
v_mfma_f32_16x16x32_bf16 v[180:183], v[232:235], v[152:155], v[180:183]
ds_read_b64_tr_b16 v[230:231], v11 offset:61216
s_waitcnt lgkmcnt(8)
v_mfma_f32_16x16x32_bf16 v[176:179], v[236:239], v[140:143], v[176:179]
ds_read_b64_tr_b16 v[232:233], v11 offset:60736
v_mfma_f32_16x16x32_bf16 v[180:183], v[236:239], v[156:159], v[180:183]
ds_read_b64_tr_b16 v[234:235], v11 offset:61248
s_waitcnt lgkmcnt(9)
v_mfma_f32_16x16x32_bf16 v[184:187], v[240:243], v[128:131], v[212:215]
ds_read_b64_tr_b16 v[236:237], v11 offset:60768
v_mfma_f32_16x16x32_bf16 v[188:191], v[240:243], v[144:147], v[216:219]
ds_read_b64_tr_b16 v[238:239], v11 offset:61280
s_waitcnt lgkmcnt(10)
v_mfma_f32_16x16x32_bf16 v[184:187], v[244:247], v[132:135], v[184:187]
ds_read_b64_tr_b16 v[240:241], v11 offset:60800
v_mfma_f32_16x16x32_bf16 v[188:191], v[244:247], v[148:151], v[188:191]
ds_read_b64_tr_b16 v[242:243], v11 offset:61312
s_waitcnt lgkmcnt(11)
v_mfma_f32_16x16x32_bf16 v[184:187], v[248:251], v[136:139], v[184:187]
ds_read_b64_tr_b16 v[244:245], v11 offset:60832
ds_read_b64_tr_b16 v[246:247], v11 offset:61344
v_mfma_f32_16x16x32_bf16 v[188:191], v[248:251], v[152:155], v[188:191]
v_max3_f32 v2, v176, v177, v178
v_max_f32 v2, v2, v179
s_waitcnt lgkmcnt(12)
v_mfma_f32_16x16x32_bf16 v[184:187], v[252:255], v[140:143], v[184:187]
ds_read_b64_tr_b16 v[248:249], v11 offset:60864
ds_read_b64_tr_b16 v[250:251], v11 offset:61376
v_mfma_f32_16x16x32_bf16 v[188:191], v[252:255], v[156:159], v[188:191]
v_max3_f32 v2, v2, v180, v181
v_max3_f32 v2, v2, v182, v183
ds_read_b64_tr_b16 v[252:253], v11 offset:60896
ds_read_b64_tr_b16 v[254:255], v11 offset:61408
s_nop 5
v_max3_f32 v2, v2, v184, v185
v_max3_f32 v2, v2, v186, v187
v_max3_f32 v2, v2, v188, v189
v_max3_f32 v2, v2, v190, v191
v_cmp_lt_f32 vcc, s3, v2
s_cbranch_vccnz W2_R4
s_waitcnt lgkmcnt(14)
v_mfma_f32_16x16x32_bf16 v[20:23], v[224:227], v[200:203], v[20:23]
v_exp_f32 v176, v176
s_waitcnt lgkmcnt(12)
v_mfma_f32_16x16x32_bf16 v[28:31], v[228:231], v[200:203], v[28:31]
v_exp_f32 v177, v177
s_waitcnt lgkmcnt(10)
v_mfma_f32_16x16x32_bf16 v[36:39], v[232:235], v[200:203], v[36:39]
v_exp_f32 v178, v178
s_waitcnt lgkmcnt(8)
v_mfma_f32_16x16x32_bf16 v[44:47], v[236:239], v[200:203], v[44:47]
v_exp_f32 v179, v179
s_waitcnt lgkmcnt(6)
v_mfma_f32_16x16x32_bf16 v[52:55], v[240:243], v[200:203], v[52:55]
v_exp_f32 v184, v184
s_waitcnt lgkmcnt(4)
v_mfma_f32_16x16x32_bf16 v[60:63], v[244:247], v[200:203], v[60:63]
v_exp_f32 v185, v185
s_waitcnt lgkmcnt(2)
v_mfma_f32_16x16x32_bf16 v[68:71], v[248:251], v[200:203], v[68:71]
v_exp_f32 v186, v186
s_waitcnt lgkmcnt(0)
v_mfma_f32_16x16x32_bf16 v[76:79], v[252:255], v[200:203], v[76:79]
v_exp_f32 v187, v187
v_mfma_f32_16x16x32_bf16 v[84:87], v[16:19], v[200:203], v[84:87]
s_waitcnt vmcnt(9)
s_barrier
v_mfma_f32_16x16x32_bf16 v[24:27], v[224:227], v[204:207], v[24:27]
v_exp_f32 v180, v180
v_cvt_pk_bf16_f32 v200, v176, v177
ds_read_b128 v[224:227], v10 offset:8704
v_mfma_f32_16x16x32_bf16 v[32:35], v[228:231], v[204:207], v[32:35]
s_add_u32 m0, s27, 0
s_add_u32 s36, s29, 65536
buffer_load_dwordx4 v12, s[12:15], s36 offen nt lds
v_exp_f32 v181, v181
ds_read_b128 v[228:231], v10 offset:8768
v_mfma_f32_16x16x32_bf16 v[40:43], v[232:235], v[204:207], v[40:43]
v_cvt_pk_bf16_f32 v201, v178, v179
s_add_u32 m0, s27, 1088
s_add_u32 s36, s29, 66560
buffer_load_dwordx4 v12, s[12:15], s36 offen nt lds
ds_read_b128 v[232:235], v10 offset:8832
v_mfma_f32_16x16x32_bf16 v[48:51], v[236:239], v[204:207], v[48:51]
v_exp_f32 v182, v182
v_cvt_pk_bf16_f32 v202, v184, v185
ds_read_b128 v[236:239], v10 offset:8896
v_mfma_f32_16x16x32_bf16 v[56:59], v[240:243], v[204:207], v[56:59]
s_add_u32 m0, s28, 60672
s_add_u32 s36, s33, 57344
buffer_load_dwordx4 v13, s[16:19], s36 offen nt lds
v_exp_f32 v183, v183
ds_read_b128 v[240:243], v10 offset:13056
v_mfma_f32_16x16x32_bf16 v[64:67], v[244:247], v[204:207], v[64:67]
v_cvt_pk_bf16_f32 v203, v186, v187
s_add_u32 m0, s28, 61728
s_add_u32 s36, s33, 57600
buffer_load_dwordx4 v13, s[16:19], s36 offen nt lds
ds_read_b128 v[244:247], v10 offset:13120
v_mfma_f32_16x16x32_bf16 v[72:75], v[248:251], v[204:207], v[72:75]
v_exp_f32 v188, v188
v_exp_f32 v189, v189
ds_read_b128 v[248:251], v10 offset:13184
v_mfma_f32_16x16x32_bf16 v[80:83], v[252:255], v[204:207], v[80:83]
v_exp_f32 v190, v190
v_exp_f32 v191, v191
ds_read_b128 v[252:255], v10 offset:13248
v_mfma_f32_16x16x32_bf16 v[88:91], v[16:19], v[204:207], v[88:91]
s_nop 0
v_cvt_pk_bf16_f32 v204, v180, v181
v_cvt_pk_bf16_f32 v205, v182, v183
v_cvt_pk_bf16_f32 v206, v188, v189
v_cvt_pk_bf16_f32 v207, v190, v191
W2_R4_back:
s_waitcnt lgkmcnt(7)
v_mfma_f32_16x16x32_bf16 v[176:179], v[224:227], v[128:131], v[212:215]
v_mfma_f32_16x16x32_bf16 v[180:183], v[224:227], v[144:147], v[216:219]
s_waitcnt lgkmcnt(6)
v_mfma_f32_16x16x32_bf16 v[176:179], v[228:231], v[132:135], v[176:179]
ds_read_b64_tr_b16 v[224:225], v11 offset:17408
v_mfma_f32_16x16x32_bf16 v[180:183], v[228:231], v[148:151], v[180:183]
ds_read_b64_tr_b16 v[226:227], v11 offset:17920
s_waitcnt lgkmcnt(7)
v_mfma_f32_16x16x32_bf16 v[176:179], v[232:235], v[136:139], v[176:179]
ds_read_b64_tr_b16 v[228:229], v11 offset:17440
v_mfma_f32_16x16x32_bf16 v[180:183], v[232:235], v[152:155], v[180:183]
ds_read_b64_tr_b16 v[230:231], v11 offset:17952
s_waitcnt lgkmcnt(8)
v_mfma_f32_16x16x32_bf16 v[176:179], v[236:239], v[140:143], v[176:179]
ds_read_b64_tr_b16 v[232:233], v11 offset:17472
v_mfma_f32_16x16x32_bf16 v[180:183], v[236:239], v[156:159], v[180:183]
ds_read_b64_tr_b16 v[234:235], v11 offset:17984
s_waitcnt lgkmcnt(9)
v_mfma_f32_16x16x32_bf16 v[184:187], v[240:243], v[128:131], v[212:215]
ds_read_b64_tr_b16 v[236:237], v11 offset:17504
v_mfma_f32_16x16x32_bf16 v[188:191], v[240:243], v[144:147], v[216:219]
ds_read_b64_tr_b16 v[238:239], v11 offset:18016
s_waitcnt lgkmcnt(10)
v_mfma_f32_16x16x32_bf16 v[184:187], v[244:247], v[132:135], v[184:187]
ds_read_b64_tr_b16 v[240:241], v11 offset:17536
v_mfma_f32_16x16x32_bf16 v[188:191], v[244:247], v[148:151], v[188:191]
ds_read_b64_tr_b16 v[242:243], v11 offset:18048
s_waitcnt lgkmcnt(11)
v_mfma_f32_16x16x32_bf16 v[184:187], v[248:251], v[136:139], v[184:187]
ds_read_b64_tr_b16 v[244:245], v11 offset:17568
ds_read_b64_tr_b16 v[246:247], v11 offset:18080
v_mfma_f32_16x16x32_bf16 v[188:191], v[248:251], v[152:155], v[188:191]
v_max3_f32 v2, v176, v177, v178
v_max_f32 v2, v2, v179
s_waitcnt lgkmcnt(12)
v_mfma_f32_16x16x32_bf16 v[184:187], v[252:255], v[140:143], v[184:187]
ds_read_b64_tr_b16 v[248:249], v11 offset:17600
ds_read_b64_tr_b16 v[250:251], v11 offset:18112
v_mfma_f32_16x16x32_bf16 v[188:191], v[252:255], v[156:159], v[188:191]
v_max3_f32 v2, v2, v180, v181
v_max3_f32 v2, v2, v182, v183
ds_read_b64_tr_b16 v[252:253], v11 offset:17632
ds_read_b64_tr_b16 v[254:255], v11 offset:18144
s_nop 5
v_max3_f32 v2, v2, v184, v185
v_max3_f32 v2, v2, v186, v187
v_max3_f32 v2, v2, v188, v189
v_max3_f32 v2, v2, v190, v191
v_cmp_lt_f32 vcc, s3, v2
s_cbranch_vccnz W2_R5
s_waitcnt lgkmcnt(14)
v_mfma_f32_16x16x32_bf16 v[20:23], v[224:227], v[200:203], v[20:23]
v_exp_f32 v176, v176
s_waitcnt lgkmcnt(12)
v_mfma_f32_16x16x32_bf16 v[28:31], v[228:231], v[200:203], v[28:31]
v_exp_f32 v177, v177
s_waitcnt lgkmcnt(10)
v_mfma_f32_16x16x32_bf16 v[36:39], v[232:235], v[200:203], v[36:39]
v_exp_f32 v178, v178
s_waitcnt lgkmcnt(8)
v_mfma_f32_16x16x32_bf16 v[44:47], v[236:239], v[200:203], v[44:47]
v_exp_f32 v179, v179
s_waitcnt lgkmcnt(6)
v_mfma_f32_16x16x32_bf16 v[52:55], v[240:243], v[200:203], v[52:55]
v_exp_f32 v184, v184
s_waitcnt lgkmcnt(4)
v_mfma_f32_16x16x32_bf16 v[60:63], v[244:247], v[200:203], v[60:63]
v_exp_f32 v185, v185
s_waitcnt lgkmcnt(2)
v_mfma_f32_16x16x32_bf16 v[68:71], v[248:251], v[200:203], v[68:71]
v_exp_f32 v186, v186
s_waitcnt lgkmcnt(0)
v_mfma_f32_16x16x32_bf16 v[76:79], v[252:255], v[200:203], v[76:79]
v_exp_f32 v187, v187
v_mfma_f32_16x16x32_bf16 v[84:87], v[16:19], v[200:203], v[84:87]
s_waitcnt vmcnt(8)
s_barrier
v_mfma_f32_16x16x32_bf16 v[24:27], v[224:227], v[204:207], v[24:27]
v_exp_f32 v180, v180
v_cvt_pk_bf16_f32 v200, v176, v177
ds_read_b128 v[224:227], v10 offset:34816
v_mfma_f32_16x16x32_bf16 v[32:35], v[228:231], v[204:207], v[32:35]
s_add_u32 m0, s27, 8704
s_add_u32 s36, s29, 73728
buffer_load_dwordx4 v12, s[12:15], s36 offen nt lds
v_exp_f32 v181, v181
ds_read_b128 v[228:231], v10 offset:34880
v_mfma_f32_16x16x32_bf16 v[40:43], v[232:235], v[204:207], v[40:43]
v_cvt_pk_bf16_f32 v201, v178, v179
s_add_u32 m0, s27, 9792
s_add_u32 s36, s29, 74752
buffer_load_dwordx4 v12, s[12:15], s36 offen nt lds
ds_read_b128 v[232:235], v10 offset:34944
v_mfma_f32_16x16x32_bf16 v[48:51], v[236:239], v[204:207], v[48:51]
v_exp_f32 v182, v182
v_cvt_pk_bf16_f32 v202, v184, v185
ds_read_b128 v[236:239], v10 offset:35008
v_mfma_f32_16x16x32_bf16 v[56:59], v[240:243], v[204:207], v[56:59]
s_add_u32 m0, s28, 17408
s_add_u32 s36, s33, 65536
buffer_load_dwordx4 v13, s[16:19], s36 offen nt lds
v_exp_f32 v183, v183
ds_read_b128 v[240:243], v10 offset:39168
v_mfma_f32_16x16x32_bf16 v[64:67], v[244:247], v[204:207], v[64:67]
v_cvt_pk_bf16_f32 v203, v186, v187
s_add_u32 m0, s28, 18464
s_add_u32 s36, s33, 65792
buffer_load_dwordx4 v13, s[16:19], s36 offen nt lds
ds_read_b128 v[244:247], v10 offset:39232
v_mfma_f32_16x16x32_bf16 v[72:75], v[248:251], v[204:207], v[72:75]
v_exp_f32 v188, v188
v_exp_f32 v189, v189
ds_read_b128 v[248:251], v10 offset:39296
v_mfma_f32_16x16x32_bf16 v[80:83], v[252:255], v[204:207], v[80:83]
v_exp_f32 v190, v190
v_exp_f32 v191, v191
ds_read_b128 v[252:255], v10 offset:39360
v_mfma_f32_16x16x32_bf16 v[88:91], v[16:19], v[204:207], v[88:91]
s_nop 0
v_cvt_pk_bf16_f32 v204, v180, v181
v_cvt_pk_bf16_f32 v205, v182, v183
v_cvt_pk_bf16_f32 v206, v188, v189
v_cvt_pk_bf16_f32 v207, v190, v191
W2_R5_back:
s_waitcnt lgkmcnt(7)
v_mfma_f32_16x16x32_bf16 v[176:179], v[224:227], v[128:131], v[212:215]
v_mfma_f32_16x16x32_bf16 v[180:183], v[224:227], v[144:147], v[216:219]
s_waitcnt lgkmcnt(6)
v_mfma_f32_16x16x32_bf16 v[176:179], v[228:231], v[132:135], v[176:179]
ds_read_b64_tr_b16 v[224:225], v11 offset:25856
v_mfma_f32_16x16x32_bf16 v[180:183], v[228:231], v[148:151], v[180:183]
ds_read_b64_tr_b16 v[226:227], v11 offset:26368
s_waitcnt lgkmcnt(7)
v_mfma_f32_16x16x32_bf16 v[176:179], v[232:235], v[136:139], v[176:179]
ds_read_b64_tr_b16 v[228:229], v11 offset:25888
v_mfma_f32_16x16x32_bf16 v[180:183], v[232:235], v[152:155], v[180:183]
ds_read_b64_tr_b16 v[230:231], v11 offset:26400
s_waitcnt lgkmcnt(8)
v_mfma_f32_16x16x32_bf16 v[176:179], v[236:239], v[140:143], v[176:179]
ds_read_b64_tr_b16 v[232:233], v11 offset:25920
v_mfma_f32_16x16x32_bf16 v[180:183], v[236:239], v[156:159], v[180:183]
ds_read_b64_tr_b16 v[234:235], v11 offset:26432
s_waitcnt lgkmcnt(9)
v_mfma_f32_16x16x32_bf16 v[184:187], v[240:243], v[128:131], v[212:215]
ds_read_b64_tr_b16 v[236:237], v11 offset:25952
v_mfma_f32_16x16x32_bf16 v[188:191], v[240:243], v[144:147], v[216:219]
ds_read_b64_tr_b16 v[238:239], v11 offset:26464
s_waitcnt lgkmcnt(10)
v_mfma_f32_16x16x32_bf16 v[184:187], v[244:247], v[132:135], v[184:187]
ds_read_b64_tr_b16 v[240:241], v11 offset:25984
v_mfma_f32_16x16x32_bf16 v[188:191], v[244:247], v[148:151], v[188:191]
ds_read_b64_tr_b16 v[242:243], v11 offset:26496
s_waitcnt lgkmcnt(11)
v_mfma_f32_16x16x32_bf16 v[184:187], v[248:251], v[136:139], v[184:187]
ds_read_b64_tr_b16 v[244:245], v11 offset:26016
ds_read_b64_tr_b16 v[246:247], v11 offset:26528
v_mfma_f32_16x16x32_bf16 v[188:191], v[248:251], v[152:155], v[188:191]
v_max3_f32 v2, v176, v177, v178
v_max_f32 v2, v2, v179
s_waitcnt lgkmcnt(12)
v_mfma_f32_16x16x32_bf16 v[184:187], v[252:255], v[140:143], v[184:187]
ds_read_b64_tr_b16 v[248:249], v11 offset:26048
ds_read_b64_tr_b16 v[250:251], v11 offset:26560
v_mfma_f32_16x16x32_bf16 v[188:191], v[252:255], v[156:159], v[188:191]
v_max3_f32 v2, v2, v180, v181
v_max3_f32 v2, v2, v182, v183
ds_read_b64_tr_b16 v[252:253], v11 offset:26080
ds_read_b64_tr_b16 v[254:255], v11 offset:26592
s_nop 5
v_max3_f32 v2, v2, v184, v185
v_max3_f32 v2, v2, v186, v187
v_max3_f32 v2, v2, v188, v189
v_max3_f32 v2, v2, v190, v191
v_cmp_lt_f32 vcc, s3, v2
s_cbranch_vccnz W2_R6
s_waitcnt lgkmcnt(14)
v_mfma_f32_16x16x32_bf16 v[20:23], v[224:227], v[200:203], v[20:23]
v_exp_f32 v176, v176
s_waitcnt lgkmcnt(12)
v_mfma_f32_16x16x32_bf16 v[28:31], v[228:231], v[200:203], v[28:31]
v_exp_f32 v177, v177
s_waitcnt lgkmcnt(10)
v_mfma_f32_16x16x32_bf16 v[36:39], v[232:235], v[200:203], v[36:39]
v_exp_f32 v178, v178
s_waitcnt lgkmcnt(8)
v_mfma_f32_16x16x32_bf16 v[44:47], v[236:239], v[200:203], v[44:47]
v_exp_f32 v179, v179
s_waitcnt lgkmcnt(6)
v_mfma_f32_16x16x32_bf16 v[52:55], v[240:243], v[200:203], v[52:55]
v_exp_f32 v184, v184
s_waitcnt lgkmcnt(4)
v_mfma_f32_16x16x32_bf16 v[60:63], v[244:247], v[200:203], v[60:63]
v_exp_f32 v185, v185
s_waitcnt lgkmcnt(2)
v_mfma_f32_16x16x32_bf16 v[68:71], v[248:251], v[200:203], v[68:71]
v_exp_f32 v186, v186
s_waitcnt lgkmcnt(0)
v_mfma_f32_16x16x32_bf16 v[76:79], v[252:255], v[200:203], v[76:79]
v_exp_f32 v187, v187
v_mfma_f32_16x16x32_bf16 v[84:87], v[16:19], v[200:203], v[84:87]
s_waitcnt vmcnt(8)
s_barrier
v_mfma_f32_16x16x32_bf16 v[24:27], v[224:227], v[204:207], v[24:27]
v_exp_f32 v180, v180
v_cvt_pk_bf16_f32 v200, v176, v177
ds_read_b128 v[224:227], v10 offset:43520
v_mfma_f32_16x16x32_bf16 v[32:35], v[228:231], v[204:207], v[32:35]
s_add_u32 m0, s27, 34816
s_add_u32 s36, s29, 81920
buffer_load_dwordx4 v12, s[12:15], s36 offen nt lds
v_exp_f32 v181, v181
ds_read_b128 v[228:231], v10 offset:43584
v_mfma_f32_16x16x32_bf16 v[40:43], v[232:235], v[204:207], v[40:43]
v_cvt_pk_bf16_f32 v201, v178, v179
s_add_u32 m0, s27, 35904
s_add_u32 s36, s29, 82944
buffer_load_dwordx4 v12, s[12:15], s36 offen nt lds
ds_read_b128 v[232:235], v10 offset:43648
v_mfma_f32_16x16x32_bf16 v[48:51], v[236:239], v[204:207], v[48:51]
v_exp_f32 v182, v182
v_cvt_pk_bf16_f32 v202, v184, v185
ds_read_b128 v[236:239], v10 offset:43712
v_mfma_f32_16x16x32_bf16 v[56:59], v[240:243], v[204:207], v[56:59]
s_add_u32 m0, s28, 25856
s_add_u32 s36, s33, 73728
buffer_load_dwordx4 v13, s[16:19], s36 offen nt lds
v_exp_f32 v183, v183
ds_read_b128 v[240:243], v10 offset:47872
v_mfma_f32_16x16x32_bf16 v[64:67], v[244:247], v[204:207], v[64:67]
v_cvt_pk_bf16_f32 v203, v186, v187
s_add_u32 m0, s28, 26912
s_add_u32 s36, s33, 73984
buffer_load_dwordx4 v13, s[16:19], s36 offen nt lds
ds_read_b128 v[244:247], v10 offset:47936
v_mfma_f32_16x16x32_bf16 v[72:75], v[248:251], v[204:207], v[72:75]
v_exp_f32 v188, v188
v_exp_f32 v189, v189
ds_read_b128 v[248:251], v10 offset:48000
v_mfma_f32_16x16x32_bf16 v[80:83], v[252:255], v[204:207], v[80:83]
v_exp_f32 v190, v190
v_exp_f32 v191, v191
ds_read_b128 v[252:255], v10 offset:48064
v_mfma_f32_16x16x32_bf16 v[88:91], v[16:19], v[204:207], v[88:91]
s_nop 0
v_cvt_pk_bf16_f32 v204, v180, v181
v_cvt_pk_bf16_f32 v205, v182, v183
v_cvt_pk_bf16_f32 v206, v188, v189
v_cvt_pk_bf16_f32 v207, v190, v191
W2_R6_back:
s_waitcnt lgkmcnt(7)
v_mfma_f32_16x16x32_bf16 v[176:179], v[224:227], v[128:131], v[212:215]
v_mfma_f32_16x16x32_bf16 v[180:183], v[224:227], v[144:147], v[216:219]
s_waitcnt lgkmcnt(6)
v_mfma_f32_16x16x32_bf16 v[176:179], v[228:231], v[132:135], v[176:179]
ds_read_b64_tr_b16 v[224:225], v11 offset:52224
v_mfma_f32_16x16x32_bf16 v[180:183], v[228:231], v[148:151], v[180:183]
ds_read_b64_tr_b16 v[226:227], v11 offset:52736
s_waitcnt lgkmcnt(7)
v_mfma_f32_16x16x32_bf16 v[176:179], v[232:235], v[136:139], v[176:179]
ds_read_b64_tr_b16 v[228:229], v11 offset:52256
v_mfma_f32_16x16x32_bf16 v[180:183], v[232:235], v[152:155], v[180:183]
ds_read_b64_tr_b16 v[230:231], v11 offset:52768
s_waitcnt lgkmcnt(8)
v_mfma_f32_16x16x32_bf16 v[176:179], v[236:239], v[140:143], v[176:179]
ds_read_b64_tr_b16 v[232:233], v11 offset:52288
v_mfma_f32_16x16x32_bf16 v[180:183], v[236:239], v[156:159], v[180:183]
ds_read_b64_tr_b16 v[234:235], v11 offset:52800
s_waitcnt lgkmcnt(9)
v_mfma_f32_16x16x32_bf16 v[184:187], v[240:243], v[128:131], v[212:215]
ds_read_b64_tr_b16 v[236:237], v11 offset:52320
v_mfma_f32_16x16x32_bf16 v[188:191], v[240:243], v[144:147], v[216:219]
ds_read_b64_tr_b16 v[238:239], v11 offset:52832
s_waitcnt lgkmcnt(10)
v_mfma_f32_16x16x32_bf16 v[184:187], v[244:247], v[132:135], v[184:187]
ds_read_b64_tr_b16 v[240:241], v11 offset:52352
v_mfma_f32_16x16x32_bf16 v[188:191], v[244:247], v[148:151], v[188:191]
ds_read_b64_tr_b16 v[242:243], v11 offset:52864
s_waitcnt lgkmcnt(11)
v_mfma_f32_16x16x32_bf16 v[184:187], v[248:251], v[136:139], v[184:187]
ds_read_b64_tr_b16 v[244:245], v11 offset:52384
ds_read_b64_tr_b16 v[246:247], v11 offset:52896
v_mfma_f32_16x16x32_bf16 v[188:191], v[248:251], v[152:155], v[188:191]
v_max3_f32 v2, v176, v177, v178
v_max_f32 v2, v2, v179
s_waitcnt lgkmcnt(12)
v_mfma_f32_16x16x32_bf16 v[184:187], v[252:255], v[140:143], v[184:187]
ds_read_b64_tr_b16 v[248:249], v11 offset:52416
ds_read_b64_tr_b16 v[250:251], v11 offset:52928
v_mfma_f32_16x16x32_bf16 v[188:191], v[252:255], v[156:159], v[188:191]
v_max3_f32 v2, v2, v180, v181
v_max3_f32 v2, v2, v182, v183
ds_read_b64_tr_b16 v[252:253], v11 offset:52448
ds_read_b64_tr_b16 v[254:255], v11 offset:52960
s_nop 5
v_max3_f32 v2, v2, v184, v185
v_max3_f32 v2, v2, v186, v187
v_max3_f32 v2, v2, v188, v189
v_max3_f32 v2, v2, v190, v191
v_cmp_lt_f32 vcc, s3, v2
s_cbranch_vccnz W2_R7
s_waitcnt lgkmcnt(14)
v_mfma_f32_16x16x32_bf16 v[20:23], v[224:227], v[200:203], v[20:23]
v_exp_f32 v176, v176
s_waitcnt lgkmcnt(12)
v_mfma_f32_16x16x32_bf16 v[28:31], v[228:231], v[200:203], v[28:31]
v_exp_f32 v177, v177
s_waitcnt lgkmcnt(10)
v_mfma_f32_16x16x32_bf16 v[36:39], v[232:235], v[200:203], v[36:39]
v_exp_f32 v178, v178
s_waitcnt lgkmcnt(8)
v_mfma_f32_16x16x32_bf16 v[44:47], v[236:239], v[200:203], v[44:47]
v_exp_f32 v179, v179
s_waitcnt lgkmcnt(6)
v_mfma_f32_16x16x32_bf16 v[52:55], v[240:243], v[200:203], v[52:55]
v_exp_f32 v184, v184
s_waitcnt lgkmcnt(4)
v_mfma_f32_16x16x32_bf16 v[60:63], v[244:247], v[200:203], v[60:63]
v_exp_f32 v185, v185
s_waitcnt lgkmcnt(2)
v_mfma_f32_16x16x32_bf16 v[68:71], v[248:251], v[200:203], v[68:71]
v_exp_f32 v186, v186
s_waitcnt lgkmcnt(0)
v_mfma_f32_16x16x32_bf16 v[76:79], v[252:255], v[200:203], v[76:79]
v_exp_f32 v187, v187
v_mfma_f32_16x16x32_bf16 v[84:87], v[16:19], v[200:203], v[84:87]
s_waitcnt vmcnt(8)
s_barrier
v_mfma_f32_16x16x32_bf16 v[24:27], v[224:227], v[204:207], v[24:27]
v_exp_f32 v180, v180
v_cvt_pk_bf16_f32 v200, v176, v177
ds_read_b128 v[224:227], v10 offset:0
v_mfma_f32_16x16x32_bf16 v[32:35], v[228:231], v[204:207], v[32:35]
s_add_u32 m0, s27, 43520
s_add_u32 s36, s29, 90112
buffer_load_dwordx4 v12, s[12:15], s36 offen nt lds
v_exp_f32 v181, v181
ds_read_b128 v[228:231], v10 offset:64
v_mfma_f32_16x16x32_bf16 v[40:43], v[232:235], v[204:207], v[40:43]
v_cvt_pk_bf16_f32 v201, v178, v179
s_add_u32 m0, s27, 44608
s_add_u32 s36, s29, 91136
buffer_load_dwordx4 v12, s[12:15], s36 offen nt lds
ds_read_b128 v[232:235], v10 offset:128
v_mfma_f32_16x16x32_bf16 v[48:51], v[236:239], v[204:207], v[48:51]
v_exp_f32 v182, v182
v_cvt_pk_bf16_f32 v202, v184, v185
ds_read_b128 v[236:239], v10 offset:192
v_mfma_f32_16x16x32_bf16 v[56:59], v[240:243], v[204:207], v[56:59]
s_add_u32 m0, s28, 52224
s_add_u32 s36, s33, 81920
buffer_load_dwordx4 v13, s[16:19], s36 offen nt lds
v_exp_f32 v183, v183
ds_read_b128 v[240:243], v10 offset:4352
v_mfma_f32_16x16x32_bf16 v[64:67], v[244:247], v[204:207], v[64:67]
v_cvt_pk_bf16_f32 v203, v186, v187
s_add_u32 m0, s28, 53280
s_add_u32 s36, s33, 82176
buffer_load_dwordx4 v13, s[16:19], s36 offen nt lds
ds_read_b128 v[244:247], v10 offset:4416
v_mfma_f32_16x16x32_bf16 v[72:75], v[248:251], v[204:207], v[72:75]
v_exp_f32 v188, v188
v_exp_f32 v189, v189
ds_read_b128 v[248:251], v10 offset:4480
v_mfma_f32_16x16x32_bf16 v[80:83], v[252:255], v[204:207], v[80:83]
v_exp_f32 v190, v190
v_exp_f32 v191, v191
ds_read_b128 v[252:255], v10 offset:4544
v_mfma_f32_16x16x32_bf16 v[88:91], v[16:19], v[204:207], v[88:91]
s_nop 0
v_cvt_pk_bf16_f32 v204, v180, v181
v_cvt_pk_bf16_f32 v205, v182, v183
v_cvt_pk_bf16_f32 v206, v188, v189
v_cvt_pk_bf16_f32 v207, v190, v191
W2_R7_back:
s_waitcnt lgkmcnt(7)
v_mfma_f32_16x16x32_bf16 v[176:179], v[224:227], v[128:131], v[212:215]
v_mfma_f32_16x16x32_bf16 v[180:183], v[224:227], v[144:147], v[216:219]
s_waitcnt lgkmcnt(6)
v_mfma_f32_16x16x32_bf16 v[176:179], v[228:231], v[132:135], v[176:179]
ds_read_b64_tr_b16 v[224:225], v11 offset:60672
v_mfma_f32_16x16x32_bf16 v[180:183], v[228:231], v[148:151], v[180:183]
ds_read_b64_tr_b16 v[226:227], v11 offset:61184
s_waitcnt lgkmcnt(7)
v_mfma_f32_16x16x32_bf16 v[176:179], v[232:235], v[136:139], v[176:179]
ds_read_b64_tr_b16 v[228:229], v11 offset:60704
v_mfma_f32_16x16x32_bf16 v[180:183], v[232:235], v[152:155], v[180:183]
ds_read_b64_tr_b16 v[230:231], v11 offset:61216
s_waitcnt lgkmcnt(8)
v_mfma_f32_16x16x32_bf16 v[176:179], v[236:239], v[140:143], v[176:179]
ds_read_b64_tr_b16 v[232:233], v11 offset:60736
v_mfma_f32_16x16x32_bf16 v[180:183], v[236:239], v[156:159], v[180:183]
ds_read_b64_tr_b16 v[234:235], v11 offset:61248
s_waitcnt lgkmcnt(9)
v_mfma_f32_16x16x32_bf16 v[184:187], v[240:243], v[128:131], v[212:215]
ds_read_b64_tr_b16 v[236:237], v11 offset:60768
v_mfma_f32_16x16x32_bf16 v[188:191], v[240:243], v[144:147], v[216:219]
ds_read_b64_tr_b16 v[238:239], v11 offset:61280
s_waitcnt lgkmcnt(10)
v_mfma_f32_16x16x32_bf16 v[184:187], v[244:247], v[132:135], v[184:187]
ds_read_b64_tr_b16 v[240:241], v11 offset:60800
v_mfma_f32_16x16x32_bf16 v[188:191], v[244:247], v[148:151], v[188:191]
ds_read_b64_tr_b16 v[242:243], v11 offset:61312
s_waitcnt lgkmcnt(11)
v_mfma_f32_16x16x32_bf16 v[184:187], v[248:251], v[136:139], v[184:187]
ds_read_b64_tr_b16 v[244:245], v11 offset:60832
ds_read_b64_tr_b16 v[246:247], v11 offset:61344
v_mfma_f32_16x16x32_bf16 v[188:191], v[248:251], v[152:155], v[188:191]
v_max3_f32 v2, v176, v177, v178
v_max_f32 v2, v2, v179
s_waitcnt lgkmcnt(12)
v_mfma_f32_16x16x32_bf16 v[184:187], v[252:255], v[140:143], v[184:187]
ds_read_b64_tr_b16 v[248:249], v11 offset:60864
ds_read_b64_tr_b16 v[250:251], v11 offset:61376
v_mfma_f32_16x16x32_bf16 v[188:191], v[252:255], v[156:159], v[188:191]
v_max3_f32 v2, v2, v180, v181
v_max3_f32 v2, v2, v182, v183
ds_read_b64_tr_b16 v[252:253], v11 offset:60896
ds_read_b64_tr_b16 v[254:255], v11 offset:61408
s_nop 5
v_max3_f32 v2, v2, v184, v185
v_max3_f32 v2, v2, v186, v187
v_max3_f32 v2, v2, v188, v189
v_max3_f32 v2, v2, v190, v191
v_cmp_lt_f32 vcc, s3, v2
s_cbranch_vccnz W2_R8
s_waitcnt lgkmcnt(14)
v_mfma_f32_16x16x32_bf16 v[20:23], v[224:227], v[200:203], v[20:23]
v_exp_f32 v176, v176
s_waitcnt lgkmcnt(12)
v_mfma_f32_16x16x32_bf16 v[28:31], v[228:231], v[200:203], v[28:31]
v_exp_f32 v177, v177
s_waitcnt lgkmcnt(10)
v_mfma_f32_16x16x32_bf16 v[36:39], v[232:235], v[200:203], v[36:39]
v_exp_f32 v178, v178
s_waitcnt lgkmcnt(8)
v_mfma_f32_16x16x32_bf16 v[44:47], v[236:239], v[200:203], v[44:47]
v_exp_f32 v179, v179
s_waitcnt lgkmcnt(6)
v_mfma_f32_16x16x32_bf16 v[52:55], v[240:243], v[200:203], v[52:55]
v_exp_f32 v184, v184
s_waitcnt lgkmcnt(4)
v_mfma_f32_16x16x32_bf16 v[60:63], v[244:247], v[200:203], v[60:63]
v_exp_f32 v185, v185
s_waitcnt lgkmcnt(2)
v_mfma_f32_16x16x32_bf16 v[68:71], v[248:251], v[200:203], v[68:71]
v_exp_f32 v186, v186
s_waitcnt lgkmcnt(0)
v_mfma_f32_16x16x32_bf16 v[76:79], v[252:255], v[200:203], v[76:79]
v_exp_f32 v187, v187
v_mfma_f32_16x16x32_bf16 v[84:87], v[16:19], v[200:203], v[84:87]
s_waitcnt vmcnt(8)
s_barrier
v_readfirstlane_b32 s46, v7
v_mfma_f32_16x16x32_bf16 v[24:27], v[224:227], v[204:207], v[24:27]
v_exp_f32 v180, v180
v_cvt_pk_bf16_f32 v200, v176, v177
ds_read_b128 v[224:227], v10 offset:8704
v_mfma_f32_16x16x32_bf16 v[32:35], v[228:231], v[204:207], v[32:35]
s_add_u32 m0, s27, 0
s_add_u32 s36, s29, 98304
buffer_load_dwordx4 v12, s[12:15], s36 offen nt lds
v_exp_f32 v181, v181
ds_read_b128 v[228:231], v10 offset:8768
v_mfma_f32_16x16x32_bf16 v[40:43], v[232:235], v[204:207], v[40:43]
v_cvt_pk_bf16_f32 v201, v178, v179
s_add_u32 m0, s27, 1088
s_add_u32 s36, s29, 99328
buffer_load_dwordx4 v12, s[12:15], s36 offen nt lds
ds_read_b128 v[232:235], v10 offset:8832
v_mfma_f32_16x16x32_bf16 v[48:51], v[236:239], v[204:207], v[48:51]
v_exp_f32 v182, v182
v_cvt_pk_bf16_f32 v202, v184, v185
ds_read_b128 v[236:239], v10 offset:8896
v_mfma_f32_16x16x32_bf16 v[56:59], v[240:243], v[204:207], v[56:59]
s_add_u32 m0, s28, 60672
s_add_u32 s36, s33, 90112
buffer_load_dwordx4 v13, s[16:19], s36 offen nt lds
v_exp_f32 v183, v183
ds_read_b128 v[240:243], v10 offset:13056
v_mfma_f32_16x16x32_bf16 v[64:67], v[244:247], v[204:207], v[64:67]
v_cvt_pk_bf16_f32 v203, v186, v187
s_add_u32 m0, s28, 61728
s_add_u32 s36, s33, 90368
buffer_load_dwordx4 v13, s[16:19], s36 offen nt lds
ds_read_b128 v[244:247], v10 offset:13120
v_mfma_f32_16x16x32_bf16 v[72:75], v[248:251], v[204:207], v[72:75]
v_exp_f32 v188, v188
v_exp_f32 v189, v189
ds_read_b128 v[248:251], v10 offset:13184
v_mfma_f32_16x16x32_bf16 v[80:83], v[252:255], v[204:207], v[80:83]
v_exp_f32 v190, v190
v_exp_f32 v191, v191
ds_read_b128 v[252:255], v10 offset:13248
v_mfma_f32_16x16x32_bf16 v[88:91], v[16:19], v[204:207], v[88:91]
s_nop 0
v_cvt_pk_bf16_f32 v204, v180, v181
v_cvt_pk_bf16_f32 v205, v182, v183
v_cvt_pk_bf16_f32 v206, v188, v189
v_cvt_pk_bf16_f32 v207, v190, v191
W2_R8_back:
s_waitcnt lgkmcnt(7)
v_mfma_f32_16x16x32_bf16 v[176:179], v[224:227], v[128:131], v[212:215]
v_mfma_f32_16x16x32_bf16 v[180:183], v[224:227], v[144:147], v[216:219]
s_waitcnt lgkmcnt(6)
v_mfma_f32_16x16x32_bf16 v[176:179], v[228:231], v[132:135], v[176:179]
ds_read_b64_tr_b16 v[224:225], v11 offset:17408
v_mfma_f32_16x16x32_bf16 v[180:183], v[228:231], v[148:151], v[180:183]
ds_read_b64_tr_b16 v[226:227], v11 offset:17920
s_waitcnt lgkmcnt(7)
v_mfma_f32_16x16x32_bf16 v[176:179], v[232:235], v[136:139], v[176:179]
ds_read_b64_tr_b16 v[228:229], v11 offset:17440
v_mfma_f32_16x16x32_bf16 v[180:183], v[232:235], v[152:155], v[180:183]
ds_read_b64_tr_b16 v[230:231], v11 offset:17952
s_waitcnt lgkmcnt(8)
v_mfma_f32_16x16x32_bf16 v[176:179], v[236:239], v[140:143], v[176:179]
ds_read_b64_tr_b16 v[232:233], v11 offset:17472
v_mfma_f32_16x16x32_bf16 v[180:183], v[236:239], v[156:159], v[180:183]
ds_read_b64_tr_b16 v[234:235], v11 offset:17984
s_waitcnt lgkmcnt(9)
v_mfma_f32_16x16x32_bf16 v[184:187], v[240:243], v[128:131], v[212:215]
ds_read_b64_tr_b16 v[236:237], v11 offset:17504
v_mfma_f32_16x16x32_bf16 v[188:191], v[240:243], v[144:147], v[216:219]
ds_read_b64_tr_b16 v[238:239], v11 offset:18016
s_waitcnt lgkmcnt(10)
v_mfma_f32_16x16x32_bf16 v[184:187], v[244:247], v[132:135], v[184:187]
ds_read_b64_tr_b16 v[240:241], v11 offset:17536
v_mfma_f32_16x16x32_bf16 v[188:191], v[244:247], v[148:151], v[188:191]
ds_read_b64_tr_b16 v[242:243], v11 offset:18048
s_waitcnt lgkmcnt(11)
v_mfma_f32_16x16x32_bf16 v[184:187], v[248:251], v[136:139], v[184:187]
ds_read_b64_tr_b16 v[244:245], v11 offset:17568
ds_read_b64_tr_b16 v[246:247], v11 offset:18080
v_mfma_f32_16x16x32_bf16 v[188:191], v[248:251], v[152:155], v[188:191]
v_max3_f32 v2, v176, v177, v178
v_max_f32 v2, v2, v179
s_waitcnt lgkmcnt(12)
v_mfma_f32_16x16x32_bf16 v[184:187], v[252:255], v[140:143], v[184:187]
ds_read_b64_tr_b16 v[248:249], v11 offset:17600
ds_read_b64_tr_b16 v[250:251], v11 offset:18112
v_mfma_f32_16x16x32_bf16 v[188:191], v[252:255], v[156:159], v[188:191]
v_max3_f32 v2, v2, v180, v181
v_max3_f32 v2, v2, v182, v183
ds_read_b64_tr_b16 v[252:253], v11 offset:17632
ds_read_b64_tr_b16 v[254:255], v11 offset:18144
s_nop 5
v_max3_f32 v2, v2, v184, v185
v_max3_f32 v2, v2, v186, v187
v_max3_f32 v2, v2, v188, v189
v_max3_f32 v2, v2, v190, v191
v_cmp_lt_f32 vcc, s3, v2
s_cbranch_vccnz W2_R9
s_waitcnt lgkmcnt(14)
v_mfma_f32_16x16x32_bf16 v[20:23], v[224:227], v[200:203], v[20:23]
v_exp_f32 v176, v176
s_waitcnt lgkmcnt(12)
v_mfma_f32_16x16x32_bf16 v[28:31], v[228:231], v[200:203], v[28:31]
v_exp_f32 v177, v177
s_waitcnt lgkmcnt(10)
v_mfma_f32_16x16x32_bf16 v[36:39], v[232:235], v[200:203], v[36:39]
v_exp_f32 v178, v178
s_waitcnt lgkmcnt(8)
v_mfma_f32_16x16x32_bf16 v[44:47], v[236:239], v[200:203], v[44:47]
v_exp_f32 v179, v179
s_waitcnt lgkmcnt(6)
v_mfma_f32_16x16x32_bf16 v[52:55], v[240:243], v[200:203], v[52:55]
v_exp_f32 v184, v184
s_waitcnt lgkmcnt(4)
v_mfma_f32_16x16x32_bf16 v[60:63], v[244:247], v[200:203], v[60:63]
v_exp_f32 v185, v185
s_waitcnt lgkmcnt(2)
v_mfma_f32_16x16x32_bf16 v[68:71], v[248:251], v[200:203], v[68:71]
v_exp_f32 v186, v186
s_waitcnt lgkmcnt(0)
v_mfma_f32_16x16x32_bf16 v[76:79], v[252:255], v[200:203], v[76:79]
v_exp_f32 v187, v187
v_mfma_f32_16x16x32_bf16 v[84:87], v[16:19], v[200:203], v[84:87]
s_waitcnt vmcnt(8)
s_barrier
v_mfma_f32_16x16x32_bf16 v[24:27], v[224:227], v[204:207], v[24:27]
v_exp_f32 v180, v180
v_cvt_pk_bf16_f32 v200, v176, v177
ds_read_b128 v[224:227], v10 offset:34816
v_mfma_f32_16x16x32_bf16 v[32:35], v[228:231], v[204:207], v[32:35]
s_add_u32 m0, s27, 8704
s_add_u32 s36, s29, 106496
buffer_load_dwordx4 v12, s[12:15], s36 offen nt lds
v_exp_f32 v181, v181
ds_read_b128 v[228:231], v10 offset:34880
v_mfma_f32_16x16x32_bf16 v[40:43], v[232:235], v[204:207], v[40:43]
v_cvt_pk_bf16_f32 v201, v178, v179
s_add_u32 m0, s27, 9792
s_add_u32 s36, s29, 107520
buffer_load_dwordx4 v12, s[12:15], s36 offen nt lds
ds_read_b128 v[232:235], v10 offset:34944
v_mfma_f32_16x16x32_bf16 v[48:51], v[236:239], v[204:207], v[48:51]
v_exp_f32 v182, v182
v_cvt_pk_bf16_f32 v202, v184, v185
ds_read_b128 v[236:239], v10 offset:35008
v_mfma_f32_16x16x32_bf16 v[56:59], v[240:243], v[204:207], v[56:59]
s_add_u32 m0, s28, 17408
s_add_u32 s36, s33, 98304
buffer_load_dwordx4 v13, s[16:19], s36 offen nt lds
v_exp_f32 v183, v183
ds_read_b128 v[240:243], v10 offset:39168
v_mfma_f32_16x16x32_bf16 v[64:67], v[244:247], v[204:207], v[64:67]
v_cvt_pk_bf16_f32 v203, v186, v187
s_add_u32 m0, s28, 18464
s_add_u32 s36, s33, 98560
buffer_load_dwordx4 v13, s[16:19], s36 offen nt lds
ds_read_b128 v[244:247], v10 offset:39232
v_mfma_f32_16x16x32_bf16 v[72:75], v[248:251], v[204:207], v[72:75]
v_exp_f32 v188, v188
v_exp_f32 v189, v189
ds_read_b128 v[248:251], v10 offset:39296
v_mfma_f32_16x16x32_bf16 v[80:83], v[252:255], v[204:207], v[80:83]
v_exp_f32 v190, v190
v_exp_f32 v191, v191
ds_read_b128 v[252:255], v10 offset:39360
v_mfma_f32_16x16x32_bf16 v[88:91], v[16:19], v[204:207], v[88:91]
s_nop 0
v_cvt_pk_bf16_f32 v204, v180, v181
v_cvt_pk_bf16_f32 v205, v182, v183
v_cvt_pk_bf16_f32 v206, v188, v189
v_cvt_pk_bf16_f32 v207, v190, v191
W2_R9_back:
s_waitcnt lgkmcnt(7)
v_mfma_f32_16x16x32_bf16 v[176:179], v[224:227], v[128:131], v[212:215]
v_mfma_f32_16x16x32_bf16 v[180:183], v[224:227], v[144:147], v[216:219]
s_waitcnt lgkmcnt(6)
v_mfma_f32_16x16x32_bf16 v[176:179], v[228:231], v[132:135], v[176:179]
ds_read_b64_tr_b16 v[224:225], v11 offset:25856
v_mfma_f32_16x16x32_bf16 v[180:183], v[228:231], v[148:151], v[180:183]
ds_read_b64_tr_b16 v[226:227], v11 offset:26368
s_waitcnt lgkmcnt(7)
v_mfma_f32_16x16x32_bf16 v[176:179], v[232:235], v[136:139], v[176:179]
ds_read_b64_tr_b16 v[228:229], v11 offset:25888
v_mfma_f32_16x16x32_bf16 v[180:183], v[232:235], v[152:155], v[180:183]
ds_read_b64_tr_b16 v[230:231], v11 offset:26400
s_waitcnt lgkmcnt(8)
v_mfma_f32_16x16x32_bf16 v[176:179], v[236:239], v[140:143], v[176:179]
ds_read_b64_tr_b16 v[232:233], v11 offset:25920
v_mfma_f32_16x16x32_bf16 v[180:183], v[236:239], v[156:159], v[180:183]
ds_read_b64_tr_b16 v[234:235], v11 offset:26432
s_waitcnt lgkmcnt(9)
v_mfma_f32_16x16x32_bf16 v[184:187], v[240:243], v[128:131], v[212:215]
ds_read_b64_tr_b16 v[236:237], v11 offset:25952
v_mfma_f32_16x16x32_bf16 v[188:191], v[240:243], v[144:147], v[216:219]
ds_read_b64_tr_b16 v[238:239], v11 offset:26464
s_waitcnt lgkmcnt(10)
v_mfma_f32_16x16x32_bf16 v[184:187], v[244:247], v[132:135], v[184:187]
ds_read_b64_tr_b16 v[240:241], v11 offset:25984
v_mfma_f32_16x16x32_bf16 v[188:191], v[244:247], v[148:151], v[188:191]
ds_read_b64_tr_b16 v[242:243], v11 offset:26496
s_waitcnt lgkmcnt(11)
v_mfma_f32_16x16x32_bf16 v[184:187], v[248:251], v[136:139], v[184:187]
ds_read_b64_tr_b16 v[244:245], v11 offset:26016
ds_read_b64_tr_b16 v[246:247], v11 offset:26528
v_mfma_f32_16x16x32_bf16 v[188:191], v[248:251], v[152:155], v[188:191]
v_max3_f32 v2, v176, v177, v178
v_max_f32 v2, v2, v179
s_waitcnt lgkmcnt(12)
v_mfma_f32_16x16x32_bf16 v[184:187], v[252:255], v[140:143], v[184:187]
ds_read_b64_tr_b16 v[248:249], v11 offset:26048
ds_read_b64_tr_b16 v[250:251], v11 offset:26560
v_mfma_f32_16x16x32_bf16 v[188:191], v[252:255], v[156:159], v[188:191]
v_max3_f32 v2, v2, v180, v181
v_max3_f32 v2, v2, v182, v183
ds_read_b64_tr_b16 v[252:253], v11 offset:26080
ds_read_b64_tr_b16 v[254:255], v11 offset:26592
s_nop 5
v_max3_f32 v2, v2, v184, v185
v_max3_f32 v2, v2, v186, v187
v_max3_f32 v2, v2, v188, v189
v_max3_f32 v2, v2, v190, v191
v_cmp_lt_f32 vcc, s3, v2
s_cbranch_vccnz W2_R10
s_waitcnt lgkmcnt(14)
v_mfma_f32_16x16x32_bf16 v[20:23], v[224:227], v[200:203], v[20:23]
v_exp_f32 v176, v176
s_waitcnt lgkmcnt(12)
v_mfma_f32_16x16x32_bf16 v[28:31], v[228:231], v[200:203], v[28:31]
v_exp_f32 v177, v177
s_waitcnt lgkmcnt(10)
v_mfma_f32_16x16x32_bf16 v[36:39], v[232:235], v[200:203], v[36:39]
v_exp_f32 v178, v178
s_waitcnt lgkmcnt(8)
v_mfma_f32_16x16x32_bf16 v[44:47], v[236:239], v[200:203], v[44:47]
v_exp_f32 v179, v179
s_waitcnt lgkmcnt(6)
v_mfma_f32_16x16x32_bf16 v[52:55], v[240:243], v[200:203], v[52:55]
v_exp_f32 v184, v184
s_waitcnt lgkmcnt(4)
v_mfma_f32_16x16x32_bf16 v[60:63], v[244:247], v[200:203], v[60:63]
v_exp_f32 v185, v185
s_waitcnt lgkmcnt(2)
v_mfma_f32_16x16x32_bf16 v[68:71], v[248:251], v[200:203], v[68:71]
v_exp_f32 v186, v186
s_waitcnt lgkmcnt(0)
v_mfma_f32_16x16x32_bf16 v[76:79], v[252:255], v[200:203], v[76:79]
v_exp_f32 v187, v187
v_mfma_f32_16x16x32_bf16 v[84:87], v[16:19], v[200:203], v[84:87]
s_waitcnt vmcnt(8)
s_barrier
v_mfma_f32_16x16x32_bf16 v[24:27], v[224:227], v[204:207], v[24:27]
v_exp_f32 v180, v180
v_cvt_pk_bf16_f32 v200, v176, v177
ds_read_b128 v[224:227], v10 offset:43520
v_mfma_f32_16x16x32_bf16 v[32:35], v[228:231], v[204:207], v[32:35]
s_add_u32 m0, s27, 34816
s_add_u32 s36, s29, 114688
buffer_load_dwordx4 v12, s[12:15], s36 offen nt lds
v_exp_f32 v181, v181
ds_read_b128 v[228:231], v10 offset:43584
v_mfma_f32_16x16x32_bf16 v[40:43], v[232:235], v[204:207], v[40:43]
v_cvt_pk_bf16_f32 v201, v178, v179
s_add_u32 m0, s27, 35904
s_add_u32 s36, s29, 115712
buffer_load_dwordx4 v12, s[12:15], s36 offen nt lds
ds_read_b128 v[232:235], v10 offset:43648
v_mfma_f32_16x16x32_bf16 v[48:51], v[236:239], v[204:207], v[48:51]
v_exp_f32 v182, v182
v_cvt_pk_bf16_f32 v202, v184, v185
ds_read_b128 v[236:239], v10 offset:43712
v_mfma_f32_16x16x32_bf16 v[56:59], v[240:243], v[204:207], v[56:59]
s_add_u32 m0, s28, 25856
s_add_u32 s36, s33, 106496
buffer_load_dwordx4 v13, s[16:19], s36 offen nt lds
v_exp_f32 v183, v183
ds_read_b128 v[240:243], v10 offset:47872
v_mfma_f32_16x16x32_bf16 v[64:67], v[244:247], v[204:207], v[64:67]
v_cvt_pk_bf16_f32 v203, v186, v187
s_add_u32 m0, s28, 26912
s_add_u32 s36, s33, 106752
buffer_load_dwordx4 v13, s[16:19], s36 offen nt lds
ds_read_b128 v[244:247], v10 offset:47936
v_mfma_f32_16x16x32_bf16 v[72:75], v[248:251], v[204:207], v[72:75]
v_exp_f32 v188, v188
v_exp_f32 v189, v189
ds_read_b128 v[248:251], v10 offset:48000
v_mfma_f32_16x16x32_bf16 v[80:83], v[252:255], v[204:207], v[80:83]
v_exp_f32 v190, v190
v_exp_f32 v191, v191
ds_read_b128 v[252:255], v10 offset:48064
v_mfma_f32_16x16x32_bf16 v[88:91], v[16:19], v[204:207], v[88:91]
s_nop 0
v_cvt_pk_bf16_f32 v204, v180, v181
v_cvt_pk_bf16_f32 v205, v182, v183
v_cvt_pk_bf16_f32 v206, v188, v189
v_cvt_pk_bf16_f32 v207, v190, v191
W2_R10_back:
s_waitcnt lgkmcnt(7)
v_mfma_f32_16x16x32_bf16 v[176:179], v[224:227], v[128:131], v[212:215]
v_mfma_f32_16x16x32_bf16 v[180:183], v[224:227], v[144:147], v[216:219]
s_waitcnt lgkmcnt(6)
v_mfma_f32_16x16x32_bf16 v[176:179], v[228:231], v[132:135], v[176:179]
ds_read_b64_tr_b16 v[224:225], v11 offset:52224
v_mfma_f32_16x16x32_bf16 v[180:183], v[228:231], v[148:151], v[180:183]
ds_read_b64_tr_b16 v[226:227], v11 offset:52736
s_waitcnt lgkmcnt(7)
v_mfma_f32_16x16x32_bf16 v[176:179], v[232:235], v[136:139], v[176:179]
ds_read_b64_tr_b16 v[228:229], v11 offset:52256
v_mfma_f32_16x16x32_bf16 v[180:183], v[232:235], v[152:155], v[180:183]
ds_read_b64_tr_b16 v[230:231], v11 offset:52768
s_waitcnt lgkmcnt(8)
v_mfma_f32_16x16x32_bf16 v[176:179], v[236:239], v[140:143], v[176:179]
ds_read_b64_tr_b16 v[232:233], v11 offset:52288
v_mfma_f32_16x16x32_bf16 v[180:183], v[236:239], v[156:159], v[180:183]
ds_read_b64_tr_b16 v[234:235], v11 offset:52800
s_waitcnt lgkmcnt(9)
v_mfma_f32_16x16x32_bf16 v[184:187], v[240:243], v[128:131], v[212:215]
ds_read_b64_tr_b16 v[236:237], v11 offset:52320
v_mfma_f32_16x16x32_bf16 v[188:191], v[240:243], v[144:147], v[216:219]
ds_read_b64_tr_b16 v[238:239], v11 offset:52832
s_waitcnt lgkmcnt(10)
v_mfma_f32_16x16x32_bf16 v[184:187], v[244:247], v[132:135], v[184:187]
ds_read_b64_tr_b16 v[240:241], v11 offset:52352
v_mfma_f32_16x16x32_bf16 v[188:191], v[244:247], v[148:151], v[188:191]
ds_read_b64_tr_b16 v[242:243], v11 offset:52864
s_waitcnt lgkmcnt(11)
v_mfma_f32_16x16x32_bf16 v[184:187], v[248:251], v[136:139], v[184:187]
ds_read_b64_tr_b16 v[244:245], v11 offset:52384
ds_read_b64_tr_b16 v[246:247], v11 offset:52896
v_mfma_f32_16x16x32_bf16 v[188:191], v[248:251], v[152:155], v[188:191]
v_max3_f32 v2, v176, v177, v178
v_max_f32 v2, v2, v179
s_waitcnt lgkmcnt(12)
v_mfma_f32_16x16x32_bf16 v[184:187], v[252:255], v[140:143], v[184:187]
ds_read_b64_tr_b16 v[248:249], v11 offset:52416
ds_read_b64_tr_b16 v[250:251], v11 offset:52928
v_mfma_f32_16x16x32_bf16 v[188:191], v[252:255], v[156:159], v[188:191]
v_max3_f32 v2, v2, v180, v181
v_max3_f32 v2, v2, v182, v183
ds_read_b64_tr_b16 v[252:253], v11 offset:52448
ds_read_b64_tr_b16 v[254:255], v11 offset:52960
s_nop 5
v_max3_f32 v2, v2, v184, v185
v_max3_f32 v2, v2, v186, v187
v_max3_f32 v2, v2, v188, v189
v_max3_f32 v2, v2, v190, v191
v_cmp_lt_f32 vcc, s3, v2
s_cbranch_vccnz W2_R11
s_waitcnt lgkmcnt(14)
v_mfma_f32_16x16x32_bf16 v[20:23], v[224:227], v[200:203], v[20:23]
v_exp_f32 v176, v176
s_waitcnt lgkmcnt(12)
v_mfma_f32_16x16x32_bf16 v[28:31], v[228:231], v[200:203], v[28:31]
v_exp_f32 v177, v177
s_waitcnt lgkmcnt(10)
v_mfma_f32_16x16x32_bf16 v[36:39], v[232:235], v[200:203], v[36:39]
v_exp_f32 v178, v178
s_waitcnt lgkmcnt(8)
v_mfma_f32_16x16x32_bf16 v[44:47], v[236:239], v[200:203], v[44:47]
v_exp_f32 v179, v179
s_waitcnt lgkmcnt(6)
v_mfma_f32_16x16x32_bf16 v[52:55], v[240:243], v[200:203], v[52:55]
v_exp_f32 v184, v184
s_waitcnt lgkmcnt(4)
v_mfma_f32_16x16x32_bf16 v[60:63], v[244:247], v[200:203], v[60:63]
v_exp_f32 v185, v185
s_waitcnt lgkmcnt(2)
v_mfma_f32_16x16x32_bf16 v[68:71], v[248:251], v[200:203], v[68:71]
v_exp_f32 v186, v186
s_waitcnt lgkmcnt(0)
v_mfma_f32_16x16x32_bf16 v[76:79], v[252:255], v[200:203], v[76:79]
v_exp_f32 v187, v187
v_mfma_f32_16x16x32_bf16 v[84:87], v[16:19], v[200:203], v[84:87]
s_waitcnt vmcnt(8)
s_barrier
v_mfma_f32_16x16x32_bf16 v[24:27], v[224:227], v[204:207], v[24:27]
v_exp_f32 v180, v180
v_cvt_pk_bf16_f32 v200, v176, v177
ds_read_b128 v[224:227], v10 offset:0
v_mfma_f32_16x16x32_bf16 v[32:35], v[228:231], v[204:207], v[32:35]
s_add_u32 m0, s27, 43520
s_add_u32 s36, s29, 122880
buffer_load_dwordx4 v12, s[12:15], s36 offen nt lds
v_exp_f32 v181, v181
ds_read_b128 v[228:231], v10 offset:64
v_mfma_f32_16x16x32_bf16 v[40:43], v[232:235], v[204:207], v[40:43]
v_cvt_pk_bf16_f32 v201, v178, v179
s_add_u32 m0, s27, 44608
s_add_u32 s36, s29, 123904
buffer_load_dwordx4 v12, s[12:15], s36 offen nt lds
ds_read_b128 v[232:235], v10 offset:128
v_mfma_f32_16x16x32_bf16 v[48:51], v[236:239], v[204:207], v[48:51]
v_exp_f32 v182, v182
v_cvt_pk_bf16_f32 v202, v184, v185
ds_read_b128 v[236:239], v10 offset:192
v_mfma_f32_16x16x32_bf16 v[56:59], v[240:243], v[204:207], v[56:59]
s_add_u32 m0, s28, 52224
s_add_u32 s36, s33, 114688
buffer_load_dwordx4 v13, s[16:19], s36 offen nt lds
v_exp_f32 v183, v183
ds_read_b128 v[240:243], v10 offset:4352
v_mfma_f32_16x16x32_bf16 v[64:67], v[244:247], v[204:207], v[64:67]
v_cvt_pk_bf16_f32 v203, v186, v187
s_add_u32 m0, s28, 53280
s_add_u32 s36, s33, 114944
buffer_load_dwordx4 v13, s[16:19], s36 offen nt lds
ds_read_b128 v[244:247], v10 offset:4416
v_mfma_f32_16x16x32_bf16 v[72:75], v[248:251], v[204:207], v[72:75]
v_exp_f32 v188, v188
v_exp_f32 v189, v189
ds_read_b128 v[248:251], v10 offset:4480
v_mfma_f32_16x16x32_bf16 v[80:83], v[252:255], v[204:207], v[80:83]
v_exp_f32 v190, v190
v_exp_f32 v191, v191
ds_read_b128 v[252:255], v10 offset:4544
v_mfma_f32_16x16x32_bf16 v[88:91], v[16:19], v[204:207], v[88:91]
s_nop 0
v_cvt_pk_bf16_f32 v204, v180, v181
v_cvt_pk_bf16_f32 v205, v182, v183
v_cvt_pk_bf16_f32 v206, v188, v189
v_cvt_pk_bf16_f32 v207, v190, v191
W2_R11_back:
s_waitcnt lgkmcnt(7)
v_mfma_f32_16x16x32_bf16 v[176:179], v[224:227], v[128:131], v[212:215]
v_mfma_f32_16x16x32_bf16 v[180:183], v[224:227], v[144:147], v[216:219]
s_waitcnt lgkmcnt(6)
v_mfma_f32_16x16x32_bf16 v[176:179], v[228:231], v[132:135], v[176:179]
ds_read_b64_tr_b16 v[224:225], v11 offset:60672
v_mfma_f32_16x16x32_bf16 v[180:183], v[228:231], v[148:151], v[180:183]
ds_read_b64_tr_b16 v[226:227], v11 offset:61184
s_waitcnt lgkmcnt(7)
v_mfma_f32_16x16x32_bf16 v[176:179], v[232:235], v[136:139], v[176:179]
ds_read_b64_tr_b16 v[228:229], v11 offset:60704
v_mfma_f32_16x16x32_bf16 v[180:183], v[232:235], v[152:155], v[180:183]
ds_read_b64_tr_b16 v[230:231], v11 offset:61216
s_waitcnt lgkmcnt(8)
v_mfma_f32_16x16x32_bf16 v[176:179], v[236:239], v[140:143], v[176:179]
ds_read_b64_tr_b16 v[232:233], v11 offset:60736
v_mfma_f32_16x16x32_bf16 v[180:183], v[236:239], v[156:159], v[180:183]
ds_read_b64_tr_b16 v[234:235], v11 offset:61248
s_waitcnt lgkmcnt(9)
v_mfma_f32_16x16x32_bf16 v[184:187], v[240:243], v[128:131], v[212:215]
ds_read_b64_tr_b16 v[236:237], v11 offset:60768
v_mfma_f32_16x16x32_bf16 v[188:191], v[240:243], v[144:147], v[216:219]
ds_read_b64_tr_b16 v[238:239], v11 offset:61280
s_waitcnt lgkmcnt(10)
v_mfma_f32_16x16x32_bf16 v[184:187], v[244:247], v[132:135], v[184:187]
ds_read_b64_tr_b16 v[240:241], v11 offset:60800
v_mfma_f32_16x16x32_bf16 v[188:191], v[244:247], v[148:151], v[188:191]
ds_read_b64_tr_b16 v[242:243], v11 offset:61312
s_waitcnt lgkmcnt(11)
v_mfma_f32_16x16x32_bf16 v[184:187], v[248:251], v[136:139], v[184:187]
ds_read_b64_tr_b16 v[244:245], v11 offset:60832
ds_read_b64_tr_b16 v[246:247], v11 offset:61344
v_mfma_f32_16x16x32_bf16 v[188:191], v[248:251], v[152:155], v[188:191]
v_max3_f32 v2, v176, v177, v178
v_max_f32 v2, v2, v179
s_waitcnt lgkmcnt(12)
v_mfma_f32_16x16x32_bf16 v[184:187], v[252:255], v[140:143], v[184:187]
ds_read_b64_tr_b16 v[248:249], v11 offset:60864
ds_read_b64_tr_b16 v[250:251], v11 offset:61376
v_mfma_f32_16x16x32_bf16 v[188:191], v[252:255], v[156:159], v[188:191]
v_max3_f32 v2, v2, v180, v181
v_max3_f32 v2, v2, v182, v183
ds_read_b64_tr_b16 v[252:253], v11 offset:60896
ds_read_b64_tr_b16 v[254:255], v11 offset:61408
s_nop 5
v_max3_f32 v2, v2, v184, v185
v_max3_f32 v2, v2, v186, v187
v_max3_f32 v2, v2, v188, v189
v_max3_f32 v2, v2, v190, v191
v_cmp_lt_f32 vcc, s3, v2
s_cbranch_vccnz W2_R12
s_waitcnt lgkmcnt(14)
v_mfma_f32_16x16x32_bf16 v[20:23], v[224:227], v[200:203], v[20:23]
v_exp_f32 v176, v176
s_waitcnt lgkmcnt(12)
v_mfma_f32_16x16x32_bf16 v[28:31], v[228:231], v[200:203], v[28:31]
v_exp_f32 v177, v177
s_waitcnt lgkmcnt(10)
v_mfma_f32_16x16x32_bf16 v[36:39], v[232:235], v[200:203], v[36:39]
v_exp_f32 v178, v178
s_waitcnt lgkmcnt(8)
v_mfma_f32_16x16x32_bf16 v[44:47], v[236:239], v[200:203], v[44:47]
v_exp_f32 v179, v179
s_waitcnt lgkmcnt(6)
v_mfma_f32_16x16x32_bf16 v[52:55], v[240:243], v[200:203], v[52:55]
v_exp_f32 v184, v184
s_waitcnt lgkmcnt(4)
v_mfma_f32_16x16x32_bf16 v[60:63], v[244:247], v[200:203], v[60:63]
v_exp_f32 v185, v185
s_waitcnt lgkmcnt(2)
v_mfma_f32_16x16x32_bf16 v[68:71], v[248:251], v[200:203], v[68:71]
v_exp_f32 v186, v186
s_waitcnt lgkmcnt(0)
v_mfma_f32_16x16x32_bf16 v[76:79], v[252:255], v[200:203], v[76:79]
v_exp_f32 v187, v187
v_mfma_f32_16x16x32_bf16 v[84:87], v[16:19], v[200:203], v[84:87]
s_waitcnt vmcnt(8)
s_barrier
v_mfma_f32_16x16x32_bf16 v[24:27], v[224:227], v[204:207], v[24:27]
v_exp_f32 v180, v180
v_cvt_pk_bf16_f32 v200, v176, v177
ds_read_b128 v[224:227], v10 offset:8704
v_mfma_f32_16x16x32_bf16 v[32:35], v[228:231], v[204:207], v[32:35]
s_add_u32 m0, s28, 60672
s_add_u32 s36, s33, 122880
buffer_load_dwordx4 v13, s[16:19], s36 offen nt lds
v_exp_f32 v181, v181
ds_read_b128 v[228:231], v10 offset:8768
v_mfma_f32_16x16x32_bf16 v[40:43], v[232:235], v[204:207], v[40:43]
v_cvt_pk_bf16_f32 v201, v178, v179
s_add_u32 m0, s28, 61728
s_add_u32 s36, s33, 123136
buffer_load_dwordx4 v13, s[16:19], s36 offen nt lds
ds_read_b128 v[232:235], v10 offset:8832
v_mfma_f32_16x16x32_bf16 v[48:51], v[236:239], v[204:207], v[48:51]
v_exp_f32 v182, v182
v_cvt_pk_bf16_f32 v202, v184, v185
ds_read_b128 v[236:239], v10 offset:8896
v_mfma_f32_16x16x32_bf16 v[56:59], v[240:243], v[204:207], v[56:59]
v_exp_f32 v183, v183
v_cvt_pk_bf16_f32 v203, v186, v187
ds_read_b128 v[240:243], v10 offset:13056
v_mfma_f32_16x16x32_bf16 v[64:67], v[244:247], v[204:207], v[64:67]
v_exp_f32 v188, v188
v_exp_f32 v189, v189
ds_read_b128 v[244:247], v10 offset:13120
v_mfma_f32_16x16x32_bf16 v[72:75], v[248:251], v[204:207], v[72:75]
v_exp_f32 v190, v190
v_exp_f32 v191, v191
ds_read_b128 v[248:251], v10 offset:13184
v_mfma_f32_16x16x32_bf16 v[80:83], v[252:255], v[204:207], v[80:83]
ds_read_b128 v[252:255], v10 offset:13248
v_mfma_f32_16x16x32_bf16 v[88:91], v[16:19], v[204:207], v[88:91]
s_nop 0
v_cvt_pk_bf16_f32 v204, v180, v181
v_cvt_pk_bf16_f32 v205, v182, v183
v_cvt_pk_bf16_f32 v206, v188, v189
v_cvt_pk_bf16_f32 v207, v190, v191
W2_R12_back:
s_waitcnt lgkmcnt(7)
v_mfma_f32_16x16x32_bf16 v[176:179], v[224:227], v[128:131], v[212:215]
v_mfma_f32_16x16x32_bf16 v[180:183], v[224:227], v[144:147], v[216:219]
s_waitcnt lgkmcnt(6)
v_mfma_f32_16x16x32_bf16 v[176:179], v[228:231], v[132:135], v[176:179]
ds_read_b64_tr_b16 v[224:225], v11 offset:17408
v_mfma_f32_16x16x32_bf16 v[180:183], v[228:231], v[148:151], v[180:183]
ds_read_b64_tr_b16 v[226:227], v11 offset:17920
s_waitcnt lgkmcnt(7)
v_mfma_f32_16x16x32_bf16 v[176:179], v[232:235], v[136:139], v[176:179]
ds_read_b64_tr_b16 v[228:229], v11 offset:17440
v_mfma_f32_16x16x32_bf16 v[180:183], v[232:235], v[152:155], v[180:183]
ds_read_b64_tr_b16 v[230:231], v11 offset:17952
s_waitcnt lgkmcnt(8)
v_mfma_f32_16x16x32_bf16 v[176:179], v[236:239], v[140:143], v[176:179]
ds_read_b64_tr_b16 v[232:233], v11 offset:17472
v_mfma_f32_16x16x32_bf16 v[180:183], v[236:239], v[156:159], v[180:183]
ds_read_b64_tr_b16 v[234:235], v11 offset:17984
s_waitcnt lgkmcnt(9)
v_mfma_f32_16x16x32_bf16 v[184:187], v[240:243], v[128:131], v[212:215]
ds_read_b64_tr_b16 v[236:237], v11 offset:17504
v_mfma_f32_16x16x32_bf16 v[188:191], v[240:243], v[144:147], v[216:219]
ds_read_b64_tr_b16 v[238:239], v11 offset:18016
s_waitcnt lgkmcnt(10)
v_mfma_f32_16x16x32_bf16 v[184:187], v[244:247], v[132:135], v[184:187]
ds_read_b64_tr_b16 v[240:241], v11 offset:17536
v_mfma_f32_16x16x32_bf16 v[188:191], v[244:247], v[148:151], v[188:191]
ds_read_b64_tr_b16 v[242:243], v11 offset:18048
s_waitcnt lgkmcnt(11)
v_mfma_f32_16x16x32_bf16 v[184:187], v[248:251], v[136:139], v[184:187]
ds_read_b64_tr_b16 v[244:245], v11 offset:17568
ds_read_b64_tr_b16 v[246:247], v11 offset:18080
v_mfma_f32_16x16x32_bf16 v[188:191], v[248:251], v[152:155], v[188:191]
v_max3_f32 v2, v176, v177, v178
v_max_f32 v2, v2, v179
s_waitcnt lgkmcnt(12)
v_mfma_f32_16x16x32_bf16 v[184:187], v[252:255], v[140:143], v[184:187]
ds_read_b64_tr_b16 v[248:249], v11 offset:17600
ds_read_b64_tr_b16 v[250:251], v11 offset:18112
v_mfma_f32_16x16x32_bf16 v[188:191], v[252:255], v[156:159], v[188:191]
v_max3_f32 v2, v2, v180, v181
v_max3_f32 v2, v2, v182, v183
ds_read_b64_tr_b16 v[252:253], v11 offset:17632
ds_read_b64_tr_b16 v[254:255], v11 offset:18144
s_nop 5
v_max3_f32 v2, v2, v184, v185
v_max3_f32 v2, v2, v186, v187
v_max3_f32 v2, v2, v188, v189
v_max3_f32 v2, v2, v190, v191
v_cmp_lt_f32 vcc, s3, v2
s_cbranch_vccnz W2_R13
s_waitcnt lgkmcnt(14)
v_mfma_f32_16x16x32_bf16 v[20:23], v[224:227], v[200:203], v[20:23]
v_exp_f32 v176, v176
s_waitcnt lgkmcnt(12)
v_mfma_f32_16x16x32_bf16 v[28:31], v[228:231], v[200:203], v[28:31]
v_exp_f32 v177, v177
s_waitcnt lgkmcnt(10)
v_mfma_f32_16x16x32_bf16 v[36:39], v[232:235], v[200:203], v[36:39]
v_exp_f32 v178, v178
s_waitcnt lgkmcnt(8)
v_mfma_f32_16x16x32_bf16 v[44:47], v[236:239], v[200:203], v[44:47]
v_exp_f32 v179, v179
s_waitcnt lgkmcnt(6)
v_mfma_f32_16x16x32_bf16 v[52:55], v[240:243], v[200:203], v[52:55]
v_exp_f32 v184, v184
s_waitcnt lgkmcnt(4)
v_mfma_f32_16x16x32_bf16 v[60:63], v[244:247], v[200:203], v[60:63]
v_exp_f32 v185, v185
s_waitcnt lgkmcnt(2)
v_mfma_f32_16x16x32_bf16 v[68:71], v[248:251], v[200:203], v[68:71]
v_exp_f32 v186, v186
s_waitcnt lgkmcnt(0)
v_mfma_f32_16x16x32_bf16 v[76:79], v[252:255], v[200:203], v[76:79]
v_exp_f32 v187, v187
v_mfma_f32_16x16x32_bf16 v[84:87], v[16:19], v[200:203], v[84:87]
s_waitcnt vmcnt(6)
s_barrier
v_mfma_f32_16x16x32_bf16 v[24:27], v[224:227], v[204:207], v[24:27]
v_exp_f32 v180, v180
v_cvt_pk_bf16_f32 v200, v176, v177
s_mul_i32 s36, s63, 5120
v_lshlrev_b32 v8, 4, v0
buffer_load_dwordx4 v[4:7], v8, s[88:91], s36 offen
ds_read_b128 v[224:227], v10 offset:34816
v_mfma_f32_16x16x32_bf16 v[32:35], v[228:231], v[204:207], v[32:35]
v_exp_f32 v181, v181
v_cvt_pk_bf16_f32 v201, v178, v179
s_mul_i32 s36, s63, 5120
buffer_load_dwordx4 v[4:7], v8, s[88:91], s36 offen offset:1024
ds_read_b128 v[228:231], v10 offset:34880
v_mfma_f32_16x16x32_bf16 v[40:43], v[232:235], v[204:207], v[40:43]
v_exp_f32 v182, v182
v_cvt_pk_bf16_f32 v202, v184, v185
s_mul_i32 s36, s63, 5120
buffer_load_dwordx4 v[4:7], v8, s[88:91], s36 offen offset:2048
ds_read_b128 v[232:235], v10 offset:34944
v_mfma_f32_16x16x32_bf16 v[48:51], v[236:239], v[204:207], v[48:51]
v_exp_f32 v183, v183
v_cvt_pk_bf16_f32 v203, v186, v187
s_mul_i32 s36, s63, 5120
buffer_load_dwordx4 v[4:7], v8, s[88:91], s36 offen offset:3072
ds_read_b128 v[236:239], v10 offset:35008
v_mfma_f32_16x16x32_bf16 v[56:59], v[240:243], v[204:207], v[56:59]
v_exp_f32 v188, v188
s_mul_i32 s36, s63, 5120
s_add_u32 s36, s36, 4096
buffer_load_dwordx4 v[4:7], v8, s[88:91], s36 offen
v_exp_f32 v189, v189
ds_read_b128 v[240:243], v10 offset:39168
v_mfma_f32_16x16x32_bf16 v[64:67], v[244:247], v[204:207], v[64:67]
v_exp_f32 v190, v190
v_exp_f32 v191, v191
ds_read_b128 v[244:247], v10 offset:39232
v_mfma_f32_16x16x32_bf16 v[72:75], v[248:251], v[204:207], v[72:75]
ds_read_b128 v[248:251], v10 offset:39296
v_mfma_f32_16x16x32_bf16 v[80:83], v[252:255], v[204:207], v[80:83]
ds_read_b128 v[252:255], v10 offset:39360
v_mfma_f32_16x16x32_bf16 v[88:91], v[16:19], v[204:207], v[88:91]
s_nop 0
v_cvt_pk_bf16_f32 v204, v180, v181
v_cvt_pk_bf16_f32 v205, v182, v183
v_cvt_pk_bf16_f32 v206, v188, v189
v_cvt_pk_bf16_f32 v207, v190, v191
W2_R13_back:
s_waitcnt lgkmcnt(7)
v_mfma_f32_16x16x32_bf16 v[176:179], v[224:227], v[128:131], v[212:215]
v_mfma_f32_16x16x32_bf16 v[180:183], v[224:227], v[144:147], v[216:219]
s_waitcnt lgkmcnt(6)
v_mfma_f32_16x16x32_bf16 v[176:179], v[228:231], v[132:135], v[176:179]
ds_read_b64_tr_b16 v[224:225], v11 offset:25856
v_mfma_f32_16x16x32_bf16 v[180:183], v[228:231], v[148:151], v[180:183]
ds_read_b64_tr_b16 v[226:227], v11 offset:26368
s_waitcnt lgkmcnt(7)
v_mfma_f32_16x16x32_bf16 v[176:179], v[232:235], v[136:139], v[176:179]
ds_read_b64_tr_b16 v[228:229], v11 offset:25888
v_mfma_f32_16x16x32_bf16 v[180:183], v[232:235], v[152:155], v[180:183]
ds_read_b64_tr_b16 v[230:231], v11 offset:26400
s_waitcnt lgkmcnt(8)
v_mfma_f32_16x16x32_bf16 v[176:179], v[236:239], v[140:143], v[176:179]
ds_read_b64_tr_b16 v[232:233], v11 offset:25920
v_mfma_f32_16x16x32_bf16 v[180:183], v[236:239], v[156:159], v[180:183]
ds_read_b64_tr_b16 v[234:235], v11 offset:26432
s_waitcnt lgkmcnt(9)
v_mfma_f32_16x16x32_bf16 v[184:187], v[240:243], v[128:131], v[212:215]
ds_read_b64_tr_b16 v[236:237], v11 offset:25952
v_mfma_f32_16x16x32_bf16 v[188:191], v[240:243], v[144:147], v[216:219]
ds_read_b64_tr_b16 v[238:239], v11 offset:26464
s_waitcnt lgkmcnt(10)
v_mfma_f32_16x16x32_bf16 v[184:187], v[244:247], v[132:135], v[184:187]
ds_read_b64_tr_b16 v[240:241], v11 offset:25984
v_mfma_f32_16x16x32_bf16 v[188:191], v[244:247], v[148:151], v[188:191]
ds_read_b64_tr_b16 v[242:243], v11 offset:26496
s_waitcnt lgkmcnt(11)
v_mfma_f32_16x16x32_bf16 v[184:187], v[248:251], v[136:139], v[184:187]
ds_read_b64_tr_b16 v[244:245], v11 offset:26016
ds_read_b64_tr_b16 v[246:247], v11 offset:26528
v_mfma_f32_16x16x32_bf16 v[188:191], v[248:251], v[152:155], v[188:191]
v_max3_f32 v2, v176, v177, v178
v_max_f32 v2, v2, v179
s_waitcnt lgkmcnt(12)
v_mfma_f32_16x16x32_bf16 v[184:187], v[252:255], v[140:143], v[184:187]
ds_read_b64_tr_b16 v[248:249], v11 offset:26048
ds_read_b64_tr_b16 v[250:251], v11 offset:26560
v_mfma_f32_16x16x32_bf16 v[188:191], v[252:255], v[156:159], v[188:191]
v_max3_f32 v2, v2, v180, v181
v_max3_f32 v2, v2, v182, v183
ds_read_b64_tr_b16 v[252:253], v11 offset:26080
ds_read_b64_tr_b16 v[254:255], v11 offset:26592
s_nop 5
v_max3_f32 v2, v2, v184, v185
v_max3_f32 v2, v2, v186, v187
v_max3_f32 v2, v2, v188, v189
v_max3_f32 v2, v2, v190, v191
v_cmp_lt_f32 vcc, s3, v2
s_cbranch_vccnz W2_R14
s_waitcnt lgkmcnt(14)
v_mfma_f32_16x16x32_bf16 v[20:23], v[224:227], v[200:203], v[20:23]
v_exp_f32 v176, v176
s_waitcnt lgkmcnt(12)
v_mfma_f32_16x16x32_bf16 v[28:31], v[228:231], v[200:203], v[28:31]
v_exp_f32 v177, v177
s_waitcnt lgkmcnt(10)
v_mfma_f32_16x16x32_bf16 v[36:39], v[232:235], v[200:203], v[36:39]
v_exp_f32 v178, v178
s_waitcnt lgkmcnt(8)
v_mfma_f32_16x16x32_bf16 v[44:47], v[236:239], v[200:203], v[44:47]
v_exp_f32 v179, v179
s_waitcnt lgkmcnt(6)
v_mfma_f32_16x16x32_bf16 v[52:55], v[240:243], v[200:203], v[52:55]
v_exp_f32 v184, v184
s_waitcnt lgkmcnt(4)
v_mfma_f32_16x16x32_bf16 v[60:63], v[244:247], v[200:203], v[60:63]
v_exp_f32 v185, v185
s_waitcnt lgkmcnt(2)
v_mfma_f32_16x16x32_bf16 v[68:71], v[248:251], v[200:203], v[68:71]
v_exp_f32 v186, v186
s_waitcnt lgkmcnt(0)
v_mfma_f32_16x16x32_bf16 v[76:79], v[252:255], v[200:203], v[76:79]
v_exp_f32 v187, v187
v_mfma_f32_16x16x32_bf16 v[84:87], v[16:19], v[200:203], v[84:87]
s_waitcnt vmcnt(7)
s_barrier
v_mfma_f32_16x16x32_bf16 v[24:27], v[224:227], v[204:207], v[24:27]
v_exp_f32 v180, v180
v_cvt_pk_bf16_f32 v200, v176, v177
ds_read_b128 v[224:227], v10 offset:43520
v_mfma_f32_16x16x32_bf16 v[32:35], v[228:231], v[204:207], v[32:35]
v_exp_f32 v181, v181
v_cvt_pk_bf16_f32 v201, v178, v179
ds_read_b128 v[228:231], v10 offset:43584
v_mfma_f32_16x16x32_bf16 v[40:43], v[232:235], v[204:207], v[40:43]
v_exp_f32 v182, v182
v_cvt_pk_bf16_f32 v202, v184, v185
ds_read_b128 v[232:235], v10 offset:43648
v_mfma_f32_16x16x32_bf16 v[48:51], v[236:239], v[204:207], v[48:51]
v_exp_f32 v183, v183
v_cvt_pk_bf16_f32 v203, v186, v187
ds_read_b128 v[236:239], v10 offset:43712
v_mfma_f32_16x16x32_bf16 v[56:59], v[240:243], v[204:207], v[56:59]
v_exp_f32 v188, v188
v_exp_f32 v189, v189
ds_read_b128 v[240:243], v10 offset:47872
v_mfma_f32_16x16x32_bf16 v[64:67], v[244:247], v[204:207], v[64:67]
v_exp_f32 v190, v190
v_exp_f32 v191, v191
ds_read_b128 v[244:247], v10 offset:47936
v_mfma_f32_16x16x32_bf16 v[72:75], v[248:251], v[204:207], v[72:75]
ds_read_b128 v[248:251], v10 offset:48000
v_mfma_f32_16x16x32_bf16 v[80:83], v[252:255], v[204:207], v[80:83]
ds_read_b128 v[252:255], v10 offset:48064
v_mfma_f32_16x16x32_bf16 v[88:91], v[16:19], v[204:207], v[88:91]
s_nop 0
v_cvt_pk_bf16_f32 v204, v180, v181
v_cvt_pk_bf16_f32 v205, v182, v183
v_cvt_pk_bf16_f32 v206, v188, v189
v_cvt_pk_bf16_f32 v207, v190, v191
W2_R14_back:
s_waitcnt lgkmcnt(7)
v_mfma_f32_16x16x32_bf16 v[176:179], v[224:227], v[128:131], v[212:215]
v_mfma_f32_16x16x32_bf16 v[180:183], v[224:227], v[144:147], v[216:219]
s_waitcnt lgkmcnt(6)
v_mfma_f32_16x16x32_bf16 v[176:179], v[228:231], v[132:135], v[176:179]
ds_read_b64_tr_b16 v[224:225], v11 offset:52224
v_mfma_f32_16x16x32_bf16 v[180:183], v[228:231], v[148:151], v[180:183]
ds_read_b64_tr_b16 v[226:227], v11 offset:52736
s_waitcnt lgkmcnt(7)
v_mfma_f32_16x16x32_bf16 v[176:179], v[232:235], v[136:139], v[176:179]
ds_read_b64_tr_b16 v[228:229], v11 offset:52256
v_mfma_f32_16x16x32_bf16 v[180:183], v[232:235], v[152:155], v[180:183]
ds_read_b64_tr_b16 v[230:231], v11 offset:52768
s_waitcnt lgkmcnt(8)
v_mfma_f32_16x16x32_bf16 v[176:179], v[236:239], v[140:143], v[176:179]
ds_read_b64_tr_b16 v[232:233], v11 offset:52288
v_mfma_f32_16x16x32_bf16 v[180:183], v[236:239], v[156:159], v[180:183]
ds_read_b64_tr_b16 v[234:235], v11 offset:52800
s_waitcnt lgkmcnt(9)
v_mfma_f32_16x16x32_bf16 v[184:187], v[240:243], v[128:131], v[212:215]
ds_read_b64_tr_b16 v[236:237], v11 offset:52320
v_mfma_f32_16x16x32_bf16 v[188:191], v[240:243], v[144:147], v[216:219]
ds_read_b64_tr_b16 v[238:239], v11 offset:52832
s_waitcnt lgkmcnt(10)
v_mfma_f32_16x16x32_bf16 v[184:187], v[244:247], v[132:135], v[184:187]
ds_read_b64_tr_b16 v[240:241], v11 offset:52352
v_mfma_f32_16x16x32_bf16 v[188:191], v[244:247], v[148:151], v[188:191]
ds_read_b64_tr_b16 v[242:243], v11 offset:52864
s_waitcnt lgkmcnt(11)
v_mfma_f32_16x16x32_bf16 v[184:187], v[248:251], v[136:139], v[184:187]
ds_read_b64_tr_b16 v[244:245], v11 offset:52384
ds_read_b64_tr_b16 v[246:247], v11 offset:52896
v_mfma_f32_16x16x32_bf16 v[188:191], v[248:251], v[152:155], v[188:191]
v_max3_f32 v2, v176, v177, v178
v_max_f32 v2, v2, v179
s_waitcnt lgkmcnt(12)
v_mfma_f32_16x16x32_bf16 v[184:187], v[252:255], v[140:143], v[184:187]
ds_read_b64_tr_b16 v[248:249], v11 offset:52416
ds_read_b64_tr_b16 v[250:251], v11 offset:52928
v_mfma_f32_16x16x32_bf16 v[188:191], v[252:255], v[156:159], v[188:191]
v_max3_f32 v2, v2, v180, v181
v_max3_f32 v2, v2, v182, v183
ds_read_b64_tr_b16 v[252:253], v11 offset:52448
ds_read_b64_tr_b16 v[254:255], v11 offset:52960
s_nop 5
v_max3_f32 v2, v2, v184, v185
v_max3_f32 v2, v2, v186, v187
v_max3_f32 v2, v2, v188, v189
v_max3_f32 v2, v2, v190, v191
v_cmp_lt_f32 vcc, s3, v2
s_cbranch_vccnz W2_R15
s_waitcnt lgkmcnt(14)
v_mfma_f32_16x16x32_bf16 v[20:23], v[224:227], v[200:203], v[20:23]
v_exp_f32 v176, v176
s_waitcnt lgkmcnt(12)
v_mfma_f32_16x16x32_bf16 v[28:31], v[228:231], v[200:203], v[28:31]
v_exp_f32 v177, v177
s_waitcnt lgkmcnt(10)
v_mfma_f32_16x16x32_bf16 v[36:39], v[232:235], v[200:203], v[36:39]
v_exp_f32 v178, v178
s_waitcnt lgkmcnt(8)
v_mfma_f32_16x16x32_bf16 v[44:47], v[236:239], v[200:203], v[44:47]
v_exp_f32 v179, v179
s_waitcnt lgkmcnt(6)
v_mfma_f32_16x16x32_bf16 v[52:55], v[240:243], v[200:203], v[52:55]
v_exp_f32 v184, v184
s_waitcnt lgkmcnt(4)
v_mfma_f32_16x16x32_bf16 v[60:63], v[244:247], v[200:203], v[60:63]
v_exp_f32 v185, v185
s_waitcnt lgkmcnt(2)
v_mfma_f32_16x16x32_bf16 v[68:71], v[248:251], v[200:203], v[68:71]
v_exp_f32 v186, v186
s_waitcnt lgkmcnt(0)
v_mfma_f32_16x16x32_bf16 v[76:79], v[252:255], v[200:203], v[76:79]
v_exp_f32 v187, v187
v_mfma_f32_16x16x32_bf16 v[84:87], v[16:19], v[200:203], v[84:87]
s_waitcnt vmcnt(5)
s_barrier
v_mfma_f32_16x16x32_bf16 v[24:27], v[224:227], v[204:207], v[24:27]
v_exp_f32 v180, v180
v_cvt_pk_bf16_f32 v200, v176, v177
v_mfma_f32_16x16x32_bf16 v[32:35], v[228:231], v[204:207], v[32:35]
v_exp_f32 v181, v181
v_mfma_f32_16x16x32_bf16 v[40:43], v[232:235], v[204:207], v[40:43]
v_cvt_pk_bf16_f32 v201, v178, v179
v_mfma_f32_16x16x32_bf16 v[48:51], v[236:239], v[204:207], v[48:51]
v_exp_f32 v182, v182
v_cvt_pk_bf16_f32 v202, v184, v185
v_mfma_f32_16x16x32_bf16 v[56:59], v[240:243], v[204:207], v[56:59]
v_exp_f32 v183, v183
v_mfma_f32_16x16x32_bf16 v[64:67], v[244:247], v[204:207], v[64:67]
v_cvt_pk_bf16_f32 v203, v186, v187
v_mfma_f32_16x16x32_bf16 v[72:75], v[248:251], v[204:207], v[72:75]
v_exp_f32 v188, v188
v_exp_f32 v189, v189
v_mfma_f32_16x16x32_bf16 v[80:83], v[252:255], v[204:207], v[80:83]
v_exp_f32 v190, v190
v_mfma_f32_16x16x32_bf16 v[88:91], v[16:19], v[204:207], v[88:91]
v_exp_f32 v191, v191
s_nop 0
v_cvt_pk_bf16_f32 v204, v180, v181
v_cvt_pk_bf16_f32 v205, v182, v183
v_cvt_pk_bf16_f32 v206, v188, v189
v_cvt_pk_bf16_f32 v207, v190, v191
W2_R15_back:
ds_read_b64_tr_b16 v[224:225], v11 offset:60672
ds_read_b64_tr_b16 v[226:227], v11 offset:61184
ds_read_b64_tr_b16 v[228:229], v11 offset:60704
ds_read_b64_tr_b16 v[230:231], v11 offset:61216
ds_read_b64_tr_b16 v[232:233], v11 offset:60736
ds_read_b64_tr_b16 v[234:235], v11 offset:61248
ds_read_b64_tr_b16 v[236:237], v11 offset:60768
ds_read_b64_tr_b16 v[238:239], v11 offset:61280
ds_read_b64_tr_b16 v[240:241], v11 offset:60800
ds_read_b64_tr_b16 v[242:243], v11 offset:61312
ds_read_b64_tr_b16 v[244:245], v11 offset:60832
ds_read_b64_tr_b16 v[246:247], v11 offset:61344
ds_read_b64_tr_b16 v[248:249], v11 offset:60864
ds_read_b64_tr_b16 v[250:251], v11 offset:61376
ds_read_b64_tr_b16 v[252:253], v11 offset:60896
ds_read_b64_tr_b16 v[254:255], v11 offset:61408
s_waitcnt lgkmcnt(0)
v_mfma_f32_16x16x32_bf16 v[20:23], v[224:227], v[200:203], v[20:23]
v_mfma_f32_16x16x32_bf16 v[28:31], v[228:231], v[200:203], v[28:31]
v_mfma_f32_16x16x32_bf16 v[36:39], v[232:235], v[200:203], v[36:39]
v_mfma_f32_16x16x32_bf16 v[44:47], v[236:239], v[200:203], v[44:47]
v_mfma_f32_16x16x32_bf16 v[52:55], v[240:243], v[200:203], v[52:55]
v_mfma_f32_16x16x32_bf16 v[60:63], v[244:247], v[200:203], v[60:63]
v_mfma_f32_16x16x32_bf16 v[68:71], v[248:251], v[200:203], v[68:71]
v_mfma_f32_16x16x32_bf16 v[76:79], v[252:255], v[200:203], v[76:79]
v_mfma_f32_16x16x32_bf16 v[84:87], v[16:19], v[200:203], v[84:87]
v_mfma_f32_16x16x32_bf16 v[24:27], v[224:227], v[204:207], v[24:27]
v_mfma_f32_16x16x32_bf16 v[32:35], v[228:231], v[204:207], v[32:35]
v_mfma_f32_16x16x32_bf16 v[40:43], v[232:235], v[204:207], v[40:43]
v_mfma_f32_16x16x32_bf16 v[48:51], v[236:239], v[204:207], v[48:51]
v_mfma_f32_16x16x32_bf16 v[56:59], v[240:243], v[204:207], v[56:59]
v_mfma_f32_16x16x32_bf16 v[64:67], v[244:247], v[204:207], v[64:67]
v_mfma_f32_16x16x32_bf16 v[72:75], v[248:251], v[204:207], v[72:75]
v_mfma_f32_16x16x32_bf16 v[80:83], v[252:255], v[204:207], v[80:83]
v_mfma_f32_16x16x32_bf16 v[88:91], v[16:19], v[204:207], v[88:91]
v_lshlrev_b32 v10, 4, v0
s_nop 15
v_rcp_f32 v2, v84
s_nop 0
v_mov_b32 v3, v2
v_pk_mul_f32 v[20:21], v[20:21], v[2:3]
v_pk_mul_f32 v[22:23], v[22:23], v[2:3]
v_pk_mul_f32 v[28:29], v[28:29], v[2:3]
v_pk_mul_f32 v[30:31], v[30:31], v[2:3]
v_cvt_pk_bf16_f32 v176, v20, v21
v_cvt_pk_bf16_f32 v177, v22, v23
v_cvt_pk_bf16_f32 v178, v28, v29
v_cvt_pk_bf16_f32 v179, v30, v31
s_add_u32 s36, s37, 0
buffer_store_dwordx4 v[176:179], v10, s[20:23], s36 offen sc1
s_nop 1
v_pk_mul_f32 v[36:37], v[36:37], v[2:3]
v_pk_mul_f32 v[38:39], v[38:39], v[2:3]
v_pk_mul_f32 v[44:45], v[44:45], v[2:3]
v_pk_mul_f32 v[46:47], v[46:47], v[2:3]
v_cvt_pk_bf16_f32 v180, v36, v37
v_cvt_pk_bf16_f32 v181, v38, v39
v_cvt_pk_bf16_f32 v182, v44, v45
v_cvt_pk_bf16_f32 v183, v46, v47
s_add_u32 s36, s37, 1024
buffer_store_dwordx4 v[180:183], v10, s[20:23], s36 offen sc1
s_nop 1
v_pk_mul_f32 v[52:53], v[52:53], v[2:3]
v_pk_mul_f32 v[54:55], v[54:55], v[2:3]
v_pk_mul_f32 v[60:61], v[60:61], v[2:3]
v_pk_mul_f32 v[62:63], v[62:63], v[2:3]
v_cvt_pk_bf16_f32 v184, v52, v53
v_cvt_pk_bf16_f32 v185, v54, v55
v_cvt_pk_bf16_f32 v186, v60, v61
v_cvt_pk_bf16_f32 v187, v62, v63
s_add_u32 s36, s37, 2048
buffer_store_dwordx4 v[184:187], v10, s[20:23], s36 offen sc1
s_nop 1
v_pk_mul_f32 v[68:69], v[68:69], v[2:3]
v_pk_mul_f32 v[70:71], v[70:71], v[2:3]
v_pk_mul_f32 v[76:77], v[76:77], v[2:3]
v_pk_mul_f32 v[78:79], v[78:79], v[2:3]
v_cvt_pk_bf16_f32 v188, v68, v69
v_cvt_pk_bf16_f32 v189, v70, v71
v_cvt_pk_bf16_f32 v190, v76, v77
v_cvt_pk_bf16_f32 v191, v78, v79
s_add_u32 s36, s37, 3072
buffer_store_dwordx4 v[188:191], v10, s[20:23], s36 offen sc1
s_nop 1
v_rcp_f32 v2, v88
s_nop 0
v_mov_b32 v3, v2
v_pk_mul_f32 v[24:25], v[24:25], v[2:3]
v_pk_mul_f32 v[26:27], v[26:27], v[2:3]
v_pk_mul_f32 v[32:33], v[32:33], v[2:3]
v_pk_mul_f32 v[34:35], v[34:35], v[2:3]
v_cvt_pk_bf16_f32 v192, v24, v25
v_cvt_pk_bf16_f32 v193, v26, v27
v_cvt_pk_bf16_f32 v194, v32, v33
v_cvt_pk_bf16_f32 v195, v34, v35
s_add_u32 s36, s37, 131072
buffer_store_dwordx4 v[192:195], v10, s[20:23], s36 offen sc1
s_nop 1
v_pk_mul_f32 v[40:41], v[40:41], v[2:3]
v_pk_mul_f32 v[42:43], v[42:43], v[2:3]
v_pk_mul_f32 v[48:49], v[48:49], v[2:3]
v_pk_mul_f32 v[50:51], v[50:51], v[2:3]
v_cvt_pk_bf16_f32 v196, v40, v41
v_cvt_pk_bf16_f32 v197, v42, v43
v_cvt_pk_bf16_f32 v198, v48, v49
v_cvt_pk_bf16_f32 v199, v50, v51
s_add_u32 s36, s37, 132096
buffer_store_dwordx4 v[196:199], v10, s[20:23], s36 offen sc1
s_nop 1
v_pk_mul_f32 v[56:57], v[56:57], v[2:3]
v_pk_mul_f32 v[58:59], v[58:59], v[2:3]
v_pk_mul_f32 v[64:65], v[64:65], v[2:3]
v_pk_mul_f32 v[66:67], v[66:67], v[2:3]
v_cvt_pk_bf16_f32 v176, v56, v57
v_cvt_pk_bf16_f32 v177, v58, v59
v_cvt_pk_bf16_f32 v178, v64, v65
v_cvt_pk_bf16_f32 v179, v66, v67
s_add_u32 s36, s37, 133120
buffer_store_dwordx4 v[176:179], v10, s[20:23], s36 offen sc1
s_nop 1
v_pk_mul_f32 v[72:73], v[72:73], v[2:3]
v_pk_mul_f32 v[74:75], v[74:75], v[2:3]
v_pk_mul_f32 v[80:81], v[80:81], v[2:3]
v_pk_mul_f32 v[82:83], v[82:83], v[2:3]
v_cvt_pk_bf16_f32 v180, v72, v73
v_cvt_pk_bf16_f32 v181, v74, v75
v_cvt_pk_bf16_f32 v182, v80, v81
v_cvt_pk_bf16_f32 v183, v82, v83
s_add_u32 s36, s37, 134144
buffer_store_dwordx4 v[180:183], v10, s[20:23], s36 offen sc1
s_nop 1
s_waitcnt vmcnt(0)
s_barrier
s_cmp_lg_u32 s24, 0
s_cbranch_scc1 FN_13
s_cmp_lg_u32 s46, 0
s_cbranch_scc1 FK_14
v_mov_b32 v2, 0
s_mov_b32 s50, 0x40000
NS_15:
s_sub_u32 s50, s50, 1
s_cbranch_scc1 NO_16
global_load_dword v3, v2, s[44:45] sc1
s_waitcnt vmcnt(0)
v_readfirstlane_b32 s46, v3
s_cmp_lg_u32 s46, 0
s_cbranch_scc1 NO_16
s_sleep 2
s_branch NS_15
NO_16:
FK_14:
s_mov_b64 exec, 1
v_mov_b32 v2, s46
s_lshl_b32 s36, s60, 3
s_add_u32 s36, s36, s62
s_lshl_b32 s36, s36, 5
s_add_u32 s36, s36, s61
s_lshl_b32 s36, s36, 2
s_add_u32 s36, s36, 33554432
v_mov_b32 v3, s36
global_store_dword v3, v2, s[56:57] sc1
s_mov_b64 exec, -1
FN_13:
s_endpgm
W2_R1:
s_waitcnt lgkmcnt(0)
v_mfma_f32_16x16x32_bf16 v[20:23], v[224:227], v[200:203], 0
v_mfma_f32_16x16x32_bf16 v[28:31], v[228:231], v[200:203], 0
v_mfma_f32_16x16x32_bf16 v[36:39], v[232:235], v[200:203], 0
v_mfma_f32_16x16x32_bf16 v[44:47], v[236:239], v[200:203], 0
v_mfma_f32_16x16x32_bf16 v[52:55], v[240:243], v[200:203], 0
v_mfma_f32_16x16x32_bf16 v[60:63], v[244:247], v[200:203], 0
v_mfma_f32_16x16x32_bf16 v[68:71], v[248:251], v[200:203], 0
v_mfma_f32_16x16x32_bf16 v[76:79], v[252:255], v[200:203], 0
v_mfma_f32_16x16x32_bf16 v[84:87], v[16:19], v[200:203], 0
v_mfma_f32_16x16x32_bf16 v[24:27], v[224:227], v[204:207], 0
v_mfma_f32_16x16x32_bf16 v[32:35], v[228:231], v[204:207], 0
v_mfma_f32_16x16x32_bf16 v[40:43], v[232:235], v[204:207], 0
v_mfma_f32_16x16x32_bf16 v[48:51], v[236:239], v[204:207], 0
v_mfma_f32_16x16x32_bf16 v[56:59], v[240:243], v[204:207], 0
v_mfma_f32_16x16x32_bf16 v[64:67], v[244:247], v[204:207], 0
v_mfma_f32_16x16x32_bf16 v[72:75], v[248:251], v[204:207], 0
v_mfma_f32_16x16x32_bf16 v[80:83], v[252:255], v[204:207], 0
v_mfma_f32_16x16x32_bf16 v[88:91], v[16:19], v[204:207], 0
s_nop 15
v_max3_f32 v2, v176, v177, v178
v_max3_f32 v2, v2, v179, v184
v_max3_f32 v2, v2, v185, v186
v_max_f32 v2, v2, v187
v_mov_b32 v3, v2
s_nop 1
v_permlane32_swap_b32 v2, v3
s_nop 1
v_max_f32 v2, v2, v3
v_mov_b32 v3, v2
s_nop 1
v_permlane16_swap_b32 v2, v3
s_nop 1
v_max_f32 v2, v2, v3
v_max_f32 v2, 0, v2
v_sub_f32 v176, v176, v2
v_sub_f32 v177, v177, v2
v_sub_f32 v178, v178, v2
v_sub_f32 v179, v179, v2
v_sub_f32 v184, v184, v2
v_sub_f32 v185, v185, v2
v_sub_f32 v186, v186, v2
v_sub_f32 v187, v187, v2
v_sub_f32 v212, v212, v2
v_sub_f32 v213, v213, v2
v_sub_f32 v214, v214, v2
v_sub_f32 v215, v215, v2
v_exp_f32 v3, -v2
s_nop 0
v_mul_f32 v20, v20, v3
v_mul_f32 v21, v21, v3
v_mul_f32 v22, v22, v3
v_mul_f32 v23, v23, v3
v_mul_f32 v28, v28, v3
v_mul_f32 v29, v29, v3
v_mul_f32 v30, v30, v3
v_mul_f32 v31, v31, v3
v_mul_f32 v36, v36, v3
v_mul_f32 v37, v37, v3
v_mul_f32 v38, v38, v3
v_mul_f32 v39, v39, v3
v_mul_f32 v44, v44, v3
v_mul_f32 v45, v45, v3
v_mul_f32 v46, v46, v3
v_mul_f32 v47, v47, v3
v_mul_f32 v52, v52, v3
v_mul_f32 v53, v53, v3
v_mul_f32 v54, v54, v3
v_mul_f32 v55, v55, v3
v_mul_f32 v60, v60, v3
v_mul_f32 v61, v61, v3
v_mul_f32 v62, v62, v3
v_mul_f32 v63, v63, v3
v_mul_f32 v68, v68, v3
v_mul_f32 v69, v69, v3
v_mul_f32 v70, v70, v3
v_mul_f32 v71, v71, v3
v_mul_f32 v76, v76, v3
v_mul_f32 v77, v77, v3
v_mul_f32 v78, v78, v3
v_mul_f32 v79, v79, v3
v_mul_f32 v84, v84, v3
v_mul_f32 v85, v85, v3
v_mul_f32 v86, v86, v3
v_mul_f32 v87, v87, v3
v_max3_f32 v2, v180, v181, v182
v_max3_f32 v2, v2, v183, v188
v_max3_f32 v2, v2, v189, v190
v_max_f32 v2, v2, v191
v_mov_b32 v3, v2
s_nop 1
v_permlane32_swap_b32 v2, v3
s_nop 1
v_max_f32 v2, v2, v3
v_mov_b32 v3, v2
s_nop 1
v_permlane16_swap_b32 v2, v3
s_nop 1
v_max_f32 v2, v2, v3
v_max_f32 v2, 0, v2
v_sub_f32 v180, v180, v2
v_sub_f32 v181, v181, v2
v_sub_f32 v182, v182, v2
v_sub_f32 v183, v183, v2
v_sub_f32 v188, v188, v2
v_sub_f32 v189, v189, v2
v_sub_f32 v190, v190, v2
v_sub_f32 v191, v191, v2
v_sub_f32 v216, v216, v2
v_sub_f32 v217, v217, v2
v_sub_f32 v218, v218, v2
v_sub_f32 v219, v219, v2
v_exp_f32 v3, -v2
s_nop 0
v_mul_f32 v24, v24, v3
v_mul_f32 v25, v25, v3
v_mul_f32 v26, v26, v3
v_mul_f32 v27, v27, v3
v_mul_f32 v32, v32, v3
v_mul_f32 v33, v33, v3
v_mul_f32 v34, v34, v3
v_mul_f32 v35, v35, v3
v_mul_f32 v40, v40, v3
v_mul_f32 v41, v41, v3
v_mul_f32 v42, v42, v3
v_mul_f32 v43, v43, v3
v_mul_f32 v48, v48, v3
v_mul_f32 v49, v49, v3
v_mul_f32 v50, v50, v3
v_mul_f32 v51, v51, v3
v_mul_f32 v56, v56, v3
v_mul_f32 v57, v57, v3
v_mul_f32 v58, v58, v3
v_mul_f32 v59, v59, v3
v_mul_f32 v64, v64, v3
v_mul_f32 v65, v65, v3
v_mul_f32 v66, v66, v3
v_mul_f32 v67, v67, v3
v_mul_f32 v72, v72, v3
v_mul_f32 v73, v73, v3
v_mul_f32 v74, v74, v3
v_mul_f32 v75, v75, v3
v_mul_f32 v80, v80, v3
v_mul_f32 v81, v81, v3
v_mul_f32 v82, v82, v3
v_mul_f32 v83, v83, v3
v_mul_f32 v88, v88, v3
v_mul_f32 v89, v89, v3
v_mul_f32 v90, v90, v3
v_mul_f32 v91, v91, v3
v_exp_f32 v176, v176
v_exp_f32 v177, v177
v_exp_f32 v178, v178
v_exp_f32 v179, v179
v_exp_f32 v184, v184
v_exp_f32 v185, v185
v_exp_f32 v186, v186
v_exp_f32 v187, v187
v_exp_f32 v180, v180
v_exp_f32 v181, v181
v_exp_f32 v182, v182
v_exp_f32 v183, v183
v_exp_f32 v188, v188
v_exp_f32 v189, v189
v_exp_f32 v190, v190
v_exp_f32 v191, v191
s_nop 0
v_cvt_pk_bf16_f32 v200, v176, v177
v_cvt_pk_bf16_f32 v201, v178, v179
v_cvt_pk_bf16_f32 v202, v184, v185
v_cvt_pk_bf16_f32 v203, v186, v187
v_cvt_pk_bf16_f32 v204, v180, v181
v_cvt_pk_bf16_f32 v205, v182, v183
v_cvt_pk_bf16_f32 v206, v188, v189
v_cvt_pk_bf16_f32 v207, v190, v191
s_waitcnt vmcnt(6)
s_barrier
s_add_u32 m0, s27, 0
s_add_u32 s36, s29, 32768
buffer_load_dwordx4 v12, s[12:15], s36 offen nt lds
s_add_u32 m0, s27, 1088
s_add_u32 s36, s29, 33792
buffer_load_dwordx4 v12, s[12:15], s36 offen nt lds
s_add_u32 m0, s27, 8704
s_add_u32 s36, s29, 40960
buffer_load_dwordx4 v12, s[12:15], s36 offen nt lds
s_add_u32 m0, s27, 9792
s_add_u32 s36, s29, 41984
buffer_load_dwordx4 v12, s[12:15], s36 offen nt lds
s_add_u32 m0, s28, 17408
s_add_u32 s36, s33, 32768
buffer_load_dwordx4 v13, s[16:19], s36 offen nt lds
s_add_u32 m0, s28, 18464
s_add_u32 s36, s33, 33024
buffer_load_dwordx4 v13, s[16:19], s36 offen nt lds
v_mov_b32 v8, 0
global_load_dword v7, v8, s[44:45] sc1
ds_read_b128 v[224:227], v10 offset:34816
ds_read_b128 v[228:231], v10 offset:34880
ds_read_b128 v[232:235], v10 offset:34944
ds_read_b128 v[236:239], v10 offset:35008
ds_read_b128 v[240:243], v10 offset:39168
ds_read_b128 v[244:247], v10 offset:39232
ds_read_b128 v[248:251], v10 offset:39296
ds_read_b128 v[252:255], v10 offset:39360
s_branch W2_R1_back
W2_R2:
s_waitcnt lgkmcnt(0)
v_mfma_f32_16x16x32_bf16 v[20:23], v[224:227], v[200:203], v[20:23]
v_mfma_f32_16x16x32_bf16 v[28:31], v[228:231], v[200:203], v[28:31]
v_mfma_f32_16x16x32_bf16 v[36:39], v[232:235], v[200:203], v[36:39]
v_mfma_f32_16x16x32_bf16 v[44:47], v[236:239], v[200:203], v[44:47]
v_mfma_f32_16x16x32_bf16 v[52:55], v[240:243], v[200:203], v[52:55]
v_mfma_f32_16x16x32_bf16 v[60:63], v[244:247], v[200:203], v[60:63]
v_mfma_f32_16x16x32_bf16 v[68:71], v[248:251], v[200:203], v[68:71]
v_mfma_f32_16x16x32_bf16 v[76:79], v[252:255], v[200:203], v[76:79]
v_mfma_f32_16x16x32_bf16 v[84:87], v[16:19], v[200:203], v[84:87]
v_mfma_f32_16x16x32_bf16 v[24:27], v[224:227], v[204:207], v[24:27]
v_mfma_f32_16x16x32_bf16 v[32:35], v[228:231], v[204:207], v[32:35]
v_mfma_f32_16x16x32_bf16 v[40:43], v[232:235], v[204:207], v[40:43]
v_mfma_f32_16x16x32_bf16 v[48:51], v[236:239], v[204:207], v[48:51]
v_mfma_f32_16x16x32_bf16 v[56:59], v[240:243], v[204:207], v[56:59]
v_mfma_f32_16x16x32_bf16 v[64:67], v[244:247], v[204:207], v[64:67]
v_mfma_f32_16x16x32_bf16 v[72:75], v[248:251], v[204:207], v[72:75]
v_mfma_f32_16x16x32_bf16 v[80:83], v[252:255], v[204:207], v[80:83]
v_mfma_f32_16x16x32_bf16 v[88:91], v[16:19], v[204:207], v[88:91]
s_nop 15
v_max3_f32 v2, v176, v177, v178
v_max3_f32 v2, v2, v179, v184
v_max3_f32 v2, v2, v185, v186
v_max_f32 v2, v2, v187
v_mov_b32 v3, v2
s_nop 1
v_permlane32_swap_b32 v2, v3
s_nop 1
v_max_f32 v2, v2, v3
v_mov_b32 v3, v2
s_nop 1
v_permlane16_swap_b32 v2, v3
s_nop 1
v_max_f32 v2, v2, v3
v_max_f32 v2, 0, v2
v_sub_f32 v176, v176, v2
v_sub_f32 v177, v177, v2
v_sub_f32 v178, v178, v2
v_sub_f32 v179, v179, v2
v_sub_f32 v184, v184, v2
v_sub_f32 v185, v185, v2
v_sub_f32 v186, v186, v2
v_sub_f32 v187, v187, v2
v_sub_f32 v212, v212, v2
v_sub_f32 v213, v213, v2
v_sub_f32 v214, v214, v2
v_sub_f32 v215, v215, v2
v_exp_f32 v3, -v2
s_nop 0
v_mul_f32 v20, v20, v3
v_mul_f32 v21, v21, v3
v_mul_f32 v22, v22, v3
v_mul_f32 v23, v23, v3
v_mul_f32 v28, v28, v3
v_mul_f32 v29, v29, v3
v_mul_f32 v30, v30, v3
v_mul_f32 v31, v31, v3
v_mul_f32 v36, v36, v3
v_mul_f32 v37, v37, v3
v_mul_f32 v38, v38, v3
v_mul_f32 v39, v39, v3
v_mul_f32 v44, v44, v3
v_mul_f32 v45, v45, v3
v_mul_f32 v46, v46, v3
v_mul_f32 v47, v47, v3
v_mul_f32 v52, v52, v3
v_mul_f32 v53, v53, v3
v_mul_f32 v54, v54, v3
v_mul_f32 v55, v55, v3
v_mul_f32 v60, v60, v3
v_mul_f32 v61, v61, v3
v_mul_f32 v62, v62, v3
v_mul_f32 v63, v63, v3
v_mul_f32 v68, v68, v3
v_mul_f32 v69, v69, v3
v_mul_f32 v70, v70, v3
v_mul_f32 v71, v71, v3
v_mul_f32 v76, v76, v3
v_mul_f32 v77, v77, v3
v_mul_f32 v78, v78, v3
v_mul_f32 v79, v79, v3
v_mul_f32 v84, v84, v3
v_mul_f32 v85, v85, v3
v_mul_f32 v86, v86, v3
v_mul_f32 v87, v87, v3
v_max3_f32 v2, v180, v181, v182
v_max3_f32 v2, v2, v183, v188
v_max3_f32 v2, v2, v189, v190
v_max_f32 v2, v2, v191
v_mov_b32 v3, v2
s_nop 1
v_permlane32_swap_b32 v2, v3
s_nop 1
v_max_f32 v2, v2, v3
v_mov_b32 v3, v2
s_nop 1
v_permlane16_swap_b32 v2, v3
s_nop 1
v_max_f32 v2, v2, v3
v_max_f32 v2, 0, v2
v_sub_f32 v180, v180, v2
v_sub_f32 v181, v181, v2
v_sub_f32 v182, v182, v2
v_sub_f32 v183, v183, v2
v_sub_f32 v188, v188, v2
v_sub_f32 v189, v189, v2
v_sub_f32 v190, v190, v2
v_sub_f32 v191, v191, v2
v_sub_f32 v216, v216, v2
v_sub_f32 v217, v217, v2
v_sub_f32 v218, v218, v2
v_sub_f32 v219, v219, v2
v_exp_f32 v3, -v2
s_nop 0
v_mul_f32 v24, v24, v3
v_mul_f32 v25, v25, v3
v_mul_f32 v26, v26, v3
v_mul_f32 v27, v27, v3
v_mul_f32 v32, v32, v3
v_mul_f32 v33, v33, v3
v_mul_f32 v34, v34, v3
v_mul_f32 v35, v35, v3
v_mul_f32 v40, v40, v3
v_mul_f32 v41, v41, v3
v_mul_f32 v42, v42, v3
v_mul_f32 v43, v43, v3
v_mul_f32 v48, v48, v3
v_mul_f32 v49, v49, v3
v_mul_f32 v50, v50, v3
v_mul_f32 v51, v51, v3
v_mul_f32 v56, v56, v3
v_mul_f32 v57, v57, v3
v_mul_f32 v58, v58, v3
v_mul_f32 v59, v59, v3
v_mul_f32 v64, v64, v3
v_mul_f32 v65, v65, v3
v_mul_f32 v66, v66, v3
v_mul_f32 v67, v67, v3
v_mul_f32 v72, v72, v3
v_mul_f32 v73, v73, v3
v_mul_f32 v74, v74, v3
v_mul_f32 v75, v75, v3
v_mul_f32 v80, v80, v3
v_mul_f32 v81, v81, v3
v_mul_f32 v82, v82, v3
v_mul_f32 v83, v83, v3
v_mul_f32 v88, v88, v3
v_mul_f32 v89, v89, v3
v_mul_f32 v90, v90, v3
v_mul_f32 v91, v91, v3
v_exp_f32 v176, v176
v_exp_f32 v177, v177
v_exp_f32 v178, v178
v_exp_f32 v179, v179
v_exp_f32 v184, v184
v_exp_f32 v185, v185
v_exp_f32 v186, v186
v_exp_f32 v187, v187
v_exp_f32 v180, v180
v_exp_f32 v181, v181
v_exp_f32 v182, v182
v_exp_f32 v183, v183
v_exp_f32 v188, v188
v_exp_f32 v189, v189
v_exp_f32 v190, v190
v_exp_f32 v191, v191
s_nop 0
v_cvt_pk_bf16_f32 v200, v176, v177
v_cvt_pk_bf16_f32 v201, v178, v179
v_cvt_pk_bf16_f32 v202, v184, v185
v_cvt_pk_bf16_f32 v203, v186, v187
v_cvt_pk_bf16_f32 v204, v180, v181
v_cvt_pk_bf16_f32 v205, v182, v183
v_cvt_pk_bf16_f32 v206, v188, v189
v_cvt_pk_bf16_f32 v207, v190, v191
s_waitcnt vmcnt(9)
s_barrier
s_add_u32 m0, s27, 34816
s_add_u32 s36, s29, 49152
buffer_load_dwordx4 v12, s[12:15], s36 offen nt lds
s_add_u32 m0, s27, 35904
s_add_u32 s36, s29, 50176
buffer_load_dwordx4 v12, s[12:15], s36 offen nt lds
s_add_u32 m0, s28, 25856
s_add_u32 s36, s33, 40960
buffer_load_dwordx4 v13, s[16:19], s36 offen nt lds
s_add_u32 m0, s28, 26912
s_add_u32 s36, s33, 41216
buffer_load_dwordx4 v13, s[16:19], s36 offen nt lds
ds_read_b128 v[224:227], v10 offset:43520
ds_read_b128 v[228:231], v10 offset:43584
ds_read_b128 v[232:235], v10 offset:43648
ds_read_b128 v[236:239], v10 offset:43712
ds_read_b128 v[240:243], v10 offset:47872
ds_read_b128 v[244:247], v10 offset:47936
ds_read_b128 v[248:251], v10 offset:48000
ds_read_b128 v[252:255], v10 offset:48064
s_branch W2_R2_back
W2_R3:
s_waitcnt lgkmcnt(0)
v_mfma_f32_16x16x32_bf16 v[20:23], v[224:227], v[200:203], v[20:23]
v_mfma_f32_16x16x32_bf16 v[28:31], v[228:231], v[200:203], v[28:31]
v_mfma_f32_16x16x32_bf16 v[36:39], v[232:235], v[200:203], v[36:39]
v_mfma_f32_16x16x32_bf16 v[44:47], v[236:239], v[200:203], v[44:47]
v_mfma_f32_16x16x32_bf16 v[52:55], v[240:243], v[200:203], v[52:55]
v_mfma_f32_16x16x32_bf16 v[60:63], v[244:247], v[200:203], v[60:63]
v_mfma_f32_16x16x32_bf16 v[68:71], v[248:251], v[200:203], v[68:71]
v_mfma_f32_16x16x32_bf16 v[76:79], v[252:255], v[200:203], v[76:79]
v_mfma_f32_16x16x32_bf16 v[84:87], v[16:19], v[200:203], v[84:87]
v_mfma_f32_16x16x32_bf16 v[24:27], v[224:227], v[204:207], v[24:27]
v_mfma_f32_16x16x32_bf16 v[32:35], v[228:231], v[204:207], v[32:35]
v_mfma_f32_16x16x32_bf16 v[40:43], v[232:235], v[204:207], v[40:43]
v_mfma_f32_16x16x32_bf16 v[48:51], v[236:239], v[204:207], v[48:51]
v_mfma_f32_16x16x32_bf16 v[56:59], v[240:243], v[204:207], v[56:59]
v_mfma_f32_16x16x32_bf16 v[64:67], v[244:247], v[204:207], v[64:67]
v_mfma_f32_16x16x32_bf16 v[72:75], v[248:251], v[204:207], v[72:75]
v_mfma_f32_16x16x32_bf16 v[80:83], v[252:255], v[204:207], v[80:83]
v_mfma_f32_16x16x32_bf16 v[88:91], v[16:19], v[204:207], v[88:91]
s_nop 15
v_max3_f32 v2, v176, v177, v178
v_max3_f32 v2, v2, v179, v184
v_max3_f32 v2, v2, v185, v186
v_max_f32 v2, v2, v187
v_mov_b32 v3, v2
s_nop 1
v_permlane32_swap_b32 v2, v3
s_nop 1
v_max_f32 v2, v2, v3
v_mov_b32 v3, v2
s_nop 1
v_permlane16_swap_b32 v2, v3
s_nop 1
v_max_f32 v2, v2, v3
v_max_f32 v2, 0, v2
v_sub_f32 v176, v176, v2
v_sub_f32 v177, v177, v2
v_sub_f32 v178, v178, v2
v_sub_f32 v179, v179, v2
v_sub_f32 v184, v184, v2
v_sub_f32 v185, v185, v2
v_sub_f32 v186, v186, v2
v_sub_f32 v187, v187, v2
v_sub_f32 v212, v212, v2
v_sub_f32 v213, v213, v2
v_sub_f32 v214, v214, v2
v_sub_f32 v215, v215, v2
v_exp_f32 v3, -v2
s_nop 0
v_mul_f32 v20, v20, v3
v_mul_f32 v21, v21, v3
v_mul_f32 v22, v22, v3
v_mul_f32 v23, v23, v3
v_mul_f32 v28, v28, v3
v_mul_f32 v29, v29, v3
v_mul_f32 v30, v30, v3
v_mul_f32 v31, v31, v3
v_mul_f32 v36, v36, v3
v_mul_f32 v37, v37, v3
v_mul_f32 v38, v38, v3
v_mul_f32 v39, v39, v3
v_mul_f32 v44, v44, v3
v_mul_f32 v45, v45, v3
v_mul_f32 v46, v46, v3
v_mul_f32 v47, v47, v3
v_mul_f32 v52, v52, v3
v_mul_f32 v53, v53, v3
v_mul_f32 v54, v54, v3
v_mul_f32 v55, v55, v3
v_mul_f32 v60, v60, v3
v_mul_f32 v61, v61, v3
v_mul_f32 v62, v62, v3
v_mul_f32 v63, v63, v3
v_mul_f32 v68, v68, v3
v_mul_f32 v69, v69, v3
v_mul_f32 v70, v70, v3
v_mul_f32 v71, v71, v3
v_mul_f32 v76, v76, v3
v_mul_f32 v77, v77, v3
v_mul_f32 v78, v78, v3
v_mul_f32 v79, v79, v3
v_mul_f32 v84, v84, v3
v_mul_f32 v85, v85, v3
v_mul_f32 v86, v86, v3
v_mul_f32 v87, v87, v3
v_max3_f32 v2, v180, v181, v182
v_max3_f32 v2, v2, v183, v188
v_max3_f32 v2, v2, v189, v190
v_max_f32 v2, v2, v191
v_mov_b32 v3, v2
s_nop 1
v_permlane32_swap_b32 v2, v3
s_nop 1
v_max_f32 v2, v2, v3
v_mov_b32 v3, v2
s_nop 1
v_permlane16_swap_b32 v2, v3
s_nop 1
v_max_f32 v2, v2, v3
v_max_f32 v2, 0, v2
v_sub_f32 v180, v180, v2
v_sub_f32 v181, v181, v2
v_sub_f32 v182, v182, v2
v_sub_f32 v183, v183, v2
v_sub_f32 v188, v188, v2
v_sub_f32 v189, v189, v2
v_sub_f32 v190, v190, v2
v_sub_f32 v191, v191, v2
v_sub_f32 v216, v216, v2
v_sub_f32 v217, v217, v2
v_sub_f32 v218, v218, v2
v_sub_f32 v219, v219, v2
v_exp_f32 v3, -v2
s_nop 0
v_mul_f32 v24, v24, v3
v_mul_f32 v25, v25, v3
v_mul_f32 v26, v26, v3
v_mul_f32 v27, v27, v3
v_mul_f32 v32, v32, v3
v_mul_f32 v33, v33, v3
v_mul_f32 v34, v34, v3
v_mul_f32 v35, v35, v3
v_mul_f32 v40, v40, v3
v_mul_f32 v41, v41, v3
v_mul_f32 v42, v42, v3
v_mul_f32 v43, v43, v3
v_mul_f32 v48, v48, v3
v_mul_f32 v49, v49, v3
v_mul_f32 v50, v50, v3
v_mul_f32 v51, v51, v3
v_mul_f32 v56, v56, v3
v_mul_f32 v57, v57, v3
v_mul_f32 v58, v58, v3
v_mul_f32 v59, v59, v3
v_mul_f32 v64, v64, v3
v_mul_f32 v65, v65, v3
v_mul_f32 v66, v66, v3
v_mul_f32 v67, v67, v3
v_mul_f32 v72, v72, v3
v_mul_f32 v73, v73, v3
v_mul_f32 v74, v74, v3
v_mul_f32 v75, v75, v3
v_mul_f32 v80, v80, v3
v_mul_f32 v81, v81, v3
v_mul_f32 v82, v82, v3
v_mul_f32 v83, v83, v3
v_mul_f32 v88, v88, v3
v_mul_f32 v89, v89, v3
v_mul_f32 v90, v90, v3
v_mul_f32 v91, v91, v3
v_exp_f32 v176, v176
v_exp_f32 v177, v177
v_exp_f32 v178, v178
v_exp_f32 v179, v179
v_exp_f32 v184, v184
v_exp_f32 v185, v185
v_exp_f32 v186, v186
v_exp_f32 v187, v187
v_exp_f32 v180, v180
v_exp_f32 v181, v181
v_exp_f32 v182, v182
v_exp_f32 v183, v183
v_exp_f32 v188, v188
v_exp_f32 v189, v189
v_exp_f32 v190, v190
v_exp_f32 v191, v191
s_nop 0
v_cvt_pk_bf16_f32 v200, v176, v177
v_cvt_pk_bf16_f32 v201, v178, v179
v_cvt_pk_bf16_f32 v202, v184, v185
v_cvt_pk_bf16_f32 v203, v186, v187
v_cvt_pk_bf16_f32 v204, v180, v181
v_cvt_pk_bf16_f32 v205, v182, v183
v_cvt_pk_bf16_f32 v206, v188, v189
v_cvt_pk_bf16_f32 v207, v190, v191
s_waitcnt vmcnt(9)
s_barrier
s_add_u32 m0, s27, 43520
s_add_u32 s36, s29, 57344
buffer_load_dwordx4 v12, s[12:15], s36 offen nt lds
s_add_u32 m0, s27, 44608
s_add_u32 s36, s29, 58368
buffer_load_dwordx4 v12, s[12:15], s36 offen nt lds
s_add_u32 m0, s28, 52224
s_add_u32 s36, s33, 49152
buffer_load_dwordx4 v13, s[16:19], s36 offen nt lds
s_add_u32 m0, s28, 53280
s_add_u32 s36, s33, 49408
buffer_load_dwordx4 v13, s[16:19], s36 offen nt lds
ds_read_b128 v[224:227], v10 offset:0
ds_read_b128 v[228:231], v10 offset:64
ds_read_b128 v[232:235], v10 offset:128
ds_read_b128 v[236:239], v10 offset:192
ds_read_b128 v[240:243], v10 offset:4352
ds_read_b128 v[244:247], v10 offset:4416
ds_read_b128 v[248:251], v10 offset:4480
ds_read_b128 v[252:255], v10 offset:4544
s_branch W2_R3_back
W2_R4:
s_waitcnt lgkmcnt(0)
v_mfma_f32_16x16x32_bf16 v[20:23], v[224:227], v[200:203], v[20:23]
v_mfma_f32_16x16x32_bf16 v[28:31], v[228:231], v[200:203], v[28:31]
v_mfma_f32_16x16x32_bf16 v[36:39], v[232:235], v[200:203], v[36:39]
v_mfma_f32_16x16x32_bf16 v[44:47], v[236:239], v[200:203], v[44:47]
v_mfma_f32_16x16x32_bf16 v[52:55], v[240:243], v[200:203], v[52:55]
v_mfma_f32_16x16x32_bf16 v[60:63], v[244:247], v[200:203], v[60:63]
v_mfma_f32_16x16x32_bf16 v[68:71], v[248:251], v[200:203], v[68:71]
v_mfma_f32_16x16x32_bf16 v[76:79], v[252:255], v[200:203], v[76:79]
v_mfma_f32_16x16x32_bf16 v[84:87], v[16:19], v[200:203], v[84:87]
v_mfma_f32_16x16x32_bf16 v[24:27], v[224:227], v[204:207], v[24:27]
v_mfma_f32_16x16x32_bf16 v[32:35], v[228:231], v[204:207], v[32:35]
v_mfma_f32_16x16x32_bf16 v[40:43], v[232:235], v[204:207], v[40:43]
v_mfma_f32_16x16x32_bf16 v[48:51], v[236:239], v[204:207], v[48:51]
v_mfma_f32_16x16x32_bf16 v[56:59], v[240:243], v[204:207], v[56:59]
v_mfma_f32_16x16x32_bf16 v[64:67], v[244:247], v[204:207], v[64:67]
v_mfma_f32_16x16x32_bf16 v[72:75], v[248:251], v[204:207], v[72:75]
v_mfma_f32_16x16x32_bf16 v[80:83], v[252:255], v[204:207], v[80:83]
v_mfma_f32_16x16x32_bf16 v[88:91], v[16:19], v[204:207], v[88:91]
s_nop 15
v_max3_f32 v2, v176, v177, v178
v_max3_f32 v2, v2, v179, v184
v_max3_f32 v2, v2, v185, v186
v_max_f32 v2, v2, v187
v_mov_b32 v3, v2
s_nop 1
v_permlane32_swap_b32 v2, v3
s_nop 1
v_max_f32 v2, v2, v3
v_mov_b32 v3, v2
s_nop 1
v_permlane16_swap_b32 v2, v3
s_nop 1
v_max_f32 v2, v2, v3
v_max_f32 v2, 0, v2
v_sub_f32 v176, v176, v2
v_sub_f32 v177, v177, v2
v_sub_f32 v178, v178, v2
v_sub_f32 v179, v179, v2
v_sub_f32 v184, v184, v2
v_sub_f32 v185, v185, v2
v_sub_f32 v186, v186, v2
v_sub_f32 v187, v187, v2
v_sub_f32 v212, v212, v2
v_sub_f32 v213, v213, v2
v_sub_f32 v214, v214, v2
v_sub_f32 v215, v215, v2
v_exp_f32 v3, -v2
s_nop 0
v_mul_f32 v20, v20, v3
v_mul_f32 v21, v21, v3
v_mul_f32 v22, v22, v3
v_mul_f32 v23, v23, v3
v_mul_f32 v28, v28, v3
v_mul_f32 v29, v29, v3
v_mul_f32 v30, v30, v3
v_mul_f32 v31, v31, v3
v_mul_f32 v36, v36, v3
v_mul_f32 v37, v37, v3
v_mul_f32 v38, v38, v3
v_mul_f32 v39, v39, v3
v_mul_f32 v44, v44, v3
v_mul_f32 v45, v45, v3
v_mul_f32 v46, v46, v3
v_mul_f32 v47, v47, v3
v_mul_f32 v52, v52, v3
v_mul_f32 v53, v53, v3
v_mul_f32 v54, v54, v3
v_mul_f32 v55, v55, v3
v_mul_f32 v60, v60, v3
v_mul_f32 v61, v61, v3
v_mul_f32 v62, v62, v3
v_mul_f32 v63, v63, v3
v_mul_f32 v68, v68, v3
v_mul_f32 v69, v69, v3
v_mul_f32 v70, v70, v3
v_mul_f32 v71, v71, v3
v_mul_f32 v76, v76, v3
v_mul_f32 v77, v77, v3
v_mul_f32 v78, v78, v3
v_mul_f32 v79, v79, v3
v_mul_f32 v84, v84, v3
v_mul_f32 v85, v85, v3
v_mul_f32 v86, v86, v3
v_mul_f32 v87, v87, v3
v_max3_f32 v2, v180, v181, v182
v_max3_f32 v2, v2, v183, v188
v_max3_f32 v2, v2, v189, v190
v_max_f32 v2, v2, v191
v_mov_b32 v3, v2
s_nop 1
v_permlane32_swap_b32 v2, v3
s_nop 1
v_max_f32 v2, v2, v3
v_mov_b32 v3, v2
s_nop 1
v_permlane16_swap_b32 v2, v3
s_nop 1
v_max_f32 v2, v2, v3
v_max_f32 v2, 0, v2
v_sub_f32 v180, v180, v2
v_sub_f32 v181, v181, v2
v_sub_f32 v182, v182, v2
v_sub_f32 v183, v183, v2
v_sub_f32 v188, v188, v2
v_sub_f32 v189, v189, v2
v_sub_f32 v190, v190, v2
v_sub_f32 v191, v191, v2
v_sub_f32 v216, v216, v2
v_sub_f32 v217, v217, v2
v_sub_f32 v218, v218, v2
v_sub_f32 v219, v219, v2
v_exp_f32 v3, -v2
s_nop 0
v_mul_f32 v24, v24, v3
v_mul_f32 v25, v25, v3
v_mul_f32 v26, v26, v3
v_mul_f32 v27, v27, v3
v_mul_f32 v32, v32, v3
v_mul_f32 v33, v33, v3
v_mul_f32 v34, v34, v3
v_mul_f32 v35, v35, v3
v_mul_f32 v40, v40, v3
v_mul_f32 v41, v41, v3
v_mul_f32 v42, v42, v3
v_mul_f32 v43, v43, v3
v_mul_f32 v48, v48, v3
v_mul_f32 v49, v49, v3
v_mul_f32 v50, v50, v3
v_mul_f32 v51, v51, v3
v_mul_f32 v56, v56, v3
v_mul_f32 v57, v57, v3
v_mul_f32 v58, v58, v3
v_mul_f32 v59, v59, v3
v_mul_f32 v64, v64, v3
v_mul_f32 v65, v65, v3
v_mul_f32 v66, v66, v3
v_mul_f32 v67, v67, v3
v_mul_f32 v72, v72, v3
v_mul_f32 v73, v73, v3
v_mul_f32 v74, v74, v3
v_mul_f32 v75, v75, v3
v_mul_f32 v80, v80, v3
v_mul_f32 v81, v81, v3
v_mul_f32 v82, v82, v3
v_mul_f32 v83, v83, v3
v_mul_f32 v88, v88, v3
v_mul_f32 v89, v89, v3
v_mul_f32 v90, v90, v3
v_mul_f32 v91, v91, v3
v_exp_f32 v176, v176
v_exp_f32 v177, v177
v_exp_f32 v178, v178
v_exp_f32 v179, v179
v_exp_f32 v184, v184
v_exp_f32 v185, v185
v_exp_f32 v186, v186
v_exp_f32 v187, v187
v_exp_f32 v180, v180
v_exp_f32 v181, v181
v_exp_f32 v182, v182
v_exp_f32 v183, v183
v_exp_f32 v188, v188
v_exp_f32 v189, v189
v_exp_f32 v190, v190
v_exp_f32 v191, v191
s_nop 0
v_cvt_pk_bf16_f32 v200, v176, v177
v_cvt_pk_bf16_f32 v201, v178, v179
v_cvt_pk_bf16_f32 v202, v184, v185
v_cvt_pk_bf16_f32 v203, v186, v187
v_cvt_pk_bf16_f32 v204, v180, v181
v_cvt_pk_bf16_f32 v205, v182, v183
v_cvt_pk_bf16_f32 v206, v188, v189
v_cvt_pk_bf16_f32 v207, v190, v191
s_waitcnt vmcnt(9)
s_barrier
s_add_u32 m0, s27, 0
s_add_u32 s36, s29, 65536
buffer_load_dwordx4 v12, s[12:15], s36 offen nt lds
s_add_u32 m0, s27, 1088
s_add_u32 s36, s29, 66560
buffer_load_dwordx4 v12, s[12:15], s36 offen nt lds
s_add_u32 m0, s28, 60672
s_add_u32 s36, s33, 57344
buffer_load_dwordx4 v13, s[16:19], s36 offen nt lds
s_add_u32 m0, s28, 61728
s_add_u32 s36, s33, 57600
buffer_load_dwordx4 v13, s[16:19], s36 offen nt lds
ds_read_b128 v[224:227], v10 offset:8704
ds_read_b128 v[228:231], v10 offset:8768
ds_read_b128 v[232:235], v10 offset:8832
ds_read_b128 v[236:239], v10 offset:8896
ds_read_b128 v[240:243], v10 offset:13056
ds_read_b128 v[244:247], v10 offset:13120
ds_read_b128 v[248:251], v10 offset:13184
ds_read_b128 v[252:255], v10 offset:13248
s_branch W2_R4_back
W2_R5:
s_waitcnt lgkmcnt(0)
v_mfma_f32_16x16x32_bf16 v[20:23], v[224:227], v[200:203], v[20:23]
v_mfma_f32_16x16x32_bf16 v[28:31], v[228:231], v[200:203], v[28:31]
v_mfma_f32_16x16x32_bf16 v[36:39], v[232:235], v[200:203], v[36:39]
v_mfma_f32_16x16x32_bf16 v[44:47], v[236:239], v[200:203], v[44:47]
v_mfma_f32_16x16x32_bf16 v[52:55], v[240:243], v[200:203], v[52:55]
v_mfma_f32_16x16x32_bf16 v[60:63], v[244:247], v[200:203], v[60:63]
v_mfma_f32_16x16x32_bf16 v[68:71], v[248:251], v[200:203], v[68:71]
v_mfma_f32_16x16x32_bf16 v[76:79], v[252:255], v[200:203], v[76:79]
v_mfma_f32_16x16x32_bf16 v[84:87], v[16:19], v[200:203], v[84:87]
v_mfma_f32_16x16x32_bf16 v[24:27], v[224:227], v[204:207], v[24:27]
v_mfma_f32_16x16x32_bf16 v[32:35], v[228:231], v[204:207], v[32:35]
v_mfma_f32_16x16x32_bf16 v[40:43], v[232:235], v[204:207], v[40:43]
v_mfma_f32_16x16x32_bf16 v[48:51], v[236:239], v[204:207], v[48:51]
v_mfma_f32_16x16x32_bf16 v[56:59], v[240:243], v[204:207], v[56:59]
v_mfma_f32_16x16x32_bf16 v[64:67], v[244:247], v[204:207], v[64:67]
v_mfma_f32_16x16x32_bf16 v[72:75], v[248:251], v[204:207], v[72:75]
v_mfma_f32_16x16x32_bf16 v[80:83], v[252:255], v[204:207], v[80:83]
v_mfma_f32_16x16x32_bf16 v[88:91], v[16:19], v[204:207], v[88:91]
s_nop 15
v_max3_f32 v2, v176, v177, v178
v_max3_f32 v2, v2, v179, v184
v_max3_f32 v2, v2, v185, v186
v_max_f32 v2, v2, v187
v_mov_b32 v3, v2
s_nop 1
v_permlane32_swap_b32 v2, v3
s_nop 1
v_max_f32 v2, v2, v3
v_mov_b32 v3, v2
s_nop 1
v_permlane16_swap_b32 v2, v3
s_nop 1
v_max_f32 v2, v2, v3
v_max_f32 v2, 0, v2
v_sub_f32 v176, v176, v2
v_sub_f32 v177, v177, v2
v_sub_f32 v178, v178, v2
v_sub_f32 v179, v179, v2
v_sub_f32 v184, v184, v2
v_sub_f32 v185, v185, v2
v_sub_f32 v186, v186, v2
v_sub_f32 v187, v187, v2
v_sub_f32 v212, v212, v2
v_sub_f32 v213, v213, v2
v_sub_f32 v214, v214, v2
v_sub_f32 v215, v215, v2
v_exp_f32 v3, -v2
s_nop 0
v_mul_f32 v20, v20, v3
v_mul_f32 v21, v21, v3
v_mul_f32 v22, v22, v3
v_mul_f32 v23, v23, v3
v_mul_f32 v28, v28, v3
v_mul_f32 v29, v29, v3
v_mul_f32 v30, v30, v3
v_mul_f32 v31, v31, v3
v_mul_f32 v36, v36, v3
v_mul_f32 v37, v37, v3
v_mul_f32 v38, v38, v3
v_mul_f32 v39, v39, v3
v_mul_f32 v44, v44, v3
v_mul_f32 v45, v45, v3
v_mul_f32 v46, v46, v3
v_mul_f32 v47, v47, v3
v_mul_f32 v52, v52, v3
v_mul_f32 v53, v53, v3
v_mul_f32 v54, v54, v3
v_mul_f32 v55, v55, v3
v_mul_f32 v60, v60, v3
v_mul_f32 v61, v61, v3
v_mul_f32 v62, v62, v3
v_mul_f32 v63, v63, v3
v_mul_f32 v68, v68, v3
v_mul_f32 v69, v69, v3
v_mul_f32 v70, v70, v3
v_mul_f32 v71, v71, v3
v_mul_f32 v76, v76, v3
v_mul_f32 v77, v77, v3
v_mul_f32 v78, v78, v3
v_mul_f32 v79, v79, v3
v_mul_f32 v84, v84, v3
v_mul_f32 v85, v85, v3
v_mul_f32 v86, v86, v3
v_mul_f32 v87, v87, v3
v_max3_f32 v2, v180, v181, v182
v_max3_f32 v2, v2, v183, v188
v_max3_f32 v2, v2, v189, v190
v_max_f32 v2, v2, v191
v_mov_b32 v3, v2
s_nop 1
v_permlane32_swap_b32 v2, v3
s_nop 1
v_max_f32 v2, v2, v3
v_mov_b32 v3, v2
s_nop 1
v_permlane16_swap_b32 v2, v3
s_nop 1
v_max_f32 v2, v2, v3
v_max_f32 v2, 0, v2
v_sub_f32 v180, v180, v2
v_sub_f32 v181, v181, v2
v_sub_f32 v182, v182, v2
v_sub_f32 v183, v183, v2
v_sub_f32 v188, v188, v2
v_sub_f32 v189, v189, v2
v_sub_f32 v190, v190, v2
v_sub_f32 v191, v191, v2
v_sub_f32 v216, v216, v2
v_sub_f32 v217, v217, v2
v_sub_f32 v218, v218, v2
v_sub_f32 v219, v219, v2
v_exp_f32 v3, -v2
s_nop 0
v_mul_f32 v24, v24, v3
v_mul_f32 v25, v25, v3
v_mul_f32 v26, v26, v3
v_mul_f32 v27, v27, v3
v_mul_f32 v32, v32, v3
v_mul_f32 v33, v33, v3
v_mul_f32 v34, v34, v3
v_mul_f32 v35, v35, v3
v_mul_f32 v40, v40, v3
v_mul_f32 v41, v41, v3
v_mul_f32 v42, v42, v3
v_mul_f32 v43, v43, v3
v_mul_f32 v48, v48, v3
v_mul_f32 v49, v49, v3
v_mul_f32 v50, v50, v3
v_mul_f32 v51, v51, v3
v_mul_f32 v56, v56, v3
v_mul_f32 v57, v57, v3
v_mul_f32 v58, v58, v3
v_mul_f32 v59, v59, v3
v_mul_f32 v64, v64, v3
v_mul_f32 v65, v65, v3
v_mul_f32 v66, v66, v3
v_mul_f32 v67, v67, v3
v_mul_f32 v72, v72, v3
v_mul_f32 v73, v73, v3
v_mul_f32 v74, v74, v3
v_mul_f32 v75, v75, v3
v_mul_f32 v80, v80, v3
v_mul_f32 v81, v81, v3
v_mul_f32 v82, v82, v3
v_mul_f32 v83, v83, v3
v_mul_f32 v88, v88, v3
v_mul_f32 v89, v89, v3
v_mul_f32 v90, v90, v3
v_mul_f32 v91, v91, v3
v_exp_f32 v176, v176
v_exp_f32 v177, v177
v_exp_f32 v178, v178
v_exp_f32 v179, v179
v_exp_f32 v184, v184
v_exp_f32 v185, v185
v_exp_f32 v186, v186
v_exp_f32 v187, v187
v_exp_f32 v180, v180
v_exp_f32 v181, v181
v_exp_f32 v182, v182
v_exp_f32 v183, v183
v_exp_f32 v188, v188
v_exp_f32 v189, v189
v_exp_f32 v190, v190
v_exp_f32 v191, v191
s_nop 0
v_cvt_pk_bf16_f32 v200, v176, v177
v_cvt_pk_bf16_f32 v201, v178, v179
v_cvt_pk_bf16_f32 v202, v184, v185
v_cvt_pk_bf16_f32 v203, v186, v187
v_cvt_pk_bf16_f32 v204, v180, v181
v_cvt_pk_bf16_f32 v205, v182, v183
v_cvt_pk_bf16_f32 v206, v188, v189
v_cvt_pk_bf16_f32 v207, v190, v191
s_waitcnt vmcnt(8)
s_barrier
s_add_u32 m0, s27, 8704
s_add_u32 s36, s29, 73728
buffer_load_dwordx4 v12, s[12:15], s36 offen nt lds
s_add_u32 m0, s27, 9792
s_add_u32 s36, s29, 74752
buffer_load_dwordx4 v12, s[12:15], s36 offen nt lds
s_add_u32 m0, s28, 17408
s_add_u32 s36, s33, 65536
buffer_load_dwordx4 v13, s[16:19], s36 offen nt lds
s_add_u32 m0, s28, 18464
s_add_u32 s36, s33, 65792
buffer_load_dwordx4 v13, s[16:19], s36 offen nt lds
ds_read_b128 v[224:227], v10 offset:34816
ds_read_b128 v[228:231], v10 offset:34880
ds_read_b128 v[232:235], v10 offset:34944
ds_read_b128 v[236:239], v10 offset:35008
ds_read_b128 v[240:243], v10 offset:39168
ds_read_b128 v[244:247], v10 offset:39232
ds_read_b128 v[248:251], v10 offset:39296
ds_read_b128 v[252:255], v10 offset:39360
s_branch W2_R5_back
W2_R6:
s_waitcnt lgkmcnt(0)
v_mfma_f32_16x16x32_bf16 v[20:23], v[224:227], v[200:203], v[20:23]
v_mfma_f32_16x16x32_bf16 v[28:31], v[228:231], v[200:203], v[28:31]
v_mfma_f32_16x16x32_bf16 v[36:39], v[232:235], v[200:203], v[36:39]
v_mfma_f32_16x16x32_bf16 v[44:47], v[236:239], v[200:203], v[44:47]
v_mfma_f32_16x16x32_bf16 v[52:55], v[240:243], v[200:203], v[52:55]
v_mfma_f32_16x16x32_bf16 v[60:63], v[244:247], v[200:203], v[60:63]
v_mfma_f32_16x16x32_bf16 v[68:71], v[248:251], v[200:203], v[68:71]
v_mfma_f32_16x16x32_bf16 v[76:79], v[252:255], v[200:203], v[76:79]
v_mfma_f32_16x16x32_bf16 v[84:87], v[16:19], v[200:203], v[84:87]
v_mfma_f32_16x16x32_bf16 v[24:27], v[224:227], v[204:207], v[24:27]
v_mfma_f32_16x16x32_bf16 v[32:35], v[228:231], v[204:207], v[32:35]
v_mfma_f32_16x16x32_bf16 v[40:43], v[232:235], v[204:207], v[40:43]
v_mfma_f32_16x16x32_bf16 v[48:51], v[236:239], v[204:207], v[48:51]
v_mfma_f32_16x16x32_bf16 v[56:59], v[240:243], v[204:207], v[56:59]
v_mfma_f32_16x16x32_bf16 v[64:67], v[244:247], v[204:207], v[64:67]
v_mfma_f32_16x16x32_bf16 v[72:75], v[248:251], v[204:207], v[72:75]
v_mfma_f32_16x16x32_bf16 v[80:83], v[252:255], v[204:207], v[80:83]
v_mfma_f32_16x16x32_bf16 v[88:91], v[16:19], v[204:207], v[88:91]
s_nop 15
v_max3_f32 v2, v176, v177, v178
v_max3_f32 v2, v2, v179, v184
v_max3_f32 v2, v2, v185, v186
v_max_f32 v2, v2, v187
v_mov_b32 v3, v2
s_nop 1
v_permlane32_swap_b32 v2, v3
s_nop 1
v_max_f32 v2, v2, v3
v_mov_b32 v3, v2
s_nop 1
v_permlane16_swap_b32 v2, v3
s_nop 1
v_max_f32 v2, v2, v3
v_max_f32 v2, 0, v2
v_sub_f32 v176, v176, v2
v_sub_f32 v177, v177, v2
v_sub_f32 v178, v178, v2
v_sub_f32 v179, v179, v2
v_sub_f32 v184, v184, v2
v_sub_f32 v185, v185, v2
v_sub_f32 v186, v186, v2
v_sub_f32 v187, v187, v2
v_sub_f32 v212, v212, v2
v_sub_f32 v213, v213, v2
v_sub_f32 v214, v214, v2
v_sub_f32 v215, v215, v2
v_exp_f32 v3, -v2
s_nop 0
v_mul_f32 v20, v20, v3
v_mul_f32 v21, v21, v3
v_mul_f32 v22, v22, v3
v_mul_f32 v23, v23, v3
v_mul_f32 v28, v28, v3
v_mul_f32 v29, v29, v3
v_mul_f32 v30, v30, v3
v_mul_f32 v31, v31, v3
v_mul_f32 v36, v36, v3
v_mul_f32 v37, v37, v3
v_mul_f32 v38, v38, v3
v_mul_f32 v39, v39, v3
v_mul_f32 v44, v44, v3
v_mul_f32 v45, v45, v3
v_mul_f32 v46, v46, v3
v_mul_f32 v47, v47, v3
v_mul_f32 v52, v52, v3
v_mul_f32 v53, v53, v3
v_mul_f32 v54, v54, v3
v_mul_f32 v55, v55, v3
v_mul_f32 v60, v60, v3
v_mul_f32 v61, v61, v3
v_mul_f32 v62, v62, v3
v_mul_f32 v63, v63, v3
v_mul_f32 v68, v68, v3
v_mul_f32 v69, v69, v3
v_mul_f32 v70, v70, v3
v_mul_f32 v71, v71, v3
v_mul_f32 v76, v76, v3
v_mul_f32 v77, v77, v3
v_mul_f32 v78, v78, v3
v_mul_f32 v79, v79, v3
v_mul_f32 v84, v84, v3
v_mul_f32 v85, v85, v3
v_mul_f32 v86, v86, v3
v_mul_f32 v87, v87, v3
v_max3_f32 v2, v180, v181, v182
v_max3_f32 v2, v2, v183, v188
v_max3_f32 v2, v2, v189, v190
v_max_f32 v2, v2, v191
v_mov_b32 v3, v2
s_nop 1
v_permlane32_swap_b32 v2, v3
s_nop 1
v_max_f32 v2, v2, v3
v_mov_b32 v3, v2
s_nop 1
v_permlane16_swap_b32 v2, v3
s_nop 1
v_max_f32 v2, v2, v3
v_max_f32 v2, 0, v2
v_sub_f32 v180, v180, v2
v_sub_f32 v181, v181, v2
v_sub_f32 v182, v182, v2
v_sub_f32 v183, v183, v2
v_sub_f32 v188, v188, v2
v_sub_f32 v189, v189, v2
v_sub_f32 v190, v190, v2
v_sub_f32 v191, v191, v2
v_sub_f32 v216, v216, v2
v_sub_f32 v217, v217, v2
v_sub_f32 v218, v218, v2
v_sub_f32 v219, v219, v2
v_exp_f32 v3, -v2
s_nop 0
v_mul_f32 v24, v24, v3
v_mul_f32 v25, v25, v3
v_mul_f32 v26, v26, v3
v_mul_f32 v27, v27, v3
v_mul_f32 v32, v32, v3
v_mul_f32 v33, v33, v3
v_mul_f32 v34, v34, v3
v_mul_f32 v35, v35, v3
v_mul_f32 v40, v40, v3
v_mul_f32 v41, v41, v3
v_mul_f32 v42, v42, v3
v_mul_f32 v43, v43, v3
v_mul_f32 v48, v48, v3
v_mul_f32 v49, v49, v3
v_mul_f32 v50, v50, v3
v_mul_f32 v51, v51, v3
v_mul_f32 v56, v56, v3
v_mul_f32 v57, v57, v3
v_mul_f32 v58, v58, v3
v_mul_f32 v59, v59, v3
v_mul_f32 v64, v64, v3
v_mul_f32 v65, v65, v3
v_mul_f32 v66, v66, v3
v_mul_f32 v67, v67, v3
v_mul_f32 v72, v72, v3
v_mul_f32 v73, v73, v3
v_mul_f32 v74, v74, v3
v_mul_f32 v75, v75, v3
v_mul_f32 v80, v80, v3
v_mul_f32 v81, v81, v3
v_mul_f32 v82, v82, v3
v_mul_f32 v83, v83, v3
v_mul_f32 v88, v88, v3
v_mul_f32 v89, v89, v3
v_mul_f32 v90, v90, v3
v_mul_f32 v91, v91, v3
v_exp_f32 v176, v176
v_exp_f32 v177, v177
v_exp_f32 v178, v178
v_exp_f32 v179, v179
v_exp_f32 v184, v184
v_exp_f32 v185, v185
v_exp_f32 v186, v186
v_exp_f32 v187, v187
v_exp_f32 v180, v180
v_exp_f32 v181, v181
v_exp_f32 v182, v182
v_exp_f32 v183, v183
v_exp_f32 v188, v188
v_exp_f32 v189, v189
v_exp_f32 v190, v190
v_exp_f32 v191, v191
s_nop 0
v_cvt_pk_bf16_f32 v200, v176, v177
v_cvt_pk_bf16_f32 v201, v178, v179
v_cvt_pk_bf16_f32 v202, v184, v185
v_cvt_pk_bf16_f32 v203, v186, v187
v_cvt_pk_bf16_f32 v204, v180, v181
v_cvt_pk_bf16_f32 v205, v182, v183
v_cvt_pk_bf16_f32 v206, v188, v189
v_cvt_pk_bf16_f32 v207, v190, v191
s_waitcnt vmcnt(8)
s_barrier
s_add_u32 m0, s27, 34816
s_add_u32 s36, s29, 81920
buffer_load_dwordx4 v12, s[12:15], s36 offen nt lds
s_add_u32 m0, s27, 35904
s_add_u32 s36, s29, 82944
buffer_load_dwordx4 v12, s[12:15], s36 offen nt lds
s_add_u32 m0, s28, 25856
s_add_u32 s36, s33, 73728
buffer_load_dwordx4 v13, s[16:19], s36 offen nt lds
s_add_u32 m0, s28, 26912
s_add_u32 s36, s33, 73984
buffer_load_dwordx4 v13, s[16:19], s36 offen nt lds
ds_read_b128 v[224:227], v10 offset:43520
ds_read_b128 v[228:231], v10 offset:43584
ds_read_b128 v[232:235], v10 offset:43648
ds_read_b128 v[236:239], v10 offset:43712
ds_read_b128 v[240:243], v10 offset:47872
ds_read_b128 v[244:247], v10 offset:47936
ds_read_b128 v[248:251], v10 offset:48000
ds_read_b128 v[252:255], v10 offset:48064
s_branch W2_R6_back
W2_R7:
s_waitcnt lgkmcnt(0)
v_mfma_f32_16x16x32_bf16 v[20:23], v[224:227], v[200:203], v[20:23]
v_mfma_f32_16x16x32_bf16 v[28:31], v[228:231], v[200:203], v[28:31]
v_mfma_f32_16x16x32_bf16 v[36:39], v[232:235], v[200:203], v[36:39]
v_mfma_f32_16x16x32_bf16 v[44:47], v[236:239], v[200:203], v[44:47]
v_mfma_f32_16x16x32_bf16 v[52:55], v[240:243], v[200:203], v[52:55]
v_mfma_f32_16x16x32_bf16 v[60:63], v[244:247], v[200:203], v[60:63]
v_mfma_f32_16x16x32_bf16 v[68:71], v[248:251], v[200:203], v[68:71]
v_mfma_f32_16x16x32_bf16 v[76:79], v[252:255], v[200:203], v[76:79]
v_mfma_f32_16x16x32_bf16 v[84:87], v[16:19], v[200:203], v[84:87]
v_mfma_f32_16x16x32_bf16 v[24:27], v[224:227], v[204:207], v[24:27]
v_mfma_f32_16x16x32_bf16 v[32:35], v[228:231], v[204:207], v[32:35]
v_mfma_f32_16x16x32_bf16 v[40:43], v[232:235], v[204:207], v[40:43]
v_mfma_f32_16x16x32_bf16 v[48:51], v[236:239], v[204:207], v[48:51]
v_mfma_f32_16x16x32_bf16 v[56:59], v[240:243], v[204:207], v[56:59]
v_mfma_f32_16x16x32_bf16 v[64:67], v[244:247], v[204:207], v[64:67]
v_mfma_f32_16x16x32_bf16 v[72:75], v[248:251], v[204:207], v[72:75]
v_mfma_f32_16x16x32_bf16 v[80:83], v[252:255], v[204:207], v[80:83]
v_mfma_f32_16x16x32_bf16 v[88:91], v[16:19], v[204:207], v[88:91]
s_nop 15
v_max3_f32 v2, v176, v177, v178
v_max3_f32 v2, v2, v179, v184
v_max3_f32 v2, v2, v185, v186
v_max_f32 v2, v2, v187
v_mov_b32 v3, v2
s_nop 1
v_permlane32_swap_b32 v2, v3
s_nop 1
v_max_f32 v2, v2, v3
v_mov_b32 v3, v2
s_nop 1
v_permlane16_swap_b32 v2, v3
s_nop 1
v_max_f32 v2, v2, v3
v_max_f32 v2, 0, v2
v_sub_f32 v176, v176, v2
v_sub_f32 v177, v177, v2
v_sub_f32 v178, v178, v2
v_sub_f32 v179, v179, v2
v_sub_f32 v184, v184, v2
v_sub_f32 v185, v185, v2
v_sub_f32 v186, v186, v2
v_sub_f32 v187, v187, v2
v_sub_f32 v212, v212, v2
v_sub_f32 v213, v213, v2
v_sub_f32 v214, v214, v2
v_sub_f32 v215, v215, v2
v_exp_f32 v3, -v2
s_nop 0
v_mul_f32 v20, v20, v3
v_mul_f32 v21, v21, v3
v_mul_f32 v22, v22, v3
v_mul_f32 v23, v23, v3
v_mul_f32 v28, v28, v3
v_mul_f32 v29, v29, v3
v_mul_f32 v30, v30, v3
v_mul_f32 v31, v31, v3
v_mul_f32 v36, v36, v3
v_mul_f32 v37, v37, v3
v_mul_f32 v38, v38, v3
v_mul_f32 v39, v39, v3
v_mul_f32 v44, v44, v3
v_mul_f32 v45, v45, v3
v_mul_f32 v46, v46, v3
v_mul_f32 v47, v47, v3
v_mul_f32 v52, v52, v3
v_mul_f32 v53, v53, v3
v_mul_f32 v54, v54, v3
v_mul_f32 v55, v55, v3
v_mul_f32 v60, v60, v3
v_mul_f32 v61, v61, v3
v_mul_f32 v62, v62, v3
v_mul_f32 v63, v63, v3
v_mul_f32 v68, v68, v3
v_mul_f32 v69, v69, v3
v_mul_f32 v70, v70, v3
v_mul_f32 v71, v71, v3
v_mul_f32 v76, v76, v3
v_mul_f32 v77, v77, v3
v_mul_f32 v78, v78, v3
v_mul_f32 v79, v79, v3
v_mul_f32 v84, v84, v3
v_mul_f32 v85, v85, v3
v_mul_f32 v86, v86, v3
v_mul_f32 v87, v87, v3
v_max3_f32 v2, v180, v181, v182
v_max3_f32 v2, v2, v183, v188
v_max3_f32 v2, v2, v189, v190
v_max_f32 v2, v2, v191
v_mov_b32 v3, v2
s_nop 1
v_permlane32_swap_b32 v2, v3
s_nop 1
v_max_f32 v2, v2, v3
v_mov_b32 v3, v2
s_nop 1
v_permlane16_swap_b32 v2, v3
s_nop 1
v_max_f32 v2, v2, v3
v_max_f32 v2, 0, v2
v_sub_f32 v180, v180, v2
v_sub_f32 v181, v181, v2
v_sub_f32 v182, v182, v2
v_sub_f32 v183, v183, v2
v_sub_f32 v188, v188, v2
v_sub_f32 v189, v189, v2
v_sub_f32 v190, v190, v2
v_sub_f32 v191, v191, v2
v_sub_f32 v216, v216, v2
v_sub_f32 v217, v217, v2
v_sub_f32 v218, v218, v2
v_sub_f32 v219, v219, v2
v_exp_f32 v3, -v2
s_nop 0
v_mul_f32 v24, v24, v3
v_mul_f32 v25, v25, v3
v_mul_f32 v26, v26, v3
v_mul_f32 v27, v27, v3
v_mul_f32 v32, v32, v3
v_mul_f32 v33, v33, v3
v_mul_f32 v34, v34, v3
v_mul_f32 v35, v35, v3
v_mul_f32 v40, v40, v3
v_mul_f32 v41, v41, v3
v_mul_f32 v42, v42, v3
v_mul_f32 v43, v43, v3
v_mul_f32 v48, v48, v3
v_mul_f32 v49, v49, v3
v_mul_f32 v50, v50, v3
v_mul_f32 v51, v51, v3
v_mul_f32 v56, v56, v3
v_mul_f32 v57, v57, v3
v_mul_f32 v58, v58, v3
v_mul_f32 v59, v59, v3
v_mul_f32 v64, v64, v3
v_mul_f32 v65, v65, v3
v_mul_f32 v66, v66, v3
v_mul_f32 v67, v67, v3
v_mul_f32 v72, v72, v3
v_mul_f32 v73, v73, v3
v_mul_f32 v74, v74, v3
v_mul_f32 v75, v75, v3
v_mul_f32 v80, v80, v3
v_mul_f32 v81, v81, v3
v_mul_f32 v82, v82, v3
v_mul_f32 v83, v83, v3
v_mul_f32 v88, v88, v3
v_mul_f32 v89, v89, v3
v_mul_f32 v90, v90, v3
v_mul_f32 v91, v91, v3
v_exp_f32 v176, v176
v_exp_f32 v177, v177
v_exp_f32 v178, v178
v_exp_f32 v179, v179
v_exp_f32 v184, v184
v_exp_f32 v185, v185
v_exp_f32 v186, v186
v_exp_f32 v187, v187
v_exp_f32 v180, v180
v_exp_f32 v181, v181
v_exp_f32 v182, v182
v_exp_f32 v183, v183
v_exp_f32 v188, v188
v_exp_f32 v189, v189
v_exp_f32 v190, v190
v_exp_f32 v191, v191
s_nop 0
v_cvt_pk_bf16_f32 v200, v176, v177
v_cvt_pk_bf16_f32 v201, v178, v179
v_cvt_pk_bf16_f32 v202, v184, v185
v_cvt_pk_bf16_f32 v203, v186, v187
v_cvt_pk_bf16_f32 v204, v180, v181
v_cvt_pk_bf16_f32 v205, v182, v183
v_cvt_pk_bf16_f32 v206, v188, v189
v_cvt_pk_bf16_f32 v207, v190, v191
s_waitcnt vmcnt(8)
s_barrier
s_add_u32 m0, s27, 43520
s_add_u32 s36, s29, 90112
buffer_load_dwordx4 v12, s[12:15], s36 offen nt lds
s_add_u32 m0, s27, 44608
s_add_u32 s36, s29, 91136
buffer_load_dwordx4 v12, s[12:15], s36 offen nt lds
s_add_u32 m0, s28, 52224
s_add_u32 s36, s33, 81920
buffer_load_dwordx4 v13, s[16:19], s36 offen nt lds
s_add_u32 m0, s28, 53280
s_add_u32 s36, s33, 82176
buffer_load_dwordx4 v13, s[16:19], s36 offen nt lds
ds_read_b128 v[224:227], v10 offset:0
ds_read_b128 v[228:231], v10 offset:64
ds_read_b128 v[232:235], v10 offset:128
ds_read_b128 v[236:239], v10 offset:192
ds_read_b128 v[240:243], v10 offset:4352
ds_read_b128 v[244:247], v10 offset:4416
ds_read_b128 v[248:251], v10 offset:4480
ds_read_b128 v[252:255], v10 offset:4544
s_branch W2_R7_back
W2_R8:
s_waitcnt lgkmcnt(0)
v_mfma_f32_16x16x32_bf16 v[20:23], v[224:227], v[200:203], v[20:23]
v_mfma_f32_16x16x32_bf16 v[28:31], v[228:231], v[200:203], v[28:31]
v_mfma_f32_16x16x32_bf16 v[36:39], v[232:235], v[200:203], v[36:39]
v_mfma_f32_16x16x32_bf16 v[44:47], v[236:239], v[200:203], v[44:47]
v_mfma_f32_16x16x32_bf16 v[52:55], v[240:243], v[200:203], v[52:55]
v_mfma_f32_16x16x32_bf16 v[60:63], v[244:247], v[200:203], v[60:63]
v_mfma_f32_16x16x32_bf16 v[68:71], v[248:251], v[200:203], v[68:71]
v_mfma_f32_16x16x32_bf16 v[76:79], v[252:255], v[200:203], v[76:79]
v_mfma_f32_16x16x32_bf16 v[84:87], v[16:19], v[200:203], v[84:87]
v_mfma_f32_16x16x32_bf16 v[24:27], v[224:227], v[204:207], v[24:27]
v_mfma_f32_16x16x32_bf16 v[32:35], v[228:231], v[204:207], v[32:35]
v_mfma_f32_16x16x32_bf16 v[40:43], v[232:235], v[204:207], v[40:43]
v_mfma_f32_16x16x32_bf16 v[48:51], v[236:239], v[204:207], v[48:51]
v_mfma_f32_16x16x32_bf16 v[56:59], v[240:243], v[204:207], v[56:59]
v_mfma_f32_16x16x32_bf16 v[64:67], v[244:247], v[204:207], v[64:67]
v_mfma_f32_16x16x32_bf16 v[72:75], v[248:251], v[204:207], v[72:75]
v_mfma_f32_16x16x32_bf16 v[80:83], v[252:255], v[204:207], v[80:83]
v_mfma_f32_16x16x32_bf16 v[88:91], v[16:19], v[204:207], v[88:91]
s_nop 15
v_max3_f32 v2, v176, v177, v178
v_max3_f32 v2, v2, v179, v184
v_max3_f32 v2, v2, v185, v186
v_max_f32 v2, v2, v187
v_mov_b32 v3, v2
s_nop 1
v_permlane32_swap_b32 v2, v3
s_nop 1
v_max_f32 v2, v2, v3
v_mov_b32 v3, v2
s_nop 1
v_permlane16_swap_b32 v2, v3
s_nop 1
v_max_f32 v2, v2, v3
v_max_f32 v2, 0, v2
v_sub_f32 v176, v176, v2
v_sub_f32 v177, v177, v2
v_sub_f32 v178, v178, v2
v_sub_f32 v179, v179, v2
v_sub_f32 v184, v184, v2
v_sub_f32 v185, v185, v2
v_sub_f32 v186, v186, v2
v_sub_f32 v187, v187, v2
v_sub_f32 v212, v212, v2
v_sub_f32 v213, v213, v2
v_sub_f32 v214, v214, v2
v_sub_f32 v215, v215, v2
v_exp_f32 v3, -v2
s_nop 0
v_mul_f32 v20, v20, v3
v_mul_f32 v21, v21, v3
v_mul_f32 v22, v22, v3
v_mul_f32 v23, v23, v3
v_mul_f32 v28, v28, v3
v_mul_f32 v29, v29, v3
v_mul_f32 v30, v30, v3
v_mul_f32 v31, v31, v3
v_mul_f32 v36, v36, v3
v_mul_f32 v37, v37, v3
v_mul_f32 v38, v38, v3
v_mul_f32 v39, v39, v3
v_mul_f32 v44, v44, v3
v_mul_f32 v45, v45, v3
v_mul_f32 v46, v46, v3
v_mul_f32 v47, v47, v3
v_mul_f32 v52, v52, v3
v_mul_f32 v53, v53, v3
v_mul_f32 v54, v54, v3
v_mul_f32 v55, v55, v3
v_mul_f32 v60, v60, v3
v_mul_f32 v61, v61, v3
v_mul_f32 v62, v62, v3
v_mul_f32 v63, v63, v3
v_mul_f32 v68, v68, v3
v_mul_f32 v69, v69, v3
v_mul_f32 v70, v70, v3
v_mul_f32 v71, v71, v3
v_mul_f32 v76, v76, v3
v_mul_f32 v77, v77, v3
v_mul_f32 v78, v78, v3
v_mul_f32 v79, v79, v3
v_mul_f32 v84, v84, v3
v_mul_f32 v85, v85, v3
v_mul_f32 v86, v86, v3
v_mul_f32 v87, v87, v3
v_max3_f32 v2, v180, v181, v182
v_max3_f32 v2, v2, v183, v188
v_max3_f32 v2, v2, v189, v190
v_max_f32 v2, v2, v191
v_mov_b32 v3, v2
s_nop 1
v_permlane32_swap_b32 v2, v3
s_nop 1
v_max_f32 v2, v2, v3
v_mov_b32 v3, v2
s_nop 1
v_permlane16_swap_b32 v2, v3
s_nop 1
v_max_f32 v2, v2, v3
v_max_f32 v2, 0, v2
v_sub_f32 v180, v180, v2
v_sub_f32 v181, v181, v2
v_sub_f32 v182, v182, v2
v_sub_f32 v183, v183, v2
v_sub_f32 v188, v188, v2
v_sub_f32 v189, v189, v2
v_sub_f32 v190, v190, v2
v_sub_f32 v191, v191, v2
v_sub_f32 v216, v216, v2
v_sub_f32 v217, v217, v2
v_sub_f32 v218, v218, v2
v_sub_f32 v219, v219, v2
v_exp_f32 v3, -v2
s_nop 0
v_mul_f32 v24, v24, v3
v_mul_f32 v25, v25, v3
v_mul_f32 v26, v26, v3
v_mul_f32 v27, v27, v3
v_mul_f32 v32, v32, v3
v_mul_f32 v33, v33, v3
v_mul_f32 v34, v34, v3
v_mul_f32 v35, v35, v3
v_mul_f32 v40, v40, v3
v_mul_f32 v41, v41, v3
v_mul_f32 v42, v42, v3
v_mul_f32 v43, v43, v3
v_mul_f32 v48, v48, v3
v_mul_f32 v49, v49, v3
v_mul_f32 v50, v50, v3
v_mul_f32 v51, v51, v3
v_mul_f32 v56, v56, v3
v_mul_f32 v57, v57, v3
v_mul_f32 v58, v58, v3
v_mul_f32 v59, v59, v3
v_mul_f32 v64, v64, v3
v_mul_f32 v65, v65, v3
v_mul_f32 v66, v66, v3
v_mul_f32 v67, v67, v3
v_mul_f32 v72, v72, v3
v_mul_f32 v73, v73, v3
v_mul_f32 v74, v74, v3
v_mul_f32 v75, v75, v3
v_mul_f32 v80, v80, v3
v_mul_f32 v81, v81, v3
v_mul_f32 v82, v82, v3
v_mul_f32 v83, v83, v3
v_mul_f32 v88, v88, v3
v_mul_f32 v89, v89, v3
v_mul_f32 v90, v90, v3
v_mul_f32 v91, v91, v3
v_exp_f32 v176, v176
v_exp_f32 v177, v177
v_exp_f32 v178, v178
v_exp_f32 v179, v179
v_exp_f32 v184, v184
v_exp_f32 v185, v185
v_exp_f32 v186, v186
v_exp_f32 v187, v187
v_exp_f32 v180, v180
v_exp_f32 v181, v181
v_exp_f32 v182, v182
v_exp_f32 v183, v183
v_exp_f32 v188, v188
v_exp_f32 v189, v189
v_exp_f32 v190, v190
v_exp_f32 v191, v191
s_nop 0
v_cvt_pk_bf16_f32 v200, v176, v177
v_cvt_pk_bf16_f32 v201, v178, v179
v_cvt_pk_bf16_f32 v202, v184, v185
v_cvt_pk_bf16_f32 v203, v186, v187
v_cvt_pk_bf16_f32 v204, v180, v181
v_cvt_pk_bf16_f32 v205, v182, v183
v_cvt_pk_bf16_f32 v206, v188, v189
v_cvt_pk_bf16_f32 v207, v190, v191
s_waitcnt vmcnt(8)
s_barrier
s_add_u32 m0, s27, 0
s_add_u32 s36, s29, 98304
buffer_load_dwordx4 v12, s[12:15], s36 offen nt lds
s_add_u32 m0, s27, 1088
s_add_u32 s36, s29, 99328
buffer_load_dwordx4 v12, s[12:15], s36 offen nt lds
s_add_u32 m0, s28, 60672
s_add_u32 s36, s33, 90112
buffer_load_dwordx4 v13, s[16:19], s36 offen nt lds
s_add_u32 m0, s28, 61728
s_add_u32 s36, s33, 90368
buffer_load_dwordx4 v13, s[16:19], s36 offen nt lds
ds_read_b128 v[224:227], v10 offset:8704
ds_read_b128 v[228:231], v10 offset:8768
ds_read_b128 v[232:235], v10 offset:8832
ds_read_b128 v[236:239], v10 offset:8896
ds_read_b128 v[240:243], v10 offset:13056
ds_read_b128 v[244:247], v10 offset:13120
ds_read_b128 v[248:251], v10 offset:13184
ds_read_b128 v[252:255], v10 offset:13248
s_branch W2_R8_back
W2_R9:
s_waitcnt lgkmcnt(0)
v_mfma_f32_16x16x32_bf16 v[20:23], v[224:227], v[200:203], v[20:23]
v_mfma_f32_16x16x32_bf16 v[28:31], v[228:231], v[200:203], v[28:31]
v_mfma_f32_16x16x32_bf16 v[36:39], v[232:235], v[200:203], v[36:39]
v_mfma_f32_16x16x32_bf16 v[44:47], v[236:239], v[200:203], v[44:47]
v_mfma_f32_16x16x32_bf16 v[52:55], v[240:243], v[200:203], v[52:55]
v_mfma_f32_16x16x32_bf16 v[60:63], v[244:247], v[200:203], v[60:63]
v_mfma_f32_16x16x32_bf16 v[68:71], v[248:251], v[200:203], v[68:71]
v_mfma_f32_16x16x32_bf16 v[76:79], v[252:255], v[200:203], v[76:79]
v_mfma_f32_16x16x32_bf16 v[84:87], v[16:19], v[200:203], v[84:87]
v_mfma_f32_16x16x32_bf16 v[24:27], v[224:227], v[204:207], v[24:27]
v_mfma_f32_16x16x32_bf16 v[32:35], v[228:231], v[204:207], v[32:35]
v_mfma_f32_16x16x32_bf16 v[40:43], v[232:235], v[204:207], v[40:43]
v_mfma_f32_16x16x32_bf16 v[48:51], v[236:239], v[204:207], v[48:51]
v_mfma_f32_16x16x32_bf16 v[56:59], v[240:243], v[204:207], v[56:59]
v_mfma_f32_16x16x32_bf16 v[64:67], v[244:247], v[204:207], v[64:67]
v_mfma_f32_16x16x32_bf16 v[72:75], v[248:251], v[204:207], v[72:75]
v_mfma_f32_16x16x32_bf16 v[80:83], v[252:255], v[204:207], v[80:83]
v_mfma_f32_16x16x32_bf16 v[88:91], v[16:19], v[204:207], v[88:91]
s_nop 15
v_max3_f32 v2, v176, v177, v178
v_max3_f32 v2, v2, v179, v184
v_max3_f32 v2, v2, v185, v186
v_max_f32 v2, v2, v187
v_mov_b32 v3, v2
s_nop 1
v_permlane32_swap_b32 v2, v3
s_nop 1
v_max_f32 v2, v2, v3
v_mov_b32 v3, v2
s_nop 1
v_permlane16_swap_b32 v2, v3
s_nop 1
v_max_f32 v2, v2, v3
v_max_f32 v2, 0, v2
v_sub_f32 v176, v176, v2
v_sub_f32 v177, v177, v2
v_sub_f32 v178, v178, v2
v_sub_f32 v179, v179, v2
v_sub_f32 v184, v184, v2
v_sub_f32 v185, v185, v2
v_sub_f32 v186, v186, v2
v_sub_f32 v187, v187, v2
v_sub_f32 v212, v212, v2
v_sub_f32 v213, v213, v2
v_sub_f32 v214, v214, v2
v_sub_f32 v215, v215, v2
v_exp_f32 v3, -v2
s_nop 0
v_mul_f32 v20, v20, v3
v_mul_f32 v21, v21, v3
v_mul_f32 v22, v22, v3
v_mul_f32 v23, v23, v3
v_mul_f32 v28, v28, v3
v_mul_f32 v29, v29, v3
v_mul_f32 v30, v30, v3
v_mul_f32 v31, v31, v3
v_mul_f32 v36, v36, v3
v_mul_f32 v37, v37, v3
v_mul_f32 v38, v38, v3
v_mul_f32 v39, v39, v3
v_mul_f32 v44, v44, v3
v_mul_f32 v45, v45, v3
v_mul_f32 v46, v46, v3
v_mul_f32 v47, v47, v3
v_mul_f32 v52, v52, v3
v_mul_f32 v53, v53, v3
v_mul_f32 v54, v54, v3
v_mul_f32 v55, v55, v3
v_mul_f32 v60, v60, v3
v_mul_f32 v61, v61, v3
v_mul_f32 v62, v62, v3
v_mul_f32 v63, v63, v3
v_mul_f32 v68, v68, v3
v_mul_f32 v69, v69, v3
v_mul_f32 v70, v70, v3
v_mul_f32 v71, v71, v3
v_mul_f32 v76, v76, v3
v_mul_f32 v77, v77, v3
v_mul_f32 v78, v78, v3
v_mul_f32 v79, v79, v3
v_mul_f32 v84, v84, v3
v_mul_f32 v85, v85, v3
v_mul_f32 v86, v86, v3
v_mul_f32 v87, v87, v3
v_max3_f32 v2, v180, v181, v182
v_max3_f32 v2, v2, v183, v188
v_max3_f32 v2, v2, v189, v190
v_max_f32 v2, v2, v191
v_mov_b32 v3, v2
s_nop 1
v_permlane32_swap_b32 v2, v3
s_nop 1
v_max_f32 v2, v2, v3
v_mov_b32 v3, v2
s_nop 1
v_permlane16_swap_b32 v2, v3
s_nop 1
v_max_f32 v2, v2, v3
v_max_f32 v2, 0, v2
v_sub_f32 v180, v180, v2
v_sub_f32 v181, v181, v2
v_sub_f32 v182, v182, v2
v_sub_f32 v183, v183, v2
v_sub_f32 v188, v188, v2
v_sub_f32 v189, v189, v2
v_sub_f32 v190, v190, v2
v_sub_f32 v191, v191, v2
v_sub_f32 v216, v216, v2
v_sub_f32 v217, v217, v2
v_sub_f32 v218, v218, v2
v_sub_f32 v219, v219, v2
v_exp_f32 v3, -v2
s_nop 0
v_mul_f32 v24, v24, v3
v_mul_f32 v25, v25, v3
v_mul_f32 v26, v26, v3
v_mul_f32 v27, v27, v3
v_mul_f32 v32, v32, v3
v_mul_f32 v33, v33, v3
v_mul_f32 v34, v34, v3
v_mul_f32 v35, v35, v3
v_mul_f32 v40, v40, v3
v_mul_f32 v41, v41, v3
v_mul_f32 v42, v42, v3
v_mul_f32 v43, v43, v3
v_mul_f32 v48, v48, v3
v_mul_f32 v49, v49, v3
v_mul_f32 v50, v50, v3
v_mul_f32 v51, v51, v3
v_mul_f32 v56, v56, v3
v_mul_f32 v57, v57, v3
v_mul_f32 v58, v58, v3
v_mul_f32 v59, v59, v3
v_mul_f32 v64, v64, v3
v_mul_f32 v65, v65, v3
v_mul_f32 v66, v66, v3
v_mul_f32 v67, v67, v3
v_mul_f32 v72, v72, v3
v_mul_f32 v73, v73, v3
v_mul_f32 v74, v74, v3
v_mul_f32 v75, v75, v3
v_mul_f32 v80, v80, v3
v_mul_f32 v81, v81, v3
v_mul_f32 v82, v82, v3
v_mul_f32 v83, v83, v3
v_mul_f32 v88, v88, v3
v_mul_f32 v89, v89, v3
v_mul_f32 v90, v90, v3
v_mul_f32 v91, v91, v3
v_exp_f32 v176, v176
v_exp_f32 v177, v177
v_exp_f32 v178, v178
v_exp_f32 v179, v179
v_exp_f32 v184, v184
v_exp_f32 v185, v185
v_exp_f32 v186, v186
v_exp_f32 v187, v187
v_exp_f32 v180, v180
v_exp_f32 v181, v181
v_exp_f32 v182, v182
v_exp_f32 v183, v183
v_exp_f32 v188, v188
v_exp_f32 v189, v189
v_exp_f32 v190, v190
v_exp_f32 v191, v191
s_nop 0
v_cvt_pk_bf16_f32 v200, v176, v177
v_cvt_pk_bf16_f32 v201, v178, v179
v_cvt_pk_bf16_f32 v202, v184, v185
v_cvt_pk_bf16_f32 v203, v186, v187
v_cvt_pk_bf16_f32 v204, v180, v181
v_cvt_pk_bf16_f32 v205, v182, v183
v_cvt_pk_bf16_f32 v206, v188, v189
v_cvt_pk_bf16_f32 v207, v190, v191
s_waitcnt vmcnt(8)
s_barrier
s_add_u32 m0, s27, 8704
s_add_u32 s36, s29, 106496
buffer_load_dwordx4 v12, s[12:15], s36 offen nt lds
s_add_u32 m0, s27, 9792
s_add_u32 s36, s29, 107520
buffer_load_dwordx4 v12, s[12:15], s36 offen nt lds
s_add_u32 m0, s28, 17408
s_add_u32 s36, s33, 98304
buffer_load_dwordx4 v13, s[16:19], s36 offen nt lds
s_add_u32 m0, s28, 18464
s_add_u32 s36, s33, 98560
buffer_load_dwordx4 v13, s[16:19], s36 offen nt lds
ds_read_b128 v[224:227], v10 offset:34816
ds_read_b128 v[228:231], v10 offset:34880
ds_read_b128 v[232:235], v10 offset:34944
ds_read_b128 v[236:239], v10 offset:35008
ds_read_b128 v[240:243], v10 offset:39168
ds_read_b128 v[244:247], v10 offset:39232
ds_read_b128 v[248:251], v10 offset:39296
ds_read_b128 v[252:255], v10 offset:39360
s_branch W2_R9_back
W2_R10:
s_waitcnt lgkmcnt(0)
v_mfma_f32_16x16x32_bf16 v[20:23], v[224:227], v[200:203], v[20:23]
v_mfma_f32_16x16x32_bf16 v[28:31], v[228:231], v[200:203], v[28:31]
v_mfma_f32_16x16x32_bf16 v[36:39], v[232:235], v[200:203], v[36:39]
v_mfma_f32_16x16x32_bf16 v[44:47], v[236:239], v[200:203], v[44:47]
v_mfma_f32_16x16x32_bf16 v[52:55], v[240:243], v[200:203], v[52:55]
v_mfma_f32_16x16x32_bf16 v[60:63], v[244:247], v[200:203], v[60:63]
v_mfma_f32_16x16x32_bf16 v[68:71], v[248:251], v[200:203], v[68:71]
v_mfma_f32_16x16x32_bf16 v[76:79], v[252:255], v[200:203], v[76:79]
v_mfma_f32_16x16x32_bf16 v[84:87], v[16:19], v[200:203], v[84:87]
v_mfma_f32_16x16x32_bf16 v[24:27], v[224:227], v[204:207], v[24:27]
v_mfma_f32_16x16x32_bf16 v[32:35], v[228:231], v[204:207], v[32:35]
v_mfma_f32_16x16x32_bf16 v[40:43], v[232:235], v[204:207], v[40:43]
v_mfma_f32_16x16x32_bf16 v[48:51], v[236:239], v[204:207], v[48:51]
v_mfma_f32_16x16x32_bf16 v[56:59], v[240:243], v[204:207], v[56:59]
v_mfma_f32_16x16x32_bf16 v[64:67], v[244:247], v[204:207], v[64:67]
v_mfma_f32_16x16x32_bf16 v[72:75], v[248:251], v[204:207], v[72:75]
v_mfma_f32_16x16x32_bf16 v[80:83], v[252:255], v[204:207], v[80:83]
v_mfma_f32_16x16x32_bf16 v[88:91], v[16:19], v[204:207], v[88:91]
s_nop 15
v_max3_f32 v2, v176, v177, v178
v_max3_f32 v2, v2, v179, v184
v_max3_f32 v2, v2, v185, v186
v_max_f32 v2, v2, v187
v_mov_b32 v3, v2
s_nop 1
v_permlane32_swap_b32 v2, v3
s_nop 1
v_max_f32 v2, v2, v3
v_mov_b32 v3, v2
s_nop 1
v_permlane16_swap_b32 v2, v3
s_nop 1
v_max_f32 v2, v2, v3
v_max_f32 v2, 0, v2
v_sub_f32 v176, v176, v2
v_sub_f32 v177, v177, v2
v_sub_f32 v178, v178, v2
v_sub_f32 v179, v179, v2
v_sub_f32 v184, v184, v2
v_sub_f32 v185, v185, v2
v_sub_f32 v186, v186, v2
v_sub_f32 v187, v187, v2
v_sub_f32 v212, v212, v2
v_sub_f32 v213, v213, v2
v_sub_f32 v214, v214, v2
v_sub_f32 v215, v215, v2
v_exp_f32 v3, -v2
s_nop 0
v_mul_f32 v20, v20, v3
v_mul_f32 v21, v21, v3
v_mul_f32 v22, v22, v3
v_mul_f32 v23, v23, v3
v_mul_f32 v28, v28, v3
v_mul_f32 v29, v29, v3
v_mul_f32 v30, v30, v3
v_mul_f32 v31, v31, v3
v_mul_f32 v36, v36, v3
v_mul_f32 v37, v37, v3
v_mul_f32 v38, v38, v3
v_mul_f32 v39, v39, v3
v_mul_f32 v44, v44, v3
v_mul_f32 v45, v45, v3
v_mul_f32 v46, v46, v3
v_mul_f32 v47, v47, v3
v_mul_f32 v52, v52, v3
v_mul_f32 v53, v53, v3
v_mul_f32 v54, v54, v3
v_mul_f32 v55, v55, v3
v_mul_f32 v60, v60, v3
v_mul_f32 v61, v61, v3
v_mul_f32 v62, v62, v3
v_mul_f32 v63, v63, v3
v_mul_f32 v68, v68, v3
v_mul_f32 v69, v69, v3
v_mul_f32 v70, v70, v3
v_mul_f32 v71, v71, v3
v_mul_f32 v76, v76, v3
v_mul_f32 v77, v77, v3
v_mul_f32 v78, v78, v3
v_mul_f32 v79, v79, v3
v_mul_f32 v84, v84, v3
v_mul_f32 v85, v85, v3
v_mul_f32 v86, v86, v3
v_mul_f32 v87, v87, v3
v_max3_f32 v2, v180, v181, v182
v_max3_f32 v2, v2, v183, v188
v_max3_f32 v2, v2, v189, v190
v_max_f32 v2, v2, v191
v_mov_b32 v3, v2
s_nop 1
v_permlane32_swap_b32 v2, v3
s_nop 1
v_max_f32 v2, v2, v3
v_mov_b32 v3, v2
s_nop 1
v_permlane16_swap_b32 v2, v3
s_nop 1
v_max_f32 v2, v2, v3
v_max_f32 v2, 0, v2
v_sub_f32 v180, v180, v2
v_sub_f32 v181, v181, v2
v_sub_f32 v182, v182, v2
v_sub_f32 v183, v183, v2
v_sub_f32 v188, v188, v2
v_sub_f32 v189, v189, v2
v_sub_f32 v190, v190, v2
v_sub_f32 v191, v191, v2
v_sub_f32 v216, v216, v2
v_sub_f32 v217, v217, v2
v_sub_f32 v218, v218, v2
v_sub_f32 v219, v219, v2
v_exp_f32 v3, -v2
s_nop 0
v_mul_f32 v24, v24, v3
v_mul_f32 v25, v25, v3
v_mul_f32 v26, v26, v3
v_mul_f32 v27, v27, v3
v_mul_f32 v32, v32, v3
v_mul_f32 v33, v33, v3
v_mul_f32 v34, v34, v3
v_mul_f32 v35, v35, v3
v_mul_f32 v40, v40, v3
v_mul_f32 v41, v41, v3
v_mul_f32 v42, v42, v3
v_mul_f32 v43, v43, v3
v_mul_f32 v48, v48, v3
v_mul_f32 v49, v49, v3
v_mul_f32 v50, v50, v3
v_mul_f32 v51, v51, v3
v_mul_f32 v56, v56, v3
v_mul_f32 v57, v57, v3
v_mul_f32 v58, v58, v3
v_mul_f32 v59, v59, v3
v_mul_f32 v64, v64, v3
v_mul_f32 v65, v65, v3
v_mul_f32 v66, v66, v3
v_mul_f32 v67, v67, v3
v_mul_f32 v72, v72, v3
v_mul_f32 v73, v73, v3
v_mul_f32 v74, v74, v3
v_mul_f32 v75, v75, v3
v_mul_f32 v80, v80, v3
v_mul_f32 v81, v81, v3
v_mul_f32 v82, v82, v3
v_mul_f32 v83, v83, v3
v_mul_f32 v88, v88, v3
v_mul_f32 v89, v89, v3
v_mul_f32 v90, v90, v3
v_mul_f32 v91, v91, v3
v_exp_f32 v176, v176
v_exp_f32 v177, v177
v_exp_f32 v178, v178
v_exp_f32 v179, v179
v_exp_f32 v184, v184
v_exp_f32 v185, v185
v_exp_f32 v186, v186
v_exp_f32 v187, v187
v_exp_f32 v180, v180
v_exp_f32 v181, v181
v_exp_f32 v182, v182
v_exp_f32 v183, v183
v_exp_f32 v188, v188
v_exp_f32 v189, v189
v_exp_f32 v190, v190
v_exp_f32 v191, v191
s_nop 0
v_cvt_pk_bf16_f32 v200, v176, v177
v_cvt_pk_bf16_f32 v201, v178, v179
v_cvt_pk_bf16_f32 v202, v184, v185
v_cvt_pk_bf16_f32 v203, v186, v187
v_cvt_pk_bf16_f32 v204, v180, v181
v_cvt_pk_bf16_f32 v205, v182, v183
v_cvt_pk_bf16_f32 v206, v188, v189
v_cvt_pk_bf16_f32 v207, v190, v191
s_waitcnt vmcnt(8)
s_barrier
s_add_u32 m0, s27, 34816
s_add_u32 s36, s29, 114688
buffer_load_dwordx4 v12, s[12:15], s36 offen nt lds
s_add_u32 m0, s27, 35904
s_add_u32 s36, s29, 115712
buffer_load_dwordx4 v12, s[12:15], s36 offen nt lds
s_add_u32 m0, s28, 25856
s_add_u32 s36, s33, 106496
buffer_load_dwordx4 v13, s[16:19], s36 offen nt lds
s_add_u32 m0, s28, 26912
s_add_u32 s36, s33, 106752
buffer_load_dwordx4 v13, s[16:19], s36 offen nt lds
ds_read_b128 v[224:227], v10 offset:43520
ds_read_b128 v[228:231], v10 offset:43584
ds_read_b128 v[232:235], v10 offset:43648
ds_read_b128 v[236:239], v10 offset:43712
ds_read_b128 v[240:243], v10 offset:47872
ds_read_b128 v[244:247], v10 offset:47936
ds_read_b128 v[248:251], v10 offset:48000
ds_read_b128 v[252:255], v10 offset:48064
s_branch W2_R10_back
W2_R11:
s_waitcnt lgkmcnt(0)
v_mfma_f32_16x16x32_bf16 v[20:23], v[224:227], v[200:203], v[20:23]
v_mfma_f32_16x16x32_bf16 v[28:31], v[228:231], v[200:203], v[28:31]
v_mfma_f32_16x16x32_bf16 v[36:39], v[232:235], v[200:203], v[36:39]
v_mfma_f32_16x16x32_bf16 v[44:47], v[236:239], v[200:203], v[44:47]
v_mfma_f32_16x16x32_bf16 v[52:55], v[240:243], v[200:203], v[52:55]
v_mfma_f32_16x16x32_bf16 v[60:63], v[244:247], v[200:203], v[60:63]
v_mfma_f32_16x16x32_bf16 v[68:71], v[248:251], v[200:203], v[68:71]
v_mfma_f32_16x16x32_bf16 v[76:79], v[252:255], v[200:203], v[76:79]
v_mfma_f32_16x16x32_bf16 v[84:87], v[16:19], v[200:203], v[84:87]
v_mfma_f32_16x16x32_bf16 v[24:27], v[224:227], v[204:207], v[24:27]
v_mfma_f32_16x16x32_bf16 v[32:35], v[228:231], v[204:207], v[32:35]
v_mfma_f32_16x16x32_bf16 v[40:43], v[232:235], v[204:207], v[40:43]
v_mfma_f32_16x16x32_bf16 v[48:51], v[236:239], v[204:207], v[48:51]
v_mfma_f32_16x16x32_bf16 v[56:59], v[240:243], v[204:207], v[56:59]
v_mfma_f32_16x16x32_bf16 v[64:67], v[244:247], v[204:207], v[64:67]
v_mfma_f32_16x16x32_bf16 v[72:75], v[248:251], v[204:207], v[72:75]
v_mfma_f32_16x16x32_bf16 v[80:83], v[252:255], v[204:207], v[80:83]
v_mfma_f32_16x16x32_bf16 v[88:91], v[16:19], v[204:207], v[88:91]
s_nop 15
v_max3_f32 v2, v176, v177, v178
v_max3_f32 v2, v2, v179, v184
v_max3_f32 v2, v2, v185, v186
v_max_f32 v2, v2, v187
v_mov_b32 v3, v2
s_nop 1
v_permlane32_swap_b32 v2, v3
s_nop 1
v_max_f32 v2, v2, v3
v_mov_b32 v3, v2
s_nop 1
v_permlane16_swap_b32 v2, v3
s_nop 1
v_max_f32 v2, v2, v3
v_max_f32 v2, 0, v2
v_sub_f32 v176, v176, v2
v_sub_f32 v177, v177, v2
v_sub_f32 v178, v178, v2
v_sub_f32 v179, v179, v2
v_sub_f32 v184, v184, v2
v_sub_f32 v185, v185, v2
v_sub_f32 v186, v186, v2
v_sub_f32 v187, v187, v2
v_sub_f32 v212, v212, v2
v_sub_f32 v213, v213, v2
v_sub_f32 v214, v214, v2
v_sub_f32 v215, v215, v2
v_exp_f32 v3, -v2
s_nop 0
v_mul_f32 v20, v20, v3
v_mul_f32 v21, v21, v3
v_mul_f32 v22, v22, v3
v_mul_f32 v23, v23, v3
v_mul_f32 v28, v28, v3
v_mul_f32 v29, v29, v3
v_mul_f32 v30, v30, v3
v_mul_f32 v31, v31, v3
v_mul_f32 v36, v36, v3
v_mul_f32 v37, v37, v3
v_mul_f32 v38, v38, v3
v_mul_f32 v39, v39, v3
v_mul_f32 v44, v44, v3
v_mul_f32 v45, v45, v3
v_mul_f32 v46, v46, v3
v_mul_f32 v47, v47, v3
v_mul_f32 v52, v52, v3
v_mul_f32 v53, v53, v3
v_mul_f32 v54, v54, v3
v_mul_f32 v55, v55, v3
v_mul_f32 v60, v60, v3
v_mul_f32 v61, v61, v3
v_mul_f32 v62, v62, v3
v_mul_f32 v63, v63, v3
v_mul_f32 v68, v68, v3
v_mul_f32 v69, v69, v3
v_mul_f32 v70, v70, v3
v_mul_f32 v71, v71, v3
v_mul_f32 v76, v76, v3
v_mul_f32 v77, v77, v3
v_mul_f32 v78, v78, v3
v_mul_f32 v79, v79, v3
v_mul_f32 v84, v84, v3
v_mul_f32 v85, v85, v3
v_mul_f32 v86, v86, v3
v_mul_f32 v87, v87, v3
v_max3_f32 v2, v180, v181, v182
v_max3_f32 v2, v2, v183, v188
v_max3_f32 v2, v2, v189, v190
v_max_f32 v2, v2, v191
v_mov_b32 v3, v2
s_nop 1
v_permlane32_swap_b32 v2, v3
s_nop 1
v_max_f32 v2, v2, v3
v_mov_b32 v3, v2
s_nop 1
v_permlane16_swap_b32 v2, v3
s_nop 1
v_max_f32 v2, v2, v3
v_max_f32 v2, 0, v2
v_sub_f32 v180, v180, v2
v_sub_f32 v181, v181, v2
v_sub_f32 v182, v182, v2
v_sub_f32 v183, v183, v2
v_sub_f32 v188, v188, v2
v_sub_f32 v189, v189, v2
v_sub_f32 v190, v190, v2
v_sub_f32 v191, v191, v2
v_sub_f32 v216, v216, v2
v_sub_f32 v217, v217, v2
v_sub_f32 v218, v218, v2
v_sub_f32 v219, v219, v2
v_exp_f32 v3, -v2
s_nop 0
v_mul_f32 v24, v24, v3
v_mul_f32 v25, v25, v3
v_mul_f32 v26, v26, v3
v_mul_f32 v27, v27, v3
v_mul_f32 v32, v32, v3
v_mul_f32 v33, v33, v3
v_mul_f32 v34, v34, v3
v_mul_f32 v35, v35, v3
v_mul_f32 v40, v40, v3
v_mul_f32 v41, v41, v3
v_mul_f32 v42, v42, v3
v_mul_f32 v43, v43, v3
v_mul_f32 v48, v48, v3
v_mul_f32 v49, v49, v3
v_mul_f32 v50, v50, v3
v_mul_f32 v51, v51, v3
v_mul_f32 v56, v56, v3
v_mul_f32 v57, v57, v3
v_mul_f32 v58, v58, v3
v_mul_f32 v59, v59, v3
v_mul_f32 v64, v64, v3
v_mul_f32 v65, v65, v3
v_mul_f32 v66, v66, v3
v_mul_f32 v67, v67, v3
v_mul_f32 v72, v72, v3
v_mul_f32 v73, v73, v3
v_mul_f32 v74, v74, v3
v_mul_f32 v75, v75, v3
v_mul_f32 v80, v80, v3
v_mul_f32 v81, v81, v3
v_mul_f32 v82, v82, v3
v_mul_f32 v83, v83, v3
v_mul_f32 v88, v88, v3
v_mul_f32 v89, v89, v3
v_mul_f32 v90, v90, v3
v_mul_f32 v91, v91, v3
v_exp_f32 v176, v176
v_exp_f32 v177, v177
v_exp_f32 v178, v178
v_exp_f32 v179, v179
v_exp_f32 v184, v184
v_exp_f32 v185, v185
v_exp_f32 v186, v186
v_exp_f32 v187, v187
v_exp_f32 v180, v180
v_exp_f32 v181, v181
v_exp_f32 v182, v182
v_exp_f32 v183, v183
v_exp_f32 v188, v188
v_exp_f32 v189, v189
v_exp_f32 v190, v190
v_exp_f32 v191, v191
s_nop 0
v_cvt_pk_bf16_f32 v200, v176, v177
v_cvt_pk_bf16_f32 v201, v178, v179
v_cvt_pk_bf16_f32 v202, v184, v185
v_cvt_pk_bf16_f32 v203, v186, v187
v_cvt_pk_bf16_f32 v204, v180, v181
v_cvt_pk_bf16_f32 v205, v182, v183
v_cvt_pk_bf16_f32 v206, v188, v189
v_cvt_pk_bf16_f32 v207, v190, v191
s_waitcnt vmcnt(8)
s_barrier
s_add_u32 m0, s27, 43520
s_add_u32 s36, s29, 122880
buffer_load_dwordx4 v12, s[12:15], s36 offen nt lds
s_add_u32 m0, s27, 44608
s_add_u32 s36, s29, 123904
buffer_load_dwordx4 v12, s[12:15], s36 offen nt lds
s_add_u32 m0, s28, 52224
s_add_u32 s36, s33, 114688
buffer_load_dwordx4 v13, s[16:19], s36 offen nt lds
s_add_u32 m0, s28, 53280
s_add_u32 s36, s33, 114944
buffer_load_dwordx4 v13, s[16:19], s36 offen nt lds
ds_read_b128 v[224:227], v10 offset:0
ds_read_b128 v[228:231], v10 offset:64
ds_read_b128 v[232:235], v10 offset:128
ds_read_b128 v[236:239], v10 offset:192
ds_read_b128 v[240:243], v10 offset:4352
ds_read_b128 v[244:247], v10 offset:4416
ds_read_b128 v[248:251], v10 offset:4480
ds_read_b128 v[252:255], v10 offset:4544
s_branch W2_R11_back
W2_R12:
s_waitcnt lgkmcnt(0)
v_mfma_f32_16x16x32_bf16 v[20:23], v[224:227], v[200:203], v[20:23]
v_mfma_f32_16x16x32_bf16 v[28:31], v[228:231], v[200:203], v[28:31]
v_mfma_f32_16x16x32_bf16 v[36:39], v[232:235], v[200:203], v[36:39]
v_mfma_f32_16x16x32_bf16 v[44:47], v[236:239], v[200:203], v[44:47]
v_mfma_f32_16x16x32_bf16 v[52:55], v[240:243], v[200:203], v[52:55]
v_mfma_f32_16x16x32_bf16 v[60:63], v[244:247], v[200:203], v[60:63]
v_mfma_f32_16x16x32_bf16 v[68:71], v[248:251], v[200:203], v[68:71]
v_mfma_f32_16x16x32_bf16 v[76:79], v[252:255], v[200:203], v[76:79]
v_mfma_f32_16x16x32_bf16 v[84:87], v[16:19], v[200:203], v[84:87]
v_mfma_f32_16x16x32_bf16 v[24:27], v[224:227], v[204:207], v[24:27]
v_mfma_f32_16x16x32_bf16 v[32:35], v[228:231], v[204:207], v[32:35]
v_mfma_f32_16x16x32_bf16 v[40:43], v[232:235], v[204:207], v[40:43]
v_mfma_f32_16x16x32_bf16 v[48:51], v[236:239], v[204:207], v[48:51]
v_mfma_f32_16x16x32_bf16 v[56:59], v[240:243], v[204:207], v[56:59]
v_mfma_f32_16x16x32_bf16 v[64:67], v[244:247], v[204:207], v[64:67]
v_mfma_f32_16x16x32_bf16 v[72:75], v[248:251], v[204:207], v[72:75]
v_mfma_f32_16x16x32_bf16 v[80:83], v[252:255], v[204:207], v[80:83]
v_mfma_f32_16x16x32_bf16 v[88:91], v[16:19], v[204:207], v[88:91]
s_nop 15
v_max3_f32 v2, v176, v177, v178
v_max3_f32 v2, v2, v179, v184
v_max3_f32 v2, v2, v185, v186
v_max_f32 v2, v2, v187
v_mov_b32 v3, v2
s_nop 1
v_permlane32_swap_b32 v2, v3
s_nop 1
v_max_f32 v2, v2, v3
v_mov_b32 v3, v2
s_nop 1
v_permlane16_swap_b32 v2, v3
s_nop 1
v_max_f32 v2, v2, v3
v_max_f32 v2, 0, v2
v_sub_f32 v176, v176, v2
v_sub_f32 v177, v177, v2
v_sub_f32 v178, v178, v2
v_sub_f32 v179, v179, v2
v_sub_f32 v184, v184, v2
v_sub_f32 v185, v185, v2
v_sub_f32 v186, v186, v2
v_sub_f32 v187, v187, v2
v_sub_f32 v212, v212, v2
v_sub_f32 v213, v213, v2
v_sub_f32 v214, v214, v2
v_sub_f32 v215, v215, v2
v_exp_f32 v3, -v2
s_nop 0
v_mul_f32 v20, v20, v3
v_mul_f32 v21, v21, v3
v_mul_f32 v22, v22, v3
v_mul_f32 v23, v23, v3
v_mul_f32 v28, v28, v3
v_mul_f32 v29, v29, v3
v_mul_f32 v30, v30, v3
v_mul_f32 v31, v31, v3
v_mul_f32 v36, v36, v3
v_mul_f32 v37, v37, v3
v_mul_f32 v38, v38, v3
v_mul_f32 v39, v39, v3
v_mul_f32 v44, v44, v3
v_mul_f32 v45, v45, v3
v_mul_f32 v46, v46, v3
v_mul_f32 v47, v47, v3
v_mul_f32 v52, v52, v3
v_mul_f32 v53, v53, v3
v_mul_f32 v54, v54, v3
v_mul_f32 v55, v55, v3
v_mul_f32 v60, v60, v3
v_mul_f32 v61, v61, v3
v_mul_f32 v62, v62, v3
v_mul_f32 v63, v63, v3
v_mul_f32 v68, v68, v3
v_mul_f32 v69, v69, v3
v_mul_f32 v70, v70, v3
v_mul_f32 v71, v71, v3
v_mul_f32 v76, v76, v3
v_mul_f32 v77, v77, v3
v_mul_f32 v78, v78, v3
v_mul_f32 v79, v79, v3
v_mul_f32 v84, v84, v3
v_mul_f32 v85, v85, v3
v_mul_f32 v86, v86, v3
v_mul_f32 v87, v87, v3
v_max3_f32 v2, v180, v181, v182
v_max3_f32 v2, v2, v183, v188
v_max3_f32 v2, v2, v189, v190
v_max_f32 v2, v2, v191
v_mov_b32 v3, v2
s_nop 1
v_permlane32_swap_b32 v2, v3
s_nop 1
v_max_f32 v2, v2, v3
v_mov_b32 v3, v2
s_nop 1
v_permlane16_swap_b32 v2, v3
s_nop 1
v_max_f32 v2, v2, v3
v_max_f32 v2, 0, v2
v_sub_f32 v180, v180, v2
v_sub_f32 v181, v181, v2
v_sub_f32 v182, v182, v2
v_sub_f32 v183, v183, v2
v_sub_f32 v188, v188, v2
v_sub_f32 v189, v189, v2
v_sub_f32 v190, v190, v2
v_sub_f32 v191, v191, v2
v_sub_f32 v216, v216, v2
v_sub_f32 v217, v217, v2
v_sub_f32 v218, v218, v2
v_sub_f32 v219, v219, v2
v_exp_f32 v3, -v2
s_nop 0
v_mul_f32 v24, v24, v3
v_mul_f32 v25, v25, v3
v_mul_f32 v26, v26, v3
v_mul_f32 v27, v27, v3
v_mul_f32 v32, v32, v3
v_mul_f32 v33, v33, v3
v_mul_f32 v34, v34, v3
v_mul_f32 v35, v35, v3
v_mul_f32 v40, v40, v3
v_mul_f32 v41, v41, v3
v_mul_f32 v42, v42, v3
v_mul_f32 v43, v43, v3
v_mul_f32 v48, v48, v3
v_mul_f32 v49, v49, v3
v_mul_f32 v50, v50, v3
v_mul_f32 v51, v51, v3
v_mul_f32 v56, v56, v3
v_mul_f32 v57, v57, v3
v_mul_f32 v58, v58, v3
v_mul_f32 v59, v59, v3
v_mul_f32 v64, v64, v3
v_mul_f32 v65, v65, v3
v_mul_f32 v66, v66, v3
v_mul_f32 v67, v67, v3
v_mul_f32 v72, v72, v3
v_mul_f32 v73, v73, v3
v_mul_f32 v74, v74, v3
v_mul_f32 v75, v75, v3
v_mul_f32 v80, v80, v3
v_mul_f32 v81, v81, v3
v_mul_f32 v82, v82, v3
v_mul_f32 v83, v83, v3
v_mul_f32 v88, v88, v3
v_mul_f32 v89, v89, v3
v_mul_f32 v90, v90, v3
v_mul_f32 v91, v91, v3
v_exp_f32 v176, v176
v_exp_f32 v177, v177
v_exp_f32 v178, v178
v_exp_f32 v179, v179
v_exp_f32 v184, v184
v_exp_f32 v185, v185
v_exp_f32 v186, v186
v_exp_f32 v187, v187
v_exp_f32 v180, v180
v_exp_f32 v181, v181
v_exp_f32 v182, v182
v_exp_f32 v183, v183
v_exp_f32 v188, v188
v_exp_f32 v189, v189
v_exp_f32 v190, v190
v_exp_f32 v191, v191
s_nop 0
v_cvt_pk_bf16_f32 v200, v176, v177
v_cvt_pk_bf16_f32 v201, v178, v179
v_cvt_pk_bf16_f32 v202, v184, v185
v_cvt_pk_bf16_f32 v203, v186, v187
v_cvt_pk_bf16_f32 v204, v180, v181
v_cvt_pk_bf16_f32 v205, v182, v183
v_cvt_pk_bf16_f32 v206, v188, v189
v_cvt_pk_bf16_f32 v207, v190, v191
s_waitcnt vmcnt(8)
s_barrier
s_add_u32 m0, s28, 60672
s_add_u32 s36, s33, 122880
buffer_load_dwordx4 v13, s[16:19], s36 offen nt lds
s_add_u32 m0, s28, 61728
s_add_u32 s36, s33, 123136
buffer_load_dwordx4 v13, s[16:19], s36 offen nt lds
ds_read_b128 v[224:227], v10 offset:8704
ds_read_b128 v[228:231], v10 offset:8768
ds_read_b128 v[232:235], v10 offset:8832
ds_read_b128 v[236:239], v10 offset:8896
ds_read_b128 v[240:243], v10 offset:13056
ds_read_b128 v[244:247], v10 offset:13120
ds_read_b128 v[248:251], v10 offset:13184
ds_read_b128 v[252:255], v10 offset:13248
s_branch W2_R12_back
W2_R13:
s_waitcnt lgkmcnt(0)
v_mfma_f32_16x16x32_bf16 v[20:23], v[224:227], v[200:203], v[20:23]
v_mfma_f32_16x16x32_bf16 v[28:31], v[228:231], v[200:203], v[28:31]
v_mfma_f32_16x16x32_bf16 v[36:39], v[232:235], v[200:203], v[36:39]
v_mfma_f32_16x16x32_bf16 v[44:47], v[236:239], v[200:203], v[44:47]
v_mfma_f32_16x16x32_bf16 v[52:55], v[240:243], v[200:203], v[52:55]
v_mfma_f32_16x16x32_bf16 v[60:63], v[244:247], v[200:203], v[60:63]
v_mfma_f32_16x16x32_bf16 v[68:71], v[248:251], v[200:203], v[68:71]
v_mfma_f32_16x16x32_bf16 v[76:79], v[252:255], v[200:203], v[76:79]
v_mfma_f32_16x16x32_bf16 v[84:87], v[16:19], v[200:203], v[84:87]
v_mfma_f32_16x16x32_bf16 v[24:27], v[224:227], v[204:207], v[24:27]
v_mfma_f32_16x16x32_bf16 v[32:35], v[228:231], v[204:207], v[32:35]
v_mfma_f32_16x16x32_bf16 v[40:43], v[232:235], v[204:207], v[40:43]
v_mfma_f32_16x16x32_bf16 v[48:51], v[236:239], v[204:207], v[48:51]
v_mfma_f32_16x16x32_bf16 v[56:59], v[240:243], v[204:207], v[56:59]
v_mfma_f32_16x16x32_bf16 v[64:67], v[244:247], v[204:207], v[64:67]
v_mfma_f32_16x16x32_bf16 v[72:75], v[248:251], v[204:207], v[72:75]
v_mfma_f32_16x16x32_bf16 v[80:83], v[252:255], v[204:207], v[80:83]
v_mfma_f32_16x16x32_bf16 v[88:91], v[16:19], v[204:207], v[88:91]
s_nop 15
v_max3_f32 v2, v176, v177, v178
v_max3_f32 v2, v2, v179, v184
v_max3_f32 v2, v2, v185, v186
v_max_f32 v2, v2, v187
v_mov_b32 v3, v2
s_nop 1
v_permlane32_swap_b32 v2, v3
s_nop 1
v_max_f32 v2, v2, v3
v_mov_b32 v3, v2
s_nop 1
v_permlane16_swap_b32 v2, v3
s_nop 1
v_max_f32 v2, v2, v3
v_max_f32 v2, 0, v2
v_sub_f32 v176, v176, v2
v_sub_f32 v177, v177, v2
v_sub_f32 v178, v178, v2
v_sub_f32 v179, v179, v2
v_sub_f32 v184, v184, v2
v_sub_f32 v185, v185, v2
v_sub_f32 v186, v186, v2
v_sub_f32 v187, v187, v2
v_sub_f32 v212, v212, v2
v_sub_f32 v213, v213, v2
v_sub_f32 v214, v214, v2
v_sub_f32 v215, v215, v2
v_exp_f32 v3, -v2
s_nop 0
v_mul_f32 v20, v20, v3
v_mul_f32 v21, v21, v3
v_mul_f32 v22, v22, v3
v_mul_f32 v23, v23, v3
v_mul_f32 v28, v28, v3
v_mul_f32 v29, v29, v3
v_mul_f32 v30, v30, v3
v_mul_f32 v31, v31, v3
v_mul_f32 v36, v36, v3
v_mul_f32 v37, v37, v3
v_mul_f32 v38, v38, v3
v_mul_f32 v39, v39, v3
v_mul_f32 v44, v44, v3
v_mul_f32 v45, v45, v3
v_mul_f32 v46, v46, v3
v_mul_f32 v47, v47, v3
v_mul_f32 v52, v52, v3
v_mul_f32 v53, v53, v3
v_mul_f32 v54, v54, v3
v_mul_f32 v55, v55, v3
v_mul_f32 v60, v60, v3
v_mul_f32 v61, v61, v3
v_mul_f32 v62, v62, v3
v_mul_f32 v63, v63, v3
v_mul_f32 v68, v68, v3
v_mul_f32 v69, v69, v3
v_mul_f32 v70, v70, v3
v_mul_f32 v71, v71, v3
v_mul_f32 v76, v76, v3
v_mul_f32 v77, v77, v3
v_mul_f32 v78, v78, v3
v_mul_f32 v79, v79, v3
v_mul_f32 v84, v84, v3
v_mul_f32 v85, v85, v3
v_mul_f32 v86, v86, v3
v_mul_f32 v87, v87, v3
v_max3_f32 v2, v180, v181, v182
v_max3_f32 v2, v2, v183, v188
v_max3_f32 v2, v2, v189, v190
v_max_f32 v2, v2, v191
v_mov_b32 v3, v2
s_nop 1
v_permlane32_swap_b32 v2, v3
s_nop 1
v_max_f32 v2, v2, v3
v_mov_b32 v3, v2
s_nop 1
v_permlane16_swap_b32 v2, v3
s_nop 1
v_max_f32 v2, v2, v3
v_max_f32 v2, 0, v2
v_sub_f32 v180, v180, v2
v_sub_f32 v181, v181, v2
v_sub_f32 v182, v182, v2
v_sub_f32 v183, v183, v2
v_sub_f32 v188, v188, v2
v_sub_f32 v189, v189, v2
v_sub_f32 v190, v190, v2
v_sub_f32 v191, v191, v2
v_sub_f32 v216, v216, v2
v_sub_f32 v217, v217, v2
v_sub_f32 v218, v218, v2
v_sub_f32 v219, v219, v2
v_exp_f32 v3, -v2
s_nop 0
v_mul_f32 v24, v24, v3
v_mul_f32 v25, v25, v3
v_mul_f32 v26, v26, v3
v_mul_f32 v27, v27, v3
v_mul_f32 v32, v32, v3
v_mul_f32 v33, v33, v3
v_mul_f32 v34, v34, v3
v_mul_f32 v35, v35, v3
v_mul_f32 v40, v40, v3
v_mul_f32 v41, v41, v3
v_mul_f32 v42, v42, v3
v_mul_f32 v43, v43, v3
v_mul_f32 v48, v48, v3
v_mul_f32 v49, v49, v3
v_mul_f32 v50, v50, v3
v_mul_f32 v51, v51, v3
v_mul_f32 v56, v56, v3
v_mul_f32 v57, v57, v3
v_mul_f32 v58, v58, v3
v_mul_f32 v59, v59, v3
v_mul_f32 v64, v64, v3
v_mul_f32 v65, v65, v3
v_mul_f32 v66, v66, v3
v_mul_f32 v67, v67, v3
v_mul_f32 v72, v72, v3
v_mul_f32 v73, v73, v3
v_mul_f32 v74, v74, v3
v_mul_f32 v75, v75, v3
v_mul_f32 v80, v80, v3
v_mul_f32 v81, v81, v3
v_mul_f32 v82, v82, v3
v_mul_f32 v83, v83, v3
v_mul_f32 v88, v88, v3
v_mul_f32 v89, v89, v3
v_mul_f32 v90, v90, v3
v_mul_f32 v91, v91, v3
v_exp_f32 v176, v176
v_exp_f32 v177, v177
v_exp_f32 v178, v178
v_exp_f32 v179, v179
v_exp_f32 v184, v184
v_exp_f32 v185, v185
v_exp_f32 v186, v186
v_exp_f32 v187, v187
v_exp_f32 v180, v180
v_exp_f32 v181, v181
v_exp_f32 v182, v182
v_exp_f32 v183, v183
v_exp_f32 v188, v188
v_exp_f32 v189, v189
v_exp_f32 v190, v190
v_exp_f32 v191, v191
s_nop 0
v_cvt_pk_bf16_f32 v200, v176, v177
v_cvt_pk_bf16_f32 v201, v178, v179
v_cvt_pk_bf16_f32 v202, v184, v185
v_cvt_pk_bf16_f32 v203, v186, v187
v_cvt_pk_bf16_f32 v204, v180, v181
v_cvt_pk_bf16_f32 v205, v182, v183
v_cvt_pk_bf16_f32 v206, v188, v189
v_cvt_pk_bf16_f32 v207, v190, v191
s_waitcnt vmcnt(6)
s_barrier
s_mul_i32 s36, s63, 5120
v_lshlrev_b32 v8, 4, v0
buffer_load_dwordx4 v[4:7], v8, s[88:91], s36 offen
s_mul_i32 s36, s63, 5120
buffer_load_dwordx4 v[4:7], v8, s[88:91], s36 offen offset:1024
s_mul_i32 s36, s63, 5120
buffer_load_dwordx4 v[4:7], v8, s[88:91], s36 offen offset:2048
s_mul_i32 s36, s63, 5120
buffer_load_dwordx4 v[4:7], v8, s[88:91], s36 offen offset:3072
s_mul_i32 s36, s63, 5120
s_add_u32 s36, s36, 4096
buffer_load_dwordx4 v[4:7], v8, s[88:91], s36 offen
ds_read_b128 v[224:227], v10 offset:34816
ds_read_b128 v[228:231], v10 offset:34880
ds_read_b128 v[232:235], v10 offset:34944
ds_read_b128 v[236:239], v10 offset:35008
ds_read_b128 v[240:243], v10 offset:39168
ds_read_b128 v[244:247], v10 offset:39232
ds_read_b128 v[248:251], v10 offset:39296
ds_read_b128 v[252:255], v10 offset:39360
s_branch W2_R13_back
W2_R14:
s_waitcnt lgkmcnt(0)
v_mfma_f32_16x16x32_bf16 v[20:23], v[224:227], v[200:203], v[20:23]
v_mfma_f32_16x16x32_bf16 v[28:31], v[228:231], v[200:203], v[28:31]
v_mfma_f32_16x16x32_bf16 v[36:39], v[232:235], v[200:203], v[36:39]
v_mfma_f32_16x16x32_bf16 v[44:47], v[236:239], v[200:203], v[44:47]
v_mfma_f32_16x16x32_bf16 v[52:55], v[240:243], v[200:203], v[52:55]
v_mfma_f32_16x16x32_bf16 v[60:63], v[244:247], v[200:203], v[60:63]
v_mfma_f32_16x16x32_bf16 v[68:71], v[248:251], v[200:203], v[68:71]
v_mfma_f32_16x16x32_bf16 v[76:79], v[252:255], v[200:203], v[76:79]
v_mfma_f32_16x16x32_bf16 v[84:87], v[16:19], v[200:203], v[84:87]
v_mfma_f32_16x16x32_bf16 v[24:27], v[224:227], v[204:207], v[24:27]
v_mfma_f32_16x16x32_bf16 v[32:35], v[228:231], v[204:207], v[32:35]
v_mfma_f32_16x16x32_bf16 v[40:43], v[232:235], v[204:207], v[40:43]
v_mfma_f32_16x16x32_bf16 v[48:51], v[236:239], v[204:207], v[48:51]
v_mfma_f32_16x16x32_bf16 v[56:59], v[240:243], v[204:207], v[56:59]
v_mfma_f32_16x16x32_bf16 v[64:67], v[244:247], v[204:207], v[64:67]
v_mfma_f32_16x16x32_bf16 v[72:75], v[248:251], v[204:207], v[72:75]
v_mfma_f32_16x16x32_bf16 v[80:83], v[252:255], v[204:207], v[80:83]
v_mfma_f32_16x16x32_bf16 v[88:91], v[16:19], v[204:207], v[88:91]
s_nop 15
v_max3_f32 v2, v176, v177, v178
v_max3_f32 v2, v2, v179, v184
v_max3_f32 v2, v2, v185, v186
v_max_f32 v2, v2, v187
v_mov_b32 v3, v2
s_nop 1
v_permlane32_swap_b32 v2, v3
s_nop 1
v_max_f32 v2, v2, v3
v_mov_b32 v3, v2
s_nop 1
v_permlane16_swap_b32 v2, v3
s_nop 1
v_max_f32 v2, v2, v3
v_max_f32 v2, 0, v2
v_sub_f32 v176, v176, v2
v_sub_f32 v177, v177, v2
v_sub_f32 v178, v178, v2
v_sub_f32 v179, v179, v2
v_sub_f32 v184, v184, v2
v_sub_f32 v185, v185, v2
v_sub_f32 v186, v186, v2
v_sub_f32 v187, v187, v2
v_sub_f32 v212, v212, v2
v_sub_f32 v213, v213, v2
v_sub_f32 v214, v214, v2
v_sub_f32 v215, v215, v2
v_exp_f32 v3, -v2
s_nop 0
v_mul_f32 v20, v20, v3
v_mul_f32 v21, v21, v3
v_mul_f32 v22, v22, v3
v_mul_f32 v23, v23, v3
v_mul_f32 v28, v28, v3
v_mul_f32 v29, v29, v3
v_mul_f32 v30, v30, v3
v_mul_f32 v31, v31, v3
v_mul_f32 v36, v36, v3
v_mul_f32 v37, v37, v3
v_mul_f32 v38, v38, v3
v_mul_f32 v39, v39, v3
v_mul_f32 v44, v44, v3
v_mul_f32 v45, v45, v3
v_mul_f32 v46, v46, v3
v_mul_f32 v47, v47, v3
v_mul_f32 v52, v52, v3
v_mul_f32 v53, v53, v3
v_mul_f32 v54, v54, v3
v_mul_f32 v55, v55, v3
v_mul_f32 v60, v60, v3
v_mul_f32 v61, v61, v3
v_mul_f32 v62, v62, v3
v_mul_f32 v63, v63, v3
v_mul_f32 v68, v68, v3
v_mul_f32 v69, v69, v3
v_mul_f32 v70, v70, v3
v_mul_f32 v71, v71, v3
v_mul_f32 v76, v76, v3
v_mul_f32 v77, v77, v3
v_mul_f32 v78, v78, v3
v_mul_f32 v79, v79, v3
v_mul_f32 v84, v84, v3
v_mul_f32 v85, v85, v3
v_mul_f32 v86, v86, v3
v_mul_f32 v87, v87, v3
v_max3_f32 v2, v180, v181, v182
v_max3_f32 v2, v2, v183, v188
v_max3_f32 v2, v2, v189, v190
v_max_f32 v2, v2, v191
v_mov_b32 v3, v2
s_nop 1
v_permlane32_swap_b32 v2, v3
s_nop 1
v_max_f32 v2, v2, v3
v_mov_b32 v3, v2
s_nop 1
v_permlane16_swap_b32 v2, v3
s_nop 1
v_max_f32 v2, v2, v3
v_max_f32 v2, 0, v2
v_sub_f32 v180, v180, v2
v_sub_f32 v181, v181, v2
v_sub_f32 v182, v182, v2
v_sub_f32 v183, v183, v2
v_sub_f32 v188, v188, v2
v_sub_f32 v189, v189, v2
v_sub_f32 v190, v190, v2
v_sub_f32 v191, v191, v2
v_sub_f32 v216, v216, v2
v_sub_f32 v217, v217, v2
v_sub_f32 v218, v218, v2
v_sub_f32 v219, v219, v2
v_exp_f32 v3, -v2
s_nop 0
v_mul_f32 v24, v24, v3
v_mul_f32 v25, v25, v3
v_mul_f32 v26, v26, v3
v_mul_f32 v27, v27, v3
v_mul_f32 v32, v32, v3
v_mul_f32 v33, v33, v3
v_mul_f32 v34, v34, v3
v_mul_f32 v35, v35, v3
v_mul_f32 v40, v40, v3
v_mul_f32 v41, v41, v3
v_mul_f32 v42, v42, v3
v_mul_f32 v43, v43, v3
v_mul_f32 v48, v48, v3
v_mul_f32 v49, v49, v3
v_mul_f32 v50, v50, v3
v_mul_f32 v51, v51, v3
v_mul_f32 v56, v56, v3
v_mul_f32 v57, v57, v3
v_mul_f32 v58, v58, v3
v_mul_f32 v59, v59, v3
v_mul_f32 v64, v64, v3
v_mul_f32 v65, v65, v3
v_mul_f32 v66, v66, v3
v_mul_f32 v67, v67, v3
v_mul_f32 v72, v72, v3
v_mul_f32 v73, v73, v3
v_mul_f32 v74, v74, v3
v_mul_f32 v75, v75, v3
v_mul_f32 v80, v80, v3
v_mul_f32 v81, v81, v3
v_mul_f32 v82, v82, v3
v_mul_f32 v83, v83, v3
v_mul_f32 v88, v88, v3
v_mul_f32 v89, v89, v3
v_mul_f32 v90, v90, v3
v_mul_f32 v91, v91, v3
v_exp_f32 v176, v176
v_exp_f32 v177, v177
v_exp_f32 v178, v178
v_exp_f32 v179, v179
v_exp_f32 v184, v184
v_exp_f32 v185, v185
v_exp_f32 v186, v186
v_exp_f32 v187, v187
v_exp_f32 v180, v180
v_exp_f32 v181, v181
v_exp_f32 v182, v182
v_exp_f32 v183, v183
v_exp_f32 v188, v188
v_exp_f32 v189, v189
v_exp_f32 v190, v190
v_exp_f32 v191, v191
s_nop 0
v_cvt_pk_bf16_f32 v200, v176, v177
v_cvt_pk_bf16_f32 v201, v178, v179
v_cvt_pk_bf16_f32 v202, v184, v185
v_cvt_pk_bf16_f32 v203, v186, v187
v_cvt_pk_bf16_f32 v204, v180, v181
v_cvt_pk_bf16_f32 v205, v182, v183
v_cvt_pk_bf16_f32 v206, v188, v189
v_cvt_pk_bf16_f32 v207, v190, v191
s_waitcnt vmcnt(7)
s_barrier
ds_read_b128 v[224:227], v10 offset:43520
ds_read_b128 v[228:231], v10 offset:43584
ds_read_b128 v[232:235], v10 offset:43648
ds_read_b128 v[236:239], v10 offset:43712
ds_read_b128 v[240:243], v10 offset:47872
ds_read_b128 v[244:247], v10 offset:47936
ds_read_b128 v[248:251], v10 offset:48000
ds_read_b128 v[252:255], v10 offset:48064
s_branch W2_R14_back
W2_R15:
s_waitcnt lgkmcnt(0)
v_mfma_f32_16x16x32_bf16 v[20:23], v[224:227], v[200:203], v[20:23]
v_mfma_f32_16x16x32_bf16 v[28:31], v[228:231], v[200:203], v[28:31]
v_mfma_f32_16x16x32_bf16 v[36:39], v[232:235], v[200:203], v[36:39]
v_mfma_f32_16x16x32_bf16 v[44:47], v[236:239], v[200:203], v[44:47]
v_mfma_f32_16x16x32_bf16 v[52:55], v[240:243], v[200:203], v[52:55]
v_mfma_f32_16x16x32_bf16 v[60:63], v[244:247], v[200:203], v[60:63]
v_mfma_f32_16x16x32_bf16 v[68:71], v[248:251], v[200:203], v[68:71]
v_mfma_f32_16x16x32_bf16 v[76:79], v[252:255], v[200:203], v[76:79]
v_mfma_f32_16x16x32_bf16 v[84:87], v[16:19], v[200:203], v[84:87]
v_mfma_f32_16x16x32_bf16 v[24:27], v[224:227], v[204:207], v[24:27]
v_mfma_f32_16x16x32_bf16 v[32:35], v[228:231], v[204:207], v[32:35]
v_mfma_f32_16x16x32_bf16 v[40:43], v[232:235], v[204:207], v[40:43]
v_mfma_f32_16x16x32_bf16 v[48:51], v[236:239], v[204:207], v[48:51]
v_mfma_f32_16x16x32_bf16 v[56:59], v[240:243], v[204:207], v[56:59]
v_mfma_f32_16x16x32_bf16 v[64:67], v[244:247], v[204:207], v[64:67]
v_mfma_f32_16x16x32_bf16 v[72:75], v[248:251], v[204:207], v[72:75]
v_mfma_f32_16x16x32_bf16 v[80:83], v[252:255], v[204:207], v[80:83]
v_mfma_f32_16x16x32_bf16 v[88:91], v[16:19], v[204:207], v[88:91]
s_nop 15
v_max3_f32 v2, v176, v177, v178
v_max3_f32 v2, v2, v179, v184
v_max3_f32 v2, v2, v185, v186
v_max_f32 v2, v2, v187
v_mov_b32 v3, v2
s_nop 1
v_permlane32_swap_b32 v2, v3
s_nop 1
v_max_f32 v2, v2, v3
v_mov_b32 v3, v2
s_nop 1
v_permlane16_swap_b32 v2, v3
s_nop 1
v_max_f32 v2, v2, v3
v_max_f32 v2, 0, v2
v_sub_f32 v176, v176, v2
v_sub_f32 v177, v177, v2
v_sub_f32 v178, v178, v2
v_sub_f32 v179, v179, v2
v_sub_f32 v184, v184, v2
v_sub_f32 v185, v185, v2
v_sub_f32 v186, v186, v2
v_sub_f32 v187, v187, v2
v_sub_f32 v212, v212, v2
v_sub_f32 v213, v213, v2
v_sub_f32 v214, v214, v2
v_sub_f32 v215, v215, v2
v_exp_f32 v3, -v2
s_nop 0
v_mul_f32 v20, v20, v3
v_mul_f32 v21, v21, v3
v_mul_f32 v22, v22, v3
v_mul_f32 v23, v23, v3
v_mul_f32 v28, v28, v3
v_mul_f32 v29, v29, v3
v_mul_f32 v30, v30, v3
v_mul_f32 v31, v31, v3
v_mul_f32 v36, v36, v3
v_mul_f32 v37, v37, v3
v_mul_f32 v38, v38, v3
v_mul_f32 v39, v39, v3
v_mul_f32 v44, v44, v3
v_mul_f32 v45, v45, v3
v_mul_f32 v46, v46, v3
v_mul_f32 v47, v47, v3
v_mul_f32 v52, v52, v3
v_mul_f32 v53, v53, v3
v_mul_f32 v54, v54, v3
v_mul_f32 v55, v55, v3
v_mul_f32 v60, v60, v3
v_mul_f32 v61, v61, v3
v_mul_f32 v62, v62, v3
v_mul_f32 v63, v63, v3
v_mul_f32 v68, v68, v3
v_mul_f32 v69, v69, v3
v_mul_f32 v70, v70, v3
v_mul_f32 v71, v71, v3
v_mul_f32 v76, v76, v3
v_mul_f32 v77, v77, v3
v_mul_f32 v78, v78, v3
v_mul_f32 v79, v79, v3
v_mul_f32 v84, v84, v3
v_mul_f32 v85, v85, v3
v_mul_f32 v86, v86, v3
v_mul_f32 v87, v87, v3
v_max3_f32 v2, v180, v181, v182
v_max3_f32 v2, v2, v183, v188
v_max3_f32 v2, v2, v189, v190
v_max_f32 v2, v2, v191
v_mov_b32 v3, v2
s_nop 1
v_permlane32_swap_b32 v2, v3
s_nop 1
v_max_f32 v2, v2, v3
v_mov_b32 v3, v2
s_nop 1
v_permlane16_swap_b32 v2, v3
s_nop 1
v_max_f32 v2, v2, v3
v_max_f32 v2, 0, v2
v_sub_f32 v180, v180, v2
v_sub_f32 v181, v181, v2
v_sub_f32 v182, v182, v2
v_sub_f32 v183, v183, v2
v_sub_f32 v188, v188, v2
v_sub_f32 v189, v189, v2
v_sub_f32 v190, v190, v2
v_sub_f32 v191, v191, v2
v_sub_f32 v216, v216, v2
v_sub_f32 v217, v217, v2
v_sub_f32 v218, v218, v2
v_sub_f32 v219, v219, v2
v_exp_f32 v3, -v2
s_nop 0
v_mul_f32 v24, v24, v3
v_mul_f32 v25, v25, v3
v_mul_f32 v26, v26, v3
v_mul_f32 v27, v27, v3
v_mul_f32 v32, v32, v3
v_mul_f32 v33, v33, v3
v_mul_f32 v34, v34, v3
v_mul_f32 v35, v35, v3
v_mul_f32 v40, v40, v3
v_mul_f32 v41, v41, v3
v_mul_f32 v42, v42, v3
v_mul_f32 v43, v43, v3
v_mul_f32 v48, v48, v3
v_mul_f32 v49, v49, v3
v_mul_f32 v50, v50, v3
v_mul_f32 v51, v51, v3
v_mul_f32 v56, v56, v3
v_mul_f32 v57, v57, v3
v_mul_f32 v58, v58, v3
v_mul_f32 v59, v59, v3
v_mul_f32 v64, v64, v3
v_mul_f32 v65, v65, v3
v_mul_f32 v66, v66, v3
v_mul_f32 v67, v67, v3
v_mul_f32 v72, v72, v3
v_mul_f32 v73, v73, v3
v_mul_f32 v74, v74, v3
v_mul_f32 v75, v75, v3
v_mul_f32 v80, v80, v3
v_mul_f32 v81, v81, v3
v_mul_f32 v82, v82, v3
v_mul_f32 v83, v83, v3
v_mul_f32 v88, v88, v3
v_mul_f32 v89, v89, v3
v_mul_f32 v90, v90, v3
v_mul_f32 v91, v91, v3
v_exp_f32 v176, v176
v_exp_f32 v177, v177
v_exp_f32 v178, v178
v_exp_f32 v179, v179
v_exp_f32 v184, v184
v_exp_f32 v185, v185
v_exp_f32 v186, v186
v_exp_f32 v187, v187
v_exp_f32 v180, v180
v_exp_f32 v181, v181
v_exp_f32 v182, v182
v_exp_f32 v183, v183
v_exp_f32 v188, v188
v_exp_f32 v189, v189
v_exp_f32 v190, v190
v_exp_f32 v191, v191
s_nop 0
v_cvt_pk_bf16_f32 v200, v176, v177
v_cvt_pk_bf16_f32 v201, v178, v179
v_cvt_pk_bf16_f32 v202, v184, v185
v_cvt_pk_bf16_f32 v203, v186, v187
v_cvt_pk_bf16_f32 v204, v180, v181
v_cvt_pk_bf16_f32 v205, v182, v183
v_cvt_pk_bf16_f32 v206, v188, v189
v_cvt_pk_bf16_f32 v207, v190, v191
s_waitcnt vmcnt(5)
s_barrier
s_branch W2_R15_back
K1_w3:
s_setprio 1
v_lshlrev_b32 v2, 4, v0
s_lshl_b32 s36, s24, 13
s_add_u32 s36, s36, s99
v_add_u32 v2, s36, v2
s_lshr_b32 s41, s63, 2
s_lshl_b32 s41, s41, 12
s_add_u32 s41, s41, 139264
v_lshlrev_b32 v3, 4, v0
v_add_u32 v3, s41, v3
ds_read_b128 v[128:131], v2 offset:34816
ds_read_b128 v[132:135], v2 offset:35840
ds_read_b128 v[136:139], v2 offset:36864
ds_read_b128 v[140:143], v2 offset:37888
ds_read_b128 v[144:147], v2 offset:38912
ds_read_b128 v[148:151], v2 offset:39936
ds_read_b128 v[152:155], v2 offset:40960
ds_read_b128 v[156:159], v2 offset:41984
ds_read_b128 v[160:163], v3 offset:0
ds_read_b128 v[164:167], v3 offset:1024
ds_read_b128 v[168:171], v3 offset:2048
ds_read_b128 v[172:175], v3 offset:3072
v_mov_b32 v16, 0x3f803f80
v_mov_b32 v17, 0x3f803f80
v_mov_b32 v18, 0x3f803f80
v_mov_b32 v19, 0x3f803f80
s_waitcnt vmcnt(2) lgkmcnt(0)
s_barrier
ds_read_b128 v[224:227], v10 offset:0
ds_read_b128 v[228:231], v10 offset:64
ds_read_b128 v[232:235], v10 offset:128
ds_read_b128 v[236:239], v10 offset:192
ds_read_b128 v[240:243], v10 offset:4352
ds_read_b128 v[244:247], v10 offset:4416
ds_read_b128 v[248:251], v10 offset:4480
ds_read_b128 v[252:255], v10 offset:4544
s_waitcnt lgkmcnt(4)
v_mfma_f32_16x16x32_bf16 v[176:179], v[224:227], v[128:131], 0
s_add_u32 m0, s27, 34816
s_add_u32 s36, s29, 16384
buffer_load_dwordx4 v12, s[12:15], s36 offen nt lds
v_mfma_f32_16x16x32_bf16 v[176:179], v[228:231], v[132:135], v[176:179]
v_mfma_f32_16x16x32_bf16 v[176:179], v[232:235], v[136:139], v[176:179]
v_mfma_f32_16x16x32_bf16 v[176:179], v[236:239], v[140:143], v[176:179]
s_add_u32 m0, s27, 35904
s_add_u32 s36, s29, 17408
buffer_load_dwordx4 v12, s[12:15], s36 offen nt lds
v_mfma_f32_16x16x32_bf16 v[180:183], v[224:227], v[144:147], 0
v_mfma_f32_16x16x32_bf16 v[180:183], v[228:231], v[148:151], v[180:183]
v_mfma_f32_16x16x32_bf16 v[180:183], v[232:235], v[152:155], v[180:183]
s_add_u32 m0, s27, 43520
s_add_u32 s36, s29, 24576
buffer_load_dwordx4 v12, s[12:15], s36 offen nt lds
v_mfma_f32_16x16x32_bf16 v[180:183], v[236:239], v[156:159], v[180:183]
v_mfma_f32_16x16x32_bf16 v[184:187], v[224:227], v[160:163], 0
v_mfma_f32_16x16x32_bf16 v[184:187], v[228:231], v[164:167], v[184:187]
s_add_u32 m0, s27, 44608
s_add_u32 s36, s29, 25600
buffer_load_dwordx4 v12, s[12:15], s36 offen nt lds
v_mfma_f32_16x16x32_bf16 v[184:187], v[232:235], v[168:171], v[184:187]
v_mfma_f32_16x16x32_bf16 v[184:187], v[236:239], v[172:175], v[184:187]
s_waitcnt lgkmcnt(0)
v_mfma_f32_16x16x32_bf16 v[188:191], v[240:243], v[128:131], 0
s_add_u32 m0, s28, 52224
s_add_u32 s36, s33, 16384
buffer_load_dwordx4 v13, s[16:19], s36 offen nt lds
v_mfma_f32_16x16x32_bf16 v[188:191], v[244:247], v[132:135], v[188:191]
v_mfma_f32_16x16x32_bf16 v[188:191], v[248:251], v[136:139], v[188:191]
v_mfma_f32_16x16x32_bf16 v[188:191], v[252:255], v[140:143], v[188:191]
s_add_u32 m0, s28, 53280
s_add_u32 s36, s33, 16640
buffer_load_dwordx4 v13, s[16:19], s36 offen nt lds
v_mfma_f32_16x16x32_bf16 v[192:195], v[240:243], v[144:147], 0
v_mfma_f32_16x16x32_bf16 v[192:195], v[244:247], v[148:151], v[192:195]
v_mfma_f32_16x16x32_bf16 v[192:195], v[248:251], v[152:155], v[192:195]
s_add_u32 m0, s28, 60672
s_add_u32 s36, s33, 24576
buffer_load_dwordx4 v13, s[16:19], s36 offen nt lds
v_mfma_f32_16x16x32_bf16 v[192:195], v[252:255], v[156:159], v[192:195]
v_mfma_f32_16x16x32_bf16 v[196:199], v[240:243], v[160:163], 0
v_mfma_f32_16x16x32_bf16 v[196:199], v[244:247], v[164:167], v[196:199]
s_add_u32 m0, s28, 61728
s_add_u32 s36, s33, 24832
buffer_load_dwordx4 v13, s[16:19], s36 offen nt lds
v_mfma_f32_16x16x32_bf16 v[196:199], v[248:251], v[168:171], v[196:199]
v_mfma_f32_16x16x32_bf16 v[196:199], v[252:255], v[172:175], v[196:199]
ds_read_b128 v[224:227], v10 offset:8704
ds_read_b128 v[228:231], v10 offset:8768
ds_read_b128 v[232:235], v10 offset:8832
ds_read_b128 v[236:239], v10 offset:8896
ds_read_b128 v[240:243], v10 offset:13056
ds_read_b128 v[244:247], v10 offset:13120
ds_read_b128 v[248:251], v10 offset:13184
ds_read_b128 v[252:255], v10 offset:13248
s_nop 7
v_max3_f32 v2, v176, v177, v178
v_max3_f32 v2, v2, v179, v188
v_max3_f32 v2, v2, v189, v190
v_max_f32 v2, v2, v191
v_mov_b32 v3, v2
s_nop 1
v_permlane32_swap_b32 v2, v3
s_nop 1
v_max_f32 v2, v2, v3
v_mov_b32 v3, v2
s_nop 1
v_permlane16_swap_b32 v2, v3
s_nop 1
v_max_f32 v2, v2, v3
v_sub_f32 v176, v176, v2
v_sub_f32 v177, v177, v2
v_sub_f32 v178, v178, v2
v_sub_f32 v179, v179, v2
v_sub_f32 v188, v188, v2
v_sub_f32 v189, v189, v2
v_sub_f32 v190, v190, v2
v_sub_f32 v191, v191, v2
v_sub_f32 v212, 0, v2
v_sub_f32 v213, 0, v2
v_sub_f32 v214, 0, v2
v_sub_f32 v215, 0, v2
v_max3_f32 v2, v180, v181, v182
v_max3_f32 v2, v2, v183, v192
v_max3_f32 v2, v2, v193, v194
v_max_f32 v2, v2, v195
v_mov_b32 v3, v2
s_nop 1
v_permlane32_swap_b32 v2, v3
s_nop 1
v_max_f32 v2, v2, v3
v_mov_b32 v3, v2
s_nop 1
v_permlane16_swap_b32 v2, v3
s_nop 1
v_max_f32 v2, v2, v3
v_sub_f32 v180, v180, v2
v_sub_f32 v181, v181, v2
v_sub_f32 v182, v182, v2
v_sub_f32 v183, v183, v2
v_sub_f32 v192, v192, v2
v_sub_f32 v193, v193, v2
v_sub_f32 v194, v194, v2
v_sub_f32 v195, v195, v2
v_sub_f32 v216, 0, v2
v_sub_f32 v217, 0, v2
v_sub_f32 v218, 0, v2
v_sub_f32 v219, 0, v2
v_max3_f32 v2, v184, v185, v186
v_max3_f32 v2, v2, v187, v196
v_max3_f32 v2, v2, v197, v198
v_max_f32 v2, v2, v199
v_mov_b32 v3, v2
s_nop 1
v_permlane32_swap_b32 v2, v3
s_nop 1
v_max_f32 v2, v2, v3
v_mov_b32 v3, v2
s_nop 1
v_permlane16_swap_b32 v2, v3
s_nop 1
v_max_f32 v2, v2, v3
v_sub_f32 v184, v184, v2
v_sub_f32 v185, v185, v2
v_sub_f32 v186, v186, v2
v_sub_f32 v187, v187, v2
v_sub_f32 v196, v196, v2
v_sub_f32 v197, v197, v2
v_sub_f32 v198, v198, v2
v_sub_f32 v199, v199, v2
v_sub_f32 v220, 0, v2
v_sub_f32 v221, 0, v2
v_sub_f32 v222, 0, v2
v_sub_f32 v223, 0, v2
v_exp_f32 v176, v176
v_exp_f32 v177, v177
v_exp_f32 v178, v178
v_exp_f32 v179, v179
v_exp_f32 v188, v188
v_exp_f32 v189, v189
v_exp_f32 v190, v190
v_exp_f32 v191, v191
v_exp_f32 v180, v180
v_exp_f32 v181, v181
v_exp_f32 v182, v182
v_exp_f32 v183, v183
v_exp_f32 v192, v192
v_exp_f32 v193, v193
v_exp_f32 v194, v194
v_exp_f32 v195, v195
v_exp_f32 v184, v184
v_exp_f32 v185, v185
v_exp_f32 v186, v186
v_exp_f32 v187, v187
v_exp_f32 v196, v196
v_exp_f32 v197, v197
v_exp_f32 v198, v198
v_exp_f32 v199, v199
v_cvt_pk_bf16_f32 v200, v176, v177
v_cvt_pk_bf16_f32 v201, v178, v179
v_cvt_pk_bf16_f32 v202, v188, v189
v_cvt_pk_bf16_f32 v203, v190, v191
v_cvt_pk_bf16_f32 v204, v180, v181
v_cvt_pk_bf16_f32 v205, v182, v183
v_cvt_pk_bf16_f32 v206, v192, v193
v_cvt_pk_bf16_f32 v207, v194, v195
v_cvt_pk_bf16_f32 v208, v184, v185
v_cvt_pk_bf16_f32 v209, v186, v187
v_cvt_pk_bf16_f32 v210, v196, v197
v_cvt_pk_bf16_f32 v211, v198, v199
s_waitcnt lgkmcnt(7)
v_mfma_f32_16x16x32_bf16 v[176:179], v[224:227], v[128:131], v[212:215]
v_mfma_f32_16x16x32_bf16 v[180:183], v[224:227], v[144:147], v[216:219]
v_mfma_f32_16x16x32_bf16 v[184:187], v[224:227], v[160:163], v[220:223]
s_waitcnt lgkmcnt(6)
v_mfma_f32_16x16x32_bf16 v[176:179], v[228:231], v[132:135], v[176:179]
ds_read_b64_tr_b16 v[224:225], v11 offset:17408
v_mfma_f32_16x16x32_bf16 v[180:183], v[228:231], v[148:151], v[180:183]
ds_read_b64_tr_b16 v[226:227], v11 offset:17920
v_mfma_f32_16x16x32_bf16 v[184:187], v[228:231], v[164:167], v[184:187]
s_waitcnt lgkmcnt(7)
v_mfma_f32_16x16x32_bf16 v[176:179], v[232:235], v[136:139], v[176:179]
ds_read_b64_tr_b16 v[228:229], v11 offset:17440
v_mfma_f32_16x16x32_bf16 v[180:183], v[232:235], v[152:155], v[180:183]
ds_read_b64_tr_b16 v[230:231], v11 offset:17952
v_mfma_f32_16x16x32_bf16 v[184:187], v[232:235], v[168:171], v[184:187]
s_waitcnt lgkmcnt(8)
v_mfma_f32_16x16x32_bf16 v[176:179], v[236:239], v[140:143], v[176:179]
ds_read_b64_tr_b16 v[232:233], v11 offset:17472
v_mfma_f32_16x16x32_bf16 v[180:183], v[236:239], v[156:159], v[180:183]
ds_read_b64_tr_b16 v[234:235], v11 offset:17984
v_mfma_f32_16x16x32_bf16 v[184:187], v[236:239], v[172:175], v[184:187]
s_waitcnt lgkmcnt(9)
v_mfma_f32_16x16x32_bf16 v[188:191], v[240:243], v[128:131], v[212:215]
ds_read_b64_tr_b16 v[236:237], v11 offset:17504
v_mfma_f32_16x16x32_bf16 v[192:195], v[240:243], v[144:147], v[216:219]
ds_read_b64_tr_b16 v[238:239], v11 offset:18016
v_mfma_f32_16x16x32_bf16 v[196:199], v[240:243], v[160:163], v[220:223]
s_waitcnt lgkmcnt(10)
v_mfma_f32_16x16x32_bf16 v[188:191], v[244:247], v[132:135], v[188:191]
ds_read_b64_tr_b16 v[240:241], v11 offset:17536
v_mfma_f32_16x16x32_bf16 v[192:195], v[244:247], v[148:151], v[192:195]
ds_read_b64_tr_b16 v[242:243], v11 offset:18048
v_mfma_f32_16x16x32_bf16 v[196:199], v[244:247], v[164:167], v[196:199]
s_waitcnt lgkmcnt(11)
v_mfma_f32_16x16x32_bf16 v[188:191], v[248:251], v[136:139], v[188:191]
ds_read_b64_tr_b16 v[244:245], v11 offset:17568
ds_read_b64_tr_b16 v[246:247], v11 offset:18080
v_mfma_f32_16x16x32_bf16 v[192:195], v[248:251], v[152:155], v[192:195]
v_max3_f32 v2, v176, v177, v178
v_max_f32 v2, v2, v179
v_mfma_f32_16x16x32_bf16 v[196:199], v[248:251], v[168:171], v[196:199]
v_max3_f32 v2, v2, v180, v181
s_waitcnt lgkmcnt(12)
v_mfma_f32_16x16x32_bf16 v[188:191], v[252:255], v[140:143], v[188:191]
ds_read_b64_tr_b16 v[248:249], v11 offset:17600
ds_read_b64_tr_b16 v[250:251], v11 offset:18112
v_mfma_f32_16x16x32_bf16 v[192:195], v[252:255], v[156:159], v[192:195]
v_max3_f32 v2, v2, v182, v183
v_max3_f32 v2, v2, v184, v185
v_mfma_f32_16x16x32_bf16 v[196:199], v[252:255], v[172:175], v[196:199]
v_max3_f32 v2, v2, v186, v187
ds_read_b64_tr_b16 v[252:253], v11 offset:17632
ds_read_b64_tr_b16 v[254:255], v11 offset:18144
s_nop 4
v_max3_f32 v2, v2, v188, v189
v_max3_f32 v2, v2, v190, v191
v_max3_f32 v2, v2, v192, v193
v_max3_f32 v2, v2, v194, v195
v_max3_f32 v2, v2, v196, v197
v_max3_f32 v2, v2, v198, v199
v_cmp_lt_f32 vcc, s3, v2
s_cbranch_vccnz W3_R1
s_waitcnt lgkmcnt(14)
v_mfma_f32_16x16x32_bf16 v[20:23], v[224:227], v[200:203], 0
v_exp_f32 v176, v176
s_waitcnt lgkmcnt(12)
v_mfma_f32_16x16x32_bf16 v[32:35], v[228:231], v[200:203], 0
v_exp_f32 v177, v177
s_waitcnt lgkmcnt(10)
v_mfma_f32_16x16x32_bf16 v[44:47], v[232:235], v[200:203], 0
v_exp_f32 v178, v178
s_waitcnt lgkmcnt(8)
v_mfma_f32_16x16x32_bf16 v[56:59], v[236:239], v[200:203], 0
v_exp_f32 v179, v179
s_waitcnt lgkmcnt(6)
v_mfma_f32_16x16x32_bf16 v[68:71], v[240:243], v[200:203], 0
v_exp_f32 v188, v188
s_waitcnt lgkmcnt(4)
v_mfma_f32_16x16x32_bf16 v[80:83], v[244:247], v[200:203], 0
v_exp_f32 v189, v189
s_waitcnt lgkmcnt(2)
v_mfma_f32_16x16x32_bf16 v[92:95], v[248:251], v[200:203], 0
v_exp_f32 v190, v190
s_waitcnt lgkmcnt(0)
v_mfma_f32_16x16x32_bf16 v[104:107], v[252:255], v[200:203], 0
v_exp_f32 v191, v191
v_mfma_f32_16x16x32_bf16 v[116:119], v[16:19], v[200:203], 0
s_waitcnt vmcnt(6)
s_barrier
v_mfma_f32_16x16x32_bf16 v[24:27], v[224:227], v[204:207], 0
v_exp_f32 v180, v180
v_cvt_pk_bf16_f32 v200, v176, v177
v_mfma_f32_16x16x32_bf16 v[36:39], v[228:231], v[204:207], 0
s_add_u32 m0, s27, 0
s_add_u32 s36, s29, 32768
buffer_load_dwordx4 v12, s[12:15], s36 offen nt lds
v_exp_f32 v181, v181
v_mfma_f32_16x16x32_bf16 v[48:51], v[232:235], v[204:207], 0
v_cvt_pk_bf16_f32 v201, v178, v179
v_mfma_f32_16x16x32_bf16 v[60:63], v[236:239], v[204:207], 0
s_add_u32 m0, s27, 1088
s_add_u32 s36, s29, 33792
buffer_load_dwordx4 v12, s[12:15], s36 offen nt lds
v_exp_f32 v182, v182
v_mfma_f32_16x16x32_bf16 v[72:75], v[240:243], v[204:207], 0
v_cvt_pk_bf16_f32 v202, v188, v189
v_mfma_f32_16x16x32_bf16 v[84:87], v[244:247], v[204:207], 0
v_exp_f32 v183, v183
v_cvt_pk_bf16_f32 v203, v190, v191
v_mfma_f32_16x16x32_bf16 v[96:99], v[248:251], v[204:207], 0
v_exp_f32 v192, v192
v_mfma_f32_16x16x32_bf16 v[108:111], v[252:255], v[204:207], 0
v_exp_f32 v193, v193
v_exp_f32 v194, v194
v_mfma_f32_16x16x32_bf16 v[120:123], v[16:19], v[204:207], 0
v_exp_f32 v195, v195
v_mfma_f32_16x16x32_bf16 v[28:31], v[224:227], v[208:211], 0
v_exp_f32 v184, v184
v_cvt_pk_bf16_f32 v204, v180, v181
s_add_u32 m0, s27, 8704
s_add_u32 s36, s29, 40960
buffer_load_dwordx4 v12, s[12:15], s36 offen nt lds
ds_read_b128 v[224:227], v10 offset:34816
v_mfma_f32_16x16x32_bf16 v[40:43], v[228:231], v[208:211], 0
v_exp_f32 v185, v185
v_cvt_pk_bf16_f32 v205, v182, v183
s_add_u32 m0, s27, 9792
s_add_u32 s36, s29, 41984
buffer_load_dwordx4 v12, s[12:15], s36 offen nt lds
ds_read_b128 v[228:231], v10 offset:34880
v_mfma_f32_16x16x32_bf16 v[52:55], v[232:235], v[208:211], 0
v_exp_f32 v186, v186
v_cvt_pk_bf16_f32 v206, v192, v193
s_add_u32 m0, s28, 17408
s_add_u32 s36, s33, 32768
buffer_load_dwordx4 v13, s[16:19], s36 offen nt lds
ds_read_b128 v[232:235], v10 offset:34944
v_mfma_f32_16x16x32_bf16 v[64:67], v[236:239], v[208:211], 0
v_exp_f32 v187, v187
v_cvt_pk_bf16_f32 v207, v194, v195
s_add_u32 m0, s28, 18464
s_add_u32 s36, s33, 33024
buffer_load_dwordx4 v13, s[16:19], s36 offen nt lds
ds_read_b128 v[236:239], v10 offset:35008
v_mfma_f32_16x16x32_bf16 v[76:79], v[240:243], v[208:211], 0
v_exp_f32 v196, v196
v_mov_b32 v8, 0
global_load_dword v7, v8, s[44:45] sc1
v_exp_f32 v197, v197
ds_read_b128 v[240:243], v10 offset:39168
v_mfma_f32_16x16x32_bf16 v[88:91], v[244:247], v[208:211], 0
v_exp_f32 v198, v198
v_exp_f32 v199, v199
ds_read_b128 v[244:247], v10 offset:39232
v_mfma_f32_16x16x32_bf16 v[100:103], v[248:251], v[208:211], 0
ds_read_b128 v[248:251], v10 offset:39296
v_mfma_f32_16x16x32_bf16 v[112:115], v[252:255], v[208:211], 0
ds_read_b128 v[252:255], v10 offset:39360
v_mfma_f32_16x16x32_bf16 v[124:127], v[16:19], v[208:211], 0
s_nop 0
v_cvt_pk_bf16_f32 v208, v184, v185
v_cvt_pk_bf16_f32 v209, v186, v187
v_cvt_pk_bf16_f32 v210, v196, v197
v_cvt_pk_bf16_f32 v211, v198, v199
W3_R1_back:
s_waitcnt lgkmcnt(7)
v_mfma_f32_16x16x32_bf16 v[176:179], v[224:227], v[128:131], v[212:215]
v_mfma_f32_16x16x32_bf16 v[180:183], v[224:227], v[144:147], v[216:219]
v_mfma_f32_16x16x32_bf16 v[184:187], v[224:227], v[160:163], v[220:223]
s_waitcnt lgkmcnt(6)
v_mfma_f32_16x16x32_bf16 v[176:179], v[228:231], v[132:135], v[176:179]
ds_read_b64_tr_b16 v[224:225], v11 offset:25856
v_mfma_f32_16x16x32_bf16 v[180:183], v[228:231], v[148:151], v[180:183]
ds_read_b64_tr_b16 v[226:227], v11 offset:26368
v_mfma_f32_16x16x32_bf16 v[184:187], v[228:231], v[164:167], v[184:187]
s_waitcnt lgkmcnt(7)
v_mfma_f32_16x16x32_bf16 v[176:179], v[232:235], v[136:139], v[176:179]
ds_read_b64_tr_b16 v[228:229], v11 offset:25888
v_mfma_f32_16x16x32_bf16 v[180:183], v[232:235], v[152:155], v[180:183]
ds_read_b64_tr_b16 v[230:231], v11 offset:26400
v_mfma_f32_16x16x32_bf16 v[184:187], v[232:235], v[168:171], v[184:187]
s_waitcnt lgkmcnt(8)
v_mfma_f32_16x16x32_bf16 v[176:179], v[236:239], v[140:143], v[176:179]
ds_read_b64_tr_b16 v[232:233], v11 offset:25920
v_mfma_f32_16x16x32_bf16 v[180:183], v[236:239], v[156:159], v[180:183]
ds_read_b64_tr_b16 v[234:235], v11 offset:26432
v_mfma_f32_16x16x32_bf16 v[184:187], v[236:239], v[172:175], v[184:187]
s_waitcnt lgkmcnt(9)
v_mfma_f32_16x16x32_bf16 v[188:191], v[240:243], v[128:131], v[212:215]
ds_read_b64_tr_b16 v[236:237], v11 offset:25952
v_mfma_f32_16x16x32_bf16 v[192:195], v[240:243], v[144:147], v[216:219]
ds_read_b64_tr_b16 v[238:239], v11 offset:26464
v_mfma_f32_16x16x32_bf16 v[196:199], v[240:243], v[160:163], v[220:223]
s_waitcnt lgkmcnt(10)
v_mfma_f32_16x16x32_bf16 v[188:191], v[244:247], v[132:135], v[188:191]
ds_read_b64_tr_b16 v[240:241], v11 offset:25984
v_mfma_f32_16x16x32_bf16 v[192:195], v[244:247], v[148:151], v[192:195]
ds_read_b64_tr_b16 v[242:243], v11 offset:26496
v_mfma_f32_16x16x32_bf16 v[196:199], v[244:247], v[164:167], v[196:199]
s_waitcnt lgkmcnt(11)
v_mfma_f32_16x16x32_bf16 v[188:191], v[248:251], v[136:139], v[188:191]
ds_read_b64_tr_b16 v[244:245], v11 offset:26016
ds_read_b64_tr_b16 v[246:247], v11 offset:26528
v_mfma_f32_16x16x32_bf16 v[192:195], v[248:251], v[152:155], v[192:195]
v_max3_f32 v2, v176, v177, v178
v_max_f32 v2, v2, v179
v_mfma_f32_16x16x32_bf16 v[196:199], v[248:251], v[168:171], v[196:199]
v_max3_f32 v2, v2, v180, v181
s_waitcnt lgkmcnt(12)
v_mfma_f32_16x16x32_bf16 v[188:191], v[252:255], v[140:143], v[188:191]
ds_read_b64_tr_b16 v[248:249], v11 offset:26048
ds_read_b64_tr_b16 v[250:251], v11 offset:26560
v_mfma_f32_16x16x32_bf16 v[192:195], v[252:255], v[156:159], v[192:195]
v_max3_f32 v2, v2, v182, v183
v_max3_f32 v2, v2, v184, v185
v_mfma_f32_16x16x32_bf16 v[196:199], v[252:255], v[172:175], v[196:199]
v_max3_f32 v2, v2, v186, v187
ds_read_b64_tr_b16 v[252:253], v11 offset:26080
ds_read_b64_tr_b16 v[254:255], v11 offset:26592
s_nop 4
v_max3_f32 v2, v2, v188, v189
v_max3_f32 v2, v2, v190, v191
v_max3_f32 v2, v2, v192, v193
v_max3_f32 v2, v2, v194, v195
v_max3_f32 v2, v2, v196, v197
v_max3_f32 v2, v2, v198, v199
v_cmp_lt_f32 vcc, s3, v2
s_cbranch_vccnz W3_R2
s_waitcnt lgkmcnt(14)
v_mfma_f32_16x16x32_bf16 v[20:23], v[224:227], v[200:203], v[20:23]
v_exp_f32 v176, v176
s_waitcnt lgkmcnt(12)
v_mfma_f32_16x16x32_bf16 v[32:35], v[228:231], v[200:203], v[32:35]
v_exp_f32 v177, v177
s_waitcnt lgkmcnt(10)
v_mfma_f32_16x16x32_bf16 v[44:47], v[232:235], v[200:203], v[44:47]
v_exp_f32 v178, v178
s_waitcnt lgkmcnt(8)
v_mfma_f32_16x16x32_bf16 v[56:59], v[236:239], v[200:203], v[56:59]
v_exp_f32 v179, v179
s_waitcnt lgkmcnt(6)
v_mfma_f32_16x16x32_bf16 v[68:71], v[240:243], v[200:203], v[68:71]
v_exp_f32 v188, v188
s_waitcnt lgkmcnt(4)
v_mfma_f32_16x16x32_bf16 v[80:83], v[244:247], v[200:203], v[80:83]
v_exp_f32 v189, v189
s_waitcnt lgkmcnt(2)
v_mfma_f32_16x16x32_bf16 v[92:95], v[248:251], v[200:203], v[92:95]
v_exp_f32 v190, v190
s_waitcnt lgkmcnt(0)
v_mfma_f32_16x16x32_bf16 v[104:107], v[252:255], v[200:203], v[104:107]
v_exp_f32 v191, v191
v_mfma_f32_16x16x32_bf16 v[116:119], v[16:19], v[200:203], v[116:119]
s_waitcnt vmcnt(9)
s_barrier
v_mfma_f32_16x16x32_bf16 v[24:27], v[224:227], v[204:207], v[24:27]
v_exp_f32 v180, v180
v_cvt_pk_bf16_f32 v200, v176, v177
v_mfma_f32_16x16x32_bf16 v[36:39], v[228:231], v[204:207], v[36:39]
s_add_u32 m0, s27, 34816
s_add_u32 s36, s29, 49152
buffer_load_dwordx4 v12, s[12:15], s36 offen nt lds
v_exp_f32 v181, v181
v_mfma_f32_16x16x32_bf16 v[48:51], v[232:235], v[204:207], v[48:51]
v_cvt_pk_bf16_f32 v201, v178, v179
v_mfma_f32_16x16x32_bf16 v[60:63], v[236:239], v[204:207], v[60:63]
s_add_u32 m0, s27, 35904
s_add_u32 s36, s29, 50176
buffer_load_dwordx4 v12, s[12:15], s36 offen nt lds
v_exp_f32 v182, v182
v_mfma_f32_16x16x32_bf16 v[72:75], v[240:243], v[204:207], v[72:75]
v_cvt_pk_bf16_f32 v202, v188, v189
v_mfma_f32_16x16x32_bf16 v[84:87], v[244:247], v[204:207], v[84:87]
v_exp_f32 v183, v183
v_cvt_pk_bf16_f32 v203, v190, v191
v_mfma_f32_16x16x32_bf16 v[96:99], v[248:251], v[204:207], v[96:99]
v_exp_f32 v192, v192
v_mfma_f32_16x16x32_bf16 v[108:111], v[252:255], v[204:207], v[108:111]
v_exp_f32 v193, v193
v_exp_f32 v194, v194
v_mfma_f32_16x16x32_bf16 v[120:123], v[16:19], v[204:207], v[120:123]
v_exp_f32 v195, v195
v_mfma_f32_16x16x32_bf16 v[28:31], v[224:227], v[208:211], v[28:31]
v_exp_f32 v184, v184
v_cvt_pk_bf16_f32 v204, v180, v181
ds_read_b128 v[224:227], v10 offset:43520
v_mfma_f32_16x16x32_bf16 v[40:43], v[228:231], v[208:211], v[40:43]
s_add_u32 m0, s28, 25856
s_add_u32 s36, s33, 40960
buffer_load_dwordx4 v13, s[16:19], s36 offen nt lds
v_exp_f32 v185, v185
ds_read_b128 v[228:231], v10 offset:43584
v_mfma_f32_16x16x32_bf16 v[52:55], v[232:235], v[208:211], v[52:55]
v_cvt_pk_bf16_f32 v205, v182, v183
s_add_u32 m0, s28, 26912
s_add_u32 s36, s33, 41216
buffer_load_dwordx4 v13, s[16:19], s36 offen nt lds
ds_read_b128 v[232:235], v10 offset:43648
v_mfma_f32_16x16x32_bf16 v[64:67], v[236:239], v[208:211], v[64:67]
v_exp_f32 v186, v186
v_cvt_pk_bf16_f32 v206, v192, v193
ds_read_b128 v[236:239], v10 offset:43712
v_mfma_f32_16x16x32_bf16 v[76:79], v[240:243], v[208:211], v[76:79]
v_exp_f32 v187, v187
v_cvt_pk_bf16_f32 v207, v194, v195
ds_read_b128 v[240:243], v10 offset:47872
v_mfma_f32_16x16x32_bf16 v[88:91], v[244:247], v[208:211], v[88:91]
v_exp_f32 v196, v196
v_exp_f32 v197, v197
ds_read_b128 v[244:247], v10 offset:47936
v_mfma_f32_16x16x32_bf16 v[100:103], v[248:251], v[208:211], v[100:103]
v_exp_f32 v198, v198
v_exp_f32 v199, v199
ds_read_b128 v[248:251], v10 offset:48000
v_mfma_f32_16x16x32_bf16 v[112:115], v[252:255], v[208:211], v[112:115]
ds_read_b128 v[252:255], v10 offset:48064
v_mfma_f32_16x16x32_bf16 v[124:127], v[16:19], v[208:211], v[124:127]
s_nop 0
v_cvt_pk_bf16_f32 v208, v184, v185
v_cvt_pk_bf16_f32 v209, v186, v187
v_cvt_pk_bf16_f32 v210, v196, v197
v_cvt_pk_bf16_f32 v211, v198, v199
W3_R2_back:
s_waitcnt lgkmcnt(7)
v_mfma_f32_16x16x32_bf16 v[176:179], v[224:227], v[128:131], v[212:215]
v_mfma_f32_16x16x32_bf16 v[180:183], v[224:227], v[144:147], v[216:219]
v_mfma_f32_16x16x32_bf16 v[184:187], v[224:227], v[160:163], v[220:223]
s_waitcnt lgkmcnt(6)
v_mfma_f32_16x16x32_bf16 v[176:179], v[228:231], v[132:135], v[176:179]
ds_read_b64_tr_b16 v[224:225], v11 offset:52224
v_mfma_f32_16x16x32_bf16 v[180:183], v[228:231], v[148:151], v[180:183]
ds_read_b64_tr_b16 v[226:227], v11 offset:52736
v_mfma_f32_16x16x32_bf16 v[184:187], v[228:231], v[164:167], v[184:187]
s_waitcnt lgkmcnt(7)
v_mfma_f32_16x16x32_bf16 v[176:179], v[232:235], v[136:139], v[176:179]
ds_read_b64_tr_b16 v[228:229], v11 offset:52256
v_mfma_f32_16x16x32_bf16 v[180:183], v[232:235], v[152:155], v[180:183]
ds_read_b64_tr_b16 v[230:231], v11 offset:52768
v_mfma_f32_16x16x32_bf16 v[184:187], v[232:235], v[168:171], v[184:187]
s_waitcnt lgkmcnt(8)
v_mfma_f32_16x16x32_bf16 v[176:179], v[236:239], v[140:143], v[176:179]
ds_read_b64_tr_b16 v[232:233], v11 offset:52288
v_mfma_f32_16x16x32_bf16 v[180:183], v[236:239], v[156:159], v[180:183]
ds_read_b64_tr_b16 v[234:235], v11 offset:52800
v_mfma_f32_16x16x32_bf16 v[184:187], v[236:239], v[172:175], v[184:187]
s_waitcnt lgkmcnt(9)
v_mfma_f32_16x16x32_bf16 v[188:191], v[240:243], v[128:131], v[212:215]
ds_read_b64_tr_b16 v[236:237], v11 offset:52320
v_mfma_f32_16x16x32_bf16 v[192:195], v[240:243], v[144:147], v[216:219]
ds_read_b64_tr_b16 v[238:239], v11 offset:52832
v_mfma_f32_16x16x32_bf16 v[196:199], v[240:243], v[160:163], v[220:223]
s_waitcnt lgkmcnt(10)
v_mfma_f32_16x16x32_bf16 v[188:191], v[244:247], v[132:135], v[188:191]
ds_read_b64_tr_b16 v[240:241], v11 offset:52352
v_mfma_f32_16x16x32_bf16 v[192:195], v[244:247], v[148:151], v[192:195]
ds_read_b64_tr_b16 v[242:243], v11 offset:52864
v_mfma_f32_16x16x32_bf16 v[196:199], v[244:247], v[164:167], v[196:199]
s_waitcnt lgkmcnt(11)
v_mfma_f32_16x16x32_bf16 v[188:191], v[248:251], v[136:139], v[188:191]
ds_read_b64_tr_b16 v[244:245], v11 offset:52384
ds_read_b64_tr_b16 v[246:247], v11 offset:52896
v_mfma_f32_16x16x32_bf16 v[192:195], v[248:251], v[152:155], v[192:195]
v_max3_f32 v2, v176, v177, v178
v_max_f32 v2, v2, v179
v_mfma_f32_16x16x32_bf16 v[196:199], v[248:251], v[168:171], v[196:199]
v_max3_f32 v2, v2, v180, v181
s_waitcnt lgkmcnt(12)
v_mfma_f32_16x16x32_bf16 v[188:191], v[252:255], v[140:143], v[188:191]
ds_read_b64_tr_b16 v[248:249], v11 offset:52416
ds_read_b64_tr_b16 v[250:251], v11 offset:52928
v_mfma_f32_16x16x32_bf16 v[192:195], v[252:255], v[156:159], v[192:195]
v_max3_f32 v2, v2, v182, v183
v_max3_f32 v2, v2, v184, v185
v_mfma_f32_16x16x32_bf16 v[196:199], v[252:255], v[172:175], v[196:199]
v_max3_f32 v2, v2, v186, v187
ds_read_b64_tr_b16 v[252:253], v11 offset:52448
ds_read_b64_tr_b16 v[254:255], v11 offset:52960
s_nop 4
v_max3_f32 v2, v2, v188, v189
v_max3_f32 v2, v2, v190, v191
v_max3_f32 v2, v2, v192, v193
v_max3_f32 v2, v2, v194, v195
v_max3_f32 v2, v2, v196, v197
v_max3_f32 v2, v2, v198, v199
v_cmp_lt_f32 vcc, s3, v2
s_cbranch_vccnz W3_R3
s_waitcnt lgkmcnt(14)
v_mfma_f32_16x16x32_bf16 v[20:23], v[224:227], v[200:203], v[20:23]
v_exp_f32 v176, v176
s_waitcnt lgkmcnt(12)
v_mfma_f32_16x16x32_bf16 v[32:35], v[228:231], v[200:203], v[32:35]
v_exp_f32 v177, v177
s_waitcnt lgkmcnt(10)
v_mfma_f32_16x16x32_bf16 v[44:47], v[232:235], v[200:203], v[44:47]
v_exp_f32 v178, v178
s_waitcnt lgkmcnt(8)
v_mfma_f32_16x16x32_bf16 v[56:59], v[236:239], v[200:203], v[56:59]
v_exp_f32 v179, v179
s_waitcnt lgkmcnt(6)
v_mfma_f32_16x16x32_bf16 v[68:71], v[240:243], v[200:203], v[68:71]
v_exp_f32 v188, v188
s_waitcnt lgkmcnt(4)
v_mfma_f32_16x16x32_bf16 v[80:83], v[244:247], v[200:203], v[80:83]
v_exp_f32 v189, v189
s_waitcnt lgkmcnt(2)
v_mfma_f32_16x16x32_bf16 v[92:95], v[248:251], v[200:203], v[92:95]
v_exp_f32 v190, v190
s_waitcnt lgkmcnt(0)
v_mfma_f32_16x16x32_bf16 v[104:107], v[252:255], v[200:203], v[104:107]
v_exp_f32 v191, v191
v_mfma_f32_16x16x32_bf16 v[116:119], v[16:19], v[200:203], v[116:119]
s_waitcnt vmcnt(9)
s_barrier
v_mfma_f32_16x16x32_bf16 v[24:27], v[224:227], v[204:207], v[24:27]
v_exp_f32 v180, v180
v_cvt_pk_bf16_f32 v200, v176, v177
v_mfma_f32_16x16x32_bf16 v[36:39], v[228:231], v[204:207], v[36:39]
s_add_u32 m0, s27, 43520
s_add_u32 s36, s29, 57344
buffer_load_dwordx4 v12, s[12:15], s36 offen nt lds
v_exp_f32 v181, v181
v_mfma_f32_16x16x32_bf16 v[48:51], v[232:235], v[204:207], v[48:51]
v_cvt_pk_bf16_f32 v201, v178, v179
v_mfma_f32_16x16x32_bf16 v[60:63], v[236:239], v[204:207], v[60:63]
s_add_u32 m0, s27, 44608
s_add_u32 s36, s29, 58368
buffer_load_dwordx4 v12, s[12:15], s36 offen nt lds
v_exp_f32 v182, v182
v_mfma_f32_16x16x32_bf16 v[72:75], v[240:243], v[204:207], v[72:75]
v_cvt_pk_bf16_f32 v202, v188, v189
v_mfma_f32_16x16x32_bf16 v[84:87], v[244:247], v[204:207], v[84:87]
v_exp_f32 v183, v183
v_cvt_pk_bf16_f32 v203, v190, v191
v_mfma_f32_16x16x32_bf16 v[96:99], v[248:251], v[204:207], v[96:99]
v_exp_f32 v192, v192
v_mfma_f32_16x16x32_bf16 v[108:111], v[252:255], v[204:207], v[108:111]
v_exp_f32 v193, v193
v_exp_f32 v194, v194
v_mfma_f32_16x16x32_bf16 v[120:123], v[16:19], v[204:207], v[120:123]
v_exp_f32 v195, v195
v_mfma_f32_16x16x32_bf16 v[28:31], v[224:227], v[208:211], v[28:31]
v_exp_f32 v184, v184
v_cvt_pk_bf16_f32 v204, v180, v181
ds_read_b128 v[224:227], v10 offset:0
v_mfma_f32_16x16x32_bf16 v[40:43], v[228:231], v[208:211], v[40:43]
s_add_u32 m0, s28, 52224
s_add_u32 s36, s33, 49152
buffer_load_dwordx4 v13, s[16:19], s36 offen nt lds
v_exp_f32 v185, v185
ds_read_b128 v[228:231], v10 offset:64
v_mfma_f32_16x16x32_bf16 v[52:55], v[232:235], v[208:211], v[52:55]
v_cvt_pk_bf16_f32 v205, v182, v183
s_add_u32 m0, s28, 53280
s_add_u32 s36, s33, 49408
buffer_load_dwordx4 v13, s[16:19], s36 offen nt lds
ds_read_b128 v[232:235], v10 offset:128
v_mfma_f32_16x16x32_bf16 v[64:67], v[236:239], v[208:211], v[64:67]
v_exp_f32 v186, v186
v_cvt_pk_bf16_f32 v206, v192, v193
ds_read_b128 v[236:239], v10 offset:192
v_mfma_f32_16x16x32_bf16 v[76:79], v[240:243], v[208:211], v[76:79]
v_exp_f32 v187, v187
v_cvt_pk_bf16_f32 v207, v194, v195
ds_read_b128 v[240:243], v10 offset:4352
v_mfma_f32_16x16x32_bf16 v[88:91], v[244:247], v[208:211], v[88:91]
v_exp_f32 v196, v196
v_exp_f32 v197, v197
ds_read_b128 v[244:247], v10 offset:4416
v_mfma_f32_16x16x32_bf16 v[100:103], v[248:251], v[208:211], v[100:103]
v_exp_f32 v198, v198
v_exp_f32 v199, v199
ds_read_b128 v[248:251], v10 offset:4480
v_mfma_f32_16x16x32_bf16 v[112:115], v[252:255], v[208:211], v[112:115]
ds_read_b128 v[252:255], v10 offset:4544
v_mfma_f32_16x16x32_bf16 v[124:127], v[16:19], v[208:211], v[124:127]
s_nop 0
v_cvt_pk_bf16_f32 v208, v184, v185
v_cvt_pk_bf16_f32 v209, v186, v187
v_cvt_pk_bf16_f32 v210, v196, v197
v_cvt_pk_bf16_f32 v211, v198, v199
W3_R3_back:
s_waitcnt lgkmcnt(7)
v_mfma_f32_16x16x32_bf16 v[176:179], v[224:227], v[128:131], v[212:215]
v_mfma_f32_16x16x32_bf16 v[180:183], v[224:227], v[144:147], v[216:219]
v_mfma_f32_16x16x32_bf16 v[184:187], v[224:227], v[160:163], v[220:223]
s_waitcnt lgkmcnt(6)
v_mfma_f32_16x16x32_bf16 v[176:179], v[228:231], v[132:135], v[176:179]
ds_read_b64_tr_b16 v[224:225], v11 offset:60672
v_mfma_f32_16x16x32_bf16 v[180:183], v[228:231], v[148:151], v[180:183]
ds_read_b64_tr_b16 v[226:227], v11 offset:61184
v_mfma_f32_16x16x32_bf16 v[184:187], v[228:231], v[164:167], v[184:187]
s_waitcnt lgkmcnt(7)
v_mfma_f32_16x16x32_bf16 v[176:179], v[232:235], v[136:139], v[176:179]
ds_read_b64_tr_b16 v[228:229], v11 offset:60704
v_mfma_f32_16x16x32_bf16 v[180:183], v[232:235], v[152:155], v[180:183]
ds_read_b64_tr_b16 v[230:231], v11 offset:61216
v_mfma_f32_16x16x32_bf16 v[184:187], v[232:235], v[168:171], v[184:187]
s_waitcnt lgkmcnt(8)
v_mfma_f32_16x16x32_bf16 v[176:179], v[236:239], v[140:143], v[176:179]
ds_read_b64_tr_b16 v[232:233], v11 offset:60736
v_mfma_f32_16x16x32_bf16 v[180:183], v[236:239], v[156:159], v[180:183]
ds_read_b64_tr_b16 v[234:235], v11 offset:61248
v_mfma_f32_16x16x32_bf16 v[184:187], v[236:239], v[172:175], v[184:187]
s_waitcnt lgkmcnt(9)
v_mfma_f32_16x16x32_bf16 v[188:191], v[240:243], v[128:131], v[212:215]
ds_read_b64_tr_b16 v[236:237], v11 offset:60768
v_mfma_f32_16x16x32_bf16 v[192:195], v[240:243], v[144:147], v[216:219]
ds_read_b64_tr_b16 v[238:239], v11 offset:61280
v_mfma_f32_16x16x32_bf16 v[196:199], v[240:243], v[160:163], v[220:223]
s_waitcnt lgkmcnt(10)
v_mfma_f32_16x16x32_bf16 v[188:191], v[244:247], v[132:135], v[188:191]
ds_read_b64_tr_b16 v[240:241], v11 offset:60800
v_mfma_f32_16x16x32_bf16 v[192:195], v[244:247], v[148:151], v[192:195]
ds_read_b64_tr_b16 v[242:243], v11 offset:61312
v_mfma_f32_16x16x32_bf16 v[196:199], v[244:247], v[164:167], v[196:199]
s_waitcnt lgkmcnt(11)
v_mfma_f32_16x16x32_bf16 v[188:191], v[248:251], v[136:139], v[188:191]
ds_read_b64_tr_b16 v[244:245], v11 offset:60832
ds_read_b64_tr_b16 v[246:247], v11 offset:61344
v_mfma_f32_16x16x32_bf16 v[192:195], v[248:251], v[152:155], v[192:195]
v_max3_f32 v2, v176, v177, v178
v_max_f32 v2, v2, v179
v_mfma_f32_16x16x32_bf16 v[196:199], v[248:251], v[168:171], v[196:199]
v_max3_f32 v2, v2, v180, v181
s_waitcnt lgkmcnt(12)
v_mfma_f32_16x16x32_bf16 v[188:191], v[252:255], v[140:143], v[188:191]
ds_read_b64_tr_b16 v[248:249], v11 offset:60864
ds_read_b64_tr_b16 v[250:251], v11 offset:61376
v_mfma_f32_16x16x32_bf16 v[192:195], v[252:255], v[156:159], v[192:195]
v_max3_f32 v2, v2, v182, v183
v_max3_f32 v2, v2, v184, v185
v_mfma_f32_16x16x32_bf16 v[196:199], v[252:255], v[172:175], v[196:199]
v_max3_f32 v2, v2, v186, v187
ds_read_b64_tr_b16 v[252:253], v11 offset:60896
ds_read_b64_tr_b16 v[254:255], v11 offset:61408
s_nop 4
v_max3_f32 v2, v2, v188, v189
v_max3_f32 v2, v2, v190, v191
v_max3_f32 v2, v2, v192, v193
v_max3_f32 v2, v2, v194, v195
v_max3_f32 v2, v2, v196, v197
v_max3_f32 v2, v2, v198, v199
v_cmp_lt_f32 vcc, s3, v2
s_cbranch_vccnz W3_R4
s_waitcnt lgkmcnt(14)
v_mfma_f32_16x16x32_bf16 v[20:23], v[224:227], v[200:203], v[20:23]
v_exp_f32 v176, v176
s_waitcnt lgkmcnt(12)
v_mfma_f32_16x16x32_bf16 v[32:35], v[228:231], v[200:203], v[32:35]
v_exp_f32 v177, v177
s_waitcnt lgkmcnt(10)
v_mfma_f32_16x16x32_bf16 v[44:47], v[232:235], v[200:203], v[44:47]
v_exp_f32 v178, v178
s_waitcnt lgkmcnt(8)
v_mfma_f32_16x16x32_bf16 v[56:59], v[236:239], v[200:203], v[56:59]
v_exp_f32 v179, v179
s_waitcnt lgkmcnt(6)
v_mfma_f32_16x16x32_bf16 v[68:71], v[240:243], v[200:203], v[68:71]
v_exp_f32 v188, v188
s_waitcnt lgkmcnt(4)
v_mfma_f32_16x16x32_bf16 v[80:83], v[244:247], v[200:203], v[80:83]
v_exp_f32 v189, v189
s_waitcnt lgkmcnt(2)
v_mfma_f32_16x16x32_bf16 v[92:95], v[248:251], v[200:203], v[92:95]
v_exp_f32 v190, v190
s_waitcnt lgkmcnt(0)
v_mfma_f32_16x16x32_bf16 v[104:107], v[252:255], v[200:203], v[104:107]
v_exp_f32 v191, v191
v_mfma_f32_16x16x32_bf16 v[116:119], v[16:19], v[200:203], v[116:119]
s_waitcnt vmcnt(9)
s_barrier
v_mfma_f32_16x16x32_bf16 v[24:27], v[224:227], v[204:207], v[24:27]
v_exp_f32 v180, v180
v_cvt_pk_bf16_f32 v200, v176, v177
v_mfma_f32_16x16x32_bf16 v[36:39], v[228:231], v[204:207], v[36:39]
s_add_u32 m0, s27, 0
s_add_u32 s36, s29, 65536
buffer_load_dwordx4 v12, s[12:15], s36 offen nt lds
v_exp_f32 v181, v181
v_mfma_f32_16x16x32_bf16 v[48:51], v[232:235], v[204:207], v[48:51]
v_cvt_pk_bf16_f32 v201, v178, v179
v_mfma_f32_16x16x32_bf16 v[60:63], v[236:239], v[204:207], v[60:63]
s_add_u32 m0, s27, 1088
s_add_u32 s36, s29, 66560
buffer_load_dwordx4 v12, s[12:15], s36 offen nt lds
v_exp_f32 v182, v182
v_mfma_f32_16x16x32_bf16 v[72:75], v[240:243], v[204:207], v[72:75]
v_cvt_pk_bf16_f32 v202, v188, v189
v_mfma_f32_16x16x32_bf16 v[84:87], v[244:247], v[204:207], v[84:87]
v_exp_f32 v183, v183
v_cvt_pk_bf16_f32 v203, v190, v191
v_mfma_f32_16x16x32_bf16 v[96:99], v[248:251], v[204:207], v[96:99]
v_exp_f32 v192, v192
v_mfma_f32_16x16x32_bf16 v[108:111], v[252:255], v[204:207], v[108:111]
v_exp_f32 v193, v193
v_exp_f32 v194, v194
v_mfma_f32_16x16x32_bf16 v[120:123], v[16:19], v[204:207], v[120:123]
v_exp_f32 v195, v195
v_mfma_f32_16x16x32_bf16 v[28:31], v[224:227], v[208:211], v[28:31]
v_exp_f32 v184, v184
v_cvt_pk_bf16_f32 v204, v180, v181
ds_read_b128 v[224:227], v10 offset:8704
v_mfma_f32_16x16x32_bf16 v[40:43], v[228:231], v[208:211], v[40:43]
s_add_u32 m0, s28, 60672
s_add_u32 s36, s33, 57344
buffer_load_dwordx4 v13, s[16:19], s36 offen nt lds
v_exp_f32 v185, v185
ds_read_b128 v[228:231], v10 offset:8768
v_mfma_f32_16x16x32_bf16 v[52:55], v[232:235], v[208:211], v[52:55]
v_cvt_pk_bf16_f32 v205, v182, v183
s_add_u32 m0, s28, 61728
s_add_u32 s36, s33, 57600
buffer_load_dwordx4 v13, s[16:19], s36 offen nt lds
ds_read_b128 v[232:235], v10 offset:8832
v_mfma_f32_16x16x32_bf16 v[64:67], v[236:239], v[208:211], v[64:67]
v_exp_f32 v186, v186
v_cvt_pk_bf16_f32 v206, v192, v193
ds_read_b128 v[236:239], v10 offset:8896
v_mfma_f32_16x16x32_bf16 v[76:79], v[240:243], v[208:211], v[76:79]
v_exp_f32 v187, v187
v_cvt_pk_bf16_f32 v207, v194, v195
ds_read_b128 v[240:243], v10 offset:13056
v_mfma_f32_16x16x32_bf16 v[88:91], v[244:247], v[208:211], v[88:91]
v_exp_f32 v196, v196
v_exp_f32 v197, v197
ds_read_b128 v[244:247], v10 offset:13120
v_mfma_f32_16x16x32_bf16 v[100:103], v[248:251], v[208:211], v[100:103]
v_exp_f32 v198, v198
v_exp_f32 v199, v199
ds_read_b128 v[248:251], v10 offset:13184
v_mfma_f32_16x16x32_bf16 v[112:115], v[252:255], v[208:211], v[112:115]
ds_read_b128 v[252:255], v10 offset:13248
v_mfma_f32_16x16x32_bf16 v[124:127], v[16:19], v[208:211], v[124:127]
s_nop 0
v_cvt_pk_bf16_f32 v208, v184, v185
v_cvt_pk_bf16_f32 v209, v186, v187
v_cvt_pk_bf16_f32 v210, v196, v197
v_cvt_pk_bf16_f32 v211, v198, v199
W3_R4_back:
s_waitcnt lgkmcnt(7)
v_mfma_f32_16x16x32_bf16 v[176:179], v[224:227], v[128:131], v[212:215]
v_mfma_f32_16x16x32_bf16 v[180:183], v[224:227], v[144:147], v[216:219]
v_mfma_f32_16x16x32_bf16 v[184:187], v[224:227], v[160:163], v[220:223]
s_waitcnt lgkmcnt(6)
v_mfma_f32_16x16x32_bf16 v[176:179], v[228:231], v[132:135], v[176:179]
ds_read_b64_tr_b16 v[224:225], v11 offset:17408
v_mfma_f32_16x16x32_bf16 v[180:183], v[228:231], v[148:151], v[180:183]
ds_read_b64_tr_b16 v[226:227], v11 offset:17920
v_mfma_f32_16x16x32_bf16 v[184:187], v[228:231], v[164:167], v[184:187]
s_waitcnt lgkmcnt(7)
v_mfma_f32_16x16x32_bf16 v[176:179], v[232:235], v[136:139], v[176:179]
ds_read_b64_tr_b16 v[228:229], v11 offset:17440
v_mfma_f32_16x16x32_bf16 v[180:183], v[232:235], v[152:155], v[180:183]
ds_read_b64_tr_b16 v[230:231], v11 offset:17952
v_mfma_f32_16x16x32_bf16 v[184:187], v[232:235], v[168:171], v[184:187]
s_waitcnt lgkmcnt(8)
v_mfma_f32_16x16x32_bf16 v[176:179], v[236:239], v[140:143], v[176:179]
ds_read_b64_tr_b16 v[232:233], v11 offset:17472
v_mfma_f32_16x16x32_bf16 v[180:183], v[236:239], v[156:159], v[180:183]
ds_read_b64_tr_b16 v[234:235], v11 offset:17984
v_mfma_f32_16x16x32_bf16 v[184:187], v[236:239], v[172:175], v[184:187]
s_waitcnt lgkmcnt(9)
v_mfma_f32_16x16x32_bf16 v[188:191], v[240:243], v[128:131], v[212:215]
ds_read_b64_tr_b16 v[236:237], v11 offset:17504
v_mfma_f32_16x16x32_bf16 v[192:195], v[240:243], v[144:147], v[216:219]
ds_read_b64_tr_b16 v[238:239], v11 offset:18016
v_mfma_f32_16x16x32_bf16 v[196:199], v[240:243], v[160:163], v[220:223]
s_waitcnt lgkmcnt(10)
v_mfma_f32_16x16x32_bf16 v[188:191], v[244:247], v[132:135], v[188:191]
ds_read_b64_tr_b16 v[240:241], v11 offset:17536
v_mfma_f32_16x16x32_bf16 v[192:195], v[244:247], v[148:151], v[192:195]
ds_read_b64_tr_b16 v[242:243], v11 offset:18048
v_mfma_f32_16x16x32_bf16 v[196:199], v[244:247], v[164:167], v[196:199]
s_waitcnt lgkmcnt(11)
v_mfma_f32_16x16x32_bf16 v[188:191], v[248:251], v[136:139], v[188:191]
ds_read_b64_tr_b16 v[244:245], v11 offset:17568
ds_read_b64_tr_b16 v[246:247], v11 offset:18080
v_mfma_f32_16x16x32_bf16 v[192:195], v[248:251], v[152:155], v[192:195]
v_max3_f32 v2, v176, v177, v178
v_max_f32 v2, v2, v179
v_mfma_f32_16x16x32_bf16 v[196:199], v[248:251], v[168:171], v[196:199]
v_max3_f32 v2, v2, v180, v181
s_waitcnt lgkmcnt(12)
v_mfma_f32_16x16x32_bf16 v[188:191], v[252:255], v[140:143], v[188:191]
ds_read_b64_tr_b16 v[248:249], v11 offset:17600
ds_read_b64_tr_b16 v[250:251], v11 offset:18112
v_mfma_f32_16x16x32_bf16 v[192:195], v[252:255], v[156:159], v[192:195]
v_max3_f32 v2, v2, v182, v183
v_max3_f32 v2, v2, v184, v185
v_mfma_f32_16x16x32_bf16 v[196:199], v[252:255], v[172:175], v[196:199]
v_max3_f32 v2, v2, v186, v187
ds_read_b64_tr_b16 v[252:253], v11 offset:17632
ds_read_b64_tr_b16 v[254:255], v11 offset:18144
s_nop 4
v_max3_f32 v2, v2, v188, v189
v_max3_f32 v2, v2, v190, v191
v_max3_f32 v2, v2, v192, v193
v_max3_f32 v2, v2, v194, v195
v_max3_f32 v2, v2, v196, v197
v_max3_f32 v2, v2, v198, v199
v_cmp_lt_f32 vcc, s3, v2
s_cbranch_vccnz W3_R5
s_waitcnt lgkmcnt(14)
v_mfma_f32_16x16x32_bf16 v[20:23], v[224:227], v[200:203], v[20:23]
v_exp_f32 v176, v176
s_waitcnt lgkmcnt(12)
v_mfma_f32_16x16x32_bf16 v[32:35], v[228:231], v[200:203], v[32:35]
v_exp_f32 v177, v177
s_waitcnt lgkmcnt(10)
v_mfma_f32_16x16x32_bf16 v[44:47], v[232:235], v[200:203], v[44:47]
v_exp_f32 v178, v178
s_waitcnt lgkmcnt(8)
v_mfma_f32_16x16x32_bf16 v[56:59], v[236:239], v[200:203], v[56:59]
v_exp_f32 v179, v179
s_waitcnt lgkmcnt(6)
v_mfma_f32_16x16x32_bf16 v[68:71], v[240:243], v[200:203], v[68:71]
v_exp_f32 v188, v188
s_waitcnt lgkmcnt(4)
v_mfma_f32_16x16x32_bf16 v[80:83], v[244:247], v[200:203], v[80:83]
v_exp_f32 v189, v189
s_waitcnt lgkmcnt(2)
v_mfma_f32_16x16x32_bf16 v[92:95], v[248:251], v[200:203], v[92:95]
v_exp_f32 v190, v190
s_waitcnt lgkmcnt(0)
v_mfma_f32_16x16x32_bf16 v[104:107], v[252:255], v[200:203], v[104:107]
v_exp_f32 v191, v191
v_mfma_f32_16x16x32_bf16 v[116:119], v[16:19], v[200:203], v[116:119]
s_waitcnt vmcnt(8)
s_barrier
v_mfma_f32_16x16x32_bf16 v[24:27], v[224:227], v[204:207], v[24:27]
v_exp_f32 v180, v180
v_cvt_pk_bf16_f32 v200, v176, v177
v_mfma_f32_16x16x32_bf16 v[36:39], v[228:231], v[204:207], v[36:39]
s_add_u32 m0, s27, 8704
s_add_u32 s36, s29, 73728
buffer_load_dwordx4 v12, s[12:15], s36 offen nt lds
v_exp_f32 v181, v181
v_mfma_f32_16x16x32_bf16 v[48:51], v[232:235], v[204:207], v[48:51]
v_cvt_pk_bf16_f32 v201, v178, v179
v_mfma_f32_16x16x32_bf16 v[60:63], v[236:239], v[204:207], v[60:63]
s_add_u32 m0, s27, 9792
s_add_u32 s36, s29, 74752
buffer_load_dwordx4 v12, s[12:15], s36 offen nt lds
v_exp_f32 v182, v182
v_mfma_f32_16x16x32_bf16 v[72:75], v[240:243], v[204:207], v[72:75]
v_cvt_pk_bf16_f32 v202, v188, v189
v_mfma_f32_16x16x32_bf16 v[84:87], v[244:247], v[204:207], v[84:87]
v_exp_f32 v183, v183
v_cvt_pk_bf16_f32 v203, v190, v191
v_mfma_f32_16x16x32_bf16 v[96:99], v[248:251], v[204:207], v[96:99]
v_exp_f32 v192, v192
v_mfma_f32_16x16x32_bf16 v[108:111], v[252:255], v[204:207], v[108:111]
v_exp_f32 v193, v193
v_exp_f32 v194, v194
v_mfma_f32_16x16x32_bf16 v[120:123], v[16:19], v[204:207], v[120:123]
v_exp_f32 v195, v195
v_mfma_f32_16x16x32_bf16 v[28:31], v[224:227], v[208:211], v[28:31]
v_exp_f32 v184, v184
v_cvt_pk_bf16_f32 v204, v180, v181
ds_read_b128 v[224:227], v10 offset:34816
v_mfma_f32_16x16x32_bf16 v[40:43], v[228:231], v[208:211], v[40:43]
s_add_u32 m0, s28, 17408
s_add_u32 s36, s33, 65536
buffer_load_dwordx4 v13, s[16:19], s36 offen nt lds
v_exp_f32 v185, v185
ds_read_b128 v[228:231], v10 offset:34880
v_mfma_f32_16x16x32_bf16 v[52:55], v[232:235], v[208:211], v[52:55]
v_cvt_pk_bf16_f32 v205, v182, v183
s_add_u32 m0, s28, 18464
s_add_u32 s36, s33, 65792
buffer_load_dwordx4 v13, s[16:19], s36 offen nt lds
ds_read_b128 v[232:235], v10 offset:34944
v_mfma_f32_16x16x32_bf16 v[64:67], v[236:239], v[208:211], v[64:67]
v_exp_f32 v186, v186
v_cvt_pk_bf16_f32 v206, v192, v193
ds_read_b128 v[236:239], v10 offset:35008
v_mfma_f32_16x16x32_bf16 v[76:79], v[240:243], v[208:211], v[76:79]
v_exp_f32 v187, v187
v_cvt_pk_bf16_f32 v207, v194, v195
ds_read_b128 v[240:243], v10 offset:39168
v_mfma_f32_16x16x32_bf16 v[88:91], v[244:247], v[208:211], v[88:91]
v_exp_f32 v196, v196
v_exp_f32 v197, v197
ds_read_b128 v[244:247], v10 offset:39232
v_mfma_f32_16x16x32_bf16 v[100:103], v[248:251], v[208:211], v[100:103]
v_exp_f32 v198, v198
v_exp_f32 v199, v199
ds_read_b128 v[248:251], v10 offset:39296
v_mfma_f32_16x16x32_bf16 v[112:115], v[252:255], v[208:211], v[112:115]
ds_read_b128 v[252:255], v10 offset:39360
v_mfma_f32_16x16x32_bf16 v[124:127], v[16:19], v[208:211], v[124:127]
s_nop 0
v_cvt_pk_bf16_f32 v208, v184, v185
v_cvt_pk_bf16_f32 v209, v186, v187
v_cvt_pk_bf16_f32 v210, v196, v197
v_cvt_pk_bf16_f32 v211, v198, v199
W3_R5_back:
s_waitcnt lgkmcnt(7)
v_mfma_f32_16x16x32_bf16 v[176:179], v[224:227], v[128:131], v[212:215]
v_mfma_f32_16x16x32_bf16 v[180:183], v[224:227], v[144:147], v[216:219]
v_mfma_f32_16x16x32_bf16 v[184:187], v[224:227], v[160:163], v[220:223]
s_waitcnt lgkmcnt(6)
v_mfma_f32_16x16x32_bf16 v[176:179], v[228:231], v[132:135], v[176:179]
ds_read_b64_tr_b16 v[224:225], v11 offset:25856
v_mfma_f32_16x16x32_bf16 v[180:183], v[228:231], v[148:151], v[180:183]
ds_read_b64_tr_b16 v[226:227], v11 offset:26368
v_mfma_f32_16x16x32_bf16 v[184:187], v[228:231], v[164:167], v[184:187]
s_waitcnt lgkmcnt(7)
v_mfma_f32_16x16x32_bf16 v[176:179], v[232:235], v[136:139], v[176:179]
ds_read_b64_tr_b16 v[228:229], v11 offset:25888
v_mfma_f32_16x16x32_bf16 v[180:183], v[232:235], v[152:155], v[180:183]
ds_read_b64_tr_b16 v[230:231], v11 offset:26400
v_mfma_f32_16x16x32_bf16 v[184:187], v[232:235], v[168:171], v[184:187]
s_waitcnt lgkmcnt(8)
v_mfma_f32_16x16x32_bf16 v[176:179], v[236:239], v[140:143], v[176:179]
ds_read_b64_tr_b16 v[232:233], v11 offset:25920
v_mfma_f32_16x16x32_bf16 v[180:183], v[236:239], v[156:159], v[180:183]
ds_read_b64_tr_b16 v[234:235], v11 offset:26432
v_mfma_f32_16x16x32_bf16 v[184:187], v[236:239], v[172:175], v[184:187]
s_waitcnt lgkmcnt(9)
v_mfma_f32_16x16x32_bf16 v[188:191], v[240:243], v[128:131], v[212:215]
ds_read_b64_tr_b16 v[236:237], v11 offset:25952
v_mfma_f32_16x16x32_bf16 v[192:195], v[240:243], v[144:147], v[216:219]
ds_read_b64_tr_b16 v[238:239], v11 offset:26464
v_mfma_f32_16x16x32_bf16 v[196:199], v[240:243], v[160:163], v[220:223]
s_waitcnt lgkmcnt(10)
v_mfma_f32_16x16x32_bf16 v[188:191], v[244:247], v[132:135], v[188:191]
ds_read_b64_tr_b16 v[240:241], v11 offset:25984
v_mfma_f32_16x16x32_bf16 v[192:195], v[244:247], v[148:151], v[192:195]
ds_read_b64_tr_b16 v[242:243], v11 offset:26496
v_mfma_f32_16x16x32_bf16 v[196:199], v[244:247], v[164:167], v[196:199]
s_waitcnt lgkmcnt(11)
v_mfma_f32_16x16x32_bf16 v[188:191], v[248:251], v[136:139], v[188:191]
ds_read_b64_tr_b16 v[244:245], v11 offset:26016
ds_read_b64_tr_b16 v[246:247], v11 offset:26528
v_mfma_f32_16x16x32_bf16 v[192:195], v[248:251], v[152:155], v[192:195]
v_max3_f32 v2, v176, v177, v178
v_max_f32 v2, v2, v179
v_mfma_f32_16x16x32_bf16 v[196:199], v[248:251], v[168:171], v[196:199]
v_max3_f32 v2, v2, v180, v181
s_waitcnt lgkmcnt(12)
v_mfma_f32_16x16x32_bf16 v[188:191], v[252:255], v[140:143], v[188:191]
ds_read_b64_tr_b16 v[248:249], v11 offset:26048
ds_read_b64_tr_b16 v[250:251], v11 offset:26560
v_mfma_f32_16x16x32_bf16 v[192:195], v[252:255], v[156:159], v[192:195]
v_max3_f32 v2, v2, v182, v183
v_max3_f32 v2, v2, v184, v185
v_mfma_f32_16x16x32_bf16 v[196:199], v[252:255], v[172:175], v[196:199]
v_max3_f32 v2, v2, v186, v187
ds_read_b64_tr_b16 v[252:253], v11 offset:26080
ds_read_b64_tr_b16 v[254:255], v11 offset:26592
s_nop 4
v_max3_f32 v2, v2, v188, v189
v_max3_f32 v2, v2, v190, v191
v_max3_f32 v2, v2, v192, v193
v_max3_f32 v2, v2, v194, v195
v_max3_f32 v2, v2, v196, v197
v_max3_f32 v2, v2, v198, v199
v_cmp_lt_f32 vcc, s3, v2
s_cbranch_vccnz W3_R6
s_waitcnt lgkmcnt(14)
v_mfma_f32_16x16x32_bf16 v[20:23], v[224:227], v[200:203], v[20:23]
v_exp_f32 v176, v176
s_waitcnt lgkmcnt(12)
v_mfma_f32_16x16x32_bf16 v[32:35], v[228:231], v[200:203], v[32:35]
v_exp_f32 v177, v177
s_waitcnt lgkmcnt(10)
v_mfma_f32_16x16x32_bf16 v[44:47], v[232:235], v[200:203], v[44:47]
v_exp_f32 v178, v178
s_waitcnt lgkmcnt(8)
v_mfma_f32_16x16x32_bf16 v[56:59], v[236:239], v[200:203], v[56:59]
v_exp_f32 v179, v179
s_waitcnt lgkmcnt(6)
v_mfma_f32_16x16x32_bf16 v[68:71], v[240:243], v[200:203], v[68:71]
v_exp_f32 v188, v188
s_waitcnt lgkmcnt(4)
v_mfma_f32_16x16x32_bf16 v[80:83], v[244:247], v[200:203], v[80:83]
v_exp_f32 v189, v189
s_waitcnt lgkmcnt(2)
v_mfma_f32_16x16x32_bf16 v[92:95], v[248:251], v[200:203], v[92:95]
v_exp_f32 v190, v190
s_waitcnt lgkmcnt(0)
v_mfma_f32_16x16x32_bf16 v[104:107], v[252:255], v[200:203], v[104:107]
v_exp_f32 v191, v191
v_mfma_f32_16x16x32_bf16 v[116:119], v[16:19], v[200:203], v[116:119]
s_waitcnt vmcnt(8)
s_barrier
v_mfma_f32_16x16x32_bf16 v[24:27], v[224:227], v[204:207], v[24:27]
v_exp_f32 v180, v180
v_cvt_pk_bf16_f32 v200, v176, v177
v_mfma_f32_16x16x32_bf16 v[36:39], v[228:231], v[204:207], v[36:39]
s_add_u32 m0, s27, 34816
s_add_u32 s36, s29, 81920
buffer_load_dwordx4 v12, s[12:15], s36 offen nt lds
v_exp_f32 v181, v181
v_mfma_f32_16x16x32_bf16 v[48:51], v[232:235], v[204:207], v[48:51]
v_cvt_pk_bf16_f32 v201, v178, v179
v_mfma_f32_16x16x32_bf16 v[60:63], v[236:239], v[204:207], v[60:63]
s_add_u32 m0, s27, 35904
s_add_u32 s36, s29, 82944
buffer_load_dwordx4 v12, s[12:15], s36 offen nt lds
v_exp_f32 v182, v182
v_mfma_f32_16x16x32_bf16 v[72:75], v[240:243], v[204:207], v[72:75]
v_cvt_pk_bf16_f32 v202, v188, v189
v_mfma_f32_16x16x32_bf16 v[84:87], v[244:247], v[204:207], v[84:87]
v_exp_f32 v183, v183
v_cvt_pk_bf16_f32 v203, v190, v191
v_mfma_f32_16x16x32_bf16 v[96:99], v[248:251], v[204:207], v[96:99]
v_exp_f32 v192, v192
v_mfma_f32_16x16x32_bf16 v[108:111], v[252:255], v[204:207], v[108:111]
v_exp_f32 v193, v193
v_exp_f32 v194, v194
v_mfma_f32_16x16x32_bf16 v[120:123], v[16:19], v[204:207], v[120:123]
v_exp_f32 v195, v195
v_mfma_f32_16x16x32_bf16 v[28:31], v[224:227], v[208:211], v[28:31]
v_exp_f32 v184, v184
v_cvt_pk_bf16_f32 v204, v180, v181
ds_read_b128 v[224:227], v10 offset:43520
v_mfma_f32_16x16x32_bf16 v[40:43], v[228:231], v[208:211], v[40:43]
s_add_u32 m0, s28, 25856
s_add_u32 s36, s33, 73728
buffer_load_dwordx4 v13, s[16:19], s36 offen nt lds
v_exp_f32 v185, v185
ds_read_b128 v[228:231], v10 offset:43584
v_mfma_f32_16x16x32_bf16 v[52:55], v[232:235], v[208:211], v[52:55]
v_cvt_pk_bf16_f32 v205, v182, v183
s_add_u32 m0, s28, 26912
s_add_u32 s36, s33, 73984
buffer_load_dwordx4 v13, s[16:19], s36 offen nt lds
ds_read_b128 v[232:235], v10 offset:43648
v_mfma_f32_16x16x32_bf16 v[64:67], v[236:239], v[208:211], v[64:67]
v_exp_f32 v186, v186
v_cvt_pk_bf16_f32 v206, v192, v193
ds_read_b128 v[236:239], v10 offset:43712
v_mfma_f32_16x16x32_bf16 v[76:79], v[240:243], v[208:211], v[76:79]
v_exp_f32 v187, v187
v_cvt_pk_bf16_f32 v207, v194, v195
ds_read_b128 v[240:243], v10 offset:47872
v_mfma_f32_16x16x32_bf16 v[88:91], v[244:247], v[208:211], v[88:91]
v_exp_f32 v196, v196
v_exp_f32 v197, v197
ds_read_b128 v[244:247], v10 offset:47936
v_mfma_f32_16x16x32_bf16 v[100:103], v[248:251], v[208:211], v[100:103]
v_exp_f32 v198, v198
v_exp_f32 v199, v199
ds_read_b128 v[248:251], v10 offset:48000
v_mfma_f32_16x16x32_bf16 v[112:115], v[252:255], v[208:211], v[112:115]
ds_read_b128 v[252:255], v10 offset:48064
v_mfma_f32_16x16x32_bf16 v[124:127], v[16:19], v[208:211], v[124:127]
s_nop 0
v_cvt_pk_bf16_f32 v208, v184, v185
v_cvt_pk_bf16_f32 v209, v186, v187
v_cvt_pk_bf16_f32 v210, v196, v197
v_cvt_pk_bf16_f32 v211, v198, v199
W3_R6_back:
s_waitcnt lgkmcnt(7)
v_mfma_f32_16x16x32_bf16 v[176:179], v[224:227], v[128:131], v[212:215]
v_mfma_f32_16x16x32_bf16 v[180:183], v[224:227], v[144:147], v[216:219]
v_mfma_f32_16x16x32_bf16 v[184:187], v[224:227], v[160:163], v[220:223]
s_waitcnt lgkmcnt(6)
v_mfma_f32_16x16x32_bf16 v[176:179], v[228:231], v[132:135], v[176:179]
ds_read_b64_tr_b16 v[224:225], v11 offset:52224
v_mfma_f32_16x16x32_bf16 v[180:183], v[228:231], v[148:151], v[180:183]
ds_read_b64_tr_b16 v[226:227], v11 offset:52736
v_mfma_f32_16x16x32_bf16 v[184:187], v[228:231], v[164:167], v[184:187]
s_waitcnt lgkmcnt(7)
v_mfma_f32_16x16x32_bf16 v[176:179], v[232:235], v[136:139], v[176:179]
ds_read_b64_tr_b16 v[228:229], v11 offset:52256
v_mfma_f32_16x16x32_bf16 v[180:183], v[232:235], v[152:155], v[180:183]
ds_read_b64_tr_b16 v[230:231], v11 offset:52768
v_mfma_f32_16x16x32_bf16 v[184:187], v[232:235], v[168:171], v[184:187]
s_waitcnt lgkmcnt(8)
v_mfma_f32_16x16x32_bf16 v[176:179], v[236:239], v[140:143], v[176:179]
ds_read_b64_tr_b16 v[232:233], v11 offset:52288
v_mfma_f32_16x16x32_bf16 v[180:183], v[236:239], v[156:159], v[180:183]
ds_read_b64_tr_b16 v[234:235], v11 offset:52800
v_mfma_f32_16x16x32_bf16 v[184:187], v[236:239], v[172:175], v[184:187]
s_waitcnt lgkmcnt(9)
v_mfma_f32_16x16x32_bf16 v[188:191], v[240:243], v[128:131], v[212:215]
ds_read_b64_tr_b16 v[236:237], v11 offset:52320
v_mfma_f32_16x16x32_bf16 v[192:195], v[240:243], v[144:147], v[216:219]
ds_read_b64_tr_b16 v[238:239], v11 offset:52832
v_mfma_f32_16x16x32_bf16 v[196:199], v[240:243], v[160:163], v[220:223]
s_waitcnt lgkmcnt(10)
v_mfma_f32_16x16x32_bf16 v[188:191], v[244:247], v[132:135], v[188:191]
ds_read_b64_tr_b16 v[240:241], v11 offset:52352
v_mfma_f32_16x16x32_bf16 v[192:195], v[244:247], v[148:151], v[192:195]
ds_read_b64_tr_b16 v[242:243], v11 offset:52864
v_mfma_f32_16x16x32_bf16 v[196:199], v[244:247], v[164:167], v[196:199]
s_waitcnt lgkmcnt(11)
v_mfma_f32_16x16x32_bf16 v[188:191], v[248:251], v[136:139], v[188:191]
ds_read_b64_tr_b16 v[244:245], v11 offset:52384
ds_read_b64_tr_b16 v[246:247], v11 offset:52896
v_mfma_f32_16x16x32_bf16 v[192:195], v[248:251], v[152:155], v[192:195]
v_max3_f32 v2, v176, v177, v178
v_max_f32 v2, v2, v179
v_mfma_f32_16x16x32_bf16 v[196:199], v[248:251], v[168:171], v[196:199]
v_max3_f32 v2, v2, v180, v181
s_waitcnt lgkmcnt(12)
v_mfma_f32_16x16x32_bf16 v[188:191], v[252:255], v[140:143], v[188:191]
ds_read_b64_tr_b16 v[248:249], v11 offset:52416
ds_read_b64_tr_b16 v[250:251], v11 offset:52928
v_mfma_f32_16x16x32_bf16 v[192:195], v[252:255], v[156:159], v[192:195]
v_max3_f32 v2, v2, v182, v183
v_max3_f32 v2, v2, v184, v185
v_mfma_f32_16x16x32_bf16 v[196:199], v[252:255], v[172:175], v[196:199]
v_max3_f32 v2, v2, v186, v187
ds_read_b64_tr_b16 v[252:253], v11 offset:52448
ds_read_b64_tr_b16 v[254:255], v11 offset:52960
s_nop 4
v_max3_f32 v2, v2, v188, v189
v_max3_f32 v2, v2, v190, v191
v_max3_f32 v2, v2, v192, v193
v_max3_f32 v2, v2, v194, v195
v_max3_f32 v2, v2, v196, v197
v_max3_f32 v2, v2, v198, v199
v_cmp_lt_f32 vcc, s3, v2
s_cbranch_vccnz W3_R7
s_waitcnt lgkmcnt(14)
v_mfma_f32_16x16x32_bf16 v[20:23], v[224:227], v[200:203], v[20:23]
v_exp_f32 v176, v176
s_waitcnt lgkmcnt(12)
v_mfma_f32_16x16x32_bf16 v[32:35], v[228:231], v[200:203], v[32:35]
v_exp_f32 v177, v177
s_waitcnt lgkmcnt(10)
v_mfma_f32_16x16x32_bf16 v[44:47], v[232:235], v[200:203], v[44:47]
v_exp_f32 v178, v178
s_waitcnt lgkmcnt(8)
v_mfma_f32_16x16x32_bf16 v[56:59], v[236:239], v[200:203], v[56:59]
v_exp_f32 v179, v179
s_waitcnt lgkmcnt(6)
v_mfma_f32_16x16x32_bf16 v[68:71], v[240:243], v[200:203], v[68:71]
v_exp_f32 v188, v188
s_waitcnt lgkmcnt(4)
v_mfma_f32_16x16x32_bf16 v[80:83], v[244:247], v[200:203], v[80:83]
v_exp_f32 v189, v189
s_waitcnt lgkmcnt(2)
v_mfma_f32_16x16x32_bf16 v[92:95], v[248:251], v[200:203], v[92:95]
v_exp_f32 v190, v190
s_waitcnt lgkmcnt(0)
v_mfma_f32_16x16x32_bf16 v[104:107], v[252:255], v[200:203], v[104:107]
v_exp_f32 v191, v191
v_mfma_f32_16x16x32_bf16 v[116:119], v[16:19], v[200:203], v[116:119]
s_waitcnt vmcnt(8)
s_barrier
v_mfma_f32_16x16x32_bf16 v[24:27], v[224:227], v[204:207], v[24:27]
v_exp_f32 v180, v180
v_cvt_pk_bf16_f32 v200, v176, v177
v_mfma_f32_16x16x32_bf16 v[36:39], v[228:231], v[204:207], v[36:39]
s_add_u32 m0, s27, 43520
s_add_u32 s36, s29, 90112
buffer_load_dwordx4 v12, s[12:15], s36 offen nt lds
v_exp_f32 v181, v181
v_mfma_f32_16x16x32_bf16 v[48:51], v[232:235], v[204:207], v[48:51]
v_cvt_pk_bf16_f32 v201, v178, v179
v_mfma_f32_16x16x32_bf16 v[60:63], v[236:239], v[204:207], v[60:63]
s_add_u32 m0, s27, 44608
s_add_u32 s36, s29, 91136
buffer_load_dwordx4 v12, s[12:15], s36 offen nt lds
v_exp_f32 v182, v182
v_mfma_f32_16x16x32_bf16 v[72:75], v[240:243], v[204:207], v[72:75]
v_cvt_pk_bf16_f32 v202, v188, v189
v_mfma_f32_16x16x32_bf16 v[84:87], v[244:247], v[204:207], v[84:87]
v_exp_f32 v183, v183
v_cvt_pk_bf16_f32 v203, v190, v191
v_mfma_f32_16x16x32_bf16 v[96:99], v[248:251], v[204:207], v[96:99]
v_exp_f32 v192, v192
v_mfma_f32_16x16x32_bf16 v[108:111], v[252:255], v[204:207], v[108:111]
v_exp_f32 v193, v193
v_exp_f32 v194, v194
v_mfma_f32_16x16x32_bf16 v[120:123], v[16:19], v[204:207], v[120:123]
v_exp_f32 v195, v195
v_mfma_f32_16x16x32_bf16 v[28:31], v[224:227], v[208:211], v[28:31]
v_exp_f32 v184, v184
v_cvt_pk_bf16_f32 v204, v180, v181
ds_read_b128 v[224:227], v10 offset:0
v_mfma_f32_16x16x32_bf16 v[40:43], v[228:231], v[208:211], v[40:43]
s_add_u32 m0, s28, 52224
s_add_u32 s36, s33, 81920
buffer_load_dwordx4 v13, s[16:19], s36 offen nt lds
v_exp_f32 v185, v185
ds_read_b128 v[228:231], v10 offset:64
v_mfma_f32_16x16x32_bf16 v[52:55], v[232:235], v[208:211], v[52:55]
v_cvt_pk_bf16_f32 v205, v182, v183
s_add_u32 m0, s28, 53280
s_add_u32 s36, s33, 82176
buffer_load_dwordx4 v13, s[16:19], s36 offen nt lds
ds_read_b128 v[232:235], v10 offset:128
v_mfma_f32_16x16x32_bf16 v[64:67], v[236:239], v[208:211], v[64:67]
v_exp_f32 v186, v186
v_cvt_pk_bf16_f32 v206, v192, v193
ds_read_b128 v[236:239], v10 offset:192
v_mfma_f32_16x16x32_bf16 v[76:79], v[240:243], v[208:211], v[76:79]
v_exp_f32 v187, v187
v_cvt_pk_bf16_f32 v207, v194, v195
ds_read_b128 v[240:243], v10 offset:4352
v_mfma_f32_16x16x32_bf16 v[88:91], v[244:247], v[208:211], v[88:91]
v_exp_f32 v196, v196
v_exp_f32 v197, v197
ds_read_b128 v[244:247], v10 offset:4416
v_mfma_f32_16x16x32_bf16 v[100:103], v[248:251], v[208:211], v[100:103]
v_exp_f32 v198, v198
v_exp_f32 v199, v199
ds_read_b128 v[248:251], v10 offset:4480
v_mfma_f32_16x16x32_bf16 v[112:115], v[252:255], v[208:211], v[112:115]
ds_read_b128 v[252:255], v10 offset:4544
v_mfma_f32_16x16x32_bf16 v[124:127], v[16:19], v[208:211], v[124:127]
s_nop 0
v_cvt_pk_bf16_f32 v208, v184, v185
v_cvt_pk_bf16_f32 v209, v186, v187
v_cvt_pk_bf16_f32 v210, v196, v197
v_cvt_pk_bf16_f32 v211, v198, v199
W3_R7_back:
s_waitcnt lgkmcnt(7)
v_mfma_f32_16x16x32_bf16 v[176:179], v[224:227], v[128:131], v[212:215]
v_mfma_f32_16x16x32_bf16 v[180:183], v[224:227], v[144:147], v[216:219]
v_mfma_f32_16x16x32_bf16 v[184:187], v[224:227], v[160:163], v[220:223]
s_waitcnt lgkmcnt(6)
v_mfma_f32_16x16x32_bf16 v[176:179], v[228:231], v[132:135], v[176:179]
ds_read_b64_tr_b16 v[224:225], v11 offset:60672
v_mfma_f32_16x16x32_bf16 v[180:183], v[228:231], v[148:151], v[180:183]
ds_read_b64_tr_b16 v[226:227], v11 offset:61184
v_mfma_f32_16x16x32_bf16 v[184:187], v[228:231], v[164:167], v[184:187]
s_waitcnt lgkmcnt(7)
v_mfma_f32_16x16x32_bf16 v[176:179], v[232:235], v[136:139], v[176:179]
ds_read_b64_tr_b16 v[228:229], v11 offset:60704
v_mfma_f32_16x16x32_bf16 v[180:183], v[232:235], v[152:155], v[180:183]
ds_read_b64_tr_b16 v[230:231], v11 offset:61216
v_mfma_f32_16x16x32_bf16 v[184:187], v[232:235], v[168:171], v[184:187]
s_waitcnt lgkmcnt(8)
v_mfma_f32_16x16x32_bf16 v[176:179], v[236:239], v[140:143], v[176:179]
ds_read_b64_tr_b16 v[232:233], v11 offset:60736
v_mfma_f32_16x16x32_bf16 v[180:183], v[236:239], v[156:159], v[180:183]
ds_read_b64_tr_b16 v[234:235], v11 offset:61248
v_mfma_f32_16x16x32_bf16 v[184:187], v[236:239], v[172:175], v[184:187]
s_waitcnt lgkmcnt(9)
v_mfma_f32_16x16x32_bf16 v[188:191], v[240:243], v[128:131], v[212:215]
ds_read_b64_tr_b16 v[236:237], v11 offset:60768
v_mfma_f32_16x16x32_bf16 v[192:195], v[240:243], v[144:147], v[216:219]
ds_read_b64_tr_b16 v[238:239], v11 offset:61280
v_mfma_f32_16x16x32_bf16 v[196:199], v[240:243], v[160:163], v[220:223]
s_waitcnt lgkmcnt(10)
v_mfma_f32_16x16x32_bf16 v[188:191], v[244:247], v[132:135], v[188:191]
ds_read_b64_tr_b16 v[240:241], v11 offset:60800
v_mfma_f32_16x16x32_bf16 v[192:195], v[244:247], v[148:151], v[192:195]
ds_read_b64_tr_b16 v[242:243], v11 offset:61312
v_mfma_f32_16x16x32_bf16 v[196:199], v[244:247], v[164:167], v[196:199]
s_waitcnt lgkmcnt(11)
v_mfma_f32_16x16x32_bf16 v[188:191], v[248:251], v[136:139], v[188:191]
ds_read_b64_tr_b16 v[244:245], v11 offset:60832
ds_read_b64_tr_b16 v[246:247], v11 offset:61344
v_mfma_f32_16x16x32_bf16 v[192:195], v[248:251], v[152:155], v[192:195]
v_max3_f32 v2, v176, v177, v178
v_max_f32 v2, v2, v179
v_mfma_f32_16x16x32_bf16 v[196:199], v[248:251], v[168:171], v[196:199]
v_max3_f32 v2, v2, v180, v181
s_waitcnt lgkmcnt(12)
v_mfma_f32_16x16x32_bf16 v[188:191], v[252:255], v[140:143], v[188:191]
ds_read_b64_tr_b16 v[248:249], v11 offset:60864
ds_read_b64_tr_b16 v[250:251], v11 offset:61376
v_mfma_f32_16x16x32_bf16 v[192:195], v[252:255], v[156:159], v[192:195]
v_max3_f32 v2, v2, v182, v183
v_max3_f32 v2, v2, v184, v185
v_mfma_f32_16x16x32_bf16 v[196:199], v[252:255], v[172:175], v[196:199]
v_max3_f32 v2, v2, v186, v187
ds_read_b64_tr_b16 v[252:253], v11 offset:60896
ds_read_b64_tr_b16 v[254:255], v11 offset:61408
s_nop 4
v_max3_f32 v2, v2, v188, v189
v_max3_f32 v2, v2, v190, v191
v_max3_f32 v2, v2, v192, v193
v_max3_f32 v2, v2, v194, v195
v_max3_f32 v2, v2, v196, v197
v_max3_f32 v2, v2, v198, v199
v_cmp_lt_f32 vcc, s3, v2
s_cbranch_vccnz W3_R8
s_waitcnt lgkmcnt(14)
v_mfma_f32_16x16x32_bf16 v[20:23], v[224:227], v[200:203], v[20:23]
v_exp_f32 v176, v176
s_waitcnt lgkmcnt(12)
v_mfma_f32_16x16x32_bf16 v[32:35], v[228:231], v[200:203], v[32:35]
v_exp_f32 v177, v177
s_waitcnt lgkmcnt(10)
v_mfma_f32_16x16x32_bf16 v[44:47], v[232:235], v[200:203], v[44:47]
v_exp_f32 v178, v178
s_waitcnt lgkmcnt(8)
v_mfma_f32_16x16x32_bf16 v[56:59], v[236:239], v[200:203], v[56:59]
v_exp_f32 v179, v179
s_waitcnt lgkmcnt(6)
v_mfma_f32_16x16x32_bf16 v[68:71], v[240:243], v[200:203], v[68:71]
v_exp_f32 v188, v188
s_waitcnt lgkmcnt(4)
v_mfma_f32_16x16x32_bf16 v[80:83], v[244:247], v[200:203], v[80:83]
v_exp_f32 v189, v189
s_waitcnt lgkmcnt(2)
v_mfma_f32_16x16x32_bf16 v[92:95], v[248:251], v[200:203], v[92:95]
v_exp_f32 v190, v190
s_waitcnt lgkmcnt(0)
v_mfma_f32_16x16x32_bf16 v[104:107], v[252:255], v[200:203], v[104:107]
v_exp_f32 v191, v191
v_mfma_f32_16x16x32_bf16 v[116:119], v[16:19], v[200:203], v[116:119]
s_waitcnt vmcnt(8)
s_barrier
v_readfirstlane_b32 s46, v7
v_mfma_f32_16x16x32_bf16 v[24:27], v[224:227], v[204:207], v[24:27]
v_exp_f32 v180, v180
v_cvt_pk_bf16_f32 v200, v176, v177
v_mfma_f32_16x16x32_bf16 v[36:39], v[228:231], v[204:207], v[36:39]
s_add_u32 m0, s27, 0
s_add_u32 s36, s29, 98304
buffer_load_dwordx4 v12, s[12:15], s36 offen nt lds
v_exp_f32 v181, v181
v_mfma_f32_16x16x32_bf16 v[48:51], v[232:235], v[204:207], v[48:51]
v_cvt_pk_bf16_f32 v201, v178, v179
v_mfma_f32_16x16x32_bf16 v[60:63], v[236:239], v[204:207], v[60:63]
s_add_u32 m0, s27, 1088
s_add_u32 s36, s29, 99328
buffer_load_dwordx4 v12, s[12:15], s36 offen nt lds
v_exp_f32 v182, v182
v_mfma_f32_16x16x32_bf16 v[72:75], v[240:243], v[204:207], v[72:75]
v_cvt_pk_bf16_f32 v202, v188, v189
v_mfma_f32_16x16x32_bf16 v[84:87], v[244:247], v[204:207], v[84:87]
v_exp_f32 v183, v183
v_cvt_pk_bf16_f32 v203, v190, v191
v_mfma_f32_16x16x32_bf16 v[96:99], v[248:251], v[204:207], v[96:99]
v_exp_f32 v192, v192
v_mfma_f32_16x16x32_bf16 v[108:111], v[252:255], v[204:207], v[108:111]
v_exp_f32 v193, v193
v_exp_f32 v194, v194
v_mfma_f32_16x16x32_bf16 v[120:123], v[16:19], v[204:207], v[120:123]
v_exp_f32 v195, v195
v_mfma_f32_16x16x32_bf16 v[28:31], v[224:227], v[208:211], v[28:31]
v_exp_f32 v184, v184
v_cvt_pk_bf16_f32 v204, v180, v181
ds_read_b128 v[224:227], v10 offset:8704
v_mfma_f32_16x16x32_bf16 v[40:43], v[228:231], v[208:211], v[40:43]
s_add_u32 m0, s28, 60672
s_add_u32 s36, s33, 90112
buffer_load_dwordx4 v13, s[16:19], s36 offen nt lds
v_exp_f32 v185, v185
ds_read_b128 v[228:231], v10 offset:8768
v_mfma_f32_16x16x32_bf16 v[52:55], v[232:235], v[208:211], v[52:55]
v_cvt_pk_bf16_f32 v205, v182, v183
s_add_u32 m0, s28, 61728
s_add_u32 s36, s33, 90368
buffer_load_dwordx4 v13, s[16:19], s36 offen nt lds
ds_read_b128 v[232:235], v10 offset:8832
v_mfma_f32_16x16x32_bf16 v[64:67], v[236:239], v[208:211], v[64:67]
v_exp_f32 v186, v186
v_cvt_pk_bf16_f32 v206, v192, v193
ds_read_b128 v[236:239], v10 offset:8896
v_mfma_f32_16x16x32_bf16 v[76:79], v[240:243], v[208:211], v[76:79]
v_exp_f32 v187, v187
v_cvt_pk_bf16_f32 v207, v194, v195
ds_read_b128 v[240:243], v10 offset:13056
v_mfma_f32_16x16x32_bf16 v[88:91], v[244:247], v[208:211], v[88:91]
v_exp_f32 v196, v196
v_exp_f32 v197, v197
ds_read_b128 v[244:247], v10 offset:13120
v_mfma_f32_16x16x32_bf16 v[100:103], v[248:251], v[208:211], v[100:103]
v_exp_f32 v198, v198
v_exp_f32 v199, v199
ds_read_b128 v[248:251], v10 offset:13184
v_mfma_f32_16x16x32_bf16 v[112:115], v[252:255], v[208:211], v[112:115]
ds_read_b128 v[252:255], v10 offset:13248
v_mfma_f32_16x16x32_bf16 v[124:127], v[16:19], v[208:211], v[124:127]
s_nop 0
v_cvt_pk_bf16_f32 v208, v184, v185
v_cvt_pk_bf16_f32 v209, v186, v187
v_cvt_pk_bf16_f32 v210, v196, v197
v_cvt_pk_bf16_f32 v211, v198, v199
W3_R8_back:
s_waitcnt lgkmcnt(7)
v_mfma_f32_16x16x32_bf16 v[176:179], v[224:227], v[128:131], v[212:215]
v_mfma_f32_16x16x32_bf16 v[180:183], v[224:227], v[144:147], v[216:219]
v_mfma_f32_16x16x32_bf16 v[184:187], v[224:227], v[160:163], v[220:223]
s_waitcnt lgkmcnt(6)
v_mfma_f32_16x16x32_bf16 v[176:179], v[228:231], v[132:135], v[176:179]
ds_read_b64_tr_b16 v[224:225], v11 offset:17408
v_mfma_f32_16x16x32_bf16 v[180:183], v[228:231], v[148:151], v[180:183]
ds_read_b64_tr_b16 v[226:227], v11 offset:17920
v_mfma_f32_16x16x32_bf16 v[184:187], v[228:231], v[164:167], v[184:187]
s_waitcnt lgkmcnt(7)
v_mfma_f32_16x16x32_bf16 v[176:179], v[232:235], v[136:139], v[176:179]
ds_read_b64_tr_b16 v[228:229], v11 offset:17440
v_mfma_f32_16x16x32_bf16 v[180:183], v[232:235], v[152:155], v[180:183]
ds_read_b64_tr_b16 v[230:231], v11 offset:17952
v_mfma_f32_16x16x32_bf16 v[184:187], v[232:235], v[168:171], v[184:187]
s_waitcnt lgkmcnt(8)
v_mfma_f32_16x16x32_bf16 v[176:179], v[236:239], v[140:143], v[176:179]
ds_read_b64_tr_b16 v[232:233], v11 offset:17472
v_mfma_f32_16x16x32_bf16 v[180:183], v[236:239], v[156:159], v[180:183]
ds_read_b64_tr_b16 v[234:235], v11 offset:17984
v_mfma_f32_16x16x32_bf16 v[184:187], v[236:239], v[172:175], v[184:187]
s_waitcnt lgkmcnt(9)
v_mfma_f32_16x16x32_bf16 v[188:191], v[240:243], v[128:131], v[212:215]
ds_read_b64_tr_b16 v[236:237], v11 offset:17504
v_mfma_f32_16x16x32_bf16 v[192:195], v[240:243], v[144:147], v[216:219]
ds_read_b64_tr_b16 v[238:239], v11 offset:18016
v_mfma_f32_16x16x32_bf16 v[196:199], v[240:243], v[160:163], v[220:223]
s_waitcnt lgkmcnt(10)
v_mfma_f32_16x16x32_bf16 v[188:191], v[244:247], v[132:135], v[188:191]
ds_read_b64_tr_b16 v[240:241], v11 offset:17536
v_mfma_f32_16x16x32_bf16 v[192:195], v[244:247], v[148:151], v[192:195]
ds_read_b64_tr_b16 v[242:243], v11 offset:18048
v_mfma_f32_16x16x32_bf16 v[196:199], v[244:247], v[164:167], v[196:199]
s_waitcnt lgkmcnt(11)
v_mfma_f32_16x16x32_bf16 v[188:191], v[248:251], v[136:139], v[188:191]
ds_read_b64_tr_b16 v[244:245], v11 offset:17568
ds_read_b64_tr_b16 v[246:247], v11 offset:18080
v_mfma_f32_16x16x32_bf16 v[192:195], v[248:251], v[152:155], v[192:195]
v_max3_f32 v2, v176, v177, v178
v_max_f32 v2, v2, v179
v_mfma_f32_16x16x32_bf16 v[196:199], v[248:251], v[168:171], v[196:199]
v_max3_f32 v2, v2, v180, v181
s_waitcnt lgkmcnt(12)
v_mfma_f32_16x16x32_bf16 v[188:191], v[252:255], v[140:143], v[188:191]
ds_read_b64_tr_b16 v[248:249], v11 offset:17600
ds_read_b64_tr_b16 v[250:251], v11 offset:18112
v_mfma_f32_16x16x32_bf16 v[192:195], v[252:255], v[156:159], v[192:195]
v_max3_f32 v2, v2, v182, v183
v_max3_f32 v2, v2, v184, v185
v_mfma_f32_16x16x32_bf16 v[196:199], v[252:255], v[172:175], v[196:199]
v_max3_f32 v2, v2, v186, v187
ds_read_b64_tr_b16 v[252:253], v11 offset:17632
ds_read_b64_tr_b16 v[254:255], v11 offset:18144
s_nop 4
v_max3_f32 v2, v2, v188, v189
v_max3_f32 v2, v2, v190, v191
v_max3_f32 v2, v2, v192, v193
v_max3_f32 v2, v2, v194, v195
v_max3_f32 v2, v2, v196, v197
v_max3_f32 v2, v2, v198, v199
v_cmp_lt_f32 vcc, s3, v2
s_cbranch_vccnz W3_R9
s_waitcnt lgkmcnt(14)
v_mfma_f32_16x16x32_bf16 v[20:23], v[224:227], v[200:203], v[20:23]
v_exp_f32 v176, v176
s_waitcnt lgkmcnt(12)
v_mfma_f32_16x16x32_bf16 v[32:35], v[228:231], v[200:203], v[32:35]
v_exp_f32 v177, v177
s_waitcnt lgkmcnt(10)
v_mfma_f32_16x16x32_bf16 v[44:47], v[232:235], v[200:203], v[44:47]
v_exp_f32 v178, v178
s_waitcnt lgkmcnt(8)
v_mfma_f32_16x16x32_bf16 v[56:59], v[236:239], v[200:203], v[56:59]
v_exp_f32 v179, v179
s_waitcnt lgkmcnt(6)
v_mfma_f32_16x16x32_bf16 v[68:71], v[240:243], v[200:203], v[68:71]
v_exp_f32 v188, v188
s_waitcnt lgkmcnt(4)
v_mfma_f32_16x16x32_bf16 v[80:83], v[244:247], v[200:203], v[80:83]
v_exp_f32 v189, v189
s_waitcnt lgkmcnt(2)
v_mfma_f32_16x16x32_bf16 v[92:95], v[248:251], v[200:203], v[92:95]
v_exp_f32 v190, v190
s_waitcnt lgkmcnt(0)
v_mfma_f32_16x16x32_bf16 v[104:107], v[252:255], v[200:203], v[104:107]
v_exp_f32 v191, v191
v_mfma_f32_16x16x32_bf16 v[116:119], v[16:19], v[200:203], v[116:119]
s_waitcnt vmcnt(8)
s_barrier
v_mfma_f32_16x16x32_bf16 v[24:27], v[224:227], v[204:207], v[24:27]
v_exp_f32 v180, v180
v_cvt_pk_bf16_f32 v200, v176, v177
v_mfma_f32_16x16x32_bf16 v[36:39], v[228:231], v[204:207], v[36:39]
s_add_u32 m0, s27, 8704
s_add_u32 s36, s29, 106496
buffer_load_dwordx4 v12, s[12:15], s36 offen nt lds
v_exp_f32 v181, v181
v_mfma_f32_16x16x32_bf16 v[48:51], v[232:235], v[204:207], v[48:51]
v_cvt_pk_bf16_f32 v201, v178, v179
v_mfma_f32_16x16x32_bf16 v[60:63], v[236:239], v[204:207], v[60:63]
s_add_u32 m0, s27, 9792
s_add_u32 s36, s29, 107520
buffer_load_dwordx4 v12, s[12:15], s36 offen nt lds
v_exp_f32 v182, v182
v_mfma_f32_16x16x32_bf16 v[72:75], v[240:243], v[204:207], v[72:75]
v_cvt_pk_bf16_f32 v202, v188, v189
v_mfma_f32_16x16x32_bf16 v[84:87], v[244:247], v[204:207], v[84:87]
v_exp_f32 v183, v183
v_cvt_pk_bf16_f32 v203, v190, v191
v_mfma_f32_16x16x32_bf16 v[96:99], v[248:251], v[204:207], v[96:99]
v_exp_f32 v192, v192
v_mfma_f32_16x16x32_bf16 v[108:111], v[252:255], v[204:207], v[108:111]
v_exp_f32 v193, v193
v_exp_f32 v194, v194
v_mfma_f32_16x16x32_bf16 v[120:123], v[16:19], v[204:207], v[120:123]
v_exp_f32 v195, v195
v_mfma_f32_16x16x32_bf16 v[28:31], v[224:227], v[208:211], v[28:31]
v_exp_f32 v184, v184
v_cvt_pk_bf16_f32 v204, v180, v181
ds_read_b128 v[224:227], v10 offset:34816
v_mfma_f32_16x16x32_bf16 v[40:43], v[228:231], v[208:211], v[40:43]
s_add_u32 m0, s28, 17408
s_add_u32 s36, s33, 98304
buffer_load_dwordx4 v13, s[16:19], s36 offen nt lds
v_exp_f32 v185, v185
ds_read_b128 v[228:231], v10 offset:34880
v_mfma_f32_16x16x32_bf16 v[52:55], v[232:235], v[208:211], v[52:55]
v_cvt_pk_bf16_f32 v205, v182, v183
s_add_u32 m0, s28, 18464
s_add_u32 s36, s33, 98560
buffer_load_dwordx4 v13, s[16:19], s36 offen nt lds
ds_read_b128 v[232:235], v10 offset:34944
v_mfma_f32_16x16x32_bf16 v[64:67], v[236:239], v[208:211], v[64:67]
v_exp_f32 v186, v186
v_cvt_pk_bf16_f32 v206, v192, v193
ds_read_b128 v[236:239], v10 offset:35008
v_mfma_f32_16x16x32_bf16 v[76:79], v[240:243], v[208:211], v[76:79]
v_exp_f32 v187, v187
v_cvt_pk_bf16_f32 v207, v194, v195
ds_read_b128 v[240:243], v10 offset:39168
v_mfma_f32_16x16x32_bf16 v[88:91], v[244:247], v[208:211], v[88:91]
v_exp_f32 v196, v196
v_exp_f32 v197, v197
ds_read_b128 v[244:247], v10 offset:39232
v_mfma_f32_16x16x32_bf16 v[100:103], v[248:251], v[208:211], v[100:103]
v_exp_f32 v198, v198
v_exp_f32 v199, v199
ds_read_b128 v[248:251], v10 offset:39296
v_mfma_f32_16x16x32_bf16 v[112:115], v[252:255], v[208:211], v[112:115]
ds_read_b128 v[252:255], v10 offset:39360
v_mfma_f32_16x16x32_bf16 v[124:127], v[16:19], v[208:211], v[124:127]
s_nop 0
v_cvt_pk_bf16_f32 v208, v184, v185
v_cvt_pk_bf16_f32 v209, v186, v187
v_cvt_pk_bf16_f32 v210, v196, v197
v_cvt_pk_bf16_f32 v211, v198, v199
W3_R9_back:
s_waitcnt lgkmcnt(7)
v_mfma_f32_16x16x32_bf16 v[176:179], v[224:227], v[128:131], v[212:215]
v_mfma_f32_16x16x32_bf16 v[180:183], v[224:227], v[144:147], v[216:219]
v_mfma_f32_16x16x32_bf16 v[184:187], v[224:227], v[160:163], v[220:223]
s_waitcnt lgkmcnt(6)
v_mfma_f32_16x16x32_bf16 v[176:179], v[228:231], v[132:135], v[176:179]
ds_read_b64_tr_b16 v[224:225], v11 offset:25856
v_mfma_f32_16x16x32_bf16 v[180:183], v[228:231], v[148:151], v[180:183]
ds_read_b64_tr_b16 v[226:227], v11 offset:26368
v_mfma_f32_16x16x32_bf16 v[184:187], v[228:231], v[164:167], v[184:187]
s_waitcnt lgkmcnt(7)
v_mfma_f32_16x16x32_bf16 v[176:179], v[232:235], v[136:139], v[176:179]
ds_read_b64_tr_b16 v[228:229], v11 offset:25888
v_mfma_f32_16x16x32_bf16 v[180:183], v[232:235], v[152:155], v[180:183]
ds_read_b64_tr_b16 v[230:231], v11 offset:26400
v_mfma_f32_16x16x32_bf16 v[184:187], v[232:235], v[168:171], v[184:187]
s_waitcnt lgkmcnt(8)
v_mfma_f32_16x16x32_bf16 v[176:179], v[236:239], v[140:143], v[176:179]
ds_read_b64_tr_b16 v[232:233], v11 offset:25920
v_mfma_f32_16x16x32_bf16 v[180:183], v[236:239], v[156:159], v[180:183]
ds_read_b64_tr_b16 v[234:235], v11 offset:26432
v_mfma_f32_16x16x32_bf16 v[184:187], v[236:239], v[172:175], v[184:187]
s_waitcnt lgkmcnt(9)
v_mfma_f32_16x16x32_bf16 v[188:191], v[240:243], v[128:131], v[212:215]
ds_read_b64_tr_b16 v[236:237], v11 offset:25952
v_mfma_f32_16x16x32_bf16 v[192:195], v[240:243], v[144:147], v[216:219]
ds_read_b64_tr_b16 v[238:239], v11 offset:26464
v_mfma_f32_16x16x32_bf16 v[196:199], v[240:243], v[160:163], v[220:223]
s_waitcnt lgkmcnt(10)
v_mfma_f32_16x16x32_bf16 v[188:191], v[244:247], v[132:135], v[188:191]
ds_read_b64_tr_b16 v[240:241], v11 offset:25984
v_mfma_f32_16x16x32_bf16 v[192:195], v[244:247], v[148:151], v[192:195]
ds_read_b64_tr_b16 v[242:243], v11 offset:26496
v_mfma_f32_16x16x32_bf16 v[196:199], v[244:247], v[164:167], v[196:199]
s_waitcnt lgkmcnt(11)
v_mfma_f32_16x16x32_bf16 v[188:191], v[248:251], v[136:139], v[188:191]
ds_read_b64_tr_b16 v[244:245], v11 offset:26016
ds_read_b64_tr_b16 v[246:247], v11 offset:26528
v_mfma_f32_16x16x32_bf16 v[192:195], v[248:251], v[152:155], v[192:195]
v_max3_f32 v2, v176, v177, v178
v_max_f32 v2, v2, v179
v_mfma_f32_16x16x32_bf16 v[196:199], v[248:251], v[168:171], v[196:199]
v_max3_f32 v2, v2, v180, v181
s_waitcnt lgkmcnt(12)
v_mfma_f32_16x16x32_bf16 v[188:191], v[252:255], v[140:143], v[188:191]
ds_read_b64_tr_b16 v[248:249], v11 offset:26048
ds_read_b64_tr_b16 v[250:251], v11 offset:26560
v_mfma_f32_16x16x32_bf16 v[192:195], v[252:255], v[156:159], v[192:195]
v_max3_f32 v2, v2, v182, v183
v_max3_f32 v2, v2, v184, v185
v_mfma_f32_16x16x32_bf16 v[196:199], v[252:255], v[172:175], v[196:199]
v_max3_f32 v2, v2, v186, v187
ds_read_b64_tr_b16 v[252:253], v11 offset:26080
ds_read_b64_tr_b16 v[254:255], v11 offset:26592
s_nop 4
v_max3_f32 v2, v2, v188, v189
v_max3_f32 v2, v2, v190, v191
v_max3_f32 v2, v2, v192, v193
v_max3_f32 v2, v2, v194, v195
v_max3_f32 v2, v2, v196, v197
v_max3_f32 v2, v2, v198, v199
v_cmp_lt_f32 vcc, s3, v2
s_cbranch_vccnz W3_R10
s_waitcnt lgkmcnt(14)
v_mfma_f32_16x16x32_bf16 v[20:23], v[224:227], v[200:203], v[20:23]
v_exp_f32 v176, v176
s_waitcnt lgkmcnt(12)
v_mfma_f32_16x16x32_bf16 v[32:35], v[228:231], v[200:203], v[32:35]
v_exp_f32 v177, v177
s_waitcnt lgkmcnt(10)
v_mfma_f32_16x16x32_bf16 v[44:47], v[232:235], v[200:203], v[44:47]
v_exp_f32 v178, v178
s_waitcnt lgkmcnt(8)
v_mfma_f32_16x16x32_bf16 v[56:59], v[236:239], v[200:203], v[56:59]
v_exp_f32 v179, v179
s_waitcnt lgkmcnt(6)
v_mfma_f32_16x16x32_bf16 v[68:71], v[240:243], v[200:203], v[68:71]
v_exp_f32 v188, v188
s_waitcnt lgkmcnt(4)
v_mfma_f32_16x16x32_bf16 v[80:83], v[244:247], v[200:203], v[80:83]
v_exp_f32 v189, v189
s_waitcnt lgkmcnt(2)
v_mfma_f32_16x16x32_bf16 v[92:95], v[248:251], v[200:203], v[92:95]
v_exp_f32 v190, v190
s_waitcnt lgkmcnt(0)
v_mfma_f32_16x16x32_bf16 v[104:107], v[252:255], v[200:203], v[104:107]
v_exp_f32 v191, v191
v_mfma_f32_16x16x32_bf16 v[116:119], v[16:19], v[200:203], v[116:119]
s_waitcnt vmcnt(8)
s_barrier
v_mfma_f32_16x16x32_bf16 v[24:27], v[224:227], v[204:207], v[24:27]
v_exp_f32 v180, v180
v_cvt_pk_bf16_f32 v200, v176, v177
v_mfma_f32_16x16x32_bf16 v[36:39], v[228:231], v[204:207], v[36:39]
s_add_u32 m0, s27, 34816
s_add_u32 s36, s29, 114688
buffer_load_dwordx4 v12, s[12:15], s36 offen nt lds
v_exp_f32 v181, v181
v_mfma_f32_16x16x32_bf16 v[48:51], v[232:235], v[204:207], v[48:51]
v_cvt_pk_bf16_f32 v201, v178, v179
v_mfma_f32_16x16x32_bf16 v[60:63], v[236:239], v[204:207], v[60:63]
s_add_u32 m0, s27, 35904
s_add_u32 s36, s29, 115712
buffer_load_dwordx4 v12, s[12:15], s36 offen nt lds
v_exp_f32 v182, v182
v_mfma_f32_16x16x32_bf16 v[72:75], v[240:243], v[204:207], v[72:75]
v_cvt_pk_bf16_f32 v202, v188, v189
v_mfma_f32_16x16x32_bf16 v[84:87], v[244:247], v[204:207], v[84:87]
v_exp_f32 v183, v183
v_cvt_pk_bf16_f32 v203, v190, v191
v_mfma_f32_16x16x32_bf16 v[96:99], v[248:251], v[204:207], v[96:99]
v_exp_f32 v192, v192
v_mfma_f32_16x16x32_bf16 v[108:111], v[252:255], v[204:207], v[108:111]
v_exp_f32 v193, v193
v_exp_f32 v194, v194
v_mfma_f32_16x16x32_bf16 v[120:123], v[16:19], v[204:207], v[120:123]
v_exp_f32 v195, v195
v_mfma_f32_16x16x32_bf16 v[28:31], v[224:227], v[208:211], v[28:31]
v_exp_f32 v184, v184
v_cvt_pk_bf16_f32 v204, v180, v181
ds_read_b128 v[224:227], v10 offset:43520
v_mfma_f32_16x16x32_bf16 v[40:43], v[228:231], v[208:211], v[40:43]
s_add_u32 m0, s28, 25856
s_add_u32 s36, s33, 106496
buffer_load_dwordx4 v13, s[16:19], s36 offen nt lds
v_exp_f32 v185, v185
ds_read_b128 v[228:231], v10 offset:43584
v_mfma_f32_16x16x32_bf16 v[52:55], v[232:235], v[208:211], v[52:55]
v_cvt_pk_bf16_f32 v205, v182, v183
s_add_u32 m0, s28, 26912
s_add_u32 s36, s33, 106752
buffer_load_dwordx4 v13, s[16:19], s36 offen nt lds
ds_read_b128 v[232:235], v10 offset:43648
v_mfma_f32_16x16x32_bf16 v[64:67], v[236:239], v[208:211], v[64:67]
v_exp_f32 v186, v186
v_cvt_pk_bf16_f32 v206, v192, v193
ds_read_b128 v[236:239], v10 offset:43712
v_mfma_f32_16x16x32_bf16 v[76:79], v[240:243], v[208:211], v[76:79]
v_exp_f32 v187, v187
v_cvt_pk_bf16_f32 v207, v194, v195
ds_read_b128 v[240:243], v10 offset:47872
v_mfma_f32_16x16x32_bf16 v[88:91], v[244:247], v[208:211], v[88:91]
v_exp_f32 v196, v196
v_exp_f32 v197, v197
ds_read_b128 v[244:247], v10 offset:47936
v_mfma_f32_16x16x32_bf16 v[100:103], v[248:251], v[208:211], v[100:103]
v_exp_f32 v198, v198
v_exp_f32 v199, v199
ds_read_b128 v[248:251], v10 offset:48000
v_mfma_f32_16x16x32_bf16 v[112:115], v[252:255], v[208:211], v[112:115]
ds_read_b128 v[252:255], v10 offset:48064
v_mfma_f32_16x16x32_bf16 v[124:127], v[16:19], v[208:211], v[124:127]
s_nop 0
v_cvt_pk_bf16_f32 v208, v184, v185
v_cvt_pk_bf16_f32 v209, v186, v187
v_cvt_pk_bf16_f32 v210, v196, v197
v_cvt_pk_bf16_f32 v211, v198, v199
W3_R10_back:
s_waitcnt lgkmcnt(7)
v_mfma_f32_16x16x32_bf16 v[176:179], v[224:227], v[128:131], v[212:215]
v_mfma_f32_16x16x32_bf16 v[180:183], v[224:227], v[144:147], v[216:219]
v_mfma_f32_16x16x32_bf16 v[184:187], v[224:227], v[160:163], v[220:223]
s_waitcnt lgkmcnt(6)
v_mfma_f32_16x16x32_bf16 v[176:179], v[228:231], v[132:135], v[176:179]
ds_read_b64_tr_b16 v[224:225], v11 offset:52224
v_mfma_f32_16x16x32_bf16 v[180:183], v[228:231], v[148:151], v[180:183]
ds_read_b64_tr_b16 v[226:227], v11 offset:52736
v_mfma_f32_16x16x32_bf16 v[184:187], v[228:231], v[164:167], v[184:187]
s_waitcnt lgkmcnt(7)
v_mfma_f32_16x16x32_bf16 v[176:179], v[232:235], v[136:139], v[176:179]
ds_read_b64_tr_b16 v[228:229], v11 offset:52256
v_mfma_f32_16x16x32_bf16 v[180:183], v[232:235], v[152:155], v[180:183]
ds_read_b64_tr_b16 v[230:231], v11 offset:52768
v_mfma_f32_16x16x32_bf16 v[184:187], v[232:235], v[168:171], v[184:187]
s_waitcnt lgkmcnt(8)
v_mfma_f32_16x16x32_bf16 v[176:179], v[236:239], v[140:143], v[176:179]
ds_read_b64_tr_b16 v[232:233], v11 offset:52288
v_mfma_f32_16x16x32_bf16 v[180:183], v[236:239], v[156:159], v[180:183]
ds_read_b64_tr_b16 v[234:235], v11 offset:52800
v_mfma_f32_16x16x32_bf16 v[184:187], v[236:239], v[172:175], v[184:187]
s_waitcnt lgkmcnt(9)
v_mfma_f32_16x16x32_bf16 v[188:191], v[240:243], v[128:131], v[212:215]
ds_read_b64_tr_b16 v[236:237], v11 offset:52320
v_mfma_f32_16x16x32_bf16 v[192:195], v[240:243], v[144:147], v[216:219]
ds_read_b64_tr_b16 v[238:239], v11 offset:52832
v_mfma_f32_16x16x32_bf16 v[196:199], v[240:243], v[160:163], v[220:223]
s_waitcnt lgkmcnt(10)
v_mfma_f32_16x16x32_bf16 v[188:191], v[244:247], v[132:135], v[188:191]
ds_read_b64_tr_b16 v[240:241], v11 offset:52352
v_mfma_f32_16x16x32_bf16 v[192:195], v[244:247], v[148:151], v[192:195]
ds_read_b64_tr_b16 v[242:243], v11 offset:52864
v_mfma_f32_16x16x32_bf16 v[196:199], v[244:247], v[164:167], v[196:199]
s_waitcnt lgkmcnt(11)
v_mfma_f32_16x16x32_bf16 v[188:191], v[248:251], v[136:139], v[188:191]
ds_read_b64_tr_b16 v[244:245], v11 offset:52384
ds_read_b64_tr_b16 v[246:247], v11 offset:52896
v_mfma_f32_16x16x32_bf16 v[192:195], v[248:251], v[152:155], v[192:195]
v_max3_f32 v2, v176, v177, v178
v_max_f32 v2, v2, v179
v_mfma_f32_16x16x32_bf16 v[196:199], v[248:251], v[168:171], v[196:199]
v_max3_f32 v2, v2, v180, v181
s_waitcnt lgkmcnt(12)
v_mfma_f32_16x16x32_bf16 v[188:191], v[252:255], v[140:143], v[188:191]
ds_read_b64_tr_b16 v[248:249], v11 offset:52416
ds_read_b64_tr_b16 v[250:251], v11 offset:52928
v_mfma_f32_16x16x32_bf16 v[192:195], v[252:255], v[156:159], v[192:195]
v_max3_f32 v2, v2, v182, v183
v_max3_f32 v2, v2, v184, v185
v_mfma_f32_16x16x32_bf16 v[196:199], v[252:255], v[172:175], v[196:199]
v_max3_f32 v2, v2, v186, v187
ds_read_b64_tr_b16 v[252:253], v11 offset:52448
ds_read_b64_tr_b16 v[254:255], v11 offset:52960
s_nop 4
v_max3_f32 v2, v2, v188, v189
v_max3_f32 v2, v2, v190, v191
v_max3_f32 v2, v2, v192, v193
v_max3_f32 v2, v2, v194, v195
v_max3_f32 v2, v2, v196, v197
v_max3_f32 v2, v2, v198, v199
v_cmp_lt_f32 vcc, s3, v2
s_cbranch_vccnz W3_R11
s_waitcnt lgkmcnt(14)
v_mfma_f32_16x16x32_bf16 v[20:23], v[224:227], v[200:203], v[20:23]
v_exp_f32 v176, v176
s_waitcnt lgkmcnt(12)
v_mfma_f32_16x16x32_bf16 v[32:35], v[228:231], v[200:203], v[32:35]
v_exp_f32 v177, v177
s_waitcnt lgkmcnt(10)
v_mfma_f32_16x16x32_bf16 v[44:47], v[232:235], v[200:203], v[44:47]
v_exp_f32 v178, v178
s_waitcnt lgkmcnt(8)
v_mfma_f32_16x16x32_bf16 v[56:59], v[236:239], v[200:203], v[56:59]
v_exp_f32 v179, v179
s_waitcnt lgkmcnt(6)
v_mfma_f32_16x16x32_bf16 v[68:71], v[240:243], v[200:203], v[68:71]
v_exp_f32 v188, v188
s_waitcnt lgkmcnt(4)
v_mfma_f32_16x16x32_bf16 v[80:83], v[244:247], v[200:203], v[80:83]
v_exp_f32 v189, v189
s_waitcnt lgkmcnt(2)
v_mfma_f32_16x16x32_bf16 v[92:95], v[248:251], v[200:203], v[92:95]
v_exp_f32 v190, v190
s_waitcnt lgkmcnt(0)
v_mfma_f32_16x16x32_bf16 v[104:107], v[252:255], v[200:203], v[104:107]
v_exp_f32 v191, v191
v_mfma_f32_16x16x32_bf16 v[116:119], v[16:19], v[200:203], v[116:119]
s_waitcnt vmcnt(8)
s_barrier
v_mfma_f32_16x16x32_bf16 v[24:27], v[224:227], v[204:207], v[24:27]
v_exp_f32 v180, v180
v_cvt_pk_bf16_f32 v200, v176, v177
v_mfma_f32_16x16x32_bf16 v[36:39], v[228:231], v[204:207], v[36:39]
s_add_u32 m0, s27, 43520
s_add_u32 s36, s29, 122880
buffer_load_dwordx4 v12, s[12:15], s36 offen nt lds
v_exp_f32 v181, v181
v_mfma_f32_16x16x32_bf16 v[48:51], v[232:235], v[204:207], v[48:51]
v_cvt_pk_bf16_f32 v201, v178, v179
v_mfma_f32_16x16x32_bf16 v[60:63], v[236:239], v[204:207], v[60:63]
s_add_u32 m0, s27, 44608
s_add_u32 s36, s29, 123904
buffer_load_dwordx4 v12, s[12:15], s36 offen nt lds
v_exp_f32 v182, v182
v_mfma_f32_16x16x32_bf16 v[72:75], v[240:243], v[204:207], v[72:75]
v_cvt_pk_bf16_f32 v202, v188, v189
v_mfma_f32_16x16x32_bf16 v[84:87], v[244:247], v[204:207], v[84:87]
v_exp_f32 v183, v183
v_cvt_pk_bf16_f32 v203, v190, v191
v_mfma_f32_16x16x32_bf16 v[96:99], v[248:251], v[204:207], v[96:99]
v_exp_f32 v192, v192
v_mfma_f32_16x16x32_bf16 v[108:111], v[252:255], v[204:207], v[108:111]
v_exp_f32 v193, v193
v_exp_f32 v194, v194
v_mfma_f32_16x16x32_bf16 v[120:123], v[16:19], v[204:207], v[120:123]
v_exp_f32 v195, v195
v_mfma_f32_16x16x32_bf16 v[28:31], v[224:227], v[208:211], v[28:31]
v_exp_f32 v184, v184
v_cvt_pk_bf16_f32 v204, v180, v181
ds_read_b128 v[224:227], v10 offset:0
v_mfma_f32_16x16x32_bf16 v[40:43], v[228:231], v[208:211], v[40:43]
s_add_u32 m0, s28, 52224
s_add_u32 s36, s33, 114688
buffer_load_dwordx4 v13, s[16:19], s36 offen nt lds
v_exp_f32 v185, v185
ds_read_b128 v[228:231], v10 offset:64
v_mfma_f32_16x16x32_bf16 v[52:55], v[232:235], v[208:211], v[52:55]
v_cvt_pk_bf16_f32 v205, v182, v183
s_add_u32 m0, s28, 53280
s_add_u32 s36, s33, 114944
buffer_load_dwordx4 v13, s[16:19], s36 offen nt lds
ds_read_b128 v[232:235], v10 offset:128
v_mfma_f32_16x16x32_bf16 v[64:67], v[236:239], v[208:211], v[64:67]
v_exp_f32 v186, v186
v_cvt_pk_bf16_f32 v206, v192, v193
ds_read_b128 v[236:239], v10 offset:192
v_mfma_f32_16x16x32_bf16 v[76:79], v[240:243], v[208:211], v[76:79]
v_exp_f32 v187, v187
v_cvt_pk_bf16_f32 v207, v194, v195
ds_read_b128 v[240:243], v10 offset:4352
v_mfma_f32_16x16x32_bf16 v[88:91], v[244:247], v[208:211], v[88:91]
v_exp_f32 v196, v196
v_exp_f32 v197, v197
ds_read_b128 v[244:247], v10 offset:4416
v_mfma_f32_16x16x32_bf16 v[100:103], v[248:251], v[208:211], v[100:103]
v_exp_f32 v198, v198
v_exp_f32 v199, v199
ds_read_b128 v[248:251], v10 offset:4480
v_mfma_f32_16x16x32_bf16 v[112:115], v[252:255], v[208:211], v[112:115]
ds_read_b128 v[252:255], v10 offset:4544
v_mfma_f32_16x16x32_bf16 v[124:127], v[16:19], v[208:211], v[124:127]
s_nop 0
v_cvt_pk_bf16_f32 v208, v184, v185
v_cvt_pk_bf16_f32 v209, v186, v187
v_cvt_pk_bf16_f32 v210, v196, v197
v_cvt_pk_bf16_f32 v211, v198, v199
W3_R11_back:
s_waitcnt lgkmcnt(7)
v_mfma_f32_16x16x32_bf16 v[176:179], v[224:227], v[128:131], v[212:215]
v_mfma_f32_16x16x32_bf16 v[180:183], v[224:227], v[144:147], v[216:219]
v_mfma_f32_16x16x32_bf16 v[184:187], v[224:227], v[160:163], v[220:223]
s_waitcnt lgkmcnt(6)
v_mfma_f32_16x16x32_bf16 v[176:179], v[228:231], v[132:135], v[176:179]
ds_read_b64_tr_b16 v[224:225], v11 offset:60672
v_mfma_f32_16x16x32_bf16 v[180:183], v[228:231], v[148:151], v[180:183]
ds_read_b64_tr_b16 v[226:227], v11 offset:61184
v_mfma_f32_16x16x32_bf16 v[184:187], v[228:231], v[164:167], v[184:187]
s_waitcnt lgkmcnt(7)
v_mfma_f32_16x16x32_bf16 v[176:179], v[232:235], v[136:139], v[176:179]
ds_read_b64_tr_b16 v[228:229], v11 offset:60704
v_mfma_f32_16x16x32_bf16 v[180:183], v[232:235], v[152:155], v[180:183]
ds_read_b64_tr_b16 v[230:231], v11 offset:61216
v_mfma_f32_16x16x32_bf16 v[184:187], v[232:235], v[168:171], v[184:187]
s_waitcnt lgkmcnt(8)
v_mfma_f32_16x16x32_bf16 v[176:179], v[236:239], v[140:143], v[176:179]
ds_read_b64_tr_b16 v[232:233], v11 offset:60736
v_mfma_f32_16x16x32_bf16 v[180:183], v[236:239], v[156:159], v[180:183]
ds_read_b64_tr_b16 v[234:235], v11 offset:61248
v_mfma_f32_16x16x32_bf16 v[184:187], v[236:239], v[172:175], v[184:187]
s_waitcnt lgkmcnt(9)
v_mfma_f32_16x16x32_bf16 v[188:191], v[240:243], v[128:131], v[212:215]
ds_read_b64_tr_b16 v[236:237], v11 offset:60768
v_mfma_f32_16x16x32_bf16 v[192:195], v[240:243], v[144:147], v[216:219]
ds_read_b64_tr_b16 v[238:239], v11 offset:61280
v_mfma_f32_16x16x32_bf16 v[196:199], v[240:243], v[160:163], v[220:223]
s_waitcnt lgkmcnt(10)
v_mfma_f32_16x16x32_bf16 v[188:191], v[244:247], v[132:135], v[188:191]
ds_read_b64_tr_b16 v[240:241], v11 offset:60800
v_mfma_f32_16x16x32_bf16 v[192:195], v[244:247], v[148:151], v[192:195]
ds_read_b64_tr_b16 v[242:243], v11 offset:61312
v_mfma_f32_16x16x32_bf16 v[196:199], v[244:247], v[164:167], v[196:199]
s_waitcnt lgkmcnt(11)
v_mfma_f32_16x16x32_bf16 v[188:191], v[248:251], v[136:139], v[188:191]
ds_read_b64_tr_b16 v[244:245], v11 offset:60832
ds_read_b64_tr_b16 v[246:247], v11 offset:61344
v_mfma_f32_16x16x32_bf16 v[192:195], v[248:251], v[152:155], v[192:195]
v_max3_f32 v2, v176, v177, v178
v_max_f32 v2, v2, v179
v_mfma_f32_16x16x32_bf16 v[196:199], v[248:251], v[168:171], v[196:199]
v_max3_f32 v2, v2, v180, v181
s_waitcnt lgkmcnt(12)
v_mfma_f32_16x16x32_bf16 v[188:191], v[252:255], v[140:143], v[188:191]
ds_read_b64_tr_b16 v[248:249], v11 offset:60864
ds_read_b64_tr_b16 v[250:251], v11 offset:61376
v_mfma_f32_16x16x32_bf16 v[192:195], v[252:255], v[156:159], v[192:195]
v_max3_f32 v2, v2, v182, v183
v_max3_f32 v2, v2, v184, v185
v_mfma_f32_16x16x32_bf16 v[196:199], v[252:255], v[172:175], v[196:199]
v_max3_f32 v2, v2, v186, v187
ds_read_b64_tr_b16 v[252:253], v11 offset:60896
ds_read_b64_tr_b16 v[254:255], v11 offset:61408
s_nop 4
v_max3_f32 v2, v2, v188, v189
v_max3_f32 v2, v2, v190, v191
v_max3_f32 v2, v2, v192, v193
v_max3_f32 v2, v2, v194, v195
v_max3_f32 v2, v2, v196, v197
v_max3_f32 v2, v2, v198, v199
v_cmp_lt_f32 vcc, s3, v2
s_cbranch_vccnz W3_R12
s_waitcnt lgkmcnt(14)
v_mfma_f32_16x16x32_bf16 v[20:23], v[224:227], v[200:203], v[20:23]
v_exp_f32 v176, v176
s_waitcnt lgkmcnt(12)
v_mfma_f32_16x16x32_bf16 v[32:35], v[228:231], v[200:203], v[32:35]
v_exp_f32 v177, v177
s_waitcnt lgkmcnt(10)
v_mfma_f32_16x16x32_bf16 v[44:47], v[232:235], v[200:203], v[44:47]
v_exp_f32 v178, v178
s_waitcnt lgkmcnt(8)
v_mfma_f32_16x16x32_bf16 v[56:59], v[236:239], v[200:203], v[56:59]
v_exp_f32 v179, v179
s_waitcnt lgkmcnt(6)
v_mfma_f32_16x16x32_bf16 v[68:71], v[240:243], v[200:203], v[68:71]
v_exp_f32 v188, v188
s_waitcnt lgkmcnt(4)
v_mfma_f32_16x16x32_bf16 v[80:83], v[244:247], v[200:203], v[80:83]
v_exp_f32 v189, v189
s_waitcnt lgkmcnt(2)
v_mfma_f32_16x16x32_bf16 v[92:95], v[248:251], v[200:203], v[92:95]
v_exp_f32 v190, v190
s_waitcnt lgkmcnt(0)
v_mfma_f32_16x16x32_bf16 v[104:107], v[252:255], v[200:203], v[104:107]
v_exp_f32 v191, v191
v_mfma_f32_16x16x32_bf16 v[116:119], v[16:19], v[200:203], v[116:119]
s_waitcnt vmcnt(8)
s_barrier
v_mfma_f32_16x16x32_bf16 v[24:27], v[224:227], v[204:207], v[24:27]
v_exp_f32 v180, v180
v_cvt_pk_bf16_f32 v200, v176, v177
v_mfma_f32_16x16x32_bf16 v[36:39], v[228:231], v[204:207], v[36:39]
s_add_u32 m0, s28, 60672
s_add_u32 s36, s33, 122880
buffer_load_dwordx4 v13, s[16:19], s36 offen nt lds
v_exp_f32 v181, v181
v_mfma_f32_16x16x32_bf16 v[48:51], v[232:235], v[204:207], v[48:51]
v_cvt_pk_bf16_f32 v201, v178, v179
v_mfma_f32_16x16x32_bf16 v[60:63], v[236:239], v[204:207], v[60:63]
s_add_u32 m0, s28, 61728
s_add_u32 s36, s33, 123136
buffer_load_dwordx4 v13, s[16:19], s36 offen nt lds
v_exp_f32 v182, v182
v_mfma_f32_16x16x32_bf16 v[72:75], v[240:243], v[204:207], v[72:75]
v_cvt_pk_bf16_f32 v202, v188, v189
v_mfma_f32_16x16x32_bf16 v[84:87], v[244:247], v[204:207], v[84:87]
v_exp_f32 v183, v183
v_cvt_pk_bf16_f32 v203, v190, v191
v_mfma_f32_16x16x32_bf16 v[96:99], v[248:251], v[204:207], v[96:99]
v_exp_f32 v192, v192
v_mfma_f32_16x16x32_bf16 v[108:111], v[252:255], v[204:207], v[108:111]
v_exp_f32 v193, v193
v_exp_f32 v194, v194
v_mfma_f32_16x16x32_bf16 v[120:123], v[16:19], v[204:207], v[120:123]
v_exp_f32 v195, v195
v_mfma_f32_16x16x32_bf16 v[28:31], v[224:227], v[208:211], v[28:31]
v_exp_f32 v184, v184
v_cvt_pk_bf16_f32 v204, v180, v181
ds_read_b128 v[224:227], v10 offset:8704
v_mfma_f32_16x16x32_bf16 v[40:43], v[228:231], v[208:211], v[40:43]
v_exp_f32 v185, v185
v_cvt_pk_bf16_f32 v205, v182, v183
ds_read_b128 v[228:231], v10 offset:8768
v_mfma_f32_16x16x32_bf16 v[52:55], v[232:235], v[208:211], v[52:55]
v_exp_f32 v186, v186
v_cvt_pk_bf16_f32 v206, v192, v193
ds_read_b128 v[232:235], v10 offset:8832
v_mfma_f32_16x16x32_bf16 v[64:67], v[236:239], v[208:211], v[64:67]
v_exp_f32 v187, v187
v_cvt_pk_bf16_f32 v207, v194, v195
ds_read_b128 v[236:239], v10 offset:8896
v_mfma_f32_16x16x32_bf16 v[76:79], v[240:243], v[208:211], v[76:79]
v_exp_f32 v196, v196
v_exp_f32 v197, v197
ds_read_b128 v[240:243], v10 offset:13056
v_mfma_f32_16x16x32_bf16 v[88:91], v[244:247], v[208:211], v[88:91]
v_exp_f32 v198, v198
v_exp_f32 v199, v199
ds_read_b128 v[244:247], v10 offset:13120
v_mfma_f32_16x16x32_bf16 v[100:103], v[248:251], v[208:211], v[100:103]
ds_read_b128 v[248:251], v10 offset:13184
v_mfma_f32_16x16x32_bf16 v[112:115], v[252:255], v[208:211], v[112:115]
ds_read_b128 v[252:255], v10 offset:13248
v_mfma_f32_16x16x32_bf16 v[124:127], v[16:19], v[208:211], v[124:127]
s_nop 0
v_cvt_pk_bf16_f32 v208, v184, v185
v_cvt_pk_bf16_f32 v209, v186, v187
v_cvt_pk_bf16_f32 v210, v196, v197
v_cvt_pk_bf16_f32 v211, v198, v199
W3_R12_back:
s_waitcnt lgkmcnt(7)
v_mfma_f32_16x16x32_bf16 v[176:179], v[224:227], v[128:131], v[212:215]
v_mfma_f32_16x16x32_bf16 v[180:183], v[224:227], v[144:147], v[216:219]
v_mfma_f32_16x16x32_bf16 v[184:187], v[224:227], v[160:163], v[220:223]
s_waitcnt lgkmcnt(6)
v_mfma_f32_16x16x32_bf16 v[176:179], v[228:231], v[132:135], v[176:179]
ds_read_b64_tr_b16 v[224:225], v11 offset:17408
v_mfma_f32_16x16x32_bf16 v[180:183], v[228:231], v[148:151], v[180:183]
ds_read_b64_tr_b16 v[226:227], v11 offset:17920
v_mfma_f32_16x16x32_bf16 v[184:187], v[228:231], v[164:167], v[184:187]
s_waitcnt lgkmcnt(7)
v_mfma_f32_16x16x32_bf16 v[176:179], v[232:235], v[136:139], v[176:179]
ds_read_b64_tr_b16 v[228:229], v11 offset:17440
v_mfma_f32_16x16x32_bf16 v[180:183], v[232:235], v[152:155], v[180:183]
ds_read_b64_tr_b16 v[230:231], v11 offset:17952
v_mfma_f32_16x16x32_bf16 v[184:187], v[232:235], v[168:171], v[184:187]
s_waitcnt lgkmcnt(8)
v_mfma_f32_16x16x32_bf16 v[176:179], v[236:239], v[140:143], v[176:179]
ds_read_b64_tr_b16 v[232:233], v11 offset:17472
v_mfma_f32_16x16x32_bf16 v[180:183], v[236:239], v[156:159], v[180:183]
ds_read_b64_tr_b16 v[234:235], v11 offset:17984
v_mfma_f32_16x16x32_bf16 v[184:187], v[236:239], v[172:175], v[184:187]
s_waitcnt lgkmcnt(9)
v_mfma_f32_16x16x32_bf16 v[188:191], v[240:243], v[128:131], v[212:215]
ds_read_b64_tr_b16 v[236:237], v11 offset:17504
v_mfma_f32_16x16x32_bf16 v[192:195], v[240:243], v[144:147], v[216:219]
ds_read_b64_tr_b16 v[238:239], v11 offset:18016
v_mfma_f32_16x16x32_bf16 v[196:199], v[240:243], v[160:163], v[220:223]
s_waitcnt lgkmcnt(10)
v_mfma_f32_16x16x32_bf16 v[188:191], v[244:247], v[132:135], v[188:191]
ds_read_b64_tr_b16 v[240:241], v11 offset:17536
v_mfma_f32_16x16x32_bf16 v[192:195], v[244:247], v[148:151], v[192:195]
ds_read_b64_tr_b16 v[242:243], v11 offset:18048
v_mfma_f32_16x16x32_bf16 v[196:199], v[244:247], v[164:167], v[196:199]
s_waitcnt lgkmcnt(11)
v_mfma_f32_16x16x32_bf16 v[188:191], v[248:251], v[136:139], v[188:191]
ds_read_b64_tr_b16 v[244:245], v11 offset:17568
ds_read_b64_tr_b16 v[246:247], v11 offset:18080
v_mfma_f32_16x16x32_bf16 v[192:195], v[248:251], v[152:155], v[192:195]
v_max3_f32 v2, v176, v177, v178
v_max_f32 v2, v2, v179
v_mfma_f32_16x16x32_bf16 v[196:199], v[248:251], v[168:171], v[196:199]
v_max3_f32 v2, v2, v180, v181
s_waitcnt lgkmcnt(12)
v_mfma_f32_16x16x32_bf16 v[188:191], v[252:255], v[140:143], v[188:191]
ds_read_b64_tr_b16 v[248:249], v11 offset:17600
ds_read_b64_tr_b16 v[250:251], v11 offset:18112
v_mfma_f32_16x16x32_bf16 v[192:195], v[252:255], v[156:159], v[192:195]
v_max3_f32 v2, v2, v182, v183
v_max3_f32 v2, v2, v184, v185
v_mfma_f32_16x16x32_bf16 v[196:199], v[252:255], v[172:175], v[196:199]
v_max3_f32 v2, v2, v186, v187
ds_read_b64_tr_b16 v[252:253], v11 offset:17632
ds_read_b64_tr_b16 v[254:255], v11 offset:18144
s_nop 4
v_max3_f32 v2, v2, v188, v189
v_max3_f32 v2, v2, v190, v191
v_max3_f32 v2, v2, v192, v193
v_max3_f32 v2, v2, v194, v195
v_max3_f32 v2, v2, v196, v197
v_max3_f32 v2, v2, v198, v199
v_cmp_lt_f32 vcc, s3, v2
s_cbranch_vccnz W3_R13
s_waitcnt lgkmcnt(14)
v_mfma_f32_16x16x32_bf16 v[20:23], v[224:227], v[200:203], v[20:23]
v_exp_f32 v176, v176
s_waitcnt lgkmcnt(12)
v_mfma_f32_16x16x32_bf16 v[32:35], v[228:231], v[200:203], v[32:35]
v_exp_f32 v177, v177
s_waitcnt lgkmcnt(10)
v_mfma_f32_16x16x32_bf16 v[44:47], v[232:235], v[200:203], v[44:47]
v_exp_f32 v178, v178
s_waitcnt lgkmcnt(8)
v_mfma_f32_16x16x32_bf16 v[56:59], v[236:239], v[200:203], v[56:59]
v_exp_f32 v179, v179
s_waitcnt lgkmcnt(6)
v_mfma_f32_16x16x32_bf16 v[68:71], v[240:243], v[200:203], v[68:71]
v_exp_f32 v188, v188
s_waitcnt lgkmcnt(4)
v_mfma_f32_16x16x32_bf16 v[80:83], v[244:247], v[200:203], v[80:83]
v_exp_f32 v189, v189
s_waitcnt lgkmcnt(2)
v_mfma_f32_16x16x32_bf16 v[92:95], v[248:251], v[200:203], v[92:95]
v_exp_f32 v190, v190
s_waitcnt lgkmcnt(0)
v_mfma_f32_16x16x32_bf16 v[104:107], v[252:255], v[200:203], v[104:107]
v_exp_f32 v191, v191
v_mfma_f32_16x16x32_bf16 v[116:119], v[16:19], v[200:203], v[116:119]
s_waitcnt vmcnt(6)
s_barrier
v_mfma_f32_16x16x32_bf16 v[24:27], v[224:227], v[204:207], v[24:27]
v_exp_f32 v180, v180
v_cvt_pk_bf16_f32 v200, v176, v177
v_mfma_f32_16x16x32_bf16 v[36:39], v[228:231], v[204:207], v[36:39]
s_mul_i32 s36, s63, 5120
v_lshlrev_b32 v8, 4, v0
buffer_load_dwordx4 v[4:7], v8, s[88:91], s36 offen
v_exp_f32 v181, v181
v_mfma_f32_16x16x32_bf16 v[48:51], v[232:235], v[204:207], v[48:51]
v_cvt_pk_bf16_f32 v201, v178, v179
v_mfma_f32_16x16x32_bf16 v[60:63], v[236:239], v[204:207], v[60:63]
s_mul_i32 s36, s63, 5120
buffer_load_dwordx4 v[4:7], v8, s[88:91], s36 offen offset:1024
v_exp_f32 v182, v182
v_mfma_f32_16x16x32_bf16 v[72:75], v[240:243], v[204:207], v[72:75]
v_cvt_pk_bf16_f32 v202, v188, v189
v_mfma_f32_16x16x32_bf16 v[84:87], v[244:247], v[204:207], v[84:87]
v_exp_f32 v183, v183
v_cvt_pk_bf16_f32 v203, v190, v191
v_mfma_f32_16x16x32_bf16 v[96:99], v[248:251], v[204:207], v[96:99]
v_exp_f32 v192, v192
v_mfma_f32_16x16x32_bf16 v[108:111], v[252:255], v[204:207], v[108:111]
v_exp_f32 v193, v193
v_exp_f32 v194, v194
v_mfma_f32_16x16x32_bf16 v[120:123], v[16:19], v[204:207], v[120:123]
v_exp_f32 v195, v195
v_mfma_f32_16x16x32_bf16 v[28:31], v[224:227], v[208:211], v[28:31]
v_exp_f32 v184, v184
v_cvt_pk_bf16_f32 v204, v180, v181
ds_read_b128 v[224:227], v10 offset:34816
v_mfma_f32_16x16x32_bf16 v[40:43], v[228:231], v[208:211], v[40:43]
s_mul_i32 s36, s63, 5120
buffer_load_dwordx4 v[4:7], v8, s[88:91], s36 offen offset:2048
v_exp_f32 v185, v185
ds_read_b128 v[228:231], v10 offset:34880
v_mfma_f32_16x16x32_bf16 v[52:55], v[232:235], v[208:211], v[52:55]
v_cvt_pk_bf16_f32 v205, v182, v183
s_mul_i32 s36, s63, 5120
buffer_load_dwordx4 v[4:7], v8, s[88:91], s36 offen offset:3072
ds_read_b128 v[232:235], v10 offset:34944
v_mfma_f32_16x16x32_bf16 v[64:67], v[236:239], v[208:211], v[64:67]
v_exp_f32 v186, v186
v_cvt_pk_bf16_f32 v206, v192, v193
ds_read_b128 v[236:239], v10 offset:35008
v_mfma_f32_16x16x32_bf16 v[76:79], v[240:243], v[208:211], v[76:79]
s_mul_i32 s36, s63, 5120
s_add_u32 s36, s36, 4096
buffer_load_dwordx4 v[4:7], v8, s[88:91], s36 offen
v_exp_f32 v187, v187
ds_read_b128 v[240:243], v10 offset:39168
v_mfma_f32_16x16x32_bf16 v[88:91], v[244:247], v[208:211], v[88:91]
v_cvt_pk_bf16_f32 v207, v194, v195
v_exp_f32 v196, v196
ds_read_b128 v[244:247], v10 offset:39232
v_mfma_f32_16x16x32_bf16 v[100:103], v[248:251], v[208:211], v[100:103]
v_exp_f32 v197, v197
v_exp_f32 v198, v198
ds_read_b128 v[248:251], v10 offset:39296
v_mfma_f32_16x16x32_bf16 v[112:115], v[252:255], v[208:211], v[112:115]
v_exp_f32 v199, v199
ds_read_b128 v[252:255], v10 offset:39360
v_mfma_f32_16x16x32_bf16 v[124:127], v[16:19], v[208:211], v[124:127]
s_nop 0
v_cvt_pk_bf16_f32 v208, v184, v185
v_cvt_pk_bf16_f32 v209, v186, v187
v_cvt_pk_bf16_f32 v210, v196, v197
v_cvt_pk_bf16_f32 v211, v198, v199
W3_R13_back:
s_waitcnt lgkmcnt(7)
v_mfma_f32_16x16x32_bf16 v[176:179], v[224:227], v[128:131], v[212:215]
v_mfma_f32_16x16x32_bf16 v[180:183], v[224:227], v[144:147], v[216:219]
v_mfma_f32_16x16x32_bf16 v[184:187], v[224:227], v[160:163], v[220:223]
s_waitcnt lgkmcnt(6)
v_mfma_f32_16x16x32_bf16 v[176:179], v[228:231], v[132:135], v[176:179]
ds_read_b64_tr_b16 v[224:225], v11 offset:25856
v_mfma_f32_16x16x32_bf16 v[180:183], v[228:231], v[148:151], v[180:183]
ds_read_b64_tr_b16 v[226:227], v11 offset:26368
v_mfma_f32_16x16x32_bf16 v[184:187], v[228:231], v[164:167], v[184:187]
s_waitcnt lgkmcnt(7)
v_mfma_f32_16x16x32_bf16 v[176:179], v[232:235], v[136:139], v[176:179]
ds_read_b64_tr_b16 v[228:229], v11 offset:25888
v_mfma_f32_16x16x32_bf16 v[180:183], v[232:235], v[152:155], v[180:183]
ds_read_b64_tr_b16 v[230:231], v11 offset:26400
v_mfma_f32_16x16x32_bf16 v[184:187], v[232:235], v[168:171], v[184:187]
s_waitcnt lgkmcnt(8)
v_mfma_f32_16x16x32_bf16 v[176:179], v[236:239], v[140:143], v[176:179]
ds_read_b64_tr_b16 v[232:233], v11 offset:25920
v_mfma_f32_16x16x32_bf16 v[180:183], v[236:239], v[156:159], v[180:183]
ds_read_b64_tr_b16 v[234:235], v11 offset:26432
v_mfma_f32_16x16x32_bf16 v[184:187], v[236:239], v[172:175], v[184:187]
s_waitcnt lgkmcnt(9)
v_mfma_f32_16x16x32_bf16 v[188:191], v[240:243], v[128:131], v[212:215]
ds_read_b64_tr_b16 v[236:237], v11 offset:25952
v_mfma_f32_16x16x32_bf16 v[192:195], v[240:243], v[144:147], v[216:219]
ds_read_b64_tr_b16 v[238:239], v11 offset:26464
v_mfma_f32_16x16x32_bf16 v[196:199], v[240:243], v[160:163], v[220:223]
s_waitcnt lgkmcnt(10)
v_mfma_f32_16x16x32_bf16 v[188:191], v[244:247], v[132:135], v[188:191]
ds_read_b64_tr_b16 v[240:241], v11 offset:25984
v_mfma_f32_16x16x32_bf16 v[192:195], v[244:247], v[148:151], v[192:195]
ds_read_b64_tr_b16 v[242:243], v11 offset:26496
v_mfma_f32_16x16x32_bf16 v[196:199], v[244:247], v[164:167], v[196:199]
s_waitcnt lgkmcnt(11)
v_mfma_f32_16x16x32_bf16 v[188:191], v[248:251], v[136:139], v[188:191]
ds_read_b64_tr_b16 v[244:245], v11 offset:26016
ds_read_b64_tr_b16 v[246:247], v11 offset:26528
v_mfma_f32_16x16x32_bf16 v[192:195], v[248:251], v[152:155], v[192:195]
v_max3_f32 v2, v176, v177, v178
v_max_f32 v2, v2, v179
v_mfma_f32_16x16x32_bf16 v[196:199], v[248:251], v[168:171], v[196:199]
v_max3_f32 v2, v2, v180, v181
s_waitcnt lgkmcnt(12)
v_mfma_f32_16x16x32_bf16 v[188:191], v[252:255], v[140:143], v[188:191]
ds_read_b64_tr_b16 v[248:249], v11 offset:26048
ds_read_b64_tr_b16 v[250:251], v11 offset:26560
v_mfma_f32_16x16x32_bf16 v[192:195], v[252:255], v[156:159], v[192:195]
v_max3_f32 v2, v2, v182, v183
v_max3_f32 v2, v2, v184, v185
v_mfma_f32_16x16x32_bf16 v[196:199], v[252:255], v[172:175], v[196:199]
v_max3_f32 v2, v2, v186, v187
ds_read_b64_tr_b16 v[252:253], v11 offset:26080
ds_read_b64_tr_b16 v[254:255], v11 offset:26592
s_nop 4
v_max3_f32 v2, v2, v188, v189
v_max3_f32 v2, v2, v190, v191
v_max3_f32 v2, v2, v192, v193
v_max3_f32 v2, v2, v194, v195
v_max3_f32 v2, v2, v196, v197
v_max3_f32 v2, v2, v198, v199
v_cmp_lt_f32 vcc, s3, v2
s_cbranch_vccnz W3_R14
s_waitcnt lgkmcnt(14)
v_mfma_f32_16x16x32_bf16 v[20:23], v[224:227], v[200:203], v[20:23]
v_exp_f32 v176, v176
s_waitcnt lgkmcnt(12)
v_mfma_f32_16x16x32_bf16 v[32:35], v[228:231], v[200:203], v[32:35]
v_exp_f32 v177, v177
s_waitcnt lgkmcnt(10)
v_mfma_f32_16x16x32_bf16 v[44:47], v[232:235], v[200:203], v[44:47]
v_exp_f32 v178, v178
s_waitcnt lgkmcnt(8)
v_mfma_f32_16x16x32_bf16 v[56:59], v[236:239], v[200:203], v[56:59]
v_exp_f32 v179, v179
s_waitcnt lgkmcnt(6)
v_mfma_f32_16x16x32_bf16 v[68:71], v[240:243], v[200:203], v[68:71]
v_exp_f32 v188, v188
s_waitcnt lgkmcnt(4)
v_mfma_f32_16x16x32_bf16 v[80:83], v[244:247], v[200:203], v[80:83]
v_exp_f32 v189, v189
s_waitcnt lgkmcnt(2)
v_mfma_f32_16x16x32_bf16 v[92:95], v[248:251], v[200:203], v[92:95]
v_exp_f32 v190, v190
s_waitcnt lgkmcnt(0)
v_mfma_f32_16x16x32_bf16 v[104:107], v[252:255], v[200:203], v[104:107]
v_exp_f32 v191, v191
v_mfma_f32_16x16x32_bf16 v[116:119], v[16:19], v[200:203], v[116:119]
s_waitcnt vmcnt(7)
s_barrier
v_mfma_f32_16x16x32_bf16 v[24:27], v[224:227], v[204:207], v[24:27]
v_exp_f32 v180, v180
v_cvt_pk_bf16_f32 v200, v176, v177
v_mfma_f32_16x16x32_bf16 v[36:39], v[228:231], v[204:207], v[36:39]
v_exp_f32 v181, v181
v_mfma_f32_16x16x32_bf16 v[48:51], v[232:235], v[204:207], v[48:51]
v_cvt_pk_bf16_f32 v201, v178, v179
v_mfma_f32_16x16x32_bf16 v[60:63], v[236:239], v[204:207], v[60:63]
v_exp_f32 v182, v182
v_cvt_pk_bf16_f32 v202, v188, v189
v_mfma_f32_16x16x32_bf16 v[72:75], v[240:243], v[204:207], v[72:75]
v_exp_f32 v183, v183
v_mfma_f32_16x16x32_bf16 v[84:87], v[244:247], v[204:207], v[84:87]
v_cvt_pk_bf16_f32 v203, v190, v191
v_mfma_f32_16x16x32_bf16 v[96:99], v[248:251], v[204:207], v[96:99]
v_exp_f32 v192, v192
v_exp_f32 v193, v193
v_mfma_f32_16x16x32_bf16 v[108:111], v[252:255], v[204:207], v[108:111]
v_exp_f32 v194, v194
v_mfma_f32_16x16x32_bf16 v[120:123], v[16:19], v[204:207], v[120:123]
v_exp_f32 v195, v195
v_mfma_f32_16x16x32_bf16 v[28:31], v[224:227], v[208:211], v[28:31]
v_exp_f32 v184, v184
v_cvt_pk_bf16_f32 v204, v180, v181
ds_read_b128 v[224:227], v10 offset:43520
v_mfma_f32_16x16x32_bf16 v[40:43], v[228:231], v[208:211], v[40:43]
v_exp_f32 v185, v185
v_cvt_pk_bf16_f32 v205, v182, v183
ds_read_b128 v[228:231], v10 offset:43584
v_mfma_f32_16x16x32_bf16 v[52:55], v[232:235], v[208:211], v[52:55]
v_exp_f32 v186, v186
v_cvt_pk_bf16_f32 v206, v192, v193
ds_read_b128 v[232:235], v10 offset:43648
v_mfma_f32_16x16x32_bf16 v[64:67], v[236:239], v[208:211], v[64:67]
v_exp_f32 v187, v187
v_cvt_pk_bf16_f32 v207, v194, v195
ds_read_b128 v[236:239], v10 offset:43712
v_mfma_f32_16x16x32_bf16 v[76:79], v[240:243], v[208:211], v[76:79]
v_exp_f32 v196, v196
v_exp_f32 v197, v197
ds_read_b128 v[240:243], v10 offset:47872
v_mfma_f32_16x16x32_bf16 v[88:91], v[244:247], v[208:211], v[88:91]
v_exp_f32 v198, v198
v_exp_f32 v199, v199
ds_read_b128 v[244:247], v10 offset:47936
v_mfma_f32_16x16x32_bf16 v[100:103], v[248:251], v[208:211], v[100:103]
ds_read_b128 v[248:251], v10 offset:48000
v_mfma_f32_16x16x32_bf16 v[112:115], v[252:255], v[208:211], v[112:115]
ds_read_b128 v[252:255], v10 offset:48064
v_mfma_f32_16x16x32_bf16 v[124:127], v[16:19], v[208:211], v[124:127]
s_nop 0
v_cvt_pk_bf16_f32 v208, v184, v185
v_cvt_pk_bf16_f32 v209, v186, v187
v_cvt_pk_bf16_f32 v210, v196, v197
v_cvt_pk_bf16_f32 v211, v198, v199
W3_R14_back:
s_waitcnt lgkmcnt(7)
v_mfma_f32_16x16x32_bf16 v[176:179], v[224:227], v[128:131], v[212:215]
v_mfma_f32_16x16x32_bf16 v[180:183], v[224:227], v[144:147], v[216:219]
v_mfma_f32_16x16x32_bf16 v[184:187], v[224:227], v[160:163], v[220:223]
s_waitcnt lgkmcnt(6)
v_mfma_f32_16x16x32_bf16 v[176:179], v[228:231], v[132:135], v[176:179]
ds_read_b64_tr_b16 v[224:225], v11 offset:52224
v_mfma_f32_16x16x32_bf16 v[180:183], v[228:231], v[148:151], v[180:183]
ds_read_b64_tr_b16 v[226:227], v11 offset:52736
v_mfma_f32_16x16x32_bf16 v[184:187], v[228:231], v[164:167], v[184:187]
s_waitcnt lgkmcnt(7)
v_mfma_f32_16x16x32_bf16 v[176:179], v[232:235], v[136:139], v[176:179]
ds_read_b64_tr_b16 v[228:229], v11 offset:52256
v_mfma_f32_16x16x32_bf16 v[180:183], v[232:235], v[152:155], v[180:183]
ds_read_b64_tr_b16 v[230:231], v11 offset:52768
v_mfma_f32_16x16x32_bf16 v[184:187], v[232:235], v[168:171], v[184:187]
s_waitcnt lgkmcnt(8)
v_mfma_f32_16x16x32_bf16 v[176:179], v[236:239], v[140:143], v[176:179]
ds_read_b64_tr_b16 v[232:233], v11 offset:52288
v_mfma_f32_16x16x32_bf16 v[180:183], v[236:239], v[156:159], v[180:183]
ds_read_b64_tr_b16 v[234:235], v11 offset:52800
v_mfma_f32_16x16x32_bf16 v[184:187], v[236:239], v[172:175], v[184:187]
s_waitcnt lgkmcnt(9)
v_mfma_f32_16x16x32_bf16 v[188:191], v[240:243], v[128:131], v[212:215]
ds_read_b64_tr_b16 v[236:237], v11 offset:52320
v_mfma_f32_16x16x32_bf16 v[192:195], v[240:243], v[144:147], v[216:219]
ds_read_b64_tr_b16 v[238:239], v11 offset:52832
v_mfma_f32_16x16x32_bf16 v[196:199], v[240:243], v[160:163], v[220:223]
s_waitcnt lgkmcnt(10)
v_mfma_f32_16x16x32_bf16 v[188:191], v[244:247], v[132:135], v[188:191]
ds_read_b64_tr_b16 v[240:241], v11 offset:52352
v_mfma_f32_16x16x32_bf16 v[192:195], v[244:247], v[148:151], v[192:195]
ds_read_b64_tr_b16 v[242:243], v11 offset:52864
v_mfma_f32_16x16x32_bf16 v[196:199], v[244:247], v[164:167], v[196:199]
s_waitcnt lgkmcnt(11)
v_mfma_f32_16x16x32_bf16 v[188:191], v[248:251], v[136:139], v[188:191]
ds_read_b64_tr_b16 v[244:245], v11 offset:52384
ds_read_b64_tr_b16 v[246:247], v11 offset:52896
v_mfma_f32_16x16x32_bf16 v[192:195], v[248:251], v[152:155], v[192:195]
v_max3_f32 v2, v176, v177, v178
v_max_f32 v2, v2, v179
v_mfma_f32_16x16x32_bf16 v[196:199], v[248:251], v[168:171], v[196:199]
v_max3_f32 v2, v2, v180, v181
s_waitcnt lgkmcnt(12)
v_mfma_f32_16x16x32_bf16 v[188:191], v[252:255], v[140:143], v[188:191]
ds_read_b64_tr_b16 v[248:249], v11 offset:52416
ds_read_b64_tr_b16 v[250:251], v11 offset:52928
v_mfma_f32_16x16x32_bf16 v[192:195], v[252:255], v[156:159], v[192:195]
v_max3_f32 v2, v2, v182, v183
v_max3_f32 v2, v2, v184, v185
v_mfma_f32_16x16x32_bf16 v[196:199], v[252:255], v[172:175], v[196:199]
v_max3_f32 v2, v2, v186, v187
ds_read_b64_tr_b16 v[252:253], v11 offset:52448
ds_read_b64_tr_b16 v[254:255], v11 offset:52960
s_nop 4
v_max3_f32 v2, v2, v188, v189
v_max3_f32 v2, v2, v190, v191
v_max3_f32 v2, v2, v192, v193
v_max3_f32 v2, v2, v194, v195
v_max3_f32 v2, v2, v196, v197
v_max3_f32 v2, v2, v198, v199
v_cmp_lt_f32 vcc, s3, v2
s_cbranch_vccnz W3_R15
s_waitcnt lgkmcnt(14)
v_mfma_f32_16x16x32_bf16 v[20:23], v[224:227], v[200:203], v[20:23]
v_exp_f32 v176, v176
s_waitcnt lgkmcnt(12)
v_mfma_f32_16x16x32_bf16 v[32:35], v[228:231], v[200:203], v[32:35]
v_exp_f32 v177, v177
s_waitcnt lgkmcnt(10)
v_mfma_f32_16x16x32_bf16 v[44:47], v[232:235], v[200:203], v[44:47]
v_exp_f32 v178, v178
s_waitcnt lgkmcnt(8)
v_mfma_f32_16x16x32_bf16 v[56:59], v[236:239], v[200:203], v[56:59]
v_exp_f32 v179, v179
s_waitcnt lgkmcnt(6)
v_mfma_f32_16x16x32_bf16 v[68:71], v[240:243], v[200:203], v[68:71]
v_exp_f32 v188, v188
s_waitcnt lgkmcnt(4)
v_mfma_f32_16x16x32_bf16 v[80:83], v[244:247], v[200:203], v[80:83]
v_exp_f32 v189, v189
s_waitcnt lgkmcnt(2)
v_mfma_f32_16x16x32_bf16 v[92:95], v[248:251], v[200:203], v[92:95]
v_exp_f32 v190, v190
s_waitcnt lgkmcnt(0)
v_mfma_f32_16x16x32_bf16 v[104:107], v[252:255], v[200:203], v[104:107]
v_exp_f32 v191, v191
v_mfma_f32_16x16x32_bf16 v[116:119], v[16:19], v[200:203], v[116:119]
s_waitcnt vmcnt(5)
s_barrier
v_mfma_f32_16x16x32_bf16 v[24:27], v[224:227], v[204:207], v[24:27]
v_exp_f32 v180, v180
v_cvt_pk_bf16_f32 v200, v176, v177
v_mfma_f32_16x16x32_bf16 v[36:39], v[228:231], v[204:207], v[36:39]
v_exp_f32 v181, v181
v_mfma_f32_16x16x32_bf16 v[48:51], v[232:235], v[204:207], v[48:51]
v_cvt_pk_bf16_f32 v201, v178, v179
v_mfma_f32_16x16x32_bf16 v[60:63], v[236:239], v[204:207], v[60:63]
v_exp_f32 v182, v182
v_cvt_pk_bf16_f32 v202, v188, v189
v_mfma_f32_16x16x32_bf16 v[72:75], v[240:243], v[204:207], v[72:75]
v_exp_f32 v183, v183
v_mfma_f32_16x16x32_bf16 v[84:87], v[244:247], v[204:207], v[84:87]
v_cvt_pk_bf16_f32 v203, v190, v191
v_mfma_f32_16x16x32_bf16 v[96:99], v[248:251], v[204:207], v[96:99]
v_exp_f32 v192, v192
v_exp_f32 v193, v193
v_mfma_f32_16x16x32_bf16 v[108:111], v[252:255], v[204:207], v[108:111]
v_exp_f32 v194, v194
v_mfma_f32_16x16x32_bf16 v[120:123], v[16:19], v[204:207], v[120:123]
v_exp_f32 v195, v195
v_mfma_f32_16x16x32_bf16 v[28:31], v[224:227], v[208:211], v[28:31]
v_exp_f32 v184, v184
v_cvt_pk_bf16_f32 v204, v180, v181
v_mfma_f32_16x16x32_bf16 v[40:43], v[228:231], v[208:211], v[40:43]
v_exp_f32 v185, v185
v_mfma_f32_16x16x32_bf16 v[52:55], v[232:235], v[208:211], v[52:55]
v_cvt_pk_bf16_f32 v205, v182, v183
v_mfma_f32_16x16x32_bf16 v[64:67], v[236:239], v[208:211], v[64:67]
v_exp_f32 v186, v186
v_cvt_pk_bf16_f32 v206, v192, v193
v_mfma_f32_16x16x32_bf16 v[76:79], v[240:243], v[208:211], v[76:79]
v_exp_f32 v187, v187
v_mfma_f32_16x16x32_bf16 v[88:91], v[244:247], v[208:211], v[88:91]
v_cvt_pk_bf16_f32 v207, v194, v195
v_mfma_f32_16x16x32_bf16 v[100:103], v[248:251], v[208:211], v[100:103]
v_exp_f32 v196, v196
v_exp_f32 v197, v197
v_mfma_f32_16x16x32_bf16 v[112:115], v[252:255], v[208:211], v[112:115]
v_exp_f32 v198, v198
v_mfma_f32_16x16x32_bf16 v[124:127], v[16:19], v[208:211], v[124:127]
v_exp_f32 v199, v199
s_nop 0
v_cvt_pk_bf16_f32 v208, v184, v185
v_cvt_pk_bf16_f32 v209, v186, v187
v_cvt_pk_bf16_f32 v210, v196, v197
v_cvt_pk_bf16_f32 v211, v198, v199
W3_R15_back:
ds_read_b64_tr_b16 v[224:225], v11 offset:60672
ds_read_b64_tr_b16 v[226:227], v11 offset:61184
ds_read_b64_tr_b16 v[228:229], v11 offset:60704
ds_read_b64_tr_b16 v[230:231], v11 offset:61216
ds_read_b64_tr_b16 v[232:233], v11 offset:60736
ds_read_b64_tr_b16 v[234:235], v11 offset:61248
ds_read_b64_tr_b16 v[236:237], v11 offset:60768
ds_read_b64_tr_b16 v[238:239], v11 offset:61280
ds_read_b64_tr_b16 v[240:241], v11 offset:60800
ds_read_b64_tr_b16 v[242:243], v11 offset:61312
ds_read_b64_tr_b16 v[244:245], v11 offset:60832
ds_read_b64_tr_b16 v[246:247], v11 offset:61344
ds_read_b64_tr_b16 v[248:249], v11 offset:60864
ds_read_b64_tr_b16 v[250:251], v11 offset:61376
ds_read_b64_tr_b16 v[252:253], v11 offset:60896
ds_read_b64_tr_b16 v[254:255], v11 offset:61408
s_waitcnt lgkmcnt(0)
v_mfma_f32_16x16x32_bf16 v[20:23], v[224:227], v[200:203], v[20:23]
v_mfma_f32_16x16x32_bf16 v[32:35], v[228:231], v[200:203], v[32:35]
v_mfma_f32_16x16x32_bf16 v[44:47], v[232:235], v[200:203], v[44:47]
v_mfma_f32_16x16x32_bf16 v[56:59], v[236:239], v[200:203], v[56:59]
v_mfma_f32_16x16x32_bf16 v[68:71], v[240:243], v[200:203], v[68:71]
v_mfma_f32_16x16x32_bf16 v[80:83], v[244:247], v[200:203], v[80:83]
v_mfma_f32_16x16x32_bf16 v[92:95], v[248:251], v[200:203], v[92:95]
v_mfma_f32_16x16x32_bf16 v[104:107], v[252:255], v[200:203], v[104:107]
v_mfma_f32_16x16x32_bf16 v[116:119], v[16:19], v[200:203], v[116:119]
v_mfma_f32_16x16x32_bf16 v[24:27], v[224:227], v[204:207], v[24:27]
v_mfma_f32_16x16x32_bf16 v[36:39], v[228:231], v[204:207], v[36:39]
v_mfma_f32_16x16x32_bf16 v[48:51], v[232:235], v[204:207], v[48:51]
v_mfma_f32_16x16x32_bf16 v[60:63], v[236:239], v[204:207], v[60:63]
v_mfma_f32_16x16x32_bf16 v[72:75], v[240:243], v[204:207], v[72:75]
v_mfma_f32_16x16x32_bf16 v[84:87], v[244:247], v[204:207], v[84:87]
v_mfma_f32_16x16x32_bf16 v[96:99], v[248:251], v[204:207], v[96:99]
v_mfma_f32_16x16x32_bf16 v[108:111], v[252:255], v[204:207], v[108:111]
v_mfma_f32_16x16x32_bf16 v[120:123], v[16:19], v[204:207], v[120:123]
v_mfma_f32_16x16x32_bf16 v[28:31], v[224:227], v[208:211], v[28:31]
v_mfma_f32_16x16x32_bf16 v[40:43], v[228:231], v[208:211], v[40:43]
v_mfma_f32_16x16x32_bf16 v[52:55], v[232:235], v[208:211], v[52:55]
v_mfma_f32_16x16x32_bf16 v[64:67], v[236:239], v[208:211], v[64:67]
v_mfma_f32_16x16x32_bf16 v[76:79], v[240:243], v[208:211], v[76:79]
v_mfma_f32_16x16x32_bf16 v[88:91], v[244:247], v[208:211], v[88:91]
v_mfma_f32_16x16x32_bf16 v[100:103], v[248:251], v[208:211], v[100:103]
v_mfma_f32_16x16x32_bf16 v[112:115], v[252:255], v[208:211], v[112:115]
v_mfma_f32_16x16x32_bf16 v[124:127], v[16:19], v[208:211], v[124:127]
v_lshlrev_b32 v10, 4, v0
s_nop 15
v_rcp_f32 v2, v116
s_nop 0
v_mov_b32 v3, v2
v_pk_mul_f32 v[20:21], v[20:21], v[2:3]
v_pk_mul_f32 v[22:23], v[22:23], v[2:3]
v_pk_mul_f32 v[32:33], v[32:33], v[2:3]
v_pk_mul_f32 v[34:35], v[34:35], v[2:3]
v_cvt_pk_bf16_f32 v176, v20, v21
v_cvt_pk_bf16_f32 v177, v22, v23
v_cvt_pk_bf16_f32 v178, v32, v33
v_cvt_pk_bf16_f32 v179, v34, v35
s_add_u32 s36, s37, 0
buffer_store_dwordx4 v[176:179], v10, s[20:23], s36 offen sc1
s_nop 1
v_pk_mul_f32 v[44:45], v[44:45], v[2:3]
v_pk_mul_f32 v[46:47], v[46:47], v[2:3]
v_pk_mul_f32 v[56:57], v[56:57], v[2:3]
v_pk_mul_f32 v[58:59], v[58:59], v[2:3]
v_cvt_pk_bf16_f32 v180, v44, v45
v_cvt_pk_bf16_f32 v181, v46, v47
v_cvt_pk_bf16_f32 v182, v56, v57
v_cvt_pk_bf16_f32 v183, v58, v59
s_add_u32 s36, s37, 1024
buffer_store_dwordx4 v[180:183], v10, s[20:23], s36 offen sc1
s_nop 1
v_pk_mul_f32 v[68:69], v[68:69], v[2:3]
v_pk_mul_f32 v[70:71], v[70:71], v[2:3]
v_pk_mul_f32 v[80:81], v[80:81], v[2:3]
v_pk_mul_f32 v[82:83], v[82:83], v[2:3]
v_cvt_pk_bf16_f32 v184, v68, v69
v_cvt_pk_bf16_f32 v185, v70, v71
v_cvt_pk_bf16_f32 v186, v80, v81
v_cvt_pk_bf16_f32 v187, v82, v83
s_add_u32 s36, s37, 2048
buffer_store_dwordx4 v[184:187], v10, s[20:23], s36 offen sc1
s_nop 1
v_pk_mul_f32 v[92:93], v[92:93], v[2:3]
v_pk_mul_f32 v[94:95], v[94:95], v[2:3]
v_pk_mul_f32 v[104:105], v[104:105], v[2:3]
v_pk_mul_f32 v[106:107], v[106:107], v[2:3]
v_cvt_pk_bf16_f32 v188, v92, v93
v_cvt_pk_bf16_f32 v189, v94, v95
v_cvt_pk_bf16_f32 v190, v104, v105
v_cvt_pk_bf16_f32 v191, v106, v107
s_add_u32 s36, s37, 3072
buffer_store_dwordx4 v[188:191], v10, s[20:23], s36 offen sc1
s_nop 1
v_rcp_f32 v2, v120
s_nop 0
v_mov_b32 v3, v2
v_pk_mul_f32 v[24:25], v[24:25], v[2:3]
v_pk_mul_f32 v[26:27], v[26:27], v[2:3]
v_pk_mul_f32 v[36:37], v[36:37], v[2:3]
v_pk_mul_f32 v[38:39], v[38:39], v[2:3]
v_cvt_pk_bf16_f32 v192, v24, v25
v_cvt_pk_bf16_f32 v193, v26, v27
v_cvt_pk_bf16_f32 v194, v36, v37
v_cvt_pk_bf16_f32 v195, v38, v39
s_add_u32 s36, s37, 131072
buffer_store_dwordx4 v[192:195], v10, s[20:23], s36 offen sc1
s_nop 1
v_pk_mul_f32 v[48:49], v[48:49], v[2:3]
v_pk_mul_f32 v[50:51], v[50:51], v[2:3]
v_pk_mul_f32 v[60:61], v[60:61], v[2:3]
v_pk_mul_f32 v[62:63], v[62:63], v[2:3]
v_cvt_pk_bf16_f32 v196, v48, v49
v_cvt_pk_bf16_f32 v197, v50, v51
v_cvt_pk_bf16_f32 v198, v60, v61
v_cvt_pk_bf16_f32 v199, v62, v63
s_add_u32 s36, s37, 132096
buffer_store_dwordx4 v[196:199], v10, s[20:23], s36 offen sc1
s_nop 1
v_pk_mul_f32 v[72:73], v[72:73], v[2:3]
v_pk_mul_f32 v[74:75], v[74:75], v[2:3]
v_pk_mul_f32 v[84:85], v[84:85], v[2:3]
v_pk_mul_f32 v[86:87], v[86:87], v[2:3]
v_cvt_pk_bf16_f32 v176, v72, v73
v_cvt_pk_bf16_f32 v177, v74, v75
v_cvt_pk_bf16_f32 v178, v84, v85
v_cvt_pk_bf16_f32 v179, v86, v87
s_add_u32 s36, s37, 133120
buffer_store_dwordx4 v[176:179], v10, s[20:23], s36 offen sc1
s_nop 1
v_pk_mul_f32 v[96:97], v[96:97], v[2:3]
v_pk_mul_f32 v[98:99], v[98:99], v[2:3]
v_pk_mul_f32 v[108:109], v[108:109], v[2:3]
v_pk_mul_f32 v[110:111], v[110:111], v[2:3]
v_cvt_pk_bf16_f32 v180, v96, v97
v_cvt_pk_bf16_f32 v181, v98, v99
v_cvt_pk_bf16_f32 v182, v108, v109
v_cvt_pk_bf16_f32 v183, v110, v111
s_add_u32 s36, s37, 134144
buffer_store_dwordx4 v[180:183], v10, s[20:23], s36 offen sc1
s_nop 1
v_rcp_f32 v2, v124
s_nop 0
v_mov_b32 v3, v2
v_pk_mul_f32 v[28:29], v[28:29], v[2:3]
v_pk_mul_f32 v[30:31], v[30:31], v[2:3]
v_pk_mul_f32 v[40:41], v[40:41], v[2:3]
v_pk_mul_f32 v[42:43], v[42:43], v[2:3]
v_cvt_pk_bf16_f32 v184, v28, v29
v_cvt_pk_bf16_f32 v185, v30, v31
v_cvt_pk_bf16_f32 v186, v40, v41
v_cvt_pk_bf16_f32 v187, v42, v43
s_add_u32 s36, s37, 262144
buffer_store_dwordx4 v[184:187], v10, s[20:23], s36 offen sc1
s_nop 1
v_pk_mul_f32 v[52:53], v[52:53], v[2:3]
v_pk_mul_f32 v[54:55], v[54:55], v[2:3]
v_pk_mul_f32 v[64:65], v[64:65], v[2:3]
v_pk_mul_f32 v[66:67], v[66:67], v[2:3]
v_cvt_pk_bf16_f32 v188, v52, v53
v_cvt_pk_bf16_f32 v189, v54, v55
v_cvt_pk_bf16_f32 v190, v64, v65
v_cvt_pk_bf16_f32 v191, v66, v67
s_add_u32 s36, s37, 263168
buffer_store_dwordx4 v[188:191], v10, s[20:23], s36 offen sc1
s_nop 1
v_pk_mul_f32 v[76:77], v[76:77], v[2:3]
v_pk_mul_f32 v[78:79], v[78:79], v[2:3]
v_pk_mul_f32 v[88:89], v[88:89], v[2:3]
v_pk_mul_f32 v[90:91], v[90:91], v[2:3]
v_cvt_pk_bf16_f32 v192, v76, v77
v_cvt_pk_bf16_f32 v193, v78, v79
v_cvt_pk_bf16_f32 v194, v88, v89
v_cvt_pk_bf16_f32 v195, v90, v91
s_add_u32 s36, s37, 264192
buffer_store_dwordx4 v[192:195], v10, s[20:23], s36 offen sc1
s_nop 1
v_pk_mul_f32 v[100:101], v[100:101], v[2:3]
v_pk_mul_f32 v[102:103], v[102:103], v[2:3]
v_pk_mul_f32 v[112:113], v[112:113], v[2:3]
v_pk_mul_f32 v[114:115], v[114:115], v[2:3]
v_cvt_pk_bf16_f32 v196, v100, v101
v_cvt_pk_bf16_f32 v197, v102, v103
v_cvt_pk_bf16_f32 v198, v112, v113
v_cvt_pk_bf16_f32 v199, v114, v115
s_add_u32 s36, s37, 265216
buffer_store_dwordx4 v[196:199], v10, s[20:23], s36 offen sc1
s_nop 1
s_waitcnt vmcnt(0)
s_barrier
s_cmp_lg_u32 s24, 0
s_cbranch_scc1 FN_17
s_cmp_lg_u32 s46, 0
s_cbranch_scc1 FK_18
v_mov_b32 v2, 0
s_mov_b32 s50, 0x40000
NS_19:
s_sub_u32 s50, s50, 1
s_cbranch_scc1 NO_20
global_load_dword v3, v2, s[44:45] sc1
s_waitcnt vmcnt(0)
v_readfirstlane_b32 s46, v3
s_cmp_lg_u32 s46, 0
s_cbranch_scc1 NO_20
s_sleep 2
s_branch NS_19
NO_20:
FK_18:
s_mov_b64 exec, 1
v_mov_b32 v2, s46
s_lshl_b32 s36, s60, 3
s_add_u32 s36, s36, s62
s_lshl_b32 s36, s36, 5
s_add_u32 s36, s36, s61
s_lshl_b32 s36, s36, 2
s_add_u32 s36, s36, 33554432
v_mov_b32 v3, s36
global_store_dword v3, v2, s[56:57] sc1
s_mov_b64 exec, -1
FN_17:
s_endpgm
W3_R1:
s_waitcnt lgkmcnt(0)
v_mfma_f32_16x16x32_bf16 v[20:23], v[224:227], v[200:203], 0
v_mfma_f32_16x16x32_bf16 v[32:35], v[228:231], v[200:203], 0
v_mfma_f32_16x16x32_bf16 v[44:47], v[232:235], v[200:203], 0
v_mfma_f32_16x16x32_bf16 v[56:59], v[236:239], v[200:203], 0
v_mfma_f32_16x16x32_bf16 v[68:71], v[240:243], v[200:203], 0
v_mfma_f32_16x16x32_bf16 v[80:83], v[244:247], v[200:203], 0
v_mfma_f32_16x16x32_bf16 v[92:95], v[248:251], v[200:203], 0
v_mfma_f32_16x16x32_bf16 v[104:107], v[252:255], v[200:203], 0
v_mfma_f32_16x16x32_bf16 v[116:119], v[16:19], v[200:203], 0
v_mfma_f32_16x16x32_bf16 v[24:27], v[224:227], v[204:207], 0
v_mfma_f32_16x16x32_bf16 v[36:39], v[228:231], v[204:207], 0
v_mfma_f32_16x16x32_bf16 v[48:51], v[232:235], v[204:207], 0
v_mfma_f32_16x16x32_bf16 v[60:63], v[236:239], v[204:207], 0
v_mfma_f32_16x16x32_bf16 v[72:75], v[240:243], v[204:207], 0
v_mfma_f32_16x16x32_bf16 v[84:87], v[244:247], v[204:207], 0
v_mfma_f32_16x16x32_bf16 v[96:99], v[248:251], v[204:207], 0
v_mfma_f32_16x16x32_bf16 v[108:111], v[252:255], v[204:207], 0
v_mfma_f32_16x16x32_bf16 v[120:123], v[16:19], v[204:207], 0
v_mfma_f32_16x16x32_bf16 v[28:31], v[224:227], v[208:211], 0
v_mfma_f32_16x16x32_bf16 v[40:43], v[228:231], v[208:211], 0
v_mfma_f32_16x16x32_bf16 v[52:55], v[232:235], v[208:211], 0
v_mfma_f32_16x16x32_bf16 v[64:67], v[236:239], v[208:211], 0
v_mfma_f32_16x16x32_bf16 v[76:79], v[240:243], v[208:211], 0
v_mfma_f32_16x16x32_bf16 v[88:91], v[244:247], v[208:211], 0
v_mfma_f32_16x16x32_bf16 v[100:103], v[248:251], v[208:211], 0
v_mfma_f32_16x16x32_bf16 v[112:115], v[252:255], v[208:211], 0
v_mfma_f32_16x16x32_bf16 v[124:127], v[16:19], v[208:211], 0
s_nop 15
v_max3_f32 v2, v176, v177, v178
v_max3_f32 v2, v2, v179, v188
v_max3_f32 v2, v2, v189, v190
v_max_f32 v2, v2, v191
v_mov_b32 v3, v2
s_nop 1
v_permlane32_swap_b32 v2, v3
s_nop 1
v_max_f32 v2, v2, v3
v_mov_b32 v3, v2
s_nop 1
v_permlane16_swap_b32 v2, v3
s_nop 1
v_max_f32 v2, v2, v3
v_max_f32 v2, 0, v2
v_sub_f32 v176, v176, v2
v_sub_f32 v177, v177, v2
v_sub_f32 v178, v178, v2
v_sub_f32 v179, v179, v2
v_sub_f32 v188, v188, v2
v_sub_f32 v189, v189, v2
v_sub_f32 v190, v190, v2
v_sub_f32 v191, v191, v2
v_sub_f32 v212, v212, v2
v_sub_f32 v213, v213, v2
v_sub_f32 v214, v214, v2
v_sub_f32 v215, v215, v2
v_exp_f32 v3, -v2
s_nop 0
v_mul_f32 v20, v20, v3
v_mul_f32 v21, v21, v3
v_mul_f32 v22, v22, v3
v_mul_f32 v23, v23, v3
v_mul_f32 v32, v32, v3
v_mul_f32 v33, v33, v3
v_mul_f32 v34, v34, v3
v_mul_f32 v35, v35, v3
v_mul_f32 v44, v44, v3
v_mul_f32 v45, v45, v3
v_mul_f32 v46, v46, v3
v_mul_f32 v47, v47, v3
v_mul_f32 v56, v56, v3
v_mul_f32 v57, v57, v3
v_mul_f32 v58, v58, v3
v_mul_f32 v59, v59, v3
v_mul_f32 v68, v68, v3
v_mul_f32 v69, v69, v3
v_mul_f32 v70, v70, v3
v_mul_f32 v71, v71, v3
v_mul_f32 v80, v80, v3
v_mul_f32 v81, v81, v3
v_mul_f32 v82, v82, v3
v_mul_f32 v83, v83, v3
v_mul_f32 v92, v92, v3
v_mul_f32 v93, v93, v3
v_mul_f32 v94, v94, v3
v_mul_f32 v95, v95, v3
v_mul_f32 v104, v104, v3
v_mul_f32 v105, v105, v3
v_mul_f32 v106, v106, v3
v_mul_f32 v107, v107, v3
v_mul_f32 v116, v116, v3
v_mul_f32 v117, v117, v3
v_mul_f32 v118, v118, v3
v_mul_f32 v119, v119, v3
v_max3_f32 v2, v180, v181, v182
v_max3_f32 v2, v2, v183, v192
v_max3_f32 v2, v2, v193, v194
v_max_f32 v2, v2, v195
v_mov_b32 v3, v2
s_nop 1
v_permlane32_swap_b32 v2, v3
s_nop 1
v_max_f32 v2, v2, v3
v_mov_b32 v3, v2
s_nop 1
v_permlane16_swap_b32 v2, v3
s_nop 1
v_max_f32 v2, v2, v3
v_max_f32 v2, 0, v2
v_sub_f32 v180, v180, v2
v_sub_f32 v181, v181, v2
v_sub_f32 v182, v182, v2
v_sub_f32 v183, v183, v2
v_sub_f32 v192, v192, v2
v_sub_f32 v193, v193, v2
v_sub_f32 v194, v194, v2
v_sub_f32 v195, v195, v2
v_sub_f32 v216, v216, v2
v_sub_f32 v217, v217, v2
v_sub_f32 v218, v218, v2
v_sub_f32 v219, v219, v2
v_exp_f32 v3, -v2
s_nop 0
v_mul_f32 v24, v24, v3
v_mul_f32 v25, v25, v3
v_mul_f32 v26, v26, v3
v_mul_f32 v27, v27, v3
v_mul_f32 v36, v36, v3
v_mul_f32 v37, v37, v3
v_mul_f32 v38, v38, v3
v_mul_f32 v39, v39, v3
v_mul_f32 v48, v48, v3
v_mul_f32 v49, v49, v3
v_mul_f32 v50, v50, v3
v_mul_f32 v51, v51, v3
v_mul_f32 v60, v60, v3
v_mul_f32 v61, v61, v3
v_mul_f32 v62, v62, v3
v_mul_f32 v63, v63, v3
v_mul_f32 v72, v72, v3
v_mul_f32 v73, v73, v3
v_mul_f32 v74, v74, v3
v_mul_f32 v75, v75, v3
v_mul_f32 v84, v84, v3
v_mul_f32 v85, v85, v3
v_mul_f32 v86, v86, v3
v_mul_f32 v87, v87, v3
v_mul_f32 v96, v96, v3
v_mul_f32 v97, v97, v3
v_mul_f32 v98, v98, v3
v_mul_f32 v99, v99, v3
v_mul_f32 v108, v108, v3
v_mul_f32 v109, v109, v3
v_mul_f32 v110, v110, v3
v_mul_f32 v111, v111, v3
v_mul_f32 v120, v120, v3
v_mul_f32 v121, v121, v3
v_mul_f32 v122, v122, v3
v_mul_f32 v123, v123, v3
v_max3_f32 v2, v184, v185, v186
v_max3_f32 v2, v2, v187, v196
v_max3_f32 v2, v2, v197, v198
v_max_f32 v2, v2, v199
v_mov_b32 v3, v2
s_nop 1
v_permlane32_swap_b32 v2, v3
s_nop 1
v_max_f32 v2, v2, v3
v_mov_b32 v3, v2
s_nop 1
v_permlane16_swap_b32 v2, v3
s_nop 1
v_max_f32 v2, v2, v3
v_max_f32 v2, 0, v2
v_sub_f32 v184, v184, v2
v_sub_f32 v185, v185, v2
v_sub_f32 v186, v186, v2
v_sub_f32 v187, v187, v2
v_sub_f32 v196, v196, v2
v_sub_f32 v197, v197, v2
v_sub_f32 v198, v198, v2
v_sub_f32 v199, v199, v2
v_sub_f32 v220, v220, v2
v_sub_f32 v221, v221, v2
v_sub_f32 v222, v222, v2
v_sub_f32 v223, v223, v2
v_exp_f32 v3, -v2
s_nop 0
v_mul_f32 v28, v28, v3
v_mul_f32 v29, v29, v3
v_mul_f32 v30, v30, v3
v_mul_f32 v31, v31, v3
v_mul_f32 v40, v40, v3
v_mul_f32 v41, v41, v3
v_mul_f32 v42, v42, v3
v_mul_f32 v43, v43, v3
v_mul_f32 v52, v52, v3
v_mul_f32 v53, v53, v3
v_mul_f32 v54, v54, v3
v_mul_f32 v55, v55, v3
v_mul_f32 v64, v64, v3
v_mul_f32 v65, v65, v3
v_mul_f32 v66, v66, v3
v_mul_f32 v67, v67, v3
v_mul_f32 v76, v76, v3
v_mul_f32 v77, v77, v3
v_mul_f32 v78, v78, v3
v_mul_f32 v79, v79, v3
v_mul_f32 v88, v88, v3
v_mul_f32 v89, v89, v3
v_mul_f32 v90, v90, v3
v_mul_f32 v91, v91, v3
v_mul_f32 v100, v100, v3
v_mul_f32 v101, v101, v3
v_mul_f32 v102, v102, v3
v_mul_f32 v103, v103, v3
v_mul_f32 v112, v112, v3
v_mul_f32 v113, v113, v3
v_mul_f32 v114, v114, v3
v_mul_f32 v115, v115, v3
v_mul_f32 v124, v124, v3
v_mul_f32 v125, v125, v3
v_mul_f32 v126, v126, v3
v_mul_f32 v127, v127, v3
v_exp_f32 v176, v176
v_exp_f32 v177, v177
v_exp_f32 v178, v178
v_exp_f32 v179, v179
v_exp_f32 v188, v188
v_exp_f32 v189, v189
v_exp_f32 v190, v190
v_exp_f32 v191, v191
v_exp_f32 v180, v180
v_exp_f32 v181, v181
v_exp_f32 v182, v182
v_exp_f32 v183, v183
v_exp_f32 v192, v192
v_exp_f32 v193, v193
v_exp_f32 v194, v194
v_exp_f32 v195, v195
v_exp_f32 v184, v184
v_exp_f32 v185, v185
v_exp_f32 v186, v186
v_exp_f32 v187, v187
v_exp_f32 v196, v196
v_exp_f32 v197, v197
v_exp_f32 v198, v198
v_exp_f32 v199, v199
s_nop 0
v_cvt_pk_bf16_f32 v200, v176, v177
v_cvt_pk_bf16_f32 v201, v178, v179
v_cvt_pk_bf16_f32 v202, v188, v189
v_cvt_pk_bf16_f32 v203, v190, v191
v_cvt_pk_bf16_f32 v204, v180, v181
v_cvt_pk_bf16_f32 v205, v182, v183
v_cvt_pk_bf16_f32 v206, v192, v193
v_cvt_pk_bf16_f32 v207, v194, v195
v_cvt_pk_bf16_f32 v208, v184, v185
v_cvt_pk_bf16_f32 v209, v186, v187
v_cvt_pk_bf16_f32 v210, v196, v197
v_cvt_pk_bf16_f32 v211, v198, v199
s_waitcnt vmcnt(6)
s_barrier
s_add_u32 m0, s27, 0
s_add_u32 s36, s29, 32768
buffer_load_dwordx4 v12, s[12:15], s36 offen nt lds
s_add_u32 m0, s27, 1088
s_add_u32 s36, s29, 33792
buffer_load_dwordx4 v12, s[12:15], s36 offen nt lds
s_add_u32 m0, s27, 8704
s_add_u32 s36, s29, 40960
buffer_load_dwordx4 v12, s[12:15], s36 offen nt lds
s_add_u32 m0, s27, 9792
s_add_u32 s36, s29, 41984
buffer_load_dwordx4 v12, s[12:15], s36 offen nt lds
s_add_u32 m0, s28, 17408
s_add_u32 s36, s33, 32768
buffer_load_dwordx4 v13, s[16:19], s36 offen nt lds
s_add_u32 m0, s28, 18464
s_add_u32 s36, s33, 33024
buffer_load_dwordx4 v13, s[16:19], s36 offen nt lds
v_mov_b32 v8, 0
global_load_dword v7, v8, s[44:45] sc1
ds_read_b128 v[224:227], v10 offset:34816
ds_read_b128 v[228:231], v10 offset:34880
ds_read_b128 v[232:235], v10 offset:34944
ds_read_b128 v[236:239], v10 offset:35008
ds_read_b128 v[240:243], v10 offset:39168
ds_read_b128 v[244:247], v10 offset:39232
ds_read_b128 v[248:251], v10 offset:39296
ds_read_b128 v[252:255], v10 offset:39360
s_branch W3_R1_back
W3_R2:
s_waitcnt lgkmcnt(0)
v_mfma_f32_16x16x32_bf16 v[20:23], v[224:227], v[200:203], v[20:23]
v_mfma_f32_16x16x32_bf16 v[32:35], v[228:231], v[200:203], v[32:35]
v_mfma_f32_16x16x32_bf16 v[44:47], v[232:235], v[200:203], v[44:47]
v_mfma_f32_16x16x32_bf16 v[56:59], v[236:239], v[200:203], v[56:59]
v_mfma_f32_16x16x32_bf16 v[68:71], v[240:243], v[200:203], v[68:71]
v_mfma_f32_16x16x32_bf16 v[80:83], v[244:247], v[200:203], v[80:83]
v_mfma_f32_16x16x32_bf16 v[92:95], v[248:251], v[200:203], v[92:95]
v_mfma_f32_16x16x32_bf16 v[104:107], v[252:255], v[200:203], v[104:107]
v_mfma_f32_16x16x32_bf16 v[116:119], v[16:19], v[200:203], v[116:119]
v_mfma_f32_16x16x32_bf16 v[24:27], v[224:227], v[204:207], v[24:27]
v_mfma_f32_16x16x32_bf16 v[36:39], v[228:231], v[204:207], v[36:39]
v_mfma_f32_16x16x32_bf16 v[48:51], v[232:235], v[204:207], v[48:51]
v_mfma_f32_16x16x32_bf16 v[60:63], v[236:239], v[204:207], v[60:63]
v_mfma_f32_16x16x32_bf16 v[72:75], v[240:243], v[204:207], v[72:75]
v_mfma_f32_16x16x32_bf16 v[84:87], v[244:247], v[204:207], v[84:87]
v_mfma_f32_16x16x32_bf16 v[96:99], v[248:251], v[204:207], v[96:99]
v_mfma_f32_16x16x32_bf16 v[108:111], v[252:255], v[204:207], v[108:111]
v_mfma_f32_16x16x32_bf16 v[120:123], v[16:19], v[204:207], v[120:123]
v_mfma_f32_16x16x32_bf16 v[28:31], v[224:227], v[208:211], v[28:31]
v_mfma_f32_16x16x32_bf16 v[40:43], v[228:231], v[208:211], v[40:43]
v_mfma_f32_16x16x32_bf16 v[52:55], v[232:235], v[208:211], v[52:55]
v_mfma_f32_16x16x32_bf16 v[64:67], v[236:239], v[208:211], v[64:67]
v_mfma_f32_16x16x32_bf16 v[76:79], v[240:243], v[208:211], v[76:79]
v_mfma_f32_16x16x32_bf16 v[88:91], v[244:247], v[208:211], v[88:91]
v_mfma_f32_16x16x32_bf16 v[100:103], v[248:251], v[208:211], v[100:103]
v_mfma_f32_16x16x32_bf16 v[112:115], v[252:255], v[208:211], v[112:115]
v_mfma_f32_16x16x32_bf16 v[124:127], v[16:19], v[208:211], v[124:127]
s_nop 15
v_max3_f32 v2, v176, v177, v178
v_max3_f32 v2, v2, v179, v188
v_max3_f32 v2, v2, v189, v190
v_max_f32 v2, v2, v191
v_mov_b32 v3, v2
s_nop 1
v_permlane32_swap_b32 v2, v3
s_nop 1
v_max_f32 v2, v2, v3
v_mov_b32 v3, v2
s_nop 1
v_permlane16_swap_b32 v2, v3
s_nop 1
v_max_f32 v2, v2, v3
v_max_f32 v2, 0, v2
v_sub_f32 v176, v176, v2
v_sub_f32 v177, v177, v2
v_sub_f32 v178, v178, v2
v_sub_f32 v179, v179, v2
v_sub_f32 v188, v188, v2
v_sub_f32 v189, v189, v2
v_sub_f32 v190, v190, v2
v_sub_f32 v191, v191, v2
v_sub_f32 v212, v212, v2
v_sub_f32 v213, v213, v2
v_sub_f32 v214, v214, v2
v_sub_f32 v215, v215, v2
v_exp_f32 v3, -v2
s_nop 0
v_mul_f32 v20, v20, v3
v_mul_f32 v21, v21, v3
v_mul_f32 v22, v22, v3
v_mul_f32 v23, v23, v3
v_mul_f32 v32, v32, v3
v_mul_f32 v33, v33, v3
v_mul_f32 v34, v34, v3
v_mul_f32 v35, v35, v3
v_mul_f32 v44, v44, v3
v_mul_f32 v45, v45, v3
v_mul_f32 v46, v46, v3
v_mul_f32 v47, v47, v3
v_mul_f32 v56, v56, v3
v_mul_f32 v57, v57, v3
v_mul_f32 v58, v58, v3
v_mul_f32 v59, v59, v3
v_mul_f32 v68, v68, v3
v_mul_f32 v69, v69, v3
v_mul_f32 v70, v70, v3
v_mul_f32 v71, v71, v3
v_mul_f32 v80, v80, v3
v_mul_f32 v81, v81, v3
v_mul_f32 v82, v82, v3
v_mul_f32 v83, v83, v3
v_mul_f32 v92, v92, v3
v_mul_f32 v93, v93, v3
v_mul_f32 v94, v94, v3
v_mul_f32 v95, v95, v3
v_mul_f32 v104, v104, v3
v_mul_f32 v105, v105, v3
v_mul_f32 v106, v106, v3
v_mul_f32 v107, v107, v3
v_mul_f32 v116, v116, v3
v_mul_f32 v117, v117, v3
v_mul_f32 v118, v118, v3
v_mul_f32 v119, v119, v3
v_max3_f32 v2, v180, v181, v182
v_max3_f32 v2, v2, v183, v192
v_max3_f32 v2, v2, v193, v194
v_max_f32 v2, v2, v195
v_mov_b32 v3, v2
s_nop 1
v_permlane32_swap_b32 v2, v3
s_nop 1
v_max_f32 v2, v2, v3
v_mov_b32 v3, v2
s_nop 1
v_permlane16_swap_b32 v2, v3
s_nop 1
v_max_f32 v2, v2, v3
v_max_f32 v2, 0, v2
v_sub_f32 v180, v180, v2
v_sub_f32 v181, v181, v2
v_sub_f32 v182, v182, v2
v_sub_f32 v183, v183, v2
v_sub_f32 v192, v192, v2
v_sub_f32 v193, v193, v2
v_sub_f32 v194, v194, v2
v_sub_f32 v195, v195, v2
v_sub_f32 v216, v216, v2
v_sub_f32 v217, v217, v2
v_sub_f32 v218, v218, v2
v_sub_f32 v219, v219, v2
v_exp_f32 v3, -v2
s_nop 0
v_mul_f32 v24, v24, v3
v_mul_f32 v25, v25, v3
v_mul_f32 v26, v26, v3
v_mul_f32 v27, v27, v3
v_mul_f32 v36, v36, v3
v_mul_f32 v37, v37, v3
v_mul_f32 v38, v38, v3
v_mul_f32 v39, v39, v3
v_mul_f32 v48, v48, v3
v_mul_f32 v49, v49, v3
v_mul_f32 v50, v50, v3
v_mul_f32 v51, v51, v3
v_mul_f32 v60, v60, v3
v_mul_f32 v61, v61, v3
v_mul_f32 v62, v62, v3
v_mul_f32 v63, v63, v3
v_mul_f32 v72, v72, v3
v_mul_f32 v73, v73, v3
v_mul_f32 v74, v74, v3
v_mul_f32 v75, v75, v3
v_mul_f32 v84, v84, v3
v_mul_f32 v85, v85, v3
v_mul_f32 v86, v86, v3
v_mul_f32 v87, v87, v3
v_mul_f32 v96, v96, v3
v_mul_f32 v97, v97, v3
v_mul_f32 v98, v98, v3
v_mul_f32 v99, v99, v3
v_mul_f32 v108, v108, v3
v_mul_f32 v109, v109, v3
v_mul_f32 v110, v110, v3
v_mul_f32 v111, v111, v3
v_mul_f32 v120, v120, v3
v_mul_f32 v121, v121, v3
v_mul_f32 v122, v122, v3
v_mul_f32 v123, v123, v3
v_max3_f32 v2, v184, v185, v186
v_max3_f32 v2, v2, v187, v196
v_max3_f32 v2, v2, v197, v198
v_max_f32 v2, v2, v199
v_mov_b32 v3, v2
s_nop 1
v_permlane32_swap_b32 v2, v3
s_nop 1
v_max_f32 v2, v2, v3
v_mov_b32 v3, v2
s_nop 1
v_permlane16_swap_b32 v2, v3
s_nop 1
v_max_f32 v2, v2, v3
v_max_f32 v2, 0, v2
v_sub_f32 v184, v184, v2
v_sub_f32 v185, v185, v2
v_sub_f32 v186, v186, v2
v_sub_f32 v187, v187, v2
v_sub_f32 v196, v196, v2
v_sub_f32 v197, v197, v2
v_sub_f32 v198, v198, v2
v_sub_f32 v199, v199, v2
v_sub_f32 v220, v220, v2
v_sub_f32 v221, v221, v2
v_sub_f32 v222, v222, v2
v_sub_f32 v223, v223, v2
v_exp_f32 v3, -v2
s_nop 0
v_mul_f32 v28, v28, v3
v_mul_f32 v29, v29, v3
v_mul_f32 v30, v30, v3
v_mul_f32 v31, v31, v3
v_mul_f32 v40, v40, v3
v_mul_f32 v41, v41, v3
v_mul_f32 v42, v42, v3
v_mul_f32 v43, v43, v3
v_mul_f32 v52, v52, v3
v_mul_f32 v53, v53, v3
v_mul_f32 v54, v54, v3
v_mul_f32 v55, v55, v3
v_mul_f32 v64, v64, v3
v_mul_f32 v65, v65, v3
v_mul_f32 v66, v66, v3
v_mul_f32 v67, v67, v3
v_mul_f32 v76, v76, v3
v_mul_f32 v77, v77, v3
v_mul_f32 v78, v78, v3
v_mul_f32 v79, v79, v3
v_mul_f32 v88, v88, v3
v_mul_f32 v89, v89, v3
v_mul_f32 v90, v90, v3
v_mul_f32 v91, v91, v3
v_mul_f32 v100, v100, v3
v_mul_f32 v101, v101, v3
v_mul_f32 v102, v102, v3
v_mul_f32 v103, v103, v3
v_mul_f32 v112, v112, v3
v_mul_f32 v113, v113, v3
v_mul_f32 v114, v114, v3
v_mul_f32 v115, v115, v3
v_mul_f32 v124, v124, v3
v_mul_f32 v125, v125, v3
v_mul_f32 v126, v126, v3
v_mul_f32 v127, v127, v3
v_exp_f32 v176, v176
v_exp_f32 v177, v177
v_exp_f32 v178, v178
v_exp_f32 v179, v179
v_exp_f32 v188, v188
v_exp_f32 v189, v189
v_exp_f32 v190, v190
v_exp_f32 v191, v191
v_exp_f32 v180, v180
v_exp_f32 v181, v181
v_exp_f32 v182, v182
v_exp_f32 v183, v183
v_exp_f32 v192, v192
v_exp_f32 v193, v193
v_exp_f32 v194, v194
v_exp_f32 v195, v195
v_exp_f32 v184, v184
v_exp_f32 v185, v185
v_exp_f32 v186, v186
v_exp_f32 v187, v187
v_exp_f32 v196, v196
v_exp_f32 v197, v197
v_exp_f32 v198, v198
v_exp_f32 v199, v199
s_nop 0
v_cvt_pk_bf16_f32 v200, v176, v177
v_cvt_pk_bf16_f32 v201, v178, v179
v_cvt_pk_bf16_f32 v202, v188, v189
v_cvt_pk_bf16_f32 v203, v190, v191
v_cvt_pk_bf16_f32 v204, v180, v181
v_cvt_pk_bf16_f32 v205, v182, v183
v_cvt_pk_bf16_f32 v206, v192, v193
v_cvt_pk_bf16_f32 v207, v194, v195
v_cvt_pk_bf16_f32 v208, v184, v185
v_cvt_pk_bf16_f32 v209, v186, v187
v_cvt_pk_bf16_f32 v210, v196, v197
v_cvt_pk_bf16_f32 v211, v198, v199
s_waitcnt vmcnt(9)
s_barrier
s_add_u32 m0, s27, 34816
s_add_u32 s36, s29, 49152
buffer_load_dwordx4 v12, s[12:15], s36 offen nt lds
s_add_u32 m0, s27, 35904
s_add_u32 s36, s29, 50176
buffer_load_dwordx4 v12, s[12:15], s36 offen nt lds
s_add_u32 m0, s28, 25856
s_add_u32 s36, s33, 40960
buffer_load_dwordx4 v13, s[16:19], s36 offen nt lds
s_add_u32 m0, s28, 26912
s_add_u32 s36, s33, 41216
buffer_load_dwordx4 v13, s[16:19], s36 offen nt lds
ds_read_b128 v[224:227], v10 offset:43520
ds_read_b128 v[228:231], v10 offset:43584
ds_read_b128 v[232:235], v10 offset:43648
ds_read_b128 v[236:239], v10 offset:43712
ds_read_b128 v[240:243], v10 offset:47872
ds_read_b128 v[244:247], v10 offset:47936
ds_read_b128 v[248:251], v10 offset:48000
ds_read_b128 v[252:255], v10 offset:48064
s_branch W3_R2_back
W3_R3:
s_waitcnt lgkmcnt(0)
v_mfma_f32_16x16x32_bf16 v[20:23], v[224:227], v[200:203], v[20:23]
v_mfma_f32_16x16x32_bf16 v[32:35], v[228:231], v[200:203], v[32:35]
v_mfma_f32_16x16x32_bf16 v[44:47], v[232:235], v[200:203], v[44:47]
v_mfma_f32_16x16x32_bf16 v[56:59], v[236:239], v[200:203], v[56:59]
v_mfma_f32_16x16x32_bf16 v[68:71], v[240:243], v[200:203], v[68:71]
v_mfma_f32_16x16x32_bf16 v[80:83], v[244:247], v[200:203], v[80:83]
v_mfma_f32_16x16x32_bf16 v[92:95], v[248:251], v[200:203], v[92:95]
v_mfma_f32_16x16x32_bf16 v[104:107], v[252:255], v[200:203], v[104:107]
v_mfma_f32_16x16x32_bf16 v[116:119], v[16:19], v[200:203], v[116:119]
v_mfma_f32_16x16x32_bf16 v[24:27], v[224:227], v[204:207], v[24:27]
v_mfma_f32_16x16x32_bf16 v[36:39], v[228:231], v[204:207], v[36:39]
v_mfma_f32_16x16x32_bf16 v[48:51], v[232:235], v[204:207], v[48:51]
v_mfma_f32_16x16x32_bf16 v[60:63], v[236:239], v[204:207], v[60:63]
v_mfma_f32_16x16x32_bf16 v[72:75], v[240:243], v[204:207], v[72:75]
v_mfma_f32_16x16x32_bf16 v[84:87], v[244:247], v[204:207], v[84:87]
v_mfma_f32_16x16x32_bf16 v[96:99], v[248:251], v[204:207], v[96:99]
v_mfma_f32_16x16x32_bf16 v[108:111], v[252:255], v[204:207], v[108:111]
v_mfma_f32_16x16x32_bf16 v[120:123], v[16:19], v[204:207], v[120:123]
v_mfma_f32_16x16x32_bf16 v[28:31], v[224:227], v[208:211], v[28:31]
v_mfma_f32_16x16x32_bf16 v[40:43], v[228:231], v[208:211], v[40:43]
v_mfma_f32_16x16x32_bf16 v[52:55], v[232:235], v[208:211], v[52:55]
v_mfma_f32_16x16x32_bf16 v[64:67], v[236:239], v[208:211], v[64:67]
v_mfma_f32_16x16x32_bf16 v[76:79], v[240:243], v[208:211], v[76:79]
v_mfma_f32_16x16x32_bf16 v[88:91], v[244:247], v[208:211], v[88:91]
v_mfma_f32_16x16x32_bf16 v[100:103], v[248:251], v[208:211], v[100:103]
v_mfma_f32_16x16x32_bf16 v[112:115], v[252:255], v[208:211], v[112:115]
v_mfma_f32_16x16x32_bf16 v[124:127], v[16:19], v[208:211], v[124:127]
s_nop 15
v_max3_f32 v2, v176, v177, v178
v_max3_f32 v2, v2, v179, v188
v_max3_f32 v2, v2, v189, v190
v_max_f32 v2, v2, v191
v_mov_b32 v3, v2
s_nop 1
v_permlane32_swap_b32 v2, v3
s_nop 1
v_max_f32 v2, v2, v3
v_mov_b32 v3, v2
s_nop 1
v_permlane16_swap_b32 v2, v3
s_nop 1
v_max_f32 v2, v2, v3
v_max_f32 v2, 0, v2
v_sub_f32 v176, v176, v2
v_sub_f32 v177, v177, v2
v_sub_f32 v178, v178, v2
v_sub_f32 v179, v179, v2
v_sub_f32 v188, v188, v2
v_sub_f32 v189, v189, v2
v_sub_f32 v190, v190, v2
v_sub_f32 v191, v191, v2
v_sub_f32 v212, v212, v2
v_sub_f32 v213, v213, v2
v_sub_f32 v214, v214, v2
v_sub_f32 v215, v215, v2
v_exp_f32 v3, -v2
s_nop 0
v_mul_f32 v20, v20, v3
v_mul_f32 v21, v21, v3
v_mul_f32 v22, v22, v3
v_mul_f32 v23, v23, v3
v_mul_f32 v32, v32, v3
v_mul_f32 v33, v33, v3
v_mul_f32 v34, v34, v3
v_mul_f32 v35, v35, v3
v_mul_f32 v44, v44, v3
v_mul_f32 v45, v45, v3
v_mul_f32 v46, v46, v3
v_mul_f32 v47, v47, v3
v_mul_f32 v56, v56, v3
v_mul_f32 v57, v57, v3
v_mul_f32 v58, v58, v3
v_mul_f32 v59, v59, v3
v_mul_f32 v68, v68, v3
v_mul_f32 v69, v69, v3
v_mul_f32 v70, v70, v3
v_mul_f32 v71, v71, v3
v_mul_f32 v80, v80, v3
v_mul_f32 v81, v81, v3
v_mul_f32 v82, v82, v3
v_mul_f32 v83, v83, v3
v_mul_f32 v92, v92, v3
v_mul_f32 v93, v93, v3
v_mul_f32 v94, v94, v3
v_mul_f32 v95, v95, v3
v_mul_f32 v104, v104, v3
v_mul_f32 v105, v105, v3
v_mul_f32 v106, v106, v3
v_mul_f32 v107, v107, v3
v_mul_f32 v116, v116, v3
v_mul_f32 v117, v117, v3
v_mul_f32 v118, v118, v3
v_mul_f32 v119, v119, v3
v_max3_f32 v2, v180, v181, v182
v_max3_f32 v2, v2, v183, v192
v_max3_f32 v2, v2, v193, v194
v_max_f32 v2, v2, v195
v_mov_b32 v3, v2
s_nop 1
v_permlane32_swap_b32 v2, v3
s_nop 1
v_max_f32 v2, v2, v3
v_mov_b32 v3, v2
s_nop 1
v_permlane16_swap_b32 v2, v3
s_nop 1
v_max_f32 v2, v2, v3
v_max_f32 v2, 0, v2
v_sub_f32 v180, v180, v2
v_sub_f32 v181, v181, v2
v_sub_f32 v182, v182, v2
v_sub_f32 v183, v183, v2
v_sub_f32 v192, v192, v2
v_sub_f32 v193, v193, v2
v_sub_f32 v194, v194, v2
v_sub_f32 v195, v195, v2
v_sub_f32 v216, v216, v2
v_sub_f32 v217, v217, v2
v_sub_f32 v218, v218, v2
v_sub_f32 v219, v219, v2
v_exp_f32 v3, -v2
s_nop 0
v_mul_f32 v24, v24, v3
v_mul_f32 v25, v25, v3
v_mul_f32 v26, v26, v3
v_mul_f32 v27, v27, v3
v_mul_f32 v36, v36, v3
v_mul_f32 v37, v37, v3
v_mul_f32 v38, v38, v3
v_mul_f32 v39, v39, v3
v_mul_f32 v48, v48, v3
v_mul_f32 v49, v49, v3
v_mul_f32 v50, v50, v3
v_mul_f32 v51, v51, v3
v_mul_f32 v60, v60, v3
v_mul_f32 v61, v61, v3
v_mul_f32 v62, v62, v3
v_mul_f32 v63, v63, v3
v_mul_f32 v72, v72, v3
v_mul_f32 v73, v73, v3
v_mul_f32 v74, v74, v3
v_mul_f32 v75, v75, v3
v_mul_f32 v84, v84, v3
v_mul_f32 v85, v85, v3
v_mul_f32 v86, v86, v3
v_mul_f32 v87, v87, v3
v_mul_f32 v96, v96, v3
v_mul_f32 v97, v97, v3
v_mul_f32 v98, v98, v3
v_mul_f32 v99, v99, v3
v_mul_f32 v108, v108, v3
v_mul_f32 v109, v109, v3
v_mul_f32 v110, v110, v3
v_mul_f32 v111, v111, v3
v_mul_f32 v120, v120, v3
v_mul_f32 v121, v121, v3
v_mul_f32 v122, v122, v3
v_mul_f32 v123, v123, v3
v_max3_f32 v2, v184, v185, v186
v_max3_f32 v2, v2, v187, v196
v_max3_f32 v2, v2, v197, v198
v_max_f32 v2, v2, v199
v_mov_b32 v3, v2
s_nop 1
v_permlane32_swap_b32 v2, v3
s_nop 1
v_max_f32 v2, v2, v3
v_mov_b32 v3, v2
s_nop 1
v_permlane16_swap_b32 v2, v3
s_nop 1
v_max_f32 v2, v2, v3
v_max_f32 v2, 0, v2
v_sub_f32 v184, v184, v2
v_sub_f32 v185, v185, v2
v_sub_f32 v186, v186, v2
v_sub_f32 v187, v187, v2
v_sub_f32 v196, v196, v2
v_sub_f32 v197, v197, v2
v_sub_f32 v198, v198, v2
v_sub_f32 v199, v199, v2
v_sub_f32 v220, v220, v2
v_sub_f32 v221, v221, v2
v_sub_f32 v222, v222, v2
v_sub_f32 v223, v223, v2
v_exp_f32 v3, -v2
s_nop 0
v_mul_f32 v28, v28, v3
v_mul_f32 v29, v29, v3
v_mul_f32 v30, v30, v3
v_mul_f32 v31, v31, v3
v_mul_f32 v40, v40, v3
v_mul_f32 v41, v41, v3
v_mul_f32 v42, v42, v3
v_mul_f32 v43, v43, v3
v_mul_f32 v52, v52, v3
v_mul_f32 v53, v53, v3
v_mul_f32 v54, v54, v3
v_mul_f32 v55, v55, v3
v_mul_f32 v64, v64, v3
v_mul_f32 v65, v65, v3
v_mul_f32 v66, v66, v3
v_mul_f32 v67, v67, v3
v_mul_f32 v76, v76, v3
v_mul_f32 v77, v77, v3
v_mul_f32 v78, v78, v3
v_mul_f32 v79, v79, v3
v_mul_f32 v88, v88, v3
v_mul_f32 v89, v89, v3
v_mul_f32 v90, v90, v3
v_mul_f32 v91, v91, v3
v_mul_f32 v100, v100, v3
v_mul_f32 v101, v101, v3
v_mul_f32 v102, v102, v3
v_mul_f32 v103, v103, v3
v_mul_f32 v112, v112, v3
v_mul_f32 v113, v113, v3
v_mul_f32 v114, v114, v3
v_mul_f32 v115, v115, v3
v_mul_f32 v124, v124, v3
v_mul_f32 v125, v125, v3
v_mul_f32 v126, v126, v3
v_mul_f32 v127, v127, v3
v_exp_f32 v176, v176
v_exp_f32 v177, v177
v_exp_f32 v178, v178
v_exp_f32 v179, v179
v_exp_f32 v188, v188
v_exp_f32 v189, v189
v_exp_f32 v190, v190
v_exp_f32 v191, v191
v_exp_f32 v180, v180
v_exp_f32 v181, v181
v_exp_f32 v182, v182
v_exp_f32 v183, v183
v_exp_f32 v192, v192
v_exp_f32 v193, v193
v_exp_f32 v194, v194
v_exp_f32 v195, v195
v_exp_f32 v184, v184
v_exp_f32 v185, v185
v_exp_f32 v186, v186
v_exp_f32 v187, v187
v_exp_f32 v196, v196
v_exp_f32 v197, v197
v_exp_f32 v198, v198
v_exp_f32 v199, v199
s_nop 0
v_cvt_pk_bf16_f32 v200, v176, v177
v_cvt_pk_bf16_f32 v201, v178, v179
v_cvt_pk_bf16_f32 v202, v188, v189
v_cvt_pk_bf16_f32 v203, v190, v191
v_cvt_pk_bf16_f32 v204, v180, v181
v_cvt_pk_bf16_f32 v205, v182, v183
v_cvt_pk_bf16_f32 v206, v192, v193
v_cvt_pk_bf16_f32 v207, v194, v195
v_cvt_pk_bf16_f32 v208, v184, v185
v_cvt_pk_bf16_f32 v209, v186, v187
v_cvt_pk_bf16_f32 v210, v196, v197
v_cvt_pk_bf16_f32 v211, v198, v199
s_waitcnt vmcnt(9)
s_barrier
s_add_u32 m0, s27, 43520
s_add_u32 s36, s29, 57344
buffer_load_dwordx4 v12, s[12:15], s36 offen nt lds
s_add_u32 m0, s27, 44608
s_add_u32 s36, s29, 58368
buffer_load_dwordx4 v12, s[12:15], s36 offen nt lds
s_add_u32 m0, s28, 52224
s_add_u32 s36, s33, 49152
buffer_load_dwordx4 v13, s[16:19], s36 offen nt lds
s_add_u32 m0, s28, 53280
s_add_u32 s36, s33, 49408
buffer_load_dwordx4 v13, s[16:19], s36 offen nt lds
ds_read_b128 v[224:227], v10 offset:0
ds_read_b128 v[228:231], v10 offset:64
ds_read_b128 v[232:235], v10 offset:128
ds_read_b128 v[236:239], v10 offset:192
ds_read_b128 v[240:243], v10 offset:4352
ds_read_b128 v[244:247], v10 offset:4416
ds_read_b128 v[248:251], v10 offset:4480
ds_read_b128 v[252:255], v10 offset:4544
s_branch W3_R3_back
W3_R4:
s_waitcnt lgkmcnt(0)
v_mfma_f32_16x16x32_bf16 v[20:23], v[224:227], v[200:203], v[20:23]
v_mfma_f32_16x16x32_bf16 v[32:35], v[228:231], v[200:203], v[32:35]
v_mfma_f32_16x16x32_bf16 v[44:47], v[232:235], v[200:203], v[44:47]
v_mfma_f32_16x16x32_bf16 v[56:59], v[236:239], v[200:203], v[56:59]
v_mfma_f32_16x16x32_bf16 v[68:71], v[240:243], v[200:203], v[68:71]
v_mfma_f32_16x16x32_bf16 v[80:83], v[244:247], v[200:203], v[80:83]
v_mfma_f32_16x16x32_bf16 v[92:95], v[248:251], v[200:203], v[92:95]
v_mfma_f32_16x16x32_bf16 v[104:107], v[252:255], v[200:203], v[104:107]
v_mfma_f32_16x16x32_bf16 v[116:119], v[16:19], v[200:203], v[116:119]
v_mfma_f32_16x16x32_bf16 v[24:27], v[224:227], v[204:207], v[24:27]
v_mfma_f32_16x16x32_bf16 v[36:39], v[228:231], v[204:207], v[36:39]
v_mfma_f32_16x16x32_bf16 v[48:51], v[232:235], v[204:207], v[48:51]
v_mfma_f32_16x16x32_bf16 v[60:63], v[236:239], v[204:207], v[60:63]
v_mfma_f32_16x16x32_bf16 v[72:75], v[240:243], v[204:207], v[72:75]
v_mfma_f32_16x16x32_bf16 v[84:87], v[244:247], v[204:207], v[84:87]
v_mfma_f32_16x16x32_bf16 v[96:99], v[248:251], v[204:207], v[96:99]
v_mfma_f32_16x16x32_bf16 v[108:111], v[252:255], v[204:207], v[108:111]
v_mfma_f32_16x16x32_bf16 v[120:123], v[16:19], v[204:207], v[120:123]
v_mfma_f32_16x16x32_bf16 v[28:31], v[224:227], v[208:211], v[28:31]
v_mfma_f32_16x16x32_bf16 v[40:43], v[228:231], v[208:211], v[40:43]
v_mfma_f32_16x16x32_bf16 v[52:55], v[232:235], v[208:211], v[52:55]
v_mfma_f32_16x16x32_bf16 v[64:67], v[236:239], v[208:211], v[64:67]
v_mfma_f32_16x16x32_bf16 v[76:79], v[240:243], v[208:211], v[76:79]
v_mfma_f32_16x16x32_bf16 v[88:91], v[244:247], v[208:211], v[88:91]
v_mfma_f32_16x16x32_bf16 v[100:103], v[248:251], v[208:211], v[100:103]
v_mfma_f32_16x16x32_bf16 v[112:115], v[252:255], v[208:211], v[112:115]
v_mfma_f32_16x16x32_bf16 v[124:127], v[16:19], v[208:211], v[124:127]
s_nop 15
v_max3_f32 v2, v176, v177, v178
v_max3_f32 v2, v2, v179, v188
v_max3_f32 v2, v2, v189, v190
v_max_f32 v2, v2, v191
v_mov_b32 v3, v2
s_nop 1
v_permlane32_swap_b32 v2, v3
s_nop 1
v_max_f32 v2, v2, v3
v_mov_b32 v3, v2
s_nop 1
v_permlane16_swap_b32 v2, v3
s_nop 1
v_max_f32 v2, v2, v3
v_max_f32 v2, 0, v2
v_sub_f32 v176, v176, v2
v_sub_f32 v177, v177, v2
v_sub_f32 v178, v178, v2
v_sub_f32 v179, v179, v2
v_sub_f32 v188, v188, v2
v_sub_f32 v189, v189, v2
v_sub_f32 v190, v190, v2
v_sub_f32 v191, v191, v2
v_sub_f32 v212, v212, v2
v_sub_f32 v213, v213, v2
v_sub_f32 v214, v214, v2
v_sub_f32 v215, v215, v2
v_exp_f32 v3, -v2
s_nop 0
v_mul_f32 v20, v20, v3
v_mul_f32 v21, v21, v3
v_mul_f32 v22, v22, v3
v_mul_f32 v23, v23, v3
v_mul_f32 v32, v32, v3
v_mul_f32 v33, v33, v3
v_mul_f32 v34, v34, v3
v_mul_f32 v35, v35, v3
v_mul_f32 v44, v44, v3
v_mul_f32 v45, v45, v3
v_mul_f32 v46, v46, v3
v_mul_f32 v47, v47, v3
v_mul_f32 v56, v56, v3
v_mul_f32 v57, v57, v3
v_mul_f32 v58, v58, v3
v_mul_f32 v59, v59, v3
v_mul_f32 v68, v68, v3
v_mul_f32 v69, v69, v3
v_mul_f32 v70, v70, v3
v_mul_f32 v71, v71, v3
v_mul_f32 v80, v80, v3
v_mul_f32 v81, v81, v3
v_mul_f32 v82, v82, v3
v_mul_f32 v83, v83, v3
v_mul_f32 v92, v92, v3
v_mul_f32 v93, v93, v3
v_mul_f32 v94, v94, v3
v_mul_f32 v95, v95, v3
v_mul_f32 v104, v104, v3
v_mul_f32 v105, v105, v3
v_mul_f32 v106, v106, v3
v_mul_f32 v107, v107, v3
v_mul_f32 v116, v116, v3
v_mul_f32 v117, v117, v3
v_mul_f32 v118, v118, v3
v_mul_f32 v119, v119, v3
v_max3_f32 v2, v180, v181, v182
v_max3_f32 v2, v2, v183, v192
v_max3_f32 v2, v2, v193, v194
v_max_f32 v2, v2, v195
v_mov_b32 v3, v2
s_nop 1
v_permlane32_swap_b32 v2, v3
s_nop 1
v_max_f32 v2, v2, v3
v_mov_b32 v3, v2
s_nop 1
v_permlane16_swap_b32 v2, v3
s_nop 1
v_max_f32 v2, v2, v3
v_max_f32 v2, 0, v2
v_sub_f32 v180, v180, v2
v_sub_f32 v181, v181, v2
v_sub_f32 v182, v182, v2
v_sub_f32 v183, v183, v2
v_sub_f32 v192, v192, v2
v_sub_f32 v193, v193, v2
v_sub_f32 v194, v194, v2
v_sub_f32 v195, v195, v2
v_sub_f32 v216, v216, v2
v_sub_f32 v217, v217, v2
v_sub_f32 v218, v218, v2
v_sub_f32 v219, v219, v2
v_exp_f32 v3, -v2
s_nop 0
v_mul_f32 v24, v24, v3
v_mul_f32 v25, v25, v3
v_mul_f32 v26, v26, v3
v_mul_f32 v27, v27, v3
v_mul_f32 v36, v36, v3
v_mul_f32 v37, v37, v3
v_mul_f32 v38, v38, v3
v_mul_f32 v39, v39, v3
v_mul_f32 v48, v48, v3
v_mul_f32 v49, v49, v3
v_mul_f32 v50, v50, v3
v_mul_f32 v51, v51, v3
v_mul_f32 v60, v60, v3
v_mul_f32 v61, v61, v3
v_mul_f32 v62, v62, v3
v_mul_f32 v63, v63, v3
v_mul_f32 v72, v72, v3
v_mul_f32 v73, v73, v3
v_mul_f32 v74, v74, v3
v_mul_f32 v75, v75, v3
v_mul_f32 v84, v84, v3
v_mul_f32 v85, v85, v3
v_mul_f32 v86, v86, v3
v_mul_f32 v87, v87, v3
v_mul_f32 v96, v96, v3
v_mul_f32 v97, v97, v3
v_mul_f32 v98, v98, v3
v_mul_f32 v99, v99, v3
v_mul_f32 v108, v108, v3
v_mul_f32 v109, v109, v3
v_mul_f32 v110, v110, v3
v_mul_f32 v111, v111, v3
v_mul_f32 v120, v120, v3
v_mul_f32 v121, v121, v3
v_mul_f32 v122, v122, v3
v_mul_f32 v123, v123, v3
v_max3_f32 v2, v184, v185, v186
v_max3_f32 v2, v2, v187, v196
v_max3_f32 v2, v2, v197, v198
v_max_f32 v2, v2, v199
v_mov_b32 v3, v2
s_nop 1
v_permlane32_swap_b32 v2, v3
s_nop 1
v_max_f32 v2, v2, v3
v_mov_b32 v3, v2
s_nop 1
v_permlane16_swap_b32 v2, v3
s_nop 1
v_max_f32 v2, v2, v3
v_max_f32 v2, 0, v2
v_sub_f32 v184, v184, v2
v_sub_f32 v185, v185, v2
v_sub_f32 v186, v186, v2
v_sub_f32 v187, v187, v2
v_sub_f32 v196, v196, v2
v_sub_f32 v197, v197, v2
v_sub_f32 v198, v198, v2
v_sub_f32 v199, v199, v2
v_sub_f32 v220, v220, v2
v_sub_f32 v221, v221, v2
v_sub_f32 v222, v222, v2
v_sub_f32 v223, v223, v2
v_exp_f32 v3, -v2
s_nop 0
v_mul_f32 v28, v28, v3
v_mul_f32 v29, v29, v3
v_mul_f32 v30, v30, v3
v_mul_f32 v31, v31, v3
v_mul_f32 v40, v40, v3
v_mul_f32 v41, v41, v3
v_mul_f32 v42, v42, v3
v_mul_f32 v43, v43, v3
v_mul_f32 v52, v52, v3
v_mul_f32 v53, v53, v3
v_mul_f32 v54, v54, v3
v_mul_f32 v55, v55, v3
v_mul_f32 v64, v64, v3
v_mul_f32 v65, v65, v3
v_mul_f32 v66, v66, v3
v_mul_f32 v67, v67, v3
v_mul_f32 v76, v76, v3
v_mul_f32 v77, v77, v3
v_mul_f32 v78, v78, v3
v_mul_f32 v79, v79, v3
v_mul_f32 v88, v88, v3
v_mul_f32 v89, v89, v3
v_mul_f32 v90, v90, v3
v_mul_f32 v91, v91, v3
v_mul_f32 v100, v100, v3
v_mul_f32 v101, v101, v3
v_mul_f32 v102, v102, v3
v_mul_f32 v103, v103, v3
v_mul_f32 v112, v112, v3
v_mul_f32 v113, v113, v3
v_mul_f32 v114, v114, v3
v_mul_f32 v115, v115, v3
v_mul_f32 v124, v124, v3
v_mul_f32 v125, v125, v3
v_mul_f32 v126, v126, v3
v_mul_f32 v127, v127, v3
v_exp_f32 v176, v176
v_exp_f32 v177, v177
v_exp_f32 v178, v178
v_exp_f32 v179, v179
v_exp_f32 v188, v188
v_exp_f32 v189, v189
v_exp_f32 v190, v190
v_exp_f32 v191, v191
v_exp_f32 v180, v180
v_exp_f32 v181, v181
v_exp_f32 v182, v182
v_exp_f32 v183, v183
v_exp_f32 v192, v192
v_exp_f32 v193, v193
v_exp_f32 v194, v194
v_exp_f32 v195, v195
v_exp_f32 v184, v184
v_exp_f32 v185, v185
v_exp_f32 v186, v186
v_exp_f32 v187, v187
v_exp_f32 v196, v196
v_exp_f32 v197, v197
v_exp_f32 v198, v198
v_exp_f32 v199, v199
s_nop 0
v_cvt_pk_bf16_f32 v200, v176, v177
v_cvt_pk_bf16_f32 v201, v178, v179
v_cvt_pk_bf16_f32 v202, v188, v189
v_cvt_pk_bf16_f32 v203, v190, v191
v_cvt_pk_bf16_f32 v204, v180, v181
v_cvt_pk_bf16_f32 v205, v182, v183
v_cvt_pk_bf16_f32 v206, v192, v193
v_cvt_pk_bf16_f32 v207, v194, v195
v_cvt_pk_bf16_f32 v208, v184, v185
v_cvt_pk_bf16_f32 v209, v186, v187
v_cvt_pk_bf16_f32 v210, v196, v197
v_cvt_pk_bf16_f32 v211, v198, v199
s_waitcnt vmcnt(9)
s_barrier
s_add_u32 m0, s27, 0
s_add_u32 s36, s29, 65536
buffer_load_dwordx4 v12, s[12:15], s36 offen nt lds
s_add_u32 m0, s27, 1088
s_add_u32 s36, s29, 66560
buffer_load_dwordx4 v12, s[12:15], s36 offen nt lds
s_add_u32 m0, s28, 60672
s_add_u32 s36, s33, 57344
buffer_load_dwordx4 v13, s[16:19], s36 offen nt lds
s_add_u32 m0, s28, 61728
s_add_u32 s36, s33, 57600
buffer_load_dwordx4 v13, s[16:19], s36 offen nt lds
ds_read_b128 v[224:227], v10 offset:8704
ds_read_b128 v[228:231], v10 offset:8768
ds_read_b128 v[232:235], v10 offset:8832
ds_read_b128 v[236:239], v10 offset:8896
ds_read_b128 v[240:243], v10 offset:13056
ds_read_b128 v[244:247], v10 offset:13120
ds_read_b128 v[248:251], v10 offset:13184
ds_read_b128 v[252:255], v10 offset:13248
s_branch W3_R4_back
W3_R5:
s_waitcnt lgkmcnt(0)
v_mfma_f32_16x16x32_bf16 v[20:23], v[224:227], v[200:203], v[20:23]
v_mfma_f32_16x16x32_bf16 v[32:35], v[228:231], v[200:203], v[32:35]
v_mfma_f32_16x16x32_bf16 v[44:47], v[232:235], v[200:203], v[44:47]
v_mfma_f32_16x16x32_bf16 v[56:59], v[236:239], v[200:203], v[56:59]
v_mfma_f32_16x16x32_bf16 v[68:71], v[240:243], v[200:203], v[68:71]
v_mfma_f32_16x16x32_bf16 v[80:83], v[244:247], v[200:203], v[80:83]
v_mfma_f32_16x16x32_bf16 v[92:95], v[248:251], v[200:203], v[92:95]
v_mfma_f32_16x16x32_bf16 v[104:107], v[252:255], v[200:203], v[104:107]
v_mfma_f32_16x16x32_bf16 v[116:119], v[16:19], v[200:203], v[116:119]
v_mfma_f32_16x16x32_bf16 v[24:27], v[224:227], v[204:207], v[24:27]
v_mfma_f32_16x16x32_bf16 v[36:39], v[228:231], v[204:207], v[36:39]
v_mfma_f32_16x16x32_bf16 v[48:51], v[232:235], v[204:207], v[48:51]
v_mfma_f32_16x16x32_bf16 v[60:63], v[236:239], v[204:207], v[60:63]
v_mfma_f32_16x16x32_bf16 v[72:75], v[240:243], v[204:207], v[72:75]
v_mfma_f32_16x16x32_bf16 v[84:87], v[244:247], v[204:207], v[84:87]
v_mfma_f32_16x16x32_bf16 v[96:99], v[248:251], v[204:207], v[96:99]
v_mfma_f32_16x16x32_bf16 v[108:111], v[252:255], v[204:207], v[108:111]
v_mfma_f32_16x16x32_bf16 v[120:123], v[16:19], v[204:207], v[120:123]
v_mfma_f32_16x16x32_bf16 v[28:31], v[224:227], v[208:211], v[28:31]
v_mfma_f32_16x16x32_bf16 v[40:43], v[228:231], v[208:211], v[40:43]
v_mfma_f32_16x16x32_bf16 v[52:55], v[232:235], v[208:211], v[52:55]
v_mfma_f32_16x16x32_bf16 v[64:67], v[236:239], v[208:211], v[64:67]
v_mfma_f32_16x16x32_bf16 v[76:79], v[240:243], v[208:211], v[76:79]
v_mfma_f32_16x16x32_bf16 v[88:91], v[244:247], v[208:211], v[88:91]
v_mfma_f32_16x16x32_bf16 v[100:103], v[248:251], v[208:211], v[100:103]
v_mfma_f32_16x16x32_bf16 v[112:115], v[252:255], v[208:211], v[112:115]
v_mfma_f32_16x16x32_bf16 v[124:127], v[16:19], v[208:211], v[124:127]
s_nop 15
v_max3_f32 v2, v176, v177, v178
v_max3_f32 v2, v2, v179, v188
v_max3_f32 v2, v2, v189, v190
v_max_f32 v2, v2, v191
v_mov_b32 v3, v2
s_nop 1
v_permlane32_swap_b32 v2, v3
s_nop 1
v_max_f32 v2, v2, v3
v_mov_b32 v3, v2
s_nop 1
v_permlane16_swap_b32 v2, v3
s_nop 1
v_max_f32 v2, v2, v3
v_max_f32 v2, 0, v2
v_sub_f32 v176, v176, v2
v_sub_f32 v177, v177, v2
v_sub_f32 v178, v178, v2
v_sub_f32 v179, v179, v2
v_sub_f32 v188, v188, v2
v_sub_f32 v189, v189, v2
v_sub_f32 v190, v190, v2
v_sub_f32 v191, v191, v2
v_sub_f32 v212, v212, v2
v_sub_f32 v213, v213, v2
v_sub_f32 v214, v214, v2
v_sub_f32 v215, v215, v2
v_exp_f32 v3, -v2
s_nop 0
v_mul_f32 v20, v20, v3
v_mul_f32 v21, v21, v3
v_mul_f32 v22, v22, v3
v_mul_f32 v23, v23, v3
v_mul_f32 v32, v32, v3
v_mul_f32 v33, v33, v3
v_mul_f32 v34, v34, v3
v_mul_f32 v35, v35, v3
v_mul_f32 v44, v44, v3
v_mul_f32 v45, v45, v3
v_mul_f32 v46, v46, v3
v_mul_f32 v47, v47, v3
v_mul_f32 v56, v56, v3
v_mul_f32 v57, v57, v3
v_mul_f32 v58, v58, v3
v_mul_f32 v59, v59, v3
v_mul_f32 v68, v68, v3
v_mul_f32 v69, v69, v3
v_mul_f32 v70, v70, v3
v_mul_f32 v71, v71, v3
v_mul_f32 v80, v80, v3
v_mul_f32 v81, v81, v3
v_mul_f32 v82, v82, v3
v_mul_f32 v83, v83, v3
v_mul_f32 v92, v92, v3
v_mul_f32 v93, v93, v3
v_mul_f32 v94, v94, v3
v_mul_f32 v95, v95, v3
v_mul_f32 v104, v104, v3
v_mul_f32 v105, v105, v3
v_mul_f32 v106, v106, v3
v_mul_f32 v107, v107, v3
v_mul_f32 v116, v116, v3
v_mul_f32 v117, v117, v3
v_mul_f32 v118, v118, v3
v_mul_f32 v119, v119, v3
v_max3_f32 v2, v180, v181, v182
v_max3_f32 v2, v2, v183, v192
v_max3_f32 v2, v2, v193, v194
v_max_f32 v2, v2, v195
v_mov_b32 v3, v2
s_nop 1
v_permlane32_swap_b32 v2, v3
s_nop 1
v_max_f32 v2, v2, v3
v_mov_b32 v3, v2
s_nop 1
v_permlane16_swap_b32 v2, v3
s_nop 1
v_max_f32 v2, v2, v3
v_max_f32 v2, 0, v2
v_sub_f32 v180, v180, v2
v_sub_f32 v181, v181, v2
v_sub_f32 v182, v182, v2
v_sub_f32 v183, v183, v2
v_sub_f32 v192, v192, v2
v_sub_f32 v193, v193, v2
v_sub_f32 v194, v194, v2
v_sub_f32 v195, v195, v2
v_sub_f32 v216, v216, v2
v_sub_f32 v217, v217, v2
v_sub_f32 v218, v218, v2
v_sub_f32 v219, v219, v2
v_exp_f32 v3, -v2
s_nop 0
v_mul_f32 v24, v24, v3
v_mul_f32 v25, v25, v3
v_mul_f32 v26, v26, v3
v_mul_f32 v27, v27, v3
v_mul_f32 v36, v36, v3
v_mul_f32 v37, v37, v3
v_mul_f32 v38, v38, v3
v_mul_f32 v39, v39, v3
v_mul_f32 v48, v48, v3
v_mul_f32 v49, v49, v3
v_mul_f32 v50, v50, v3
v_mul_f32 v51, v51, v3
v_mul_f32 v60, v60, v3
v_mul_f32 v61, v61, v3
v_mul_f32 v62, v62, v3
v_mul_f32 v63, v63, v3
v_mul_f32 v72, v72, v3
v_mul_f32 v73, v73, v3
v_mul_f32 v74, v74, v3
v_mul_f32 v75, v75, v3
v_mul_f32 v84, v84, v3
v_mul_f32 v85, v85, v3
v_mul_f32 v86, v86, v3
v_mul_f32 v87, v87, v3
v_mul_f32 v96, v96, v3
v_mul_f32 v97, v97, v3
v_mul_f32 v98, v98, v3
v_mul_f32 v99, v99, v3
v_mul_f32 v108, v108, v3
v_mul_f32 v109, v109, v3
v_mul_f32 v110, v110, v3
v_mul_f32 v111, v111, v3
v_mul_f32 v120, v120, v3
v_mul_f32 v121, v121, v3
v_mul_f32 v122, v122, v3
v_mul_f32 v123, v123, v3
v_max3_f32 v2, v184, v185, v186
v_max3_f32 v2, v2, v187, v196
v_max3_f32 v2, v2, v197, v198
v_max_f32 v2, v2, v199
v_mov_b32 v3, v2
s_nop 1
v_permlane32_swap_b32 v2, v3
s_nop 1
v_max_f32 v2, v2, v3
v_mov_b32 v3, v2
s_nop 1
v_permlane16_swap_b32 v2, v3
s_nop 1
v_max_f32 v2, v2, v3
v_max_f32 v2, 0, v2
v_sub_f32 v184, v184, v2
v_sub_f32 v185, v185, v2
v_sub_f32 v186, v186, v2
v_sub_f32 v187, v187, v2
v_sub_f32 v196, v196, v2
v_sub_f32 v197, v197, v2
v_sub_f32 v198, v198, v2
v_sub_f32 v199, v199, v2
v_sub_f32 v220, v220, v2
v_sub_f32 v221, v221, v2
v_sub_f32 v222, v222, v2
v_sub_f32 v223, v223, v2
v_exp_f32 v3, -v2
s_nop 0
v_mul_f32 v28, v28, v3
v_mul_f32 v29, v29, v3
v_mul_f32 v30, v30, v3
v_mul_f32 v31, v31, v3
v_mul_f32 v40, v40, v3
v_mul_f32 v41, v41, v3
v_mul_f32 v42, v42, v3
v_mul_f32 v43, v43, v3
v_mul_f32 v52, v52, v3
v_mul_f32 v53, v53, v3
v_mul_f32 v54, v54, v3
v_mul_f32 v55, v55, v3
v_mul_f32 v64, v64, v3
v_mul_f32 v65, v65, v3
v_mul_f32 v66, v66, v3
v_mul_f32 v67, v67, v3
v_mul_f32 v76, v76, v3
v_mul_f32 v77, v77, v3
v_mul_f32 v78, v78, v3
v_mul_f32 v79, v79, v3
v_mul_f32 v88, v88, v3
v_mul_f32 v89, v89, v3
v_mul_f32 v90, v90, v3
v_mul_f32 v91, v91, v3
v_mul_f32 v100, v100, v3
v_mul_f32 v101, v101, v3
v_mul_f32 v102, v102, v3
v_mul_f32 v103, v103, v3
v_mul_f32 v112, v112, v3
v_mul_f32 v113, v113, v3
v_mul_f32 v114, v114, v3
v_mul_f32 v115, v115, v3
v_mul_f32 v124, v124, v3
v_mul_f32 v125, v125, v3
v_mul_f32 v126, v126, v3
v_mul_f32 v127, v127, v3
v_exp_f32 v176, v176
v_exp_f32 v177, v177
v_exp_f32 v178, v178
v_exp_f32 v179, v179
v_exp_f32 v188, v188
v_exp_f32 v189, v189
v_exp_f32 v190, v190
v_exp_f32 v191, v191
v_exp_f32 v180, v180
v_exp_f32 v181, v181
v_exp_f32 v182, v182
v_exp_f32 v183, v183
v_exp_f32 v192, v192
v_exp_f32 v193, v193
v_exp_f32 v194, v194
v_exp_f32 v195, v195
v_exp_f32 v184, v184
v_exp_f32 v185, v185
v_exp_f32 v186, v186
v_exp_f32 v187, v187
v_exp_f32 v196, v196
v_exp_f32 v197, v197
v_exp_f32 v198, v198
v_exp_f32 v199, v199
s_nop 0
v_cvt_pk_bf16_f32 v200, v176, v177
v_cvt_pk_bf16_f32 v201, v178, v179
v_cvt_pk_bf16_f32 v202, v188, v189
v_cvt_pk_bf16_f32 v203, v190, v191
v_cvt_pk_bf16_f32 v204, v180, v181
v_cvt_pk_bf16_f32 v205, v182, v183
v_cvt_pk_bf16_f32 v206, v192, v193
v_cvt_pk_bf16_f32 v207, v194, v195
v_cvt_pk_bf16_f32 v208, v184, v185
v_cvt_pk_bf16_f32 v209, v186, v187
v_cvt_pk_bf16_f32 v210, v196, v197
v_cvt_pk_bf16_f32 v211, v198, v199
s_waitcnt vmcnt(8)
s_barrier
s_add_u32 m0, s27, 8704
s_add_u32 s36, s29, 73728
buffer_load_dwordx4 v12, s[12:15], s36 offen nt lds
s_add_u32 m0, s27, 9792
s_add_u32 s36, s29, 74752
buffer_load_dwordx4 v12, s[12:15], s36 offen nt lds
s_add_u32 m0, s28, 17408
s_add_u32 s36, s33, 65536
buffer_load_dwordx4 v13, s[16:19], s36 offen nt lds
s_add_u32 m0, s28, 18464
s_add_u32 s36, s33, 65792
buffer_load_dwordx4 v13, s[16:19], s36 offen nt lds
ds_read_b128 v[224:227], v10 offset:34816
ds_read_b128 v[228:231], v10 offset:34880
ds_read_b128 v[232:235], v10 offset:34944
ds_read_b128 v[236:239], v10 offset:35008
ds_read_b128 v[240:243], v10 offset:39168
ds_read_b128 v[244:247], v10 offset:39232
ds_read_b128 v[248:251], v10 offset:39296
ds_read_b128 v[252:255], v10 offset:39360
s_branch W3_R5_back
W3_R6:
s_waitcnt lgkmcnt(0)
v_mfma_f32_16x16x32_bf16 v[20:23], v[224:227], v[200:203], v[20:23]
v_mfma_f32_16x16x32_bf16 v[32:35], v[228:231], v[200:203], v[32:35]
v_mfma_f32_16x16x32_bf16 v[44:47], v[232:235], v[200:203], v[44:47]
v_mfma_f32_16x16x32_bf16 v[56:59], v[236:239], v[200:203], v[56:59]
v_mfma_f32_16x16x32_bf16 v[68:71], v[240:243], v[200:203], v[68:71]
v_mfma_f32_16x16x32_bf16 v[80:83], v[244:247], v[200:203], v[80:83]
v_mfma_f32_16x16x32_bf16 v[92:95], v[248:251], v[200:203], v[92:95]
v_mfma_f32_16x16x32_bf16 v[104:107], v[252:255], v[200:203], v[104:107]
v_mfma_f32_16x16x32_bf16 v[116:119], v[16:19], v[200:203], v[116:119]
v_mfma_f32_16x16x32_bf16 v[24:27], v[224:227], v[204:207], v[24:27]
v_mfma_f32_16x16x32_bf16 v[36:39], v[228:231], v[204:207], v[36:39]
v_mfma_f32_16x16x32_bf16 v[48:51], v[232:235], v[204:207], v[48:51]
v_mfma_f32_16x16x32_bf16 v[60:63], v[236:239], v[204:207], v[60:63]
v_mfma_f32_16x16x32_bf16 v[72:75], v[240:243], v[204:207], v[72:75]
v_mfma_f32_16x16x32_bf16 v[84:87], v[244:247], v[204:207], v[84:87]
v_mfma_f32_16x16x32_bf16 v[96:99], v[248:251], v[204:207], v[96:99]
v_mfma_f32_16x16x32_bf16 v[108:111], v[252:255], v[204:207], v[108:111]
v_mfma_f32_16x16x32_bf16 v[120:123], v[16:19], v[204:207], v[120:123]
v_mfma_f32_16x16x32_bf16 v[28:31], v[224:227], v[208:211], v[28:31]
v_mfma_f32_16x16x32_bf16 v[40:43], v[228:231], v[208:211], v[40:43]
v_mfma_f32_16x16x32_bf16 v[52:55], v[232:235], v[208:211], v[52:55]
v_mfma_f32_16x16x32_bf16 v[64:67], v[236:239], v[208:211], v[64:67]
v_mfma_f32_16x16x32_bf16 v[76:79], v[240:243], v[208:211], v[76:79]
v_mfma_f32_16x16x32_bf16 v[88:91], v[244:247], v[208:211], v[88:91]
v_mfma_f32_16x16x32_bf16 v[100:103], v[248:251], v[208:211], v[100:103]
v_mfma_f32_16x16x32_bf16 v[112:115], v[252:255], v[208:211], v[112:115]
v_mfma_f32_16x16x32_bf16 v[124:127], v[16:19], v[208:211], v[124:127]
s_nop 15
v_max3_f32 v2, v176, v177, v178
v_max3_f32 v2, v2, v179, v188
v_max3_f32 v2, v2, v189, v190
v_max_f32 v2, v2, v191
v_mov_b32 v3, v2
s_nop 1
v_permlane32_swap_b32 v2, v3
s_nop 1
v_max_f32 v2, v2, v3
v_mov_b32 v3, v2
s_nop 1
v_permlane16_swap_b32 v2, v3
s_nop 1
v_max_f32 v2, v2, v3
v_max_f32 v2, 0, v2
v_sub_f32 v176, v176, v2
v_sub_f32 v177, v177, v2
v_sub_f32 v178, v178, v2
v_sub_f32 v179, v179, v2
v_sub_f32 v188, v188, v2
v_sub_f32 v189, v189, v2
v_sub_f32 v190, v190, v2
v_sub_f32 v191, v191, v2
v_sub_f32 v212, v212, v2
v_sub_f32 v213, v213, v2
v_sub_f32 v214, v214, v2
v_sub_f32 v215, v215, v2
v_exp_f32 v3, -v2
s_nop 0
v_mul_f32 v20, v20, v3
v_mul_f32 v21, v21, v3
v_mul_f32 v22, v22, v3
v_mul_f32 v23, v23, v3
v_mul_f32 v32, v32, v3
v_mul_f32 v33, v33, v3
v_mul_f32 v34, v34, v3
v_mul_f32 v35, v35, v3
v_mul_f32 v44, v44, v3
v_mul_f32 v45, v45, v3
v_mul_f32 v46, v46, v3
v_mul_f32 v47, v47, v3
v_mul_f32 v56, v56, v3
v_mul_f32 v57, v57, v3
v_mul_f32 v58, v58, v3
v_mul_f32 v59, v59, v3
v_mul_f32 v68, v68, v3
v_mul_f32 v69, v69, v3
v_mul_f32 v70, v70, v3
v_mul_f32 v71, v71, v3
v_mul_f32 v80, v80, v3
v_mul_f32 v81, v81, v3
v_mul_f32 v82, v82, v3
v_mul_f32 v83, v83, v3
v_mul_f32 v92, v92, v3
v_mul_f32 v93, v93, v3
v_mul_f32 v94, v94, v3
v_mul_f32 v95, v95, v3
v_mul_f32 v104, v104, v3
v_mul_f32 v105, v105, v3
v_mul_f32 v106, v106, v3
v_mul_f32 v107, v107, v3
v_mul_f32 v116, v116, v3
v_mul_f32 v117, v117, v3
v_mul_f32 v118, v118, v3
v_mul_f32 v119, v119, v3
v_max3_f32 v2, v180, v181, v182
v_max3_f32 v2, v2, v183, v192
v_max3_f32 v2, v2, v193, v194
v_max_f32 v2, v2, v195
v_mov_b32 v3, v2
s_nop 1
v_permlane32_swap_b32 v2, v3
s_nop 1
v_max_f32 v2, v2, v3
v_mov_b32 v3, v2
s_nop 1
v_permlane16_swap_b32 v2, v3
s_nop 1
v_max_f32 v2, v2, v3
v_max_f32 v2, 0, v2
v_sub_f32 v180, v180, v2
v_sub_f32 v181, v181, v2
v_sub_f32 v182, v182, v2
v_sub_f32 v183, v183, v2
v_sub_f32 v192, v192, v2
v_sub_f32 v193, v193, v2
v_sub_f32 v194, v194, v2
v_sub_f32 v195, v195, v2
v_sub_f32 v216, v216, v2
v_sub_f32 v217, v217, v2
v_sub_f32 v218, v218, v2
v_sub_f32 v219, v219, v2
v_exp_f32 v3, -v2
s_nop 0
v_mul_f32 v24, v24, v3
v_mul_f32 v25, v25, v3
v_mul_f32 v26, v26, v3
v_mul_f32 v27, v27, v3
v_mul_f32 v36, v36, v3
v_mul_f32 v37, v37, v3
v_mul_f32 v38, v38, v3
v_mul_f32 v39, v39, v3
v_mul_f32 v48, v48, v3
v_mul_f32 v49, v49, v3
v_mul_f32 v50, v50, v3
v_mul_f32 v51, v51, v3
v_mul_f32 v60, v60, v3
v_mul_f32 v61, v61, v3
v_mul_f32 v62, v62, v3
v_mul_f32 v63, v63, v3
v_mul_f32 v72, v72, v3
v_mul_f32 v73, v73, v3
v_mul_f32 v74, v74, v3
v_mul_f32 v75, v75, v3
v_mul_f32 v84, v84, v3
v_mul_f32 v85, v85, v3
v_mul_f32 v86, v86, v3
v_mul_f32 v87, v87, v3
v_mul_f32 v96, v96, v3
v_mul_f32 v97, v97, v3
v_mul_f32 v98, v98, v3
v_mul_f32 v99, v99, v3
v_mul_f32 v108, v108, v3
v_mul_f32 v109, v109, v3
v_mul_f32 v110, v110, v3
v_mul_f32 v111, v111, v3
v_mul_f32 v120, v120, v3
v_mul_f32 v121, v121, v3
v_mul_f32 v122, v122, v3
v_mul_f32 v123, v123, v3
v_max3_f32 v2, v184, v185, v186
v_max3_f32 v2, v2, v187, v196
v_max3_f32 v2, v2, v197, v198
v_max_f32 v2, v2, v199
v_mov_b32 v3, v2
s_nop 1
v_permlane32_swap_b32 v2, v3
s_nop 1
v_max_f32 v2, v2, v3
v_mov_b32 v3, v2
s_nop 1
v_permlane16_swap_b32 v2, v3
s_nop 1
v_max_f32 v2, v2, v3
v_max_f32 v2, 0, v2
v_sub_f32 v184, v184, v2
v_sub_f32 v185, v185, v2
v_sub_f32 v186, v186, v2
v_sub_f32 v187, v187, v2
v_sub_f32 v196, v196, v2
v_sub_f32 v197, v197, v2
v_sub_f32 v198, v198, v2
v_sub_f32 v199, v199, v2
v_sub_f32 v220, v220, v2
v_sub_f32 v221, v221, v2
v_sub_f32 v222, v222, v2
v_sub_f32 v223, v223, v2
v_exp_f32 v3, -v2
s_nop 0
v_mul_f32 v28, v28, v3
v_mul_f32 v29, v29, v3
v_mul_f32 v30, v30, v3
v_mul_f32 v31, v31, v3
v_mul_f32 v40, v40, v3
v_mul_f32 v41, v41, v3
v_mul_f32 v42, v42, v3
v_mul_f32 v43, v43, v3
v_mul_f32 v52, v52, v3
v_mul_f32 v53, v53, v3
v_mul_f32 v54, v54, v3
v_mul_f32 v55, v55, v3
v_mul_f32 v64, v64, v3
v_mul_f32 v65, v65, v3
v_mul_f32 v66, v66, v3
v_mul_f32 v67, v67, v3
v_mul_f32 v76, v76, v3
v_mul_f32 v77, v77, v3
v_mul_f32 v78, v78, v3
v_mul_f32 v79, v79, v3
v_mul_f32 v88, v88, v3
v_mul_f32 v89, v89, v3
v_mul_f32 v90, v90, v3
v_mul_f32 v91, v91, v3
v_mul_f32 v100, v100, v3
v_mul_f32 v101, v101, v3
v_mul_f32 v102, v102, v3
v_mul_f32 v103, v103, v3
v_mul_f32 v112, v112, v3
v_mul_f32 v113, v113, v3
v_mul_f32 v114, v114, v3
v_mul_f32 v115, v115, v3
v_mul_f32 v124, v124, v3
v_mul_f32 v125, v125, v3
v_mul_f32 v126, v126, v3
v_mul_f32 v127, v127, v3
v_exp_f32 v176, v176
v_exp_f32 v177, v177
v_exp_f32 v178, v178
v_exp_f32 v179, v179
v_exp_f32 v188, v188
v_exp_f32 v189, v189
v_exp_f32 v190, v190
v_exp_f32 v191, v191
v_exp_f32 v180, v180
v_exp_f32 v181, v181
v_exp_f32 v182, v182
v_exp_f32 v183, v183
v_exp_f32 v192, v192
v_exp_f32 v193, v193
v_exp_f32 v194, v194
v_exp_f32 v195, v195
v_exp_f32 v184, v184
v_exp_f32 v185, v185
v_exp_f32 v186, v186
v_exp_f32 v187, v187
v_exp_f32 v196, v196
v_exp_f32 v197, v197
v_exp_f32 v198, v198
v_exp_f32 v199, v199
s_nop 0
v_cvt_pk_bf16_f32 v200, v176, v177
v_cvt_pk_bf16_f32 v201, v178, v179
v_cvt_pk_bf16_f32 v202, v188, v189
v_cvt_pk_bf16_f32 v203, v190, v191
v_cvt_pk_bf16_f32 v204, v180, v181
v_cvt_pk_bf16_f32 v205, v182, v183
v_cvt_pk_bf16_f32 v206, v192, v193
v_cvt_pk_bf16_f32 v207, v194, v195
v_cvt_pk_bf16_f32 v208, v184, v185
v_cvt_pk_bf16_f32 v209, v186, v187
v_cvt_pk_bf16_f32 v210, v196, v197
v_cvt_pk_bf16_f32 v211, v198, v199
s_waitcnt vmcnt(8)
s_barrier
s_add_u32 m0, s27, 34816
s_add_u32 s36, s29, 81920
buffer_load_dwordx4 v12, s[12:15], s36 offen nt lds
s_add_u32 m0, s27, 35904
s_add_u32 s36, s29, 82944
buffer_load_dwordx4 v12, s[12:15], s36 offen nt lds
s_add_u32 m0, s28, 25856
s_add_u32 s36, s33, 73728
buffer_load_dwordx4 v13, s[16:19], s36 offen nt lds
s_add_u32 m0, s28, 26912
s_add_u32 s36, s33, 73984
buffer_load_dwordx4 v13, s[16:19], s36 offen nt lds
ds_read_b128 v[224:227], v10 offset:43520
ds_read_b128 v[228:231], v10 offset:43584
ds_read_b128 v[232:235], v10 offset:43648
ds_read_b128 v[236:239], v10 offset:43712
ds_read_b128 v[240:243], v10 offset:47872
ds_read_b128 v[244:247], v10 offset:47936
ds_read_b128 v[248:251], v10 offset:48000
ds_read_b128 v[252:255], v10 offset:48064
s_branch W3_R6_back
W3_R7:
s_waitcnt lgkmcnt(0)
v_mfma_f32_16x16x32_bf16 v[20:23], v[224:227], v[200:203], v[20:23]
v_mfma_f32_16x16x32_bf16 v[32:35], v[228:231], v[200:203], v[32:35]
v_mfma_f32_16x16x32_bf16 v[44:47], v[232:235], v[200:203], v[44:47]
v_mfma_f32_16x16x32_bf16 v[56:59], v[236:239], v[200:203], v[56:59]
v_mfma_f32_16x16x32_bf16 v[68:71], v[240:243], v[200:203], v[68:71]
v_mfma_f32_16x16x32_bf16 v[80:83], v[244:247], v[200:203], v[80:83]
v_mfma_f32_16x16x32_bf16 v[92:95], v[248:251], v[200:203], v[92:95]
v_mfma_f32_16x16x32_bf16 v[104:107], v[252:255], v[200:203], v[104:107]
v_mfma_f32_16x16x32_bf16 v[116:119], v[16:19], v[200:203], v[116:119]
v_mfma_f32_16x16x32_bf16 v[24:27], v[224:227], v[204:207], v[24:27]
v_mfma_f32_16x16x32_bf16 v[36:39], v[228:231], v[204:207], v[36:39]
v_mfma_f32_16x16x32_bf16 v[48:51], v[232:235], v[204:207], v[48:51]
v_mfma_f32_16x16x32_bf16 v[60:63], v[236:239], v[204:207], v[60:63]
v_mfma_f32_16x16x32_bf16 v[72:75], v[240:243], v[204:207], v[72:75]
v_mfma_f32_16x16x32_bf16 v[84:87], v[244:247], v[204:207], v[84:87]
v_mfma_f32_16x16x32_bf16 v[96:99], v[248:251], v[204:207], v[96:99]
v_mfma_f32_16x16x32_bf16 v[108:111], v[252:255], v[204:207], v[108:111]
v_mfma_f32_16x16x32_bf16 v[120:123], v[16:19], v[204:207], v[120:123]
v_mfma_f32_16x16x32_bf16 v[28:31], v[224:227], v[208:211], v[28:31]
v_mfma_f32_16x16x32_bf16 v[40:43], v[228:231], v[208:211], v[40:43]
v_mfma_f32_16x16x32_bf16 v[52:55], v[232:235], v[208:211], v[52:55]
v_mfma_f32_16x16x32_bf16 v[64:67], v[236:239], v[208:211], v[64:67]
v_mfma_f32_16x16x32_bf16 v[76:79], v[240:243], v[208:211], v[76:79]
v_mfma_f32_16x16x32_bf16 v[88:91], v[244:247], v[208:211], v[88:91]
v_mfma_f32_16x16x32_bf16 v[100:103], v[248:251], v[208:211], v[100:103]
v_mfma_f32_16x16x32_bf16 v[112:115], v[252:255], v[208:211], v[112:115]
v_mfma_f32_16x16x32_bf16 v[124:127], v[16:19], v[208:211], v[124:127]
s_nop 15
v_max3_f32 v2, v176, v177, v178
v_max3_f32 v2, v2, v179, v188
v_max3_f32 v2, v2, v189, v190
v_max_f32 v2, v2, v191
v_mov_b32 v3, v2
s_nop 1
v_permlane32_swap_b32 v2, v3
s_nop 1
v_max_f32 v2, v2, v3
v_mov_b32 v3, v2
s_nop 1
v_permlane16_swap_b32 v2, v3
s_nop 1
v_max_f32 v2, v2, v3
v_max_f32 v2, 0, v2
v_sub_f32 v176, v176, v2
v_sub_f32 v177, v177, v2
v_sub_f32 v178, v178, v2
v_sub_f32 v179, v179, v2
v_sub_f32 v188, v188, v2
v_sub_f32 v189, v189, v2
v_sub_f32 v190, v190, v2
v_sub_f32 v191, v191, v2
v_sub_f32 v212, v212, v2
v_sub_f32 v213, v213, v2
v_sub_f32 v214, v214, v2
v_sub_f32 v215, v215, v2
v_exp_f32 v3, -v2
s_nop 0
v_mul_f32 v20, v20, v3
v_mul_f32 v21, v21, v3
v_mul_f32 v22, v22, v3
v_mul_f32 v23, v23, v3
v_mul_f32 v32, v32, v3
v_mul_f32 v33, v33, v3
v_mul_f32 v34, v34, v3
v_mul_f32 v35, v35, v3
v_mul_f32 v44, v44, v3
v_mul_f32 v45, v45, v3
v_mul_f32 v46, v46, v3
v_mul_f32 v47, v47, v3
v_mul_f32 v56, v56, v3
v_mul_f32 v57, v57, v3
v_mul_f32 v58, v58, v3
v_mul_f32 v59, v59, v3
v_mul_f32 v68, v68, v3
v_mul_f32 v69, v69, v3
v_mul_f32 v70, v70, v3
v_mul_f32 v71, v71, v3
v_mul_f32 v80, v80, v3
v_mul_f32 v81, v81, v3
v_mul_f32 v82, v82, v3
v_mul_f32 v83, v83, v3
v_mul_f32 v92, v92, v3
v_mul_f32 v93, v93, v3
v_mul_f32 v94, v94, v3
v_mul_f32 v95, v95, v3
v_mul_f32 v104, v104, v3
v_mul_f32 v105, v105, v3
v_mul_f32 v106, v106, v3
v_mul_f32 v107, v107, v3
v_mul_f32 v116, v116, v3
v_mul_f32 v117, v117, v3
v_mul_f32 v118, v118, v3
v_mul_f32 v119, v119, v3
v_max3_f32 v2, v180, v181, v182
v_max3_f32 v2, v2, v183, v192
v_max3_f32 v2, v2, v193, v194
v_max_f32 v2, v2, v195
v_mov_b32 v3, v2
s_nop 1
v_permlane32_swap_b32 v2, v3
s_nop 1
v_max_f32 v2, v2, v3
v_mov_b32 v3, v2
s_nop 1
v_permlane16_swap_b32 v2, v3
s_nop 1
v_max_f32 v2, v2, v3
v_max_f32 v2, 0, v2
v_sub_f32 v180, v180, v2
v_sub_f32 v181, v181, v2
v_sub_f32 v182, v182, v2
v_sub_f32 v183, v183, v2
v_sub_f32 v192, v192, v2
v_sub_f32 v193, v193, v2
v_sub_f32 v194, v194, v2
v_sub_f32 v195, v195, v2
v_sub_f32 v216, v216, v2
v_sub_f32 v217, v217, v2
v_sub_f32 v218, v218, v2
v_sub_f32 v219, v219, v2
v_exp_f32 v3, -v2
s_nop 0
v_mul_f32 v24, v24, v3
v_mul_f32 v25, v25, v3
v_mul_f32 v26, v26, v3
v_mul_f32 v27, v27, v3
v_mul_f32 v36, v36, v3
v_mul_f32 v37, v37, v3
v_mul_f32 v38, v38, v3
v_mul_f32 v39, v39, v3
v_mul_f32 v48, v48, v3
v_mul_f32 v49, v49, v3
v_mul_f32 v50, v50, v3
v_mul_f32 v51, v51, v3
v_mul_f32 v60, v60, v3
v_mul_f32 v61, v61, v3
v_mul_f32 v62, v62, v3
v_mul_f32 v63, v63, v3
v_mul_f32 v72, v72, v3
v_mul_f32 v73, v73, v3
v_mul_f32 v74, v74, v3
v_mul_f32 v75, v75, v3
v_mul_f32 v84, v84, v3
v_mul_f32 v85, v85, v3
v_mul_f32 v86, v86, v3
v_mul_f32 v87, v87, v3
v_mul_f32 v96, v96, v3
v_mul_f32 v97, v97, v3
v_mul_f32 v98, v98, v3
v_mul_f32 v99, v99, v3
v_mul_f32 v108, v108, v3
v_mul_f32 v109, v109, v3
v_mul_f32 v110, v110, v3
v_mul_f32 v111, v111, v3
v_mul_f32 v120, v120, v3
v_mul_f32 v121, v121, v3
v_mul_f32 v122, v122, v3
v_mul_f32 v123, v123, v3
v_max3_f32 v2, v184, v185, v186
v_max3_f32 v2, v2, v187, v196
v_max3_f32 v2, v2, v197, v198
v_max_f32 v2, v2, v199
v_mov_b32 v3, v2
s_nop 1
v_permlane32_swap_b32 v2, v3
s_nop 1
v_max_f32 v2, v2, v3
v_mov_b32 v3, v2
s_nop 1
v_permlane16_swap_b32 v2, v3
s_nop 1
v_max_f32 v2, v2, v3
v_max_f32 v2, 0, v2
v_sub_f32 v184, v184, v2
v_sub_f32 v185, v185, v2
v_sub_f32 v186, v186, v2
v_sub_f32 v187, v187, v2
v_sub_f32 v196, v196, v2
v_sub_f32 v197, v197, v2
v_sub_f32 v198, v198, v2
v_sub_f32 v199, v199, v2
v_sub_f32 v220, v220, v2
v_sub_f32 v221, v221, v2
v_sub_f32 v222, v222, v2
v_sub_f32 v223, v223, v2
v_exp_f32 v3, -v2
s_nop 0
v_mul_f32 v28, v28, v3
v_mul_f32 v29, v29, v3
v_mul_f32 v30, v30, v3
v_mul_f32 v31, v31, v3
v_mul_f32 v40, v40, v3
v_mul_f32 v41, v41, v3
v_mul_f32 v42, v42, v3
v_mul_f32 v43, v43, v3
v_mul_f32 v52, v52, v3
v_mul_f32 v53, v53, v3
v_mul_f32 v54, v54, v3
v_mul_f32 v55, v55, v3
v_mul_f32 v64, v64, v3
v_mul_f32 v65, v65, v3
v_mul_f32 v66, v66, v3
v_mul_f32 v67, v67, v3
v_mul_f32 v76, v76, v3
v_mul_f32 v77, v77, v3
v_mul_f32 v78, v78, v3
v_mul_f32 v79, v79, v3
v_mul_f32 v88, v88, v3
v_mul_f32 v89, v89, v3
v_mul_f32 v90, v90, v3
v_mul_f32 v91, v91, v3
v_mul_f32 v100, v100, v3
v_mul_f32 v101, v101, v3
v_mul_f32 v102, v102, v3
v_mul_f32 v103, v103, v3
v_mul_f32 v112, v112, v3
v_mul_f32 v113, v113, v3
v_mul_f32 v114, v114, v3
v_mul_f32 v115, v115, v3
v_mul_f32 v124, v124, v3
v_mul_f32 v125, v125, v3
v_mul_f32 v126, v126, v3
v_mul_f32 v127, v127, v3
v_exp_f32 v176, v176
v_exp_f32 v177, v177
v_exp_f32 v178, v178
v_exp_f32 v179, v179
v_exp_f32 v188, v188
v_exp_f32 v189, v189
v_exp_f32 v190, v190
v_exp_f32 v191, v191
v_exp_f32 v180, v180
v_exp_f32 v181, v181
v_exp_f32 v182, v182
v_exp_f32 v183, v183
v_exp_f32 v192, v192
v_exp_f32 v193, v193
v_exp_f32 v194, v194
v_exp_f32 v195, v195
v_exp_f32 v184, v184
v_exp_f32 v185, v185
v_exp_f32 v186, v186
v_exp_f32 v187, v187
v_exp_f32 v196, v196
v_exp_f32 v197, v197
v_exp_f32 v198, v198
v_exp_f32 v199, v199
s_nop 0
v_cvt_pk_bf16_f32 v200, v176, v177
v_cvt_pk_bf16_f32 v201, v178, v179
v_cvt_pk_bf16_f32 v202, v188, v189
v_cvt_pk_bf16_f32 v203, v190, v191
v_cvt_pk_bf16_f32 v204, v180, v181
v_cvt_pk_bf16_f32 v205, v182, v183
v_cvt_pk_bf16_f32 v206, v192, v193
v_cvt_pk_bf16_f32 v207, v194, v195
v_cvt_pk_bf16_f32 v208, v184, v185
v_cvt_pk_bf16_f32 v209, v186, v187
v_cvt_pk_bf16_f32 v210, v196, v197
v_cvt_pk_bf16_f32 v211, v198, v199
s_waitcnt vmcnt(8)
s_barrier
s_add_u32 m0, s27, 43520
s_add_u32 s36, s29, 90112
buffer_load_dwordx4 v12, s[12:15], s36 offen nt lds
s_add_u32 m0, s27, 44608
s_add_u32 s36, s29, 91136
buffer_load_dwordx4 v12, s[12:15], s36 offen nt lds
s_add_u32 m0, s28, 52224
s_add_u32 s36, s33, 81920
buffer_load_dwordx4 v13, s[16:19], s36 offen nt lds
s_add_u32 m0, s28, 53280
s_add_u32 s36, s33, 82176
buffer_load_dwordx4 v13, s[16:19], s36 offen nt lds
ds_read_b128 v[224:227], v10 offset:0
ds_read_b128 v[228:231], v10 offset:64
ds_read_b128 v[232:235], v10 offset:128
ds_read_b128 v[236:239], v10 offset:192
ds_read_b128 v[240:243], v10 offset:4352
ds_read_b128 v[244:247], v10 offset:4416
ds_read_b128 v[248:251], v10 offset:4480
ds_read_b128 v[252:255], v10 offset:4544
s_branch W3_R7_back
W3_R8:
s_waitcnt lgkmcnt(0)
v_mfma_f32_16x16x32_bf16 v[20:23], v[224:227], v[200:203], v[20:23]
v_mfma_f32_16x16x32_bf16 v[32:35], v[228:231], v[200:203], v[32:35]
v_mfma_f32_16x16x32_bf16 v[44:47], v[232:235], v[200:203], v[44:47]
v_mfma_f32_16x16x32_bf16 v[56:59], v[236:239], v[200:203], v[56:59]
v_mfma_f32_16x16x32_bf16 v[68:71], v[240:243], v[200:203], v[68:71]
v_mfma_f32_16x16x32_bf16 v[80:83], v[244:247], v[200:203], v[80:83]
v_mfma_f32_16x16x32_bf16 v[92:95], v[248:251], v[200:203], v[92:95]
v_mfma_f32_16x16x32_bf16 v[104:107], v[252:255], v[200:203], v[104:107]
v_mfma_f32_16x16x32_bf16 v[116:119], v[16:19], v[200:203], v[116:119]
v_mfma_f32_16x16x32_bf16 v[24:27], v[224:227], v[204:207], v[24:27]
v_mfma_f32_16x16x32_bf16 v[36:39], v[228:231], v[204:207], v[36:39]
v_mfma_f32_16x16x32_bf16 v[48:51], v[232:235], v[204:207], v[48:51]
v_mfma_f32_16x16x32_bf16 v[60:63], v[236:239], v[204:207], v[60:63]
v_mfma_f32_16x16x32_bf16 v[72:75], v[240:243], v[204:207], v[72:75]
v_mfma_f32_16x16x32_bf16 v[84:87], v[244:247], v[204:207], v[84:87]
v_mfma_f32_16x16x32_bf16 v[96:99], v[248:251], v[204:207], v[96:99]
v_mfma_f32_16x16x32_bf16 v[108:111], v[252:255], v[204:207], v[108:111]
v_mfma_f32_16x16x32_bf16 v[120:123], v[16:19], v[204:207], v[120:123]
v_mfma_f32_16x16x32_bf16 v[28:31], v[224:227], v[208:211], v[28:31]
v_mfma_f32_16x16x32_bf16 v[40:43], v[228:231], v[208:211], v[40:43]
v_mfma_f32_16x16x32_bf16 v[52:55], v[232:235], v[208:211], v[52:55]
v_mfma_f32_16x16x32_bf16 v[64:67], v[236:239], v[208:211], v[64:67]
v_mfma_f32_16x16x32_bf16 v[76:79], v[240:243], v[208:211], v[76:79]
v_mfma_f32_16x16x32_bf16 v[88:91], v[244:247], v[208:211], v[88:91]
v_mfma_f32_16x16x32_bf16 v[100:103], v[248:251], v[208:211], v[100:103]
v_mfma_f32_16x16x32_bf16 v[112:115], v[252:255], v[208:211], v[112:115]
v_mfma_f32_16x16x32_bf16 v[124:127], v[16:19], v[208:211], v[124:127]
s_nop 15
v_max3_f32 v2, v176, v177, v178
v_max3_f32 v2, v2, v179, v188
v_max3_f32 v2, v2, v189, v190
v_max_f32 v2, v2, v191
v_mov_b32 v3, v2
s_nop 1
v_permlane32_swap_b32 v2, v3
s_nop 1
v_max_f32 v2, v2, v3
v_mov_b32 v3, v2
s_nop 1
v_permlane16_swap_b32 v2, v3
s_nop 1
v_max_f32 v2, v2, v3
v_max_f32 v2, 0, v2
v_sub_f32 v176, v176, v2
v_sub_f32 v177, v177, v2
v_sub_f32 v178, v178, v2
v_sub_f32 v179, v179, v2
v_sub_f32 v188, v188, v2
v_sub_f32 v189, v189, v2
v_sub_f32 v190, v190, v2
v_sub_f32 v191, v191, v2
v_sub_f32 v212, v212, v2
v_sub_f32 v213, v213, v2
v_sub_f32 v214, v214, v2
v_sub_f32 v215, v215, v2
v_exp_f32 v3, -v2
s_nop 0
v_mul_f32 v20, v20, v3
v_mul_f32 v21, v21, v3
v_mul_f32 v22, v22, v3
v_mul_f32 v23, v23, v3
v_mul_f32 v32, v32, v3
v_mul_f32 v33, v33, v3
v_mul_f32 v34, v34, v3
v_mul_f32 v35, v35, v3
v_mul_f32 v44, v44, v3
v_mul_f32 v45, v45, v3
v_mul_f32 v46, v46, v3
v_mul_f32 v47, v47, v3
v_mul_f32 v56, v56, v3
v_mul_f32 v57, v57, v3
v_mul_f32 v58, v58, v3
v_mul_f32 v59, v59, v3
v_mul_f32 v68, v68, v3
v_mul_f32 v69, v69, v3
v_mul_f32 v70, v70, v3
v_mul_f32 v71, v71, v3
v_mul_f32 v80, v80, v3
v_mul_f32 v81, v81, v3
v_mul_f32 v82, v82, v3
v_mul_f32 v83, v83, v3
v_mul_f32 v92, v92, v3
v_mul_f32 v93, v93, v3
v_mul_f32 v94, v94, v3
v_mul_f32 v95, v95, v3
v_mul_f32 v104, v104, v3
v_mul_f32 v105, v105, v3
v_mul_f32 v106, v106, v3
v_mul_f32 v107, v107, v3
v_mul_f32 v116, v116, v3
v_mul_f32 v117, v117, v3
v_mul_f32 v118, v118, v3
v_mul_f32 v119, v119, v3
v_max3_f32 v2, v180, v181, v182
v_max3_f32 v2, v2, v183, v192
v_max3_f32 v2, v2, v193, v194
v_max_f32 v2, v2, v195
v_mov_b32 v3, v2
s_nop 1
v_permlane32_swap_b32 v2, v3
s_nop 1
v_max_f32 v2, v2, v3
v_mov_b32 v3, v2
s_nop 1
v_permlane16_swap_b32 v2, v3
s_nop 1
v_max_f32 v2, v2, v3
v_max_f32 v2, 0, v2
v_sub_f32 v180, v180, v2
v_sub_f32 v181, v181, v2
v_sub_f32 v182, v182, v2
v_sub_f32 v183, v183, v2
v_sub_f32 v192, v192, v2
v_sub_f32 v193, v193, v2
v_sub_f32 v194, v194, v2
v_sub_f32 v195, v195, v2
v_sub_f32 v216, v216, v2
v_sub_f32 v217, v217, v2
v_sub_f32 v218, v218, v2
v_sub_f32 v219, v219, v2
v_exp_f32 v3, -v2
s_nop 0
v_mul_f32 v24, v24, v3
v_mul_f32 v25, v25, v3
v_mul_f32 v26, v26, v3
v_mul_f32 v27, v27, v3
v_mul_f32 v36, v36, v3
v_mul_f32 v37, v37, v3
v_mul_f32 v38, v38, v3
v_mul_f32 v39, v39, v3
v_mul_f32 v48, v48, v3
v_mul_f32 v49, v49, v3
v_mul_f32 v50, v50, v3
v_mul_f32 v51, v51, v3
v_mul_f32 v60, v60, v3
v_mul_f32 v61, v61, v3
v_mul_f32 v62, v62, v3
v_mul_f32 v63, v63, v3
v_mul_f32 v72, v72, v3
v_mul_f32 v73, v73, v3
v_mul_f32 v74, v74, v3
v_mul_f32 v75, v75, v3
v_mul_f32 v84, v84, v3
v_mul_f32 v85, v85, v3
v_mul_f32 v86, v86, v3
v_mul_f32 v87, v87, v3
v_mul_f32 v96, v96, v3
v_mul_f32 v97, v97, v3
v_mul_f32 v98, v98, v3
v_mul_f32 v99, v99, v3
v_mul_f32 v108, v108, v3
v_mul_f32 v109, v109, v3
v_mul_f32 v110, v110, v3
v_mul_f32 v111, v111, v3
v_mul_f32 v120, v120, v3
v_mul_f32 v121, v121, v3
v_mul_f32 v122, v122, v3
v_mul_f32 v123, v123, v3
v_max3_f32 v2, v184, v185, v186
v_max3_f32 v2, v2, v187, v196
v_max3_f32 v2, v2, v197, v198
v_max_f32 v2, v2, v199
v_mov_b32 v3, v2
s_nop 1
v_permlane32_swap_b32 v2, v3
s_nop 1
v_max_f32 v2, v2, v3
v_mov_b32 v3, v2
s_nop 1
v_permlane16_swap_b32 v2, v3
s_nop 1
v_max_f32 v2, v2, v3
v_max_f32 v2, 0, v2
v_sub_f32 v184, v184, v2
v_sub_f32 v185, v185, v2
v_sub_f32 v186, v186, v2
v_sub_f32 v187, v187, v2
v_sub_f32 v196, v196, v2
v_sub_f32 v197, v197, v2
v_sub_f32 v198, v198, v2
v_sub_f32 v199, v199, v2
v_sub_f32 v220, v220, v2
v_sub_f32 v221, v221, v2
v_sub_f32 v222, v222, v2
v_sub_f32 v223, v223, v2
v_exp_f32 v3, -v2
s_nop 0
v_mul_f32 v28, v28, v3
v_mul_f32 v29, v29, v3
v_mul_f32 v30, v30, v3
v_mul_f32 v31, v31, v3
v_mul_f32 v40, v40, v3
v_mul_f32 v41, v41, v3
v_mul_f32 v42, v42, v3
v_mul_f32 v43, v43, v3
v_mul_f32 v52, v52, v3
v_mul_f32 v53, v53, v3
v_mul_f32 v54, v54, v3
v_mul_f32 v55, v55, v3
v_mul_f32 v64, v64, v3
v_mul_f32 v65, v65, v3
v_mul_f32 v66, v66, v3
v_mul_f32 v67, v67, v3
v_mul_f32 v76, v76, v3
v_mul_f32 v77, v77, v3
v_mul_f32 v78, v78, v3
v_mul_f32 v79, v79, v3
v_mul_f32 v88, v88, v3
v_mul_f32 v89, v89, v3
v_mul_f32 v90, v90, v3
v_mul_f32 v91, v91, v3
v_mul_f32 v100, v100, v3
v_mul_f32 v101, v101, v3
v_mul_f32 v102, v102, v3
v_mul_f32 v103, v103, v3
v_mul_f32 v112, v112, v3
v_mul_f32 v113, v113, v3
v_mul_f32 v114, v114, v3
v_mul_f32 v115, v115, v3
v_mul_f32 v124, v124, v3
v_mul_f32 v125, v125, v3
v_mul_f32 v126, v126, v3
v_mul_f32 v127, v127, v3
v_exp_f32 v176, v176
v_exp_f32 v177, v177
v_exp_f32 v178, v178
v_exp_f32 v179, v179
v_exp_f32 v188, v188
v_exp_f32 v189, v189
v_exp_f32 v190, v190
v_exp_f32 v191, v191
v_exp_f32 v180, v180
v_exp_f32 v181, v181
v_exp_f32 v182, v182
v_exp_f32 v183, v183
v_exp_f32 v192, v192
v_exp_f32 v193, v193
v_exp_f32 v194, v194
v_exp_f32 v195, v195
v_exp_f32 v184, v184
v_exp_f32 v185, v185
v_exp_f32 v186, v186
v_exp_f32 v187, v187
v_exp_f32 v196, v196
v_exp_f32 v197, v197
v_exp_f32 v198, v198
v_exp_f32 v199, v199
s_nop 0
v_cvt_pk_bf16_f32 v200, v176, v177
v_cvt_pk_bf16_f32 v201, v178, v179
v_cvt_pk_bf16_f32 v202, v188, v189
v_cvt_pk_bf16_f32 v203, v190, v191
v_cvt_pk_bf16_f32 v204, v180, v181
v_cvt_pk_bf16_f32 v205, v182, v183
v_cvt_pk_bf16_f32 v206, v192, v193
v_cvt_pk_bf16_f32 v207, v194, v195
v_cvt_pk_bf16_f32 v208, v184, v185
v_cvt_pk_bf16_f32 v209, v186, v187
v_cvt_pk_bf16_f32 v210, v196, v197
v_cvt_pk_bf16_f32 v211, v198, v199
s_waitcnt vmcnt(8)
s_barrier
s_add_u32 m0, s27, 0
s_add_u32 s36, s29, 98304
buffer_load_dwordx4 v12, s[12:15], s36 offen nt lds
s_add_u32 m0, s27, 1088
s_add_u32 s36, s29, 99328
buffer_load_dwordx4 v12, s[12:15], s36 offen nt lds
s_add_u32 m0, s28, 60672
s_add_u32 s36, s33, 90112
buffer_load_dwordx4 v13, s[16:19], s36 offen nt lds
s_add_u32 m0, s28, 61728
s_add_u32 s36, s33, 90368
buffer_load_dwordx4 v13, s[16:19], s36 offen nt lds
ds_read_b128 v[224:227], v10 offset:8704
ds_read_b128 v[228:231], v10 offset:8768
ds_read_b128 v[232:235], v10 offset:8832
ds_read_b128 v[236:239], v10 offset:8896
ds_read_b128 v[240:243], v10 offset:13056
ds_read_b128 v[244:247], v10 offset:13120
ds_read_b128 v[248:251], v10 offset:13184
ds_read_b128 v[252:255], v10 offset:13248
s_branch W3_R8_back
W3_R9:
s_waitcnt lgkmcnt(0)
v_mfma_f32_16x16x32_bf16 v[20:23], v[224:227], v[200:203], v[20:23]
v_mfma_f32_16x16x32_bf16 v[32:35], v[228:231], v[200:203], v[32:35]
v_mfma_f32_16x16x32_bf16 v[44:47], v[232:235], v[200:203], v[44:47]
v_mfma_f32_16x16x32_bf16 v[56:59], v[236:239], v[200:203], v[56:59]
v_mfma_f32_16x16x32_bf16 v[68:71], v[240:243], v[200:203], v[68:71]
v_mfma_f32_16x16x32_bf16 v[80:83], v[244:247], v[200:203], v[80:83]
v_mfma_f32_16x16x32_bf16 v[92:95], v[248:251], v[200:203], v[92:95]
v_mfma_f32_16x16x32_bf16 v[104:107], v[252:255], v[200:203], v[104:107]
v_mfma_f32_16x16x32_bf16 v[116:119], v[16:19], v[200:203], v[116:119]
v_mfma_f32_16x16x32_bf16 v[24:27], v[224:227], v[204:207], v[24:27]
v_mfma_f32_16x16x32_bf16 v[36:39], v[228:231], v[204:207], v[36:39]
v_mfma_f32_16x16x32_bf16 v[48:51], v[232:235], v[204:207], v[48:51]
v_mfma_f32_16x16x32_bf16 v[60:63], v[236:239], v[204:207], v[60:63]
v_mfma_f32_16x16x32_bf16 v[72:75], v[240:243], v[204:207], v[72:75]
v_mfma_f32_16x16x32_bf16 v[84:87], v[244:247], v[204:207], v[84:87]
v_mfma_f32_16x16x32_bf16 v[96:99], v[248:251], v[204:207], v[96:99]
v_mfma_f32_16x16x32_bf16 v[108:111], v[252:255], v[204:207], v[108:111]
v_mfma_f32_16x16x32_bf16 v[120:123], v[16:19], v[204:207], v[120:123]
v_mfma_f32_16x16x32_bf16 v[28:31], v[224:227], v[208:211], v[28:31]
v_mfma_f32_16x16x32_bf16 v[40:43], v[228:231], v[208:211], v[40:43]
v_mfma_f32_16x16x32_bf16 v[52:55], v[232:235], v[208:211], v[52:55]
v_mfma_f32_16x16x32_bf16 v[64:67], v[236:239], v[208:211], v[64:67]
v_mfma_f32_16x16x32_bf16 v[76:79], v[240:243], v[208:211], v[76:79]
v_mfma_f32_16x16x32_bf16 v[88:91], v[244:247], v[208:211], v[88:91]
v_mfma_f32_16x16x32_bf16 v[100:103], v[248:251], v[208:211], v[100:103]
v_mfma_f32_16x16x32_bf16 v[112:115], v[252:255], v[208:211], v[112:115]
v_mfma_f32_16x16x32_bf16 v[124:127], v[16:19], v[208:211], v[124:127]
s_nop 15
v_max3_f32 v2, v176, v177, v178
v_max3_f32 v2, v2, v179, v188
v_max3_f32 v2, v2, v189, v190
v_max_f32 v2, v2, v191
v_mov_b32 v3, v2
s_nop 1
v_permlane32_swap_b32 v2, v3
s_nop 1
v_max_f32 v2, v2, v3
v_mov_b32 v3, v2
s_nop 1
v_permlane16_swap_b32 v2, v3
s_nop 1
v_max_f32 v2, v2, v3
v_max_f32 v2, 0, v2
v_sub_f32 v176, v176, v2
v_sub_f32 v177, v177, v2
v_sub_f32 v178, v178, v2
v_sub_f32 v179, v179, v2
v_sub_f32 v188, v188, v2
v_sub_f32 v189, v189, v2
v_sub_f32 v190, v190, v2
v_sub_f32 v191, v191, v2
v_sub_f32 v212, v212, v2
v_sub_f32 v213, v213, v2
v_sub_f32 v214, v214, v2
v_sub_f32 v215, v215, v2
v_exp_f32 v3, -v2
s_nop 0
v_mul_f32 v20, v20, v3
v_mul_f32 v21, v21, v3
v_mul_f32 v22, v22, v3
v_mul_f32 v23, v23, v3
v_mul_f32 v32, v32, v3
v_mul_f32 v33, v33, v3
v_mul_f32 v34, v34, v3
v_mul_f32 v35, v35, v3
v_mul_f32 v44, v44, v3
v_mul_f32 v45, v45, v3
v_mul_f32 v46, v46, v3
v_mul_f32 v47, v47, v3
v_mul_f32 v56, v56, v3
v_mul_f32 v57, v57, v3
v_mul_f32 v58, v58, v3
v_mul_f32 v59, v59, v3
v_mul_f32 v68, v68, v3
v_mul_f32 v69, v69, v3
v_mul_f32 v70, v70, v3
v_mul_f32 v71, v71, v3
v_mul_f32 v80, v80, v3
v_mul_f32 v81, v81, v3
v_mul_f32 v82, v82, v3
v_mul_f32 v83, v83, v3
v_mul_f32 v92, v92, v3
v_mul_f32 v93, v93, v3
v_mul_f32 v94, v94, v3
v_mul_f32 v95, v95, v3
v_mul_f32 v104, v104, v3
v_mul_f32 v105, v105, v3
v_mul_f32 v106, v106, v3
v_mul_f32 v107, v107, v3
v_mul_f32 v116, v116, v3
v_mul_f32 v117, v117, v3
v_mul_f32 v118, v118, v3
v_mul_f32 v119, v119, v3
v_max3_f32 v2, v180, v181, v182
v_max3_f32 v2, v2, v183, v192
v_max3_f32 v2, v2, v193, v194
v_max_f32 v2, v2, v195
v_mov_b32 v3, v2
s_nop 1
v_permlane32_swap_b32 v2, v3
s_nop 1
v_max_f32 v2, v2, v3
v_mov_b32 v3, v2
s_nop 1
v_permlane16_swap_b32 v2, v3
s_nop 1
v_max_f32 v2, v2, v3
v_max_f32 v2, 0, v2
v_sub_f32 v180, v180, v2
v_sub_f32 v181, v181, v2
v_sub_f32 v182, v182, v2
v_sub_f32 v183, v183, v2
v_sub_f32 v192, v192, v2
v_sub_f32 v193, v193, v2
v_sub_f32 v194, v194, v2
v_sub_f32 v195, v195, v2
v_sub_f32 v216, v216, v2
v_sub_f32 v217, v217, v2
v_sub_f32 v218, v218, v2
v_sub_f32 v219, v219, v2
v_exp_f32 v3, -v2
s_nop 0
v_mul_f32 v24, v24, v3
v_mul_f32 v25, v25, v3
v_mul_f32 v26, v26, v3
v_mul_f32 v27, v27, v3
v_mul_f32 v36, v36, v3
v_mul_f32 v37, v37, v3
v_mul_f32 v38, v38, v3
v_mul_f32 v39, v39, v3
v_mul_f32 v48, v48, v3
v_mul_f32 v49, v49, v3
v_mul_f32 v50, v50, v3
v_mul_f32 v51, v51, v3
v_mul_f32 v60, v60, v3
v_mul_f32 v61, v61, v3
v_mul_f32 v62, v62, v3
v_mul_f32 v63, v63, v3
v_mul_f32 v72, v72, v3
v_mul_f32 v73, v73, v3
v_mul_f32 v74, v74, v3
v_mul_f32 v75, v75, v3
v_mul_f32 v84, v84, v3
v_mul_f32 v85, v85, v3
v_mul_f32 v86, v86, v3
v_mul_f32 v87, v87, v3
v_mul_f32 v96, v96, v3
v_mul_f32 v97, v97, v3
v_mul_f32 v98, v98, v3
v_mul_f32 v99, v99, v3
v_mul_f32 v108, v108, v3
v_mul_f32 v109, v109, v3
v_mul_f32 v110, v110, v3
v_mul_f32 v111, v111, v3
v_mul_f32 v120, v120, v3
v_mul_f32 v121, v121, v3
v_mul_f32 v122, v122, v3
v_mul_f32 v123, v123, v3
v_max3_f32 v2, v184, v185, v186
v_max3_f32 v2, v2, v187, v196
v_max3_f32 v2, v2, v197, v198
v_max_f32 v2, v2, v199
v_mov_b32 v3, v2
s_nop 1
v_permlane32_swap_b32 v2, v3
s_nop 1
v_max_f32 v2, v2, v3
v_mov_b32 v3, v2
s_nop 1
v_permlane16_swap_b32 v2, v3
s_nop 1
v_max_f32 v2, v2, v3
v_max_f32 v2, 0, v2
v_sub_f32 v184, v184, v2
v_sub_f32 v185, v185, v2
v_sub_f32 v186, v186, v2
v_sub_f32 v187, v187, v2
v_sub_f32 v196, v196, v2
v_sub_f32 v197, v197, v2
v_sub_f32 v198, v198, v2
v_sub_f32 v199, v199, v2
v_sub_f32 v220, v220, v2
v_sub_f32 v221, v221, v2
v_sub_f32 v222, v222, v2
v_sub_f32 v223, v223, v2
v_exp_f32 v3, -v2
s_nop 0
v_mul_f32 v28, v28, v3
v_mul_f32 v29, v29, v3
v_mul_f32 v30, v30, v3
v_mul_f32 v31, v31, v3
v_mul_f32 v40, v40, v3
v_mul_f32 v41, v41, v3
v_mul_f32 v42, v42, v3
v_mul_f32 v43, v43, v3
v_mul_f32 v52, v52, v3
v_mul_f32 v53, v53, v3
v_mul_f32 v54, v54, v3
v_mul_f32 v55, v55, v3
v_mul_f32 v64, v64, v3
v_mul_f32 v65, v65, v3
v_mul_f32 v66, v66, v3
v_mul_f32 v67, v67, v3
v_mul_f32 v76, v76, v3
v_mul_f32 v77, v77, v3
v_mul_f32 v78, v78, v3
v_mul_f32 v79, v79, v3
v_mul_f32 v88, v88, v3
v_mul_f32 v89, v89, v3
v_mul_f32 v90, v90, v3
v_mul_f32 v91, v91, v3
v_mul_f32 v100, v100, v3
v_mul_f32 v101, v101, v3
v_mul_f32 v102, v102, v3
v_mul_f32 v103, v103, v3
v_mul_f32 v112, v112, v3
v_mul_f32 v113, v113, v3
v_mul_f32 v114, v114, v3
v_mul_f32 v115, v115, v3
v_mul_f32 v124, v124, v3
v_mul_f32 v125, v125, v3
v_mul_f32 v126, v126, v3
v_mul_f32 v127, v127, v3
v_exp_f32 v176, v176
v_exp_f32 v177, v177
v_exp_f32 v178, v178
v_exp_f32 v179, v179
v_exp_f32 v188, v188
v_exp_f32 v189, v189
v_exp_f32 v190, v190
v_exp_f32 v191, v191
v_exp_f32 v180, v180
v_exp_f32 v181, v181
v_exp_f32 v182, v182
v_exp_f32 v183, v183
v_exp_f32 v192, v192
v_exp_f32 v193, v193
v_exp_f32 v194, v194
v_exp_f32 v195, v195
v_exp_f32 v184, v184
v_exp_f32 v185, v185
v_exp_f32 v186, v186
v_exp_f32 v187, v187
v_exp_f32 v196, v196
v_exp_f32 v197, v197
v_exp_f32 v198, v198
v_exp_f32 v199, v199
s_nop 0
v_cvt_pk_bf16_f32 v200, v176, v177
v_cvt_pk_bf16_f32 v201, v178, v179
v_cvt_pk_bf16_f32 v202, v188, v189
v_cvt_pk_bf16_f32 v203, v190, v191
v_cvt_pk_bf16_f32 v204, v180, v181
v_cvt_pk_bf16_f32 v205, v182, v183
v_cvt_pk_bf16_f32 v206, v192, v193
v_cvt_pk_bf16_f32 v207, v194, v195
v_cvt_pk_bf16_f32 v208, v184, v185
v_cvt_pk_bf16_f32 v209, v186, v187
v_cvt_pk_bf16_f32 v210, v196, v197
v_cvt_pk_bf16_f32 v211, v198, v199
s_waitcnt vmcnt(8)
s_barrier
s_add_u32 m0, s27, 8704
s_add_u32 s36, s29, 106496
buffer_load_dwordx4 v12, s[12:15], s36 offen nt lds
s_add_u32 m0, s27, 9792
s_add_u32 s36, s29, 107520
buffer_load_dwordx4 v12, s[12:15], s36 offen nt lds
s_add_u32 m0, s28, 17408
s_add_u32 s36, s33, 98304
buffer_load_dwordx4 v13, s[16:19], s36 offen nt lds
s_add_u32 m0, s28, 18464
s_add_u32 s36, s33, 98560
buffer_load_dwordx4 v13, s[16:19], s36 offen nt lds
ds_read_b128 v[224:227], v10 offset:34816
ds_read_b128 v[228:231], v10 offset:34880
ds_read_b128 v[232:235], v10 offset:34944
ds_read_b128 v[236:239], v10 offset:35008
ds_read_b128 v[240:243], v10 offset:39168
ds_read_b128 v[244:247], v10 offset:39232
ds_read_b128 v[248:251], v10 offset:39296
ds_read_b128 v[252:255], v10 offset:39360
s_branch W3_R9_back
W3_R10:
s_waitcnt lgkmcnt(0)
v_mfma_f32_16x16x32_bf16 v[20:23], v[224:227], v[200:203], v[20:23]
v_mfma_f32_16x16x32_bf16 v[32:35], v[228:231], v[200:203], v[32:35]
v_mfma_f32_16x16x32_bf16 v[44:47], v[232:235], v[200:203], v[44:47]
v_mfma_f32_16x16x32_bf16 v[56:59], v[236:239], v[200:203], v[56:59]
v_mfma_f32_16x16x32_bf16 v[68:71], v[240:243], v[200:203], v[68:71]
v_mfma_f32_16x16x32_bf16 v[80:83], v[244:247], v[200:203], v[80:83]
v_mfma_f32_16x16x32_bf16 v[92:95], v[248:251], v[200:203], v[92:95]
v_mfma_f32_16x16x32_bf16 v[104:107], v[252:255], v[200:203], v[104:107]
v_mfma_f32_16x16x32_bf16 v[116:119], v[16:19], v[200:203], v[116:119]
v_mfma_f32_16x16x32_bf16 v[24:27], v[224:227], v[204:207], v[24:27]
v_mfma_f32_16x16x32_bf16 v[36:39], v[228:231], v[204:207], v[36:39]
v_mfma_f32_16x16x32_bf16 v[48:51], v[232:235], v[204:207], v[48:51]
v_mfma_f32_16x16x32_bf16 v[60:63], v[236:239], v[204:207], v[60:63]
v_mfma_f32_16x16x32_bf16 v[72:75], v[240:243], v[204:207], v[72:75]
v_mfma_f32_16x16x32_bf16 v[84:87], v[244:247], v[204:207], v[84:87]
v_mfma_f32_16x16x32_bf16 v[96:99], v[248:251], v[204:207], v[96:99]
v_mfma_f32_16x16x32_bf16 v[108:111], v[252:255], v[204:207], v[108:111]
v_mfma_f32_16x16x32_bf16 v[120:123], v[16:19], v[204:207], v[120:123]
v_mfma_f32_16x16x32_bf16 v[28:31], v[224:227], v[208:211], v[28:31]
v_mfma_f32_16x16x32_bf16 v[40:43], v[228:231], v[208:211], v[40:43]
v_mfma_f32_16x16x32_bf16 v[52:55], v[232:235], v[208:211], v[52:55]
v_mfma_f32_16x16x32_bf16 v[64:67], v[236:239], v[208:211], v[64:67]
v_mfma_f32_16x16x32_bf16 v[76:79], v[240:243], v[208:211], v[76:79]
v_mfma_f32_16x16x32_bf16 v[88:91], v[244:247], v[208:211], v[88:91]
v_mfma_f32_16x16x32_bf16 v[100:103], v[248:251], v[208:211], v[100:103]
v_mfma_f32_16x16x32_bf16 v[112:115], v[252:255], v[208:211], v[112:115]
v_mfma_f32_16x16x32_bf16 v[124:127], v[16:19], v[208:211], v[124:127]
s_nop 15
v_max3_f32 v2, v176, v177, v178
v_max3_f32 v2, v2, v179, v188
v_max3_f32 v2, v2, v189, v190
v_max_f32 v2, v2, v191
v_mov_b32 v3, v2
s_nop 1
v_permlane32_swap_b32 v2, v3
s_nop 1
v_max_f32 v2, v2, v3
v_mov_b32 v3, v2
s_nop 1
v_permlane16_swap_b32 v2, v3
s_nop 1
v_max_f32 v2, v2, v3
v_max_f32 v2, 0, v2
v_sub_f32 v176, v176, v2
v_sub_f32 v177, v177, v2
v_sub_f32 v178, v178, v2
v_sub_f32 v179, v179, v2
v_sub_f32 v188, v188, v2
v_sub_f32 v189, v189, v2
v_sub_f32 v190, v190, v2
v_sub_f32 v191, v191, v2
v_sub_f32 v212, v212, v2
v_sub_f32 v213, v213, v2
v_sub_f32 v214, v214, v2
v_sub_f32 v215, v215, v2
v_exp_f32 v3, -v2
s_nop 0
v_mul_f32 v20, v20, v3
v_mul_f32 v21, v21, v3
v_mul_f32 v22, v22, v3
v_mul_f32 v23, v23, v3
v_mul_f32 v32, v32, v3
v_mul_f32 v33, v33, v3
v_mul_f32 v34, v34, v3
v_mul_f32 v35, v35, v3
v_mul_f32 v44, v44, v3
v_mul_f32 v45, v45, v3
v_mul_f32 v46, v46, v3
v_mul_f32 v47, v47, v3
v_mul_f32 v56, v56, v3
v_mul_f32 v57, v57, v3
v_mul_f32 v58, v58, v3
v_mul_f32 v59, v59, v3
v_mul_f32 v68, v68, v3
v_mul_f32 v69, v69, v3
v_mul_f32 v70, v70, v3
v_mul_f32 v71, v71, v3
v_mul_f32 v80, v80, v3
v_mul_f32 v81, v81, v3
v_mul_f32 v82, v82, v3
v_mul_f32 v83, v83, v3
v_mul_f32 v92, v92, v3
v_mul_f32 v93, v93, v3
v_mul_f32 v94, v94, v3
v_mul_f32 v95, v95, v3
v_mul_f32 v104, v104, v3
v_mul_f32 v105, v105, v3
v_mul_f32 v106, v106, v3
v_mul_f32 v107, v107, v3
v_mul_f32 v116, v116, v3
v_mul_f32 v117, v117, v3
v_mul_f32 v118, v118, v3
v_mul_f32 v119, v119, v3
v_max3_f32 v2, v180, v181, v182
v_max3_f32 v2, v2, v183, v192
v_max3_f32 v2, v2, v193, v194
v_max_f32 v2, v2, v195
v_mov_b32 v3, v2
s_nop 1
v_permlane32_swap_b32 v2, v3
s_nop 1
v_max_f32 v2, v2, v3
v_mov_b32 v3, v2
s_nop 1
v_permlane16_swap_b32 v2, v3
s_nop 1
v_max_f32 v2, v2, v3
v_max_f32 v2, 0, v2
v_sub_f32 v180, v180, v2
v_sub_f32 v181, v181, v2
v_sub_f32 v182, v182, v2
v_sub_f32 v183, v183, v2
v_sub_f32 v192, v192, v2
v_sub_f32 v193, v193, v2
v_sub_f32 v194, v194, v2
v_sub_f32 v195, v195, v2
v_sub_f32 v216, v216, v2
v_sub_f32 v217, v217, v2
v_sub_f32 v218, v218, v2
v_sub_f32 v219, v219, v2
v_exp_f32 v3, -v2
s_nop 0
v_mul_f32 v24, v24, v3
v_mul_f32 v25, v25, v3
v_mul_f32 v26, v26, v3
v_mul_f32 v27, v27, v3
v_mul_f32 v36, v36, v3
v_mul_f32 v37, v37, v3
v_mul_f32 v38, v38, v3
v_mul_f32 v39, v39, v3
v_mul_f32 v48, v48, v3
v_mul_f32 v49, v49, v3
v_mul_f32 v50, v50, v3
v_mul_f32 v51, v51, v3
v_mul_f32 v60, v60, v3
v_mul_f32 v61, v61, v3
v_mul_f32 v62, v62, v3
v_mul_f32 v63, v63, v3
v_mul_f32 v72, v72, v3
v_mul_f32 v73, v73, v3
v_mul_f32 v74, v74, v3
v_mul_f32 v75, v75, v3
v_mul_f32 v84, v84, v3
v_mul_f32 v85, v85, v3
v_mul_f32 v86, v86, v3
v_mul_f32 v87, v87, v3
v_mul_f32 v96, v96, v3
v_mul_f32 v97, v97, v3
v_mul_f32 v98, v98, v3
v_mul_f32 v99, v99, v3
v_mul_f32 v108, v108, v3
v_mul_f32 v109, v109, v3
v_mul_f32 v110, v110, v3
v_mul_f32 v111, v111, v3
v_mul_f32 v120, v120, v3
v_mul_f32 v121, v121, v3
v_mul_f32 v122, v122, v3
v_mul_f32 v123, v123, v3
v_max3_f32 v2, v184, v185, v186
v_max3_f32 v2, v2, v187, v196
v_max3_f32 v2, v2, v197, v198
v_max_f32 v2, v2, v199
v_mov_b32 v3, v2
s_nop 1
v_permlane32_swap_b32 v2, v3
s_nop 1
v_max_f32 v2, v2, v3
v_mov_b32 v3, v2
s_nop 1
v_permlane16_swap_b32 v2, v3
s_nop 1
v_max_f32 v2, v2, v3
v_max_f32 v2, 0, v2
v_sub_f32 v184, v184, v2
v_sub_f32 v185, v185, v2
v_sub_f32 v186, v186, v2
v_sub_f32 v187, v187, v2
v_sub_f32 v196, v196, v2
v_sub_f32 v197, v197, v2
v_sub_f32 v198, v198, v2
v_sub_f32 v199, v199, v2
v_sub_f32 v220, v220, v2
v_sub_f32 v221, v221, v2
v_sub_f32 v222, v222, v2
v_sub_f32 v223, v223, v2
v_exp_f32 v3, -v2
s_nop 0
v_mul_f32 v28, v28, v3
v_mul_f32 v29, v29, v3
v_mul_f32 v30, v30, v3
v_mul_f32 v31, v31, v3
v_mul_f32 v40, v40, v3
v_mul_f32 v41, v41, v3
v_mul_f32 v42, v42, v3
v_mul_f32 v43, v43, v3
v_mul_f32 v52, v52, v3
v_mul_f32 v53, v53, v3
v_mul_f32 v54, v54, v3
v_mul_f32 v55, v55, v3
v_mul_f32 v64, v64, v3
v_mul_f32 v65, v65, v3
v_mul_f32 v66, v66, v3
v_mul_f32 v67, v67, v3
v_mul_f32 v76, v76, v3
v_mul_f32 v77, v77, v3
v_mul_f32 v78, v78, v3
v_mul_f32 v79, v79, v3
v_mul_f32 v88, v88, v3
v_mul_f32 v89, v89, v3
v_mul_f32 v90, v90, v3
v_mul_f32 v91, v91, v3
v_mul_f32 v100, v100, v3
v_mul_f32 v101, v101, v3
v_mul_f32 v102, v102, v3
v_mul_f32 v103, v103, v3
v_mul_f32 v112, v112, v3
v_mul_f32 v113, v113, v3
v_mul_f32 v114, v114, v3
v_mul_f32 v115, v115, v3
v_mul_f32 v124, v124, v3
v_mul_f32 v125, v125, v3
v_mul_f32 v126, v126, v3
v_mul_f32 v127, v127, v3
v_exp_f32 v176, v176
v_exp_f32 v177, v177
v_exp_f32 v178, v178
v_exp_f32 v179, v179
v_exp_f32 v188, v188
v_exp_f32 v189, v189
v_exp_f32 v190, v190
v_exp_f32 v191, v191
v_exp_f32 v180, v180
v_exp_f32 v181, v181
v_exp_f32 v182, v182
v_exp_f32 v183, v183
v_exp_f32 v192, v192
v_exp_f32 v193, v193
v_exp_f32 v194, v194
v_exp_f32 v195, v195
v_exp_f32 v184, v184
v_exp_f32 v185, v185
v_exp_f32 v186, v186
v_exp_f32 v187, v187
v_exp_f32 v196, v196
v_exp_f32 v197, v197
v_exp_f32 v198, v198
v_exp_f32 v199, v199
s_nop 0
v_cvt_pk_bf16_f32 v200, v176, v177
v_cvt_pk_bf16_f32 v201, v178, v179
v_cvt_pk_bf16_f32 v202, v188, v189
v_cvt_pk_bf16_f32 v203, v190, v191
v_cvt_pk_bf16_f32 v204, v180, v181
v_cvt_pk_bf16_f32 v205, v182, v183
v_cvt_pk_bf16_f32 v206, v192, v193
v_cvt_pk_bf16_f32 v207, v194, v195
v_cvt_pk_bf16_f32 v208, v184, v185
v_cvt_pk_bf16_f32 v209, v186, v187
v_cvt_pk_bf16_f32 v210, v196, v197
v_cvt_pk_bf16_f32 v211, v198, v199
s_waitcnt vmcnt(8)
s_barrier
s_add_u32 m0, s27, 34816
s_add_u32 s36, s29, 114688
buffer_load_dwordx4 v12, s[12:15], s36 offen nt lds
s_add_u32 m0, s27, 35904
s_add_u32 s36, s29, 115712
buffer_load_dwordx4 v12, s[12:15], s36 offen nt lds
s_add_u32 m0, s28, 25856
s_add_u32 s36, s33, 106496
buffer_load_dwordx4 v13, s[16:19], s36 offen nt lds
s_add_u32 m0, s28, 26912
s_add_u32 s36, s33, 106752
buffer_load_dwordx4 v13, s[16:19], s36 offen nt lds
ds_read_b128 v[224:227], v10 offset:43520
ds_read_b128 v[228:231], v10 offset:43584
ds_read_b128 v[232:235], v10 offset:43648
ds_read_b128 v[236:239], v10 offset:43712
ds_read_b128 v[240:243], v10 offset:47872
ds_read_b128 v[244:247], v10 offset:47936
ds_read_b128 v[248:251], v10 offset:48000
ds_read_b128 v[252:255], v10 offset:48064
s_branch W3_R10_back
W3_R11:
s_waitcnt lgkmcnt(0)
v_mfma_f32_16x16x32_bf16 v[20:23], v[224:227], v[200:203], v[20:23]
v_mfma_f32_16x16x32_bf16 v[32:35], v[228:231], v[200:203], v[32:35]
v_mfma_f32_16x16x32_bf16 v[44:47], v[232:235], v[200:203], v[44:47]
v_mfma_f32_16x16x32_bf16 v[56:59], v[236:239], v[200:203], v[56:59]
v_mfma_f32_16x16x32_bf16 v[68:71], v[240:243], v[200:203], v[68:71]
v_mfma_f32_16x16x32_bf16 v[80:83], v[244:247], v[200:203], v[80:83]
v_mfma_f32_16x16x32_bf16 v[92:95], v[248:251], v[200:203], v[92:95]
v_mfma_f32_16x16x32_bf16 v[104:107], v[252:255], v[200:203], v[104:107]
v_mfma_f32_16x16x32_bf16 v[116:119], v[16:19], v[200:203], v[116:119]
v_mfma_f32_16x16x32_bf16 v[24:27], v[224:227], v[204:207], v[24:27]
v_mfma_f32_16x16x32_bf16 v[36:39], v[228:231], v[204:207], v[36:39]
v_mfma_f32_16x16x32_bf16 v[48:51], v[232:235], v[204:207], v[48:51]
v_mfma_f32_16x16x32_bf16 v[60:63], v[236:239], v[204:207], v[60:63]
v_mfma_f32_16x16x32_bf16 v[72:75], v[240:243], v[204:207], v[72:75]
v_mfma_f32_16x16x32_bf16 v[84:87], v[244:247], v[204:207], v[84:87]
v_mfma_f32_16x16x32_bf16 v[96:99], v[248:251], v[204:207], v[96:99]
v_mfma_f32_16x16x32_bf16 v[108:111], v[252:255], v[204:207], v[108:111]
v_mfma_f32_16x16x32_bf16 v[120:123], v[16:19], v[204:207], v[120:123]
v_mfma_f32_16x16x32_bf16 v[28:31], v[224:227], v[208:211], v[28:31]
v_mfma_f32_16x16x32_bf16 v[40:43], v[228:231], v[208:211], v[40:43]
v_mfma_f32_16x16x32_bf16 v[52:55], v[232:235], v[208:211], v[52:55]
v_mfma_f32_16x16x32_bf16 v[64:67], v[236:239], v[208:211], v[64:67]
v_mfma_f32_16x16x32_bf16 v[76:79], v[240:243], v[208:211], v[76:79]
v_mfma_f32_16x16x32_bf16 v[88:91], v[244:247], v[208:211], v[88:91]
v_mfma_f32_16x16x32_bf16 v[100:103], v[248:251], v[208:211], v[100:103]
v_mfma_f32_16x16x32_bf16 v[112:115], v[252:255], v[208:211], v[112:115]
v_mfma_f32_16x16x32_bf16 v[124:127], v[16:19], v[208:211], v[124:127]
s_nop 15
v_max3_f32 v2, v176, v177, v178
v_max3_f32 v2, v2, v179, v188
v_max3_f32 v2, v2, v189, v190
v_max_f32 v2, v2, v191
v_mov_b32 v3, v2
s_nop 1
v_permlane32_swap_b32 v2, v3
s_nop 1
v_max_f32 v2, v2, v3
v_mov_b32 v3, v2
s_nop 1
v_permlane16_swap_b32 v2, v3
s_nop 1
v_max_f32 v2, v2, v3
v_max_f32 v2, 0, v2
v_sub_f32 v176, v176, v2
v_sub_f32 v177, v177, v2
v_sub_f32 v178, v178, v2
v_sub_f32 v179, v179, v2
v_sub_f32 v188, v188, v2
v_sub_f32 v189, v189, v2
v_sub_f32 v190, v190, v2
v_sub_f32 v191, v191, v2
v_sub_f32 v212, v212, v2
v_sub_f32 v213, v213, v2
v_sub_f32 v214, v214, v2
v_sub_f32 v215, v215, v2
v_exp_f32 v3, -v2
s_nop 0
v_mul_f32 v20, v20, v3
v_mul_f32 v21, v21, v3
v_mul_f32 v22, v22, v3
v_mul_f32 v23, v23, v3
v_mul_f32 v32, v32, v3
v_mul_f32 v33, v33, v3
v_mul_f32 v34, v34, v3
v_mul_f32 v35, v35, v3
v_mul_f32 v44, v44, v3
v_mul_f32 v45, v45, v3
v_mul_f32 v46, v46, v3
v_mul_f32 v47, v47, v3
v_mul_f32 v56, v56, v3
v_mul_f32 v57, v57, v3
v_mul_f32 v58, v58, v3
v_mul_f32 v59, v59, v3
v_mul_f32 v68, v68, v3
v_mul_f32 v69, v69, v3
v_mul_f32 v70, v70, v3
v_mul_f32 v71, v71, v3
v_mul_f32 v80, v80, v3
v_mul_f32 v81, v81, v3
v_mul_f32 v82, v82, v3
v_mul_f32 v83, v83, v3
v_mul_f32 v92, v92, v3
v_mul_f32 v93, v93, v3
v_mul_f32 v94, v94, v3
v_mul_f32 v95, v95, v3
v_mul_f32 v104, v104, v3
v_mul_f32 v105, v105, v3
v_mul_f32 v106, v106, v3
v_mul_f32 v107, v107, v3
v_mul_f32 v116, v116, v3
v_mul_f32 v117, v117, v3
v_mul_f32 v118, v118, v3
v_mul_f32 v119, v119, v3
v_max3_f32 v2, v180, v181, v182
v_max3_f32 v2, v2, v183, v192
v_max3_f32 v2, v2, v193, v194
v_max_f32 v2, v2, v195
v_mov_b32 v3, v2
s_nop 1
v_permlane32_swap_b32 v2, v3
s_nop 1
v_max_f32 v2, v2, v3
v_mov_b32 v3, v2
s_nop 1
v_permlane16_swap_b32 v2, v3
s_nop 1
v_max_f32 v2, v2, v3
v_max_f32 v2, 0, v2
v_sub_f32 v180, v180, v2
v_sub_f32 v181, v181, v2
v_sub_f32 v182, v182, v2
v_sub_f32 v183, v183, v2
v_sub_f32 v192, v192, v2
v_sub_f32 v193, v193, v2
v_sub_f32 v194, v194, v2
v_sub_f32 v195, v195, v2
v_sub_f32 v216, v216, v2
v_sub_f32 v217, v217, v2
v_sub_f32 v218, v218, v2
v_sub_f32 v219, v219, v2
v_exp_f32 v3, -v2
s_nop 0
v_mul_f32 v24, v24, v3
v_mul_f32 v25, v25, v3
v_mul_f32 v26, v26, v3
v_mul_f32 v27, v27, v3
v_mul_f32 v36, v36, v3
v_mul_f32 v37, v37, v3
v_mul_f32 v38, v38, v3
v_mul_f32 v39, v39, v3
v_mul_f32 v48, v48, v3
v_mul_f32 v49, v49, v3
v_mul_f32 v50, v50, v3
v_mul_f32 v51, v51, v3
v_mul_f32 v60, v60, v3
v_mul_f32 v61, v61, v3
v_mul_f32 v62, v62, v3
v_mul_f32 v63, v63, v3
v_mul_f32 v72, v72, v3
v_mul_f32 v73, v73, v3
v_mul_f32 v74, v74, v3
v_mul_f32 v75, v75, v3
v_mul_f32 v84, v84, v3
v_mul_f32 v85, v85, v3
v_mul_f32 v86, v86, v3
v_mul_f32 v87, v87, v3
v_mul_f32 v96, v96, v3
v_mul_f32 v97, v97, v3
v_mul_f32 v98, v98, v3
v_mul_f32 v99, v99, v3
v_mul_f32 v108, v108, v3
v_mul_f32 v109, v109, v3
v_mul_f32 v110, v110, v3
v_mul_f32 v111, v111, v3
v_mul_f32 v120, v120, v3
v_mul_f32 v121, v121, v3
v_mul_f32 v122, v122, v3
v_mul_f32 v123, v123, v3
v_max3_f32 v2, v184, v185, v186
v_max3_f32 v2, v2, v187, v196
v_max3_f32 v2, v2, v197, v198
v_max_f32 v2, v2, v199
v_mov_b32 v3, v2
s_nop 1
v_permlane32_swap_b32 v2, v3
s_nop 1
v_max_f32 v2, v2, v3
v_mov_b32 v3, v2
s_nop 1
v_permlane16_swap_b32 v2, v3
s_nop 1
v_max_f32 v2, v2, v3
v_max_f32 v2, 0, v2
v_sub_f32 v184, v184, v2
v_sub_f32 v185, v185, v2
v_sub_f32 v186, v186, v2
v_sub_f32 v187, v187, v2
v_sub_f32 v196, v196, v2
v_sub_f32 v197, v197, v2
v_sub_f32 v198, v198, v2
v_sub_f32 v199, v199, v2
v_sub_f32 v220, v220, v2
v_sub_f32 v221, v221, v2
v_sub_f32 v222, v222, v2
v_sub_f32 v223, v223, v2
v_exp_f32 v3, -v2
s_nop 0
v_mul_f32 v28, v28, v3
v_mul_f32 v29, v29, v3
v_mul_f32 v30, v30, v3
v_mul_f32 v31, v31, v3
v_mul_f32 v40, v40, v3
v_mul_f32 v41, v41, v3
v_mul_f32 v42, v42, v3
v_mul_f32 v43, v43, v3
v_mul_f32 v52, v52, v3
v_mul_f32 v53, v53, v3
v_mul_f32 v54, v54, v3
v_mul_f32 v55, v55, v3
v_mul_f32 v64, v64, v3
v_mul_f32 v65, v65, v3
v_mul_f32 v66, v66, v3
v_mul_f32 v67, v67, v3
v_mul_f32 v76, v76, v3
v_mul_f32 v77, v77, v3
v_mul_f32 v78, v78, v3
v_mul_f32 v79, v79, v3
v_mul_f32 v88, v88, v3
v_mul_f32 v89, v89, v3
v_mul_f32 v90, v90, v3
v_mul_f32 v91, v91, v3
v_mul_f32 v100, v100, v3
v_mul_f32 v101, v101, v3
v_mul_f32 v102, v102, v3
v_mul_f32 v103, v103, v3
v_mul_f32 v112, v112, v3
v_mul_f32 v113, v113, v3
v_mul_f32 v114, v114, v3
v_mul_f32 v115, v115, v3
v_mul_f32 v124, v124, v3
v_mul_f32 v125, v125, v3
v_mul_f32 v126, v126, v3
v_mul_f32 v127, v127, v3
v_exp_f32 v176, v176
v_exp_f32 v177, v177
v_exp_f32 v178, v178
v_exp_f32 v179, v179
v_exp_f32 v188, v188
v_exp_f32 v189, v189
v_exp_f32 v190, v190
v_exp_f32 v191, v191
v_exp_f32 v180, v180
v_exp_f32 v181, v181
v_exp_f32 v182, v182
v_exp_f32 v183, v183
v_exp_f32 v192, v192
v_exp_f32 v193, v193
v_exp_f32 v194, v194
v_exp_f32 v195, v195
v_exp_f32 v184, v184
v_exp_f32 v185, v185
v_exp_f32 v186, v186
v_exp_f32 v187, v187
v_exp_f32 v196, v196
v_exp_f32 v197, v197
v_exp_f32 v198, v198
v_exp_f32 v199, v199
s_nop 0
v_cvt_pk_bf16_f32 v200, v176, v177
v_cvt_pk_bf16_f32 v201, v178, v179
v_cvt_pk_bf16_f32 v202, v188, v189
v_cvt_pk_bf16_f32 v203, v190, v191
v_cvt_pk_bf16_f32 v204, v180, v181
v_cvt_pk_bf16_f32 v205, v182, v183
v_cvt_pk_bf16_f32 v206, v192, v193
v_cvt_pk_bf16_f32 v207, v194, v195
v_cvt_pk_bf16_f32 v208, v184, v185
v_cvt_pk_bf16_f32 v209, v186, v187
v_cvt_pk_bf16_f32 v210, v196, v197
v_cvt_pk_bf16_f32 v211, v198, v199
s_waitcnt vmcnt(8)
s_barrier
s_add_u32 m0, s27, 43520
s_add_u32 s36, s29, 122880
buffer_load_dwordx4 v12, s[12:15], s36 offen nt lds
s_add_u32 m0, s27, 44608
s_add_u32 s36, s29, 123904
buffer_load_dwordx4 v12, s[12:15], s36 offen nt lds
s_add_u32 m0, s28, 52224
s_add_u32 s36, s33, 114688
buffer_load_dwordx4 v13, s[16:19], s36 offen nt lds
s_add_u32 m0, s28, 53280
s_add_u32 s36, s33, 114944
buffer_load_dwordx4 v13, s[16:19], s36 offen nt lds
ds_read_b128 v[224:227], v10 offset:0
ds_read_b128 v[228:231], v10 offset:64
ds_read_b128 v[232:235], v10 offset:128
ds_read_b128 v[236:239], v10 offset:192
ds_read_b128 v[240:243], v10 offset:4352
ds_read_b128 v[244:247], v10 offset:4416
ds_read_b128 v[248:251], v10 offset:4480
ds_read_b128 v[252:255], v10 offset:4544
s_branch W3_R11_back
W3_R12:
s_waitcnt lgkmcnt(0)
v_mfma_f32_16x16x32_bf16 v[20:23], v[224:227], v[200:203], v[20:23]
v_mfma_f32_16x16x32_bf16 v[32:35], v[228:231], v[200:203], v[32:35]
v_mfma_f32_16x16x32_bf16 v[44:47], v[232:235], v[200:203], v[44:47]
v_mfma_f32_16x16x32_bf16 v[56:59], v[236:239], v[200:203], v[56:59]
v_mfma_f32_16x16x32_bf16 v[68:71], v[240:243], v[200:203], v[68:71]
v_mfma_f32_16x16x32_bf16 v[80:83], v[244:247], v[200:203], v[80:83]
v_mfma_f32_16x16x32_bf16 v[92:95], v[248:251], v[200:203], v[92:95]
v_mfma_f32_16x16x32_bf16 v[104:107], v[252:255], v[200:203], v[104:107]
v_mfma_f32_16x16x32_bf16 v[116:119], v[16:19], v[200:203], v[116:119]
v_mfma_f32_16x16x32_bf16 v[24:27], v[224:227], v[204:207], v[24:27]
v_mfma_f32_16x16x32_bf16 v[36:39], v[228:231], v[204:207], v[36:39]
v_mfma_f32_16x16x32_bf16 v[48:51], v[232:235], v[204:207], v[48:51]
v_mfma_f32_16x16x32_bf16 v[60:63], v[236:239], v[204:207], v[60:63]
v_mfma_f32_16x16x32_bf16 v[72:75], v[240:243], v[204:207], v[72:75]
v_mfma_f32_16x16x32_bf16 v[84:87], v[244:247], v[204:207], v[84:87]
v_mfma_f32_16x16x32_bf16 v[96:99], v[248:251], v[204:207], v[96:99]
v_mfma_f32_16x16x32_bf16 v[108:111], v[252:255], v[204:207], v[108:111]
v_mfma_f32_16x16x32_bf16 v[120:123], v[16:19], v[204:207], v[120:123]
v_mfma_f32_16x16x32_bf16 v[28:31], v[224:227], v[208:211], v[28:31]
v_mfma_f32_16x16x32_bf16 v[40:43], v[228:231], v[208:211], v[40:43]
v_mfma_f32_16x16x32_bf16 v[52:55], v[232:235], v[208:211], v[52:55]
v_mfma_f32_16x16x32_bf16 v[64:67], v[236:239], v[208:211], v[64:67]
v_mfma_f32_16x16x32_bf16 v[76:79], v[240:243], v[208:211], v[76:79]
v_mfma_f32_16x16x32_bf16 v[88:91], v[244:247], v[208:211], v[88:91]
v_mfma_f32_16x16x32_bf16 v[100:103], v[248:251], v[208:211], v[100:103]
v_mfma_f32_16x16x32_bf16 v[112:115], v[252:255], v[208:211], v[112:115]
v_mfma_f32_16x16x32_bf16 v[124:127], v[16:19], v[208:211], v[124:127]
s_nop 15
v_max3_f32 v2, v176, v177, v178
v_max3_f32 v2, v2, v179, v188
v_max3_f32 v2, v2, v189, v190
v_max_f32 v2, v2, v191
v_mov_b32 v3, v2
s_nop 1
v_permlane32_swap_b32 v2, v3
s_nop 1
v_max_f32 v2, v2, v3
v_mov_b32 v3, v2
s_nop 1
v_permlane16_swap_b32 v2, v3
s_nop 1
v_max_f32 v2, v2, v3
v_max_f32 v2, 0, v2
v_sub_f32 v176, v176, v2
v_sub_f32 v177, v177, v2
v_sub_f32 v178, v178, v2
v_sub_f32 v179, v179, v2
v_sub_f32 v188, v188, v2
v_sub_f32 v189, v189, v2
v_sub_f32 v190, v190, v2
v_sub_f32 v191, v191, v2
v_sub_f32 v212, v212, v2
v_sub_f32 v213, v213, v2
v_sub_f32 v214, v214, v2
v_sub_f32 v215, v215, v2
v_exp_f32 v3, -v2
s_nop 0
v_mul_f32 v20, v20, v3
v_mul_f32 v21, v21, v3
v_mul_f32 v22, v22, v3
v_mul_f32 v23, v23, v3
v_mul_f32 v32, v32, v3
v_mul_f32 v33, v33, v3
v_mul_f32 v34, v34, v3
v_mul_f32 v35, v35, v3
v_mul_f32 v44, v44, v3
v_mul_f32 v45, v45, v3
v_mul_f32 v46, v46, v3
v_mul_f32 v47, v47, v3
v_mul_f32 v56, v56, v3
v_mul_f32 v57, v57, v3
v_mul_f32 v58, v58, v3
v_mul_f32 v59, v59, v3
v_mul_f32 v68, v68, v3
v_mul_f32 v69, v69, v3
v_mul_f32 v70, v70, v3
v_mul_f32 v71, v71, v3
v_mul_f32 v80, v80, v3
v_mul_f32 v81, v81, v3
v_mul_f32 v82, v82, v3
v_mul_f32 v83, v83, v3
v_mul_f32 v92, v92, v3
v_mul_f32 v93, v93, v3
v_mul_f32 v94, v94, v3
v_mul_f32 v95, v95, v3
v_mul_f32 v104, v104, v3
v_mul_f32 v105, v105, v3
v_mul_f32 v106, v106, v3
v_mul_f32 v107, v107, v3
v_mul_f32 v116, v116, v3
v_mul_f32 v117, v117, v3
v_mul_f32 v118, v118, v3
v_mul_f32 v119, v119, v3
v_max3_f32 v2, v180, v181, v182
v_max3_f32 v2, v2, v183, v192
v_max3_f32 v2, v2, v193, v194
v_max_f32 v2, v2, v195
v_mov_b32 v3, v2
s_nop 1
v_permlane32_swap_b32 v2, v3
s_nop 1
v_max_f32 v2, v2, v3
v_mov_b32 v3, v2
s_nop 1
v_permlane16_swap_b32 v2, v3
s_nop 1
v_max_f32 v2, v2, v3
v_max_f32 v2, 0, v2
v_sub_f32 v180, v180, v2
v_sub_f32 v181, v181, v2
v_sub_f32 v182, v182, v2
v_sub_f32 v183, v183, v2
v_sub_f32 v192, v192, v2
v_sub_f32 v193, v193, v2
v_sub_f32 v194, v194, v2
v_sub_f32 v195, v195, v2
v_sub_f32 v216, v216, v2
v_sub_f32 v217, v217, v2
v_sub_f32 v218, v218, v2
v_sub_f32 v219, v219, v2
v_exp_f32 v3, -v2
s_nop 0
v_mul_f32 v24, v24, v3
v_mul_f32 v25, v25, v3
v_mul_f32 v26, v26, v3
v_mul_f32 v27, v27, v3
v_mul_f32 v36, v36, v3
v_mul_f32 v37, v37, v3
v_mul_f32 v38, v38, v3
v_mul_f32 v39, v39, v3
v_mul_f32 v48, v48, v3
v_mul_f32 v49, v49, v3
v_mul_f32 v50, v50, v3
v_mul_f32 v51, v51, v3
v_mul_f32 v60, v60, v3
v_mul_f32 v61, v61, v3
v_mul_f32 v62, v62, v3
v_mul_f32 v63, v63, v3
v_mul_f32 v72, v72, v3
v_mul_f32 v73, v73, v3
v_mul_f32 v74, v74, v3
v_mul_f32 v75, v75, v3
v_mul_f32 v84, v84, v3
v_mul_f32 v85, v85, v3
v_mul_f32 v86, v86, v3
v_mul_f32 v87, v87, v3
v_mul_f32 v96, v96, v3
v_mul_f32 v97, v97, v3
v_mul_f32 v98, v98, v3
v_mul_f32 v99, v99, v3
v_mul_f32 v108, v108, v3
v_mul_f32 v109, v109, v3
v_mul_f32 v110, v110, v3
v_mul_f32 v111, v111, v3
v_mul_f32 v120, v120, v3
v_mul_f32 v121, v121, v3
v_mul_f32 v122, v122, v3
v_mul_f32 v123, v123, v3
v_max3_f32 v2, v184, v185, v186
v_max3_f32 v2, v2, v187, v196
v_max3_f32 v2, v2, v197, v198
v_max_f32 v2, v2, v199
v_mov_b32 v3, v2
s_nop 1
v_permlane32_swap_b32 v2, v3
s_nop 1
v_max_f32 v2, v2, v3
v_mov_b32 v3, v2
s_nop 1
v_permlane16_swap_b32 v2, v3
s_nop 1
v_max_f32 v2, v2, v3
v_max_f32 v2, 0, v2
v_sub_f32 v184, v184, v2
v_sub_f32 v185, v185, v2
v_sub_f32 v186, v186, v2
v_sub_f32 v187, v187, v2
v_sub_f32 v196, v196, v2
v_sub_f32 v197, v197, v2
v_sub_f32 v198, v198, v2
v_sub_f32 v199, v199, v2
v_sub_f32 v220, v220, v2
v_sub_f32 v221, v221, v2
v_sub_f32 v222, v222, v2
v_sub_f32 v223, v223, v2
v_exp_f32 v3, -v2
s_nop 0
v_mul_f32 v28, v28, v3
v_mul_f32 v29, v29, v3
v_mul_f32 v30, v30, v3
v_mul_f32 v31, v31, v3
v_mul_f32 v40, v40, v3
v_mul_f32 v41, v41, v3
v_mul_f32 v42, v42, v3
v_mul_f32 v43, v43, v3
v_mul_f32 v52, v52, v3
v_mul_f32 v53, v53, v3
v_mul_f32 v54, v54, v3
v_mul_f32 v55, v55, v3
v_mul_f32 v64, v64, v3
v_mul_f32 v65, v65, v3
v_mul_f32 v66, v66, v3
v_mul_f32 v67, v67, v3
v_mul_f32 v76, v76, v3
v_mul_f32 v77, v77, v3
v_mul_f32 v78, v78, v3
v_mul_f32 v79, v79, v3
v_mul_f32 v88, v88, v3
v_mul_f32 v89, v89, v3
v_mul_f32 v90, v90, v3
v_mul_f32 v91, v91, v3
v_mul_f32 v100, v100, v3
v_mul_f32 v101, v101, v3
v_mul_f32 v102, v102, v3
v_mul_f32 v103, v103, v3
v_mul_f32 v112, v112, v3
v_mul_f32 v113, v113, v3
v_mul_f32 v114, v114, v3
v_mul_f32 v115, v115, v3
v_mul_f32 v124, v124, v3
v_mul_f32 v125, v125, v3
v_mul_f32 v126, v126, v3
v_mul_f32 v127, v127, v3
v_exp_f32 v176, v176
v_exp_f32 v177, v177
v_exp_f32 v178, v178
v_exp_f32 v179, v179
v_exp_f32 v188, v188
v_exp_f32 v189, v189
v_exp_f32 v190, v190
v_exp_f32 v191, v191
v_exp_f32 v180, v180
v_exp_f32 v181, v181
v_exp_f32 v182, v182
v_exp_f32 v183, v183
v_exp_f32 v192, v192
v_exp_f32 v193, v193
v_exp_f32 v194, v194
v_exp_f32 v195, v195
v_exp_f32 v184, v184
v_exp_f32 v185, v185
v_exp_f32 v186, v186
v_exp_f32 v187, v187
v_exp_f32 v196, v196
v_exp_f32 v197, v197
v_exp_f32 v198, v198
v_exp_f32 v199, v199
s_nop 0
v_cvt_pk_bf16_f32 v200, v176, v177
v_cvt_pk_bf16_f32 v201, v178, v179
v_cvt_pk_bf16_f32 v202, v188, v189
v_cvt_pk_bf16_f32 v203, v190, v191
v_cvt_pk_bf16_f32 v204, v180, v181
v_cvt_pk_bf16_f32 v205, v182, v183
v_cvt_pk_bf16_f32 v206, v192, v193
v_cvt_pk_bf16_f32 v207, v194, v195
v_cvt_pk_bf16_f32 v208, v184, v185
v_cvt_pk_bf16_f32 v209, v186, v187
v_cvt_pk_bf16_f32 v210, v196, v197
v_cvt_pk_bf16_f32 v211, v198, v199
s_waitcnt vmcnt(8)
s_barrier
s_add_u32 m0, s28, 60672
s_add_u32 s36, s33, 122880
buffer_load_dwordx4 v13, s[16:19], s36 offen nt lds
s_add_u32 m0, s28, 61728
s_add_u32 s36, s33, 123136
buffer_load_dwordx4 v13, s[16:19], s36 offen nt lds
ds_read_b128 v[224:227], v10 offset:8704
ds_read_b128 v[228:231], v10 offset:8768
ds_read_b128 v[232:235], v10 offset:8832
ds_read_b128 v[236:239], v10 offset:8896
ds_read_b128 v[240:243], v10 offset:13056
ds_read_b128 v[244:247], v10 offset:13120
ds_read_b128 v[248:251], v10 offset:13184
ds_read_b128 v[252:255], v10 offset:13248
s_branch W3_R12_back
W3_R13:
s_waitcnt lgkmcnt(0)
v_mfma_f32_16x16x32_bf16 v[20:23], v[224:227], v[200:203], v[20:23]
v_mfma_f32_16x16x32_bf16 v[32:35], v[228:231], v[200:203], v[32:35]
v_mfma_f32_16x16x32_bf16 v[44:47], v[232:235], v[200:203], v[44:47]
v_mfma_f32_16x16x32_bf16 v[56:59], v[236:239], v[200:203], v[56:59]
v_mfma_f32_16x16x32_bf16 v[68:71], v[240:243], v[200:203], v[68:71]
v_mfma_f32_16x16x32_bf16 v[80:83], v[244:247], v[200:203], v[80:83]
v_mfma_f32_16x16x32_bf16 v[92:95], v[248:251], v[200:203], v[92:95]
v_mfma_f32_16x16x32_bf16 v[104:107], v[252:255], v[200:203], v[104:107]
v_mfma_f32_16x16x32_bf16 v[116:119], v[16:19], v[200:203], v[116:119]
v_mfma_f32_16x16x32_bf16 v[24:27], v[224:227], v[204:207], v[24:27]
v_mfma_f32_16x16x32_bf16 v[36:39], v[228:231], v[204:207], v[36:39]
v_mfma_f32_16x16x32_bf16 v[48:51], v[232:235], v[204:207], v[48:51]
v_mfma_f32_16x16x32_bf16 v[60:63], v[236:239], v[204:207], v[60:63]
v_mfma_f32_16x16x32_bf16 v[72:75], v[240:243], v[204:207], v[72:75]
v_mfma_f32_16x16x32_bf16 v[84:87], v[244:247], v[204:207], v[84:87]
v_mfma_f32_16x16x32_bf16 v[96:99], v[248:251], v[204:207], v[96:99]
v_mfma_f32_16x16x32_bf16 v[108:111], v[252:255], v[204:207], v[108:111]
v_mfma_f32_16x16x32_bf16 v[120:123], v[16:19], v[204:207], v[120:123]
v_mfma_f32_16x16x32_bf16 v[28:31], v[224:227], v[208:211], v[28:31]
v_mfma_f32_16x16x32_bf16 v[40:43], v[228:231], v[208:211], v[40:43]
v_mfma_f32_16x16x32_bf16 v[52:55], v[232:235], v[208:211], v[52:55]
v_mfma_f32_16x16x32_bf16 v[64:67], v[236:239], v[208:211], v[64:67]
v_mfma_f32_16x16x32_bf16 v[76:79], v[240:243], v[208:211], v[76:79]
v_mfma_f32_16x16x32_bf16 v[88:91], v[244:247], v[208:211], v[88:91]
v_mfma_f32_16x16x32_bf16 v[100:103], v[248:251], v[208:211], v[100:103]
v_mfma_f32_16x16x32_bf16 v[112:115], v[252:255], v[208:211], v[112:115]
v_mfma_f32_16x16x32_bf16 v[124:127], v[16:19], v[208:211], v[124:127]
s_nop 15
v_max3_f32 v2, v176, v177, v178
v_max3_f32 v2, v2, v179, v188
v_max3_f32 v2, v2, v189, v190
v_max_f32 v2, v2, v191
v_mov_b32 v3, v2
s_nop 1
v_permlane32_swap_b32 v2, v3
s_nop 1
v_max_f32 v2, v2, v3
v_mov_b32 v3, v2
s_nop 1
v_permlane16_swap_b32 v2, v3
s_nop 1
v_max_f32 v2, v2, v3
v_max_f32 v2, 0, v2
v_sub_f32 v176, v176, v2
v_sub_f32 v177, v177, v2
v_sub_f32 v178, v178, v2
v_sub_f32 v179, v179, v2
v_sub_f32 v188, v188, v2
v_sub_f32 v189, v189, v2
v_sub_f32 v190, v190, v2
v_sub_f32 v191, v191, v2
v_sub_f32 v212, v212, v2
v_sub_f32 v213, v213, v2
v_sub_f32 v214, v214, v2
v_sub_f32 v215, v215, v2
v_exp_f32 v3, -v2
s_nop 0
v_mul_f32 v20, v20, v3
v_mul_f32 v21, v21, v3
v_mul_f32 v22, v22, v3
v_mul_f32 v23, v23, v3
v_mul_f32 v32, v32, v3
v_mul_f32 v33, v33, v3
v_mul_f32 v34, v34, v3
v_mul_f32 v35, v35, v3
v_mul_f32 v44, v44, v3
v_mul_f32 v45, v45, v3
v_mul_f32 v46, v46, v3
v_mul_f32 v47, v47, v3
v_mul_f32 v56, v56, v3
v_mul_f32 v57, v57, v3
v_mul_f32 v58, v58, v3
v_mul_f32 v59, v59, v3
v_mul_f32 v68, v68, v3
v_mul_f32 v69, v69, v3
v_mul_f32 v70, v70, v3
v_mul_f32 v71, v71, v3
v_mul_f32 v80, v80, v3
v_mul_f32 v81, v81, v3
v_mul_f32 v82, v82, v3
v_mul_f32 v83, v83, v3
v_mul_f32 v92, v92, v3
v_mul_f32 v93, v93, v3
v_mul_f32 v94, v94, v3
v_mul_f32 v95, v95, v3
v_mul_f32 v104, v104, v3
v_mul_f32 v105, v105, v3
v_mul_f32 v106, v106, v3
v_mul_f32 v107, v107, v3
v_mul_f32 v116, v116, v3
v_mul_f32 v117, v117, v3
v_mul_f32 v118, v118, v3
v_mul_f32 v119, v119, v3
v_max3_f32 v2, v180, v181, v182
v_max3_f32 v2, v2, v183, v192
v_max3_f32 v2, v2, v193, v194
v_max_f32 v2, v2, v195
v_mov_b32 v3, v2
s_nop 1
v_permlane32_swap_b32 v2, v3
s_nop 1
v_max_f32 v2, v2, v3
v_mov_b32 v3, v2
s_nop 1
v_permlane16_swap_b32 v2, v3
s_nop 1
v_max_f32 v2, v2, v3
v_max_f32 v2, 0, v2
v_sub_f32 v180, v180, v2
v_sub_f32 v181, v181, v2
v_sub_f32 v182, v182, v2
v_sub_f32 v183, v183, v2
v_sub_f32 v192, v192, v2
v_sub_f32 v193, v193, v2
v_sub_f32 v194, v194, v2
v_sub_f32 v195, v195, v2
v_sub_f32 v216, v216, v2
v_sub_f32 v217, v217, v2
v_sub_f32 v218, v218, v2
v_sub_f32 v219, v219, v2
v_exp_f32 v3, -v2
s_nop 0
v_mul_f32 v24, v24, v3
v_mul_f32 v25, v25, v3
v_mul_f32 v26, v26, v3
v_mul_f32 v27, v27, v3
v_mul_f32 v36, v36, v3
v_mul_f32 v37, v37, v3
v_mul_f32 v38, v38, v3
v_mul_f32 v39, v39, v3
v_mul_f32 v48, v48, v3
v_mul_f32 v49, v49, v3
v_mul_f32 v50, v50, v3
v_mul_f32 v51, v51, v3
v_mul_f32 v60, v60, v3
v_mul_f32 v61, v61, v3
v_mul_f32 v62, v62, v3
v_mul_f32 v63, v63, v3
v_mul_f32 v72, v72, v3
v_mul_f32 v73, v73, v3
v_mul_f32 v74, v74, v3
v_mul_f32 v75, v75, v3
v_mul_f32 v84, v84, v3
v_mul_f32 v85, v85, v3
v_mul_f32 v86, v86, v3
v_mul_f32 v87, v87, v3
v_mul_f32 v96, v96, v3
v_mul_f32 v97, v97, v3
v_mul_f32 v98, v98, v3
v_mul_f32 v99, v99, v3
v_mul_f32 v108, v108, v3
v_mul_f32 v109, v109, v3
v_mul_f32 v110, v110, v3
v_mul_f32 v111, v111, v3
v_mul_f32 v120, v120, v3
v_mul_f32 v121, v121, v3
v_mul_f32 v122, v122, v3
v_mul_f32 v123, v123, v3
v_max3_f32 v2, v184, v185, v186
v_max3_f32 v2, v2, v187, v196
v_max3_f32 v2, v2, v197, v198
v_max_f32 v2, v2, v199
v_mov_b32 v3, v2
s_nop 1
v_permlane32_swap_b32 v2, v3
s_nop 1
v_max_f32 v2, v2, v3
v_mov_b32 v3, v2
s_nop 1
v_permlane16_swap_b32 v2, v3
s_nop 1
v_max_f32 v2, v2, v3
v_max_f32 v2, 0, v2
v_sub_f32 v184, v184, v2
v_sub_f32 v185, v185, v2
v_sub_f32 v186, v186, v2
v_sub_f32 v187, v187, v2
v_sub_f32 v196, v196, v2
v_sub_f32 v197, v197, v2
v_sub_f32 v198, v198, v2
v_sub_f32 v199, v199, v2
v_sub_f32 v220, v220, v2
v_sub_f32 v221, v221, v2
v_sub_f32 v222, v222, v2
v_sub_f32 v223, v223, v2
v_exp_f32 v3, -v2
s_nop 0
v_mul_f32 v28, v28, v3
v_mul_f32 v29, v29, v3
v_mul_f32 v30, v30, v3
v_mul_f32 v31, v31, v3
v_mul_f32 v40, v40, v3
v_mul_f32 v41, v41, v3
v_mul_f32 v42, v42, v3
v_mul_f32 v43, v43, v3
v_mul_f32 v52, v52, v3
v_mul_f32 v53, v53, v3
v_mul_f32 v54, v54, v3
v_mul_f32 v55, v55, v3
v_mul_f32 v64, v64, v3
v_mul_f32 v65, v65, v3
v_mul_f32 v66, v66, v3
v_mul_f32 v67, v67, v3
v_mul_f32 v76, v76, v3
v_mul_f32 v77, v77, v3
v_mul_f32 v78, v78, v3
v_mul_f32 v79, v79, v3
v_mul_f32 v88, v88, v3
v_mul_f32 v89, v89, v3
v_mul_f32 v90, v90, v3
v_mul_f32 v91, v91, v3
v_mul_f32 v100, v100, v3
v_mul_f32 v101, v101, v3
v_mul_f32 v102, v102, v3
v_mul_f32 v103, v103, v3
v_mul_f32 v112, v112, v3
v_mul_f32 v113, v113, v3
v_mul_f32 v114, v114, v3
v_mul_f32 v115, v115, v3
v_mul_f32 v124, v124, v3
v_mul_f32 v125, v125, v3
v_mul_f32 v126, v126, v3
v_mul_f32 v127, v127, v3
v_exp_f32 v176, v176
v_exp_f32 v177, v177
v_exp_f32 v178, v178
v_exp_f32 v179, v179
v_exp_f32 v188, v188
v_exp_f32 v189, v189
v_exp_f32 v190, v190
v_exp_f32 v191, v191
v_exp_f32 v180, v180
v_exp_f32 v181, v181
v_exp_f32 v182, v182
v_exp_f32 v183, v183
v_exp_f32 v192, v192
v_exp_f32 v193, v193
v_exp_f32 v194, v194
v_exp_f32 v195, v195
v_exp_f32 v184, v184
v_exp_f32 v185, v185
v_exp_f32 v186, v186
v_exp_f32 v187, v187
v_exp_f32 v196, v196
v_exp_f32 v197, v197
v_exp_f32 v198, v198
v_exp_f32 v199, v199
s_nop 0
v_cvt_pk_bf16_f32 v200, v176, v177
v_cvt_pk_bf16_f32 v201, v178, v179
v_cvt_pk_bf16_f32 v202, v188, v189
v_cvt_pk_bf16_f32 v203, v190, v191
v_cvt_pk_bf16_f32 v204, v180, v181
v_cvt_pk_bf16_f32 v205, v182, v183
v_cvt_pk_bf16_f32 v206, v192, v193
v_cvt_pk_bf16_f32 v207, v194, v195
v_cvt_pk_bf16_f32 v208, v184, v185
v_cvt_pk_bf16_f32 v209, v186, v187
v_cvt_pk_bf16_f32 v210, v196, v197
v_cvt_pk_bf16_f32 v211, v198, v199
s_waitcnt vmcnt(6)
s_barrier
s_mul_i32 s36, s63, 5120
v_lshlrev_b32 v8, 4, v0
buffer_load_dwordx4 v[4:7], v8, s[88:91], s36 offen
s_mul_i32 s36, s63, 5120
buffer_load_dwordx4 v[4:7], v8, s[88:91], s36 offen offset:1024
s_mul_i32 s36, s63, 5120
buffer_load_dwordx4 v[4:7], v8, s[88:91], s36 offen offset:2048
s_mul_i32 s36, s63, 5120
buffer_load_dwordx4 v[4:7], v8, s[88:91], s36 offen offset:3072
s_mul_i32 s36, s63, 5120
s_add_u32 s36, s36, 4096
buffer_load_dwordx4 v[4:7], v8, s[88:91], s36 offen
ds_read_b128 v[224:227], v10 offset:34816
ds_read_b128 v[228:231], v10 offset:34880
ds_read_b128 v[232:235], v10 offset:34944
ds_read_b128 v[236:239], v10 offset:35008
ds_read_b128 v[240:243], v10 offset:39168
ds_read_b128 v[244:247], v10 offset:39232
ds_read_b128 v[248:251], v10 offset:39296
ds_read_b128 v[252:255], v10 offset:39360
s_branch W3_R13_back
W3_R14:
s_waitcnt lgkmcnt(0)
v_mfma_f32_16x16x32_bf16 v[20:23], v[224:227], v[200:203], v[20:23]
v_mfma_f32_16x16x32_bf16 v[32:35], v[228:231], v[200:203], v[32:35]
v_mfma_f32_16x16x32_bf16 v[44:47], v[232:235], v[200:203], v[44:47]
v_mfma_f32_16x16x32_bf16 v[56:59], v[236:239], v[200:203], v[56:59]
v_mfma_f32_16x16x32_bf16 v[68:71], v[240:243], v[200:203], v[68:71]
v_mfma_f32_16x16x32_bf16 v[80:83], v[244:247], v[200:203], v[80:83]
v_mfma_f32_16x16x32_bf16 v[92:95], v[248:251], v[200:203], v[92:95]
v_mfma_f32_16x16x32_bf16 v[104:107], v[252:255], v[200:203], v[104:107]
v_mfma_f32_16x16x32_bf16 v[116:119], v[16:19], v[200:203], v[116:119]
v_mfma_f32_16x16x32_bf16 v[24:27], v[224:227], v[204:207], v[24:27]
v_mfma_f32_16x16x32_bf16 v[36:39], v[228:231], v[204:207], v[36:39]
v_mfma_f32_16x16x32_bf16 v[48:51], v[232:235], v[204:207], v[48:51]
v_mfma_f32_16x16x32_bf16 v[60:63], v[236:239], v[204:207], v[60:63]
v_mfma_f32_16x16x32_bf16 v[72:75], v[240:243], v[204:207], v[72:75]
v_mfma_f32_16x16x32_bf16 v[84:87], v[244:247], v[204:207], v[84:87]
v_mfma_f32_16x16x32_bf16 v[96:99], v[248:251], v[204:207], v[96:99]
v_mfma_f32_16x16x32_bf16 v[108:111], v[252:255], v[204:207], v[108:111]
v_mfma_f32_16x16x32_bf16 v[120:123], v[16:19], v[204:207], v[120:123]
v_mfma_f32_16x16x32_bf16 v[28:31], v[224:227], v[208:211], v[28:31]
v_mfma_f32_16x16x32_bf16 v[40:43], v[228:231], v[208:211], v[40:43]
v_mfma_f32_16x16x32_bf16 v[52:55], v[232:235], v[208:211], v[52:55]
v_mfma_f32_16x16x32_bf16 v[64:67], v[236:239], v[208:211], v[64:67]
v_mfma_f32_16x16x32_bf16 v[76:79], v[240:243], v[208:211], v[76:79]
v_mfma_f32_16x16x32_bf16 v[88:91], v[244:247], v[208:211], v[88:91]
v_mfma_f32_16x16x32_bf16 v[100:103], v[248:251], v[208:211], v[100:103]
v_mfma_f32_16x16x32_bf16 v[112:115], v[252:255], v[208:211], v[112:115]
v_mfma_f32_16x16x32_bf16 v[124:127], v[16:19], v[208:211], v[124:127]
s_nop 15
v_max3_f32 v2, v176, v177, v178
v_max3_f32 v2, v2, v179, v188
v_max3_f32 v2, v2, v189, v190
v_max_f32 v2, v2, v191
v_mov_b32 v3, v2
s_nop 1
v_permlane32_swap_b32 v2, v3
s_nop 1
v_max_f32 v2, v2, v3
v_mov_b32 v3, v2
s_nop 1
v_permlane16_swap_b32 v2, v3
s_nop 1
v_max_f32 v2, v2, v3
v_max_f32 v2, 0, v2
v_sub_f32 v176, v176, v2
v_sub_f32 v177, v177, v2
v_sub_f32 v178, v178, v2
v_sub_f32 v179, v179, v2
v_sub_f32 v188, v188, v2
v_sub_f32 v189, v189, v2
v_sub_f32 v190, v190, v2
v_sub_f32 v191, v191, v2
v_sub_f32 v212, v212, v2
v_sub_f32 v213, v213, v2
v_sub_f32 v214, v214, v2
v_sub_f32 v215, v215, v2
v_exp_f32 v3, -v2
s_nop 0
v_mul_f32 v20, v20, v3
v_mul_f32 v21, v21, v3
v_mul_f32 v22, v22, v3
v_mul_f32 v23, v23, v3
v_mul_f32 v32, v32, v3
v_mul_f32 v33, v33, v3
v_mul_f32 v34, v34, v3
v_mul_f32 v35, v35, v3
v_mul_f32 v44, v44, v3
v_mul_f32 v45, v45, v3
v_mul_f32 v46, v46, v3
v_mul_f32 v47, v47, v3
v_mul_f32 v56, v56, v3
v_mul_f32 v57, v57, v3
v_mul_f32 v58, v58, v3
v_mul_f32 v59, v59, v3
v_mul_f32 v68, v68, v3
v_mul_f32 v69, v69, v3
v_mul_f32 v70, v70, v3
v_mul_f32 v71, v71, v3
v_mul_f32 v80, v80, v3
v_mul_f32 v81, v81, v3
v_mul_f32 v82, v82, v3
v_mul_f32 v83, v83, v3
v_mul_f32 v92, v92, v3
v_mul_f32 v93, v93, v3
v_mul_f32 v94, v94, v3
v_mul_f32 v95, v95, v3
v_mul_f32 v104, v104, v3
v_mul_f32 v105, v105, v3
v_mul_f32 v106, v106, v3
v_mul_f32 v107, v107, v3
v_mul_f32 v116, v116, v3
v_mul_f32 v117, v117, v3
v_mul_f32 v118, v118, v3
v_mul_f32 v119, v119, v3
v_max3_f32 v2, v180, v181, v182
v_max3_f32 v2, v2, v183, v192
v_max3_f32 v2, v2, v193, v194
v_max_f32 v2, v2, v195
v_mov_b32 v3, v2
s_nop 1
v_permlane32_swap_b32 v2, v3
s_nop 1
v_max_f32 v2, v2, v3
v_mov_b32 v3, v2
s_nop 1
v_permlane16_swap_b32 v2, v3
s_nop 1
v_max_f32 v2, v2, v3
v_max_f32 v2, 0, v2
v_sub_f32 v180, v180, v2
v_sub_f32 v181, v181, v2
v_sub_f32 v182, v182, v2
v_sub_f32 v183, v183, v2
v_sub_f32 v192, v192, v2
v_sub_f32 v193, v193, v2
v_sub_f32 v194, v194, v2
v_sub_f32 v195, v195, v2
v_sub_f32 v216, v216, v2
v_sub_f32 v217, v217, v2
v_sub_f32 v218, v218, v2
v_sub_f32 v219, v219, v2
v_exp_f32 v3, -v2
s_nop 0
v_mul_f32 v24, v24, v3
v_mul_f32 v25, v25, v3
v_mul_f32 v26, v26, v3
v_mul_f32 v27, v27, v3
v_mul_f32 v36, v36, v3
v_mul_f32 v37, v37, v3
v_mul_f32 v38, v38, v3
v_mul_f32 v39, v39, v3
v_mul_f32 v48, v48, v3
v_mul_f32 v49, v49, v3
v_mul_f32 v50, v50, v3
v_mul_f32 v51, v51, v3
v_mul_f32 v60, v60, v3
v_mul_f32 v61, v61, v3
v_mul_f32 v62, v62, v3
v_mul_f32 v63, v63, v3
v_mul_f32 v72, v72, v3
v_mul_f32 v73, v73, v3
v_mul_f32 v74, v74, v3
v_mul_f32 v75, v75, v3
v_mul_f32 v84, v84, v3
v_mul_f32 v85, v85, v3
v_mul_f32 v86, v86, v3
v_mul_f32 v87, v87, v3
v_mul_f32 v96, v96, v3
v_mul_f32 v97, v97, v3
v_mul_f32 v98, v98, v3
v_mul_f32 v99, v99, v3
v_mul_f32 v108, v108, v3
v_mul_f32 v109, v109, v3
v_mul_f32 v110, v110, v3
v_mul_f32 v111, v111, v3
v_mul_f32 v120, v120, v3
v_mul_f32 v121, v121, v3
v_mul_f32 v122, v122, v3
v_mul_f32 v123, v123, v3
v_max3_f32 v2, v184, v185, v186
v_max3_f32 v2, v2, v187, v196
v_max3_f32 v2, v2, v197, v198
v_max_f32 v2, v2, v199
v_mov_b32 v3, v2
s_nop 1
v_permlane32_swap_b32 v2, v3
s_nop 1
v_max_f32 v2, v2, v3
v_mov_b32 v3, v2
s_nop 1
v_permlane16_swap_b32 v2, v3
s_nop 1
v_max_f32 v2, v2, v3
v_max_f32 v2, 0, v2
v_sub_f32 v184, v184, v2
v_sub_f32 v185, v185, v2
v_sub_f32 v186, v186, v2
v_sub_f32 v187, v187, v2
v_sub_f32 v196, v196, v2
v_sub_f32 v197, v197, v2
v_sub_f32 v198, v198, v2
v_sub_f32 v199, v199, v2
v_sub_f32 v220, v220, v2
v_sub_f32 v221, v221, v2
v_sub_f32 v222, v222, v2
v_sub_f32 v223, v223, v2
v_exp_f32 v3, -v2
s_nop 0
v_mul_f32 v28, v28, v3
v_mul_f32 v29, v29, v3
v_mul_f32 v30, v30, v3
v_mul_f32 v31, v31, v3
v_mul_f32 v40, v40, v3
v_mul_f32 v41, v41, v3
v_mul_f32 v42, v42, v3
v_mul_f32 v43, v43, v3
v_mul_f32 v52, v52, v3
v_mul_f32 v53, v53, v3
v_mul_f32 v54, v54, v3
v_mul_f32 v55, v55, v3
v_mul_f32 v64, v64, v3
v_mul_f32 v65, v65, v3
v_mul_f32 v66, v66, v3
v_mul_f32 v67, v67, v3
v_mul_f32 v76, v76, v3
v_mul_f32 v77, v77, v3
v_mul_f32 v78, v78, v3
v_mul_f32 v79, v79, v3
v_mul_f32 v88, v88, v3
v_mul_f32 v89, v89, v3
v_mul_f32 v90, v90, v3
v_mul_f32 v91, v91, v3
v_mul_f32 v100, v100, v3
v_mul_f32 v101, v101, v3
v_mul_f32 v102, v102, v3
v_mul_f32 v103, v103, v3
v_mul_f32 v112, v112, v3
v_mul_f32 v113, v113, v3
v_mul_f32 v114, v114, v3
v_mul_f32 v115, v115, v3
v_mul_f32 v124, v124, v3
v_mul_f32 v125, v125, v3
v_mul_f32 v126, v126, v3
v_mul_f32 v127, v127, v3
v_exp_f32 v176, v176
v_exp_f32 v177, v177
v_exp_f32 v178, v178
v_exp_f32 v179, v179
v_exp_f32 v188, v188
v_exp_f32 v189, v189
v_exp_f32 v190, v190
v_exp_f32 v191, v191
v_exp_f32 v180, v180
v_exp_f32 v181, v181
v_exp_f32 v182, v182
v_exp_f32 v183, v183
v_exp_f32 v192, v192
v_exp_f32 v193, v193
v_exp_f32 v194, v194
v_exp_f32 v195, v195
v_exp_f32 v184, v184
v_exp_f32 v185, v185
v_exp_f32 v186, v186
v_exp_f32 v187, v187
v_exp_f32 v196, v196
v_exp_f32 v197, v197
v_exp_f32 v198, v198
v_exp_f32 v199, v199
s_nop 0
v_cvt_pk_bf16_f32 v200, v176, v177
v_cvt_pk_bf16_f32 v201, v178, v179
v_cvt_pk_bf16_f32 v202, v188, v189
v_cvt_pk_bf16_f32 v203, v190, v191
v_cvt_pk_bf16_f32 v204, v180, v181
v_cvt_pk_bf16_f32 v205, v182, v183
v_cvt_pk_bf16_f32 v206, v192, v193
v_cvt_pk_bf16_f32 v207, v194, v195
v_cvt_pk_bf16_f32 v208, v184, v185
v_cvt_pk_bf16_f32 v209, v186, v187
v_cvt_pk_bf16_f32 v210, v196, v197
v_cvt_pk_bf16_f32 v211, v198, v199
s_waitcnt vmcnt(7)
s_barrier
ds_read_b128 v[224:227], v10 offset:43520
ds_read_b128 v[228:231], v10 offset:43584
ds_read_b128 v[232:235], v10 offset:43648
ds_read_b128 v[236:239], v10 offset:43712
ds_read_b128 v[240:243], v10 offset:47872
ds_read_b128 v[244:247], v10 offset:47936
ds_read_b128 v[248:251], v10 offset:48000
ds_read_b128 v[252:255], v10 offset:48064
s_branch W3_R14_back
W3_R15:
s_waitcnt lgkmcnt(0)
v_mfma_f32_16x16x32_bf16 v[20:23], v[224:227], v[200:203], v[20:23]
v_mfma_f32_16x16x32_bf16 v[32:35], v[228:231], v[200:203], v[32:35]
v_mfma_f32_16x16x32_bf16 v[44:47], v[232:235], v[200:203], v[44:47]
v_mfma_f32_16x16x32_bf16 v[56:59], v[236:239], v[200:203], v[56:59]
v_mfma_f32_16x16x32_bf16 v[68:71], v[240:243], v[200:203], v[68:71]
v_mfma_f32_16x16x32_bf16 v[80:83], v[244:247], v[200:203], v[80:83]
v_mfma_f32_16x16x32_bf16 v[92:95], v[248:251], v[200:203], v[92:95]
v_mfma_f32_16x16x32_bf16 v[104:107], v[252:255], v[200:203], v[104:107]
v_mfma_f32_16x16x32_bf16 v[116:119], v[16:19], v[200:203], v[116:119]
v_mfma_f32_16x16x32_bf16 v[24:27], v[224:227], v[204:207], v[24:27]
v_mfma_f32_16x16x32_bf16 v[36:39], v[228:231], v[204:207], v[36:39]
v_mfma_f32_16x16x32_bf16 v[48:51], v[232:235], v[204:207], v[48:51]
v_mfma_f32_16x16x32_bf16 v[60:63], v[236:239], v[204:207], v[60:63]
v_mfma_f32_16x16x32_bf16 v[72:75], v[240:243], v[204:207], v[72:75]
v_mfma_f32_16x16x32_bf16 v[84:87], v[244:247], v[204:207], v[84:87]
v_mfma_f32_16x16x32_bf16 v[96:99], v[248:251], v[204:207], v[96:99]
v_mfma_f32_16x16x32_bf16 v[108:111], v[252:255], v[204:207], v[108:111]
v_mfma_f32_16x16x32_bf16 v[120:123], v[16:19], v[204:207], v[120:123]
v_mfma_f32_16x16x32_bf16 v[28:31], v[224:227], v[208:211], v[28:31]
v_mfma_f32_16x16x32_bf16 v[40:43], v[228:231], v[208:211], v[40:43]
v_mfma_f32_16x16x32_bf16 v[52:55], v[232:235], v[208:211], v[52:55]
v_mfma_f32_16x16x32_bf16 v[64:67], v[236:239], v[208:211], v[64:67]
v_mfma_f32_16x16x32_bf16 v[76:79], v[240:243], v[208:211], v[76:79]
v_mfma_f32_16x16x32_bf16 v[88:91], v[244:247], v[208:211], v[88:91]
v_mfma_f32_16x16x32_bf16 v[100:103], v[248:251], v[208:211], v[100:103]
v_mfma_f32_16x16x32_bf16 v[112:115], v[252:255], v[208:211], v[112:115]
v_mfma_f32_16x16x32_bf16 v[124:127], v[16:19], v[208:211], v[124:127]
s_nop 15
v_max3_f32 v2, v176, v177, v178
v_max3_f32 v2, v2, v179, v188
v_max3_f32 v2, v2, v189, v190
v_max_f32 v2, v2, v191
v_mov_b32 v3, v2
s_nop 1
v_permlane32_swap_b32 v2, v3
s_nop 1
v_max_f32 v2, v2, v3
v_mov_b32 v3, v2
s_nop 1
v_permlane16_swap_b32 v2, v3
s_nop 1
v_max_f32 v2, v2, v3
v_max_f32 v2, 0, v2
v_sub_f32 v176, v176, v2
v_sub_f32 v177, v177, v2
v_sub_f32 v178, v178, v2
v_sub_f32 v179, v179, v2
v_sub_f32 v188, v188, v2
v_sub_f32 v189, v189, v2
v_sub_f32 v190, v190, v2
v_sub_f32 v191, v191, v2
v_sub_f32 v212, v212, v2
v_sub_f32 v213, v213, v2
v_sub_f32 v214, v214, v2
v_sub_f32 v215, v215, v2
v_exp_f32 v3, -v2
s_nop 0
v_mul_f32 v20, v20, v3
v_mul_f32 v21, v21, v3
v_mul_f32 v22, v22, v3
v_mul_f32 v23, v23, v3
v_mul_f32 v32, v32, v3
v_mul_f32 v33, v33, v3
v_mul_f32 v34, v34, v3
v_mul_f32 v35, v35, v3
v_mul_f32 v44, v44, v3
v_mul_f32 v45, v45, v3
v_mul_f32 v46, v46, v3
v_mul_f32 v47, v47, v3
v_mul_f32 v56, v56, v3
v_mul_f32 v57, v57, v3
v_mul_f32 v58, v58, v3
v_mul_f32 v59, v59, v3
v_mul_f32 v68, v68, v3
v_mul_f32 v69, v69, v3
v_mul_f32 v70, v70, v3
v_mul_f32 v71, v71, v3
v_mul_f32 v80, v80, v3
v_mul_f32 v81, v81, v3
v_mul_f32 v82, v82, v3
v_mul_f32 v83, v83, v3
v_mul_f32 v92, v92, v3
v_mul_f32 v93, v93, v3
v_mul_f32 v94, v94, v3
v_mul_f32 v95, v95, v3
v_mul_f32 v104, v104, v3
v_mul_f32 v105, v105, v3
v_mul_f32 v106, v106, v3
v_mul_f32 v107, v107, v3
v_mul_f32 v116, v116, v3
v_mul_f32 v117, v117, v3
v_mul_f32 v118, v118, v3
v_mul_f32 v119, v119, v3
v_max3_f32 v2, v180, v181, v182
v_max3_f32 v2, v2, v183, v192
v_max3_f32 v2, v2, v193, v194
v_max_f32 v2, v2, v195
v_mov_b32 v3, v2
s_nop 1
v_permlane32_swap_b32 v2, v3
s_nop 1
v_max_f32 v2, v2, v3
v_mov_b32 v3, v2
s_nop 1
v_permlane16_swap_b32 v2, v3
s_nop 1
v_max_f32 v2, v2, v3
v_max_f32 v2, 0, v2
v_sub_f32 v180, v180, v2
v_sub_f32 v181, v181, v2
v_sub_f32 v182, v182, v2
v_sub_f32 v183, v183, v2
v_sub_f32 v192, v192, v2
v_sub_f32 v193, v193, v2
v_sub_f32 v194, v194, v2
v_sub_f32 v195, v195, v2
v_sub_f32 v216, v216, v2
v_sub_f32 v217, v217, v2
v_sub_f32 v218, v218, v2
v_sub_f32 v219, v219, v2
v_exp_f32 v3, -v2
s_nop 0
v_mul_f32 v24, v24, v3
v_mul_f32 v25, v25, v3
v_mul_f32 v26, v26, v3
v_mul_f32 v27, v27, v3
v_mul_f32 v36, v36, v3
v_mul_f32 v37, v37, v3
v_mul_f32 v38, v38, v3
v_mul_f32 v39, v39, v3
v_mul_f32 v48, v48, v3
v_mul_f32 v49, v49, v3
v_mul_f32 v50, v50, v3
v_mul_f32 v51, v51, v3
v_mul_f32 v60, v60, v3
v_mul_f32 v61, v61, v3
v_mul_f32 v62, v62, v3
v_mul_f32 v63, v63, v3
v_mul_f32 v72, v72, v3
v_mul_f32 v73, v73, v3
v_mul_f32 v74, v74, v3
v_mul_f32 v75, v75, v3
v_mul_f32 v84, v84, v3
v_mul_f32 v85, v85, v3
v_mul_f32 v86, v86, v3
v_mul_f32 v87, v87, v3
v_mul_f32 v96, v96, v3
v_mul_f32 v97, v97, v3
v_mul_f32 v98, v98, v3
v_mul_f32 v99, v99, v3
v_mul_f32 v108, v108, v3
v_mul_f32 v109, v109, v3
v_mul_f32 v110, v110, v3
v_mul_f32 v111, v111, v3
v_mul_f32 v120, v120, v3
v_mul_f32 v121, v121, v3
v_mul_f32 v122, v122, v3
v_mul_f32 v123, v123, v3
v_max3_f32 v2, v184, v185, v186
v_max3_f32 v2, v2, v187, v196
v_max3_f32 v2, v2, v197, v198
v_max_f32 v2, v2, v199
v_mov_b32 v3, v2
s_nop 1
v_permlane32_swap_b32 v2, v3
s_nop 1
v_max_f32 v2, v2, v3
v_mov_b32 v3, v2
s_nop 1
v_permlane16_swap_b32 v2, v3
s_nop 1
v_max_f32 v2, v2, v3
v_max_f32 v2, 0, v2
v_sub_f32 v184, v184, v2
v_sub_f32 v185, v185, v2
v_sub_f32 v186, v186, v2
v_sub_f32 v187, v187, v2
v_sub_f32 v196, v196, v2
v_sub_f32 v197, v197, v2
v_sub_f32 v198, v198, v2
v_sub_f32 v199, v199, v2
v_sub_f32 v220, v220, v2
v_sub_f32 v221, v221, v2
v_sub_f32 v222, v222, v2
v_sub_f32 v223, v223, v2
v_exp_f32 v3, -v2
s_nop 0
v_mul_f32 v28, v28, v3
v_mul_f32 v29, v29, v3
v_mul_f32 v30, v30, v3
v_mul_f32 v31, v31, v3
v_mul_f32 v40, v40, v3
v_mul_f32 v41, v41, v3
v_mul_f32 v42, v42, v3
v_mul_f32 v43, v43, v3
v_mul_f32 v52, v52, v3
v_mul_f32 v53, v53, v3
v_mul_f32 v54, v54, v3
v_mul_f32 v55, v55, v3
v_mul_f32 v64, v64, v3
v_mul_f32 v65, v65, v3
v_mul_f32 v66, v66, v3
v_mul_f32 v67, v67, v3
v_mul_f32 v76, v76, v3
v_mul_f32 v77, v77, v3
v_mul_f32 v78, v78, v3
v_mul_f32 v79, v79, v3
v_mul_f32 v88, v88, v3
v_mul_f32 v89, v89, v3
v_mul_f32 v90, v90, v3
v_mul_f32 v91, v91, v3
v_mul_f32 v100, v100, v3
v_mul_f32 v101, v101, v3
v_mul_f32 v102, v102, v3
v_mul_f32 v103, v103, v3
v_mul_f32 v112, v112, v3
v_mul_f32 v113, v113, v3
v_mul_f32 v114, v114, v3
v_mul_f32 v115, v115, v3
v_mul_f32 v124, v124, v3
v_mul_f32 v125, v125, v3
v_mul_f32 v126, v126, v3
v_mul_f32 v127, v127, v3
v_exp_f32 v176, v176
v_exp_f32 v177, v177
v_exp_f32 v178, v178
v_exp_f32 v179, v179
v_exp_f32 v188, v188
v_exp_f32 v189, v189
v_exp_f32 v190, v190
v_exp_f32 v191, v191
v_exp_f32 v180, v180
v_exp_f32 v181, v181
v_exp_f32 v182, v182
v_exp_f32 v183, v183
v_exp_f32 v192, v192
v_exp_f32 v193, v193
v_exp_f32 v194, v194
v_exp_f32 v195, v195
v_exp_f32 v184, v184
v_exp_f32 v185, v185
v_exp_f32 v186, v186
v_exp_f32 v187, v187
v_exp_f32 v196, v196
v_exp_f32 v197, v197
v_exp_f32 v198, v198
v_exp_f32 v199, v199
s_nop 0
v_cvt_pk_bf16_f32 v200, v176, v177
v_cvt_pk_bf16_f32 v201, v178, v179
v_cvt_pk_bf16_f32 v202, v188, v189
v_cvt_pk_bf16_f32 v203, v190, v191
v_cvt_pk_bf16_f32 v204, v180, v181
v_cvt_pk_bf16_f32 v205, v182, v183
v_cvt_pk_bf16_f32 v206, v192, v193
v_cvt_pk_bf16_f32 v207, v194, v195
v_cvt_pk_bf16_f32 v208, v184, v185
v_cvt_pk_bf16_f32 v209, v186, v187
v_cvt_pk_bf16_f32 v210, v196, v197
v_cvt_pk_bf16_f32 v211, v198, v199
s_waitcnt vmcnt(5)
s_barrier
s_branch W3_R15_back
K1_end:
s_endpgm
G_entry:
s_load_dwordx2 s[4:5], s[0:1], 32
s_load_dwordx2 s[6:7], s[0:1], 72
s_load_dwordx4 s[8:11], s[0:1], 80
s_load_dwordx2 s[56:57], s[0:1], 96
v_lshrrev_b32 v1, 6, v0
v_and_b32 v0, 63, v0
v_readfirstlane_b32 s20, v1
s_sub_u32 s21, s2, 256
s_lshr_b32 s22, s21, 3
s_and_b32 s21, s21, 7
s_lshr_b32 s23, s21, 2
s_and_b32 s24, s21, 3
s_mul_i32 s25, s22, 52
s_lshr_b32 s25, s25, 8
s_mul_i32 s26, s25, 5
s_sub_u32 s26, s22, s26
s_and_b32 s27, s20, 1
s_lshr_b32 s28, s20, 1
v_lshlrev_b32 v15, 4, v0
v_lshrrev_b32 v2, 4, v0
v_and_b32 v5, 15, v0
v_mul_u32_u24 v10, 10240, v2
v_lshl_add_u32 v10, v5, 4, v10
v_lshrrev_b32 v7, 2, v0
v_and_b32 v7, 3, v7
v_and_b32 v8, 1, v2
v_lshl_add_u32 v9, v8, 2, v7
v_mul_u32_u24 v11, 1056, v9
v_lshrrev_b32 v3, 1, v2
v_lshl_add_u32 v11, v3, 8, v11
v_and_b32 v4, 3, v0
v_lshl_add_u32 v11, v4, 3, v11
s_lshl_b32 s36, s28, 6
s_add_u32 s36, s36, 24576
v_add_u32 v11, s36, v11
s_mul_i32 s36, s27, 12288
v_add_u32 v12, s36, v15
v_add_u32 v18, 41472, v11
v_add_u32 v19, 41472, v12
v_add_u32 v20, 82944, v11
v_add_u32 v21, 82944, v12
v_mov_b32 v16, v11
v_mov_b32 v17, v12
s_mul_i32 s40, s25, 12
s_mul_i32 s41, s40, 57
s_lshr_b32 s41, s41, 9
s_add_u32 s40, s40, 11
s_mul_i32 s42, s40, 57
s_lshr_b32 s42, s42, 9
s_lshl_b32 s43, s23, 3
s_add_u32 s41, s41, s43
s_add_u32 s42, s42, s43
s_lshl_b32 s41, s41, 7
s_lshl_b32 s42, s42, 7
s_lshl_b32 s43, s24, 5
s_add_u32 s43, s43, 33554432
s_add_u32 s41, s41, s43
s_add_u32 s42, s42, s43
v_mov_b32 v22, s41
v_mov_b32 v23, s42
v_and_b32 v2, 8, v0
v_cmp_eq_u32 vcc, 0, v2
v_and_b32 v3, 7, v0
s_nop 0
v_cndmask_b32 v22, v23, v22, vcc
v_lshl_add_u32 v22, v3, 2, v22
s_waitcnt lgkmcnt(0)
s_mov_b32 s44, s10
s_mov_b32 s45, s11
s_cmp_eq_u32 s23, 0
s_cselect_b32 s12, s4, s6
s_cselect_b32 s13, s5, s7
s_lshl_b32 s36, s26, 8
s_mul_i32 s37, s24, 1310720
s_add_u32 s36, s36, s37
s_add_u32 s12, s12, s36
s_addc_u32 s13, s13, 0
s_sub_u32 s14, 5242880, s36
s_mov_b32 s15, 0x20000
s_mul_i32 s30, s23, 9437184
s_mul_i32 s31, s25, 1572864
s_add_u32 s30, s30, s31
s_lshl_b32 s31, s24, 15
s_add_u32 s30, s30, s31
s_add_u32 s16, s56, s30
s_addc_u32 s17, s57, 0
s_sub_u32 s18, 1572864, s31
s_mov_b32 s19, 0x20000
s_mul_i32 s36, s20, 3
s_add_u32 s36, s36, 0
s_lshr_b32 s37, s36, 1
s_lshl_b32 s37, s37, 17
s_and_b32 s38, s36, 1
s_lshl_b32 s38, s38, 10
s_add_u32 s30, s37, s38
s_mul_i32 s36, s20, 3
s_add_u32 s36, s36, 1
s_lshr_b32 s37, s36, 1
s_lshl_b32 s37, s37, 17
s_and_b32 s38, s36, 1
s_lshl_b32 s38, s38, 10
s_add_u32 s31, s37, s38
s_mul_i32 s36, s20, 3
s_add_u32 s36, s36, 2
s_lshr_b32 s37, s36, 1
s_lshl_b32 s37, s37, 17
s_and_b32 s38, s36, 1
s_lshl_b32 s38, s38, 10
s_add_u32 s32, s37, s38
s_mul_i32 s33, s20, 3072
s_lshl_b32 s36, s20, 1
s_and_b32 s37, s36, 7
s_lshr_b32 s38, s36, 3
s_lshl_b32 s38, s38, 5
s_add_u32 s37, s37, s38
s_mul_i32 s34, s37, 1280
s_mul_i32 s35, s36, 1056
s_add_u32 s35, s35, 24576
v_mov_b32 v2, 0
global_load_dword v3, v2, s[44:45] sc1
s_cmp_lg_u32 s20, 0
s_cbranch_scc1 GW_21
global_load_dword v23, v22, s[56:57] sc1
GW_21:
s_add_u32 m0, s35, 0
s_add_u32 s36, s34, 0
buffer_load_dwordx4 v10, s[12:15], s36 offen  lds
s_add_u32 m0, s35, 1056
s_add_u32 s36, s34, 1280
buffer_load_dwordx4 v10, s[12:15], s36 offen  lds
s_add_u32 m0, s35, 41472
s_add_u32 s36, s34, 81920
buffer_load_dwordx4 v10, s[12:15], s36 offen  lds
s_add_u32 m0, s35, 42528
s_add_u32 s36, s34, 83200
buffer_load_dwordx4 v10, s[12:15], s36 offen  lds
s_add_u32 m0, s35, 82944
s_add_u32 s36, s34, 163840
buffer_load_dwordx4 v10, s[12:15], s36 offen  lds
s_add_u32 m0, s35, 84000
s_add_u32 s36, s34, 165120
buffer_load_dwordx4 v10, s[12:15], s36 offen  lds
s_waitcnt vmcnt(6)
v_readfirstlane_b32 s51, v3
s_cmp_lg_u32 s51, 0
s_cbranch_scc1 NK_22
v_mov_b32 v2, 0
s_mov_b32 s50, 0x40000
NS_23:
s_sub_u32 s50, s50, 1
s_cbranch_scc1 NO_24
global_load_dword v3, v2, s[44:45] sc1
s_waitcnt vmcnt(0)
v_readfirstlane_b32 s51, v3
s_cmp_lg_u32 s51, 0
s_cbranch_scc1 NO_24
s_sleep 2
s_branch NS_23
NO_24:
NK_22:
s_cmp_lg_u32 s20, 0
s_cbranch_scc1 GN_25
v_cmp_eq_u32 vcc, s51, v23
s_nop 1
s_and_b32 s46, vcc_lo, 0xffff
s_cmp_eq_u32 s46, 0xffff
s_cbranch_scc1 GO_26
s_mov_b32 s50, 0x40000
GS_27:
s_sub_u32 s50, s50, 1
s_cbranch_scc1 GO_26
s_sleep 4
global_load_dword v23, v22, s[56:57] sc1
s_waitcnt vmcnt(0)
v_cmp_eq_u32 vcc, s51, v23
s_nop 1
s_and_b32 s46, vcc_lo, 0xffff
s_cmp_eq_u32 s46, 0xffff
s_cbranch_scc1 GO_26
s_branch GS_27
GO_26:
GN_25:
s_barrier
s_add_u32 m0, s33, 0
s_add_u32 s36, s30, 0
buffer_load_dwordx4 v15, s[16:19], s36 offen  lds
s_add_u32 m0, s33, 1024
s_add_u32 s36, s31, 0
buffer_load_dwordx4 v15, s[16:19], s36 offen  lds
s_add_u32 m0, s33, 2048
s_add_u32 s36, s32, 0
buffer_load_dwordx4 v15, s[16:19], s36 offen  lds
s_add_u32 m0, s33, 41472
s_add_u32 s36, s30, 2048
buffer_load_dwordx4 v15, s[16:19], s36 offen  lds
s_add_u32 m0, s33, 42496
s_add_u32 s36, s31, 2048
buffer_load_dwordx4 v15, s[16:19], s36 offen  lds
s_add_u32 m0, s33, 43520
s_add_u32 s36, s32, 2048
buffer_load_dwordx4 v15, s[16:19], s36 offen  lds
s_add_u32 m0, s33, 82944
s_add_u32 s36, s30, 4096
buffer_load_dwordx4 v15, s[16:19], s36 offen  lds
s_add_u32 m0, s33, 83968
s_add_u32 s36, s31, 4096
buffer_load_dwordx4 v15, s[16:19], s36 offen  lds
s_add_u32 m0, s33, 84992
s_add_u32 s36, s32, 4096
buffer_load_dwordx4 v15, s[16:19], s36 offen  lds
s_waitcnt vmcnt(6)
s_barrier
ds_read_b64_tr_b16 v[168:169], v16 offset:0
ds_read_b64_tr_b16 v[170:171], v16 offset:512
ds_read_b64_tr_b16 v[172:173], v16 offset:32
ds_read_b64_tr_b16 v[174:175], v16 offset:544
ds_read_b128 v[72:75], v17 offset:0
ds_read_b128 v[76:79], v17 offset:2048
ds_read_b128 v[80:83], v17 offset:4096
ds_read_b128 v[84:87], v17 offset:6144
ds_read_b128 v[88:91], v17 offset:8192
ds_read_b128 v[92:95], v17 offset:10240
ds_read_b64_tr_b16 v[176:177], v16 offset:8448
ds_read_b64_tr_b16 v[178:179], v16 offset:8960
ds_read_b64_tr_b16 v[180:181], v16 offset:8480
ds_read_b64_tr_b16 v[182:183], v16 offset:8992
ds_read_b128 v[96:99], v17 offset:1024
ds_read_b128 v[100:103], v17 offset:3072
ds_read_b128 v[104:107], v17 offset:5120
ds_read_b128 v[108:111], v17 offset:7168
ds_read_b128 v[112:115], v17 offset:9216
ds_read_b128 v[116:119], v17 offset:11264
s_waitcnt vmcnt(3) lgkmcnt(0)
s_barrier
v_mfma_f32_16x16x32_bf16 v[24:27], v[168:171], v[72:75], 0
s_add_u32 m0, s33, 0
s_add_u32 s36, s30, 6144
buffer_load_dwordx4 v15, s[16:19], s36 offen  lds
ds_read_b64_tr_b16 v[184:185], v18 offset:0
v_mfma_f32_16x16x32_bf16 v[28:31], v[168:171], v[76:79], 0
ds_read_b64_tr_b16 v[186:187], v18 offset:512
v_mfma_f32_16x16x32_bf16 v[32:35], v[168:171], v[80:83], 0
ds_read_b64_tr_b16 v[188:189], v18 offset:32
v_mfma_f32_16x16x32_bf16 v[36:39], v[168:171], v[84:87], 0
ds_read_b64_tr_b16 v[190:191], v18 offset:544
v_mfma_f32_16x16x32_bf16 v[40:43], v[168:171], v[88:91], 0
s_add_u32 m0, s33, 1024
s_add_u32 s36, s31, 6144
buffer_load_dwordx4 v15, s[16:19], s36 offen  lds
v_mfma_f32_16x16x32_bf16 v[44:47], v[168:171], v[92:95], 0
ds_read_b128 v[120:123], v19 offset:0
v_mfma_f32_16x16x32_bf16 v[48:51], v[172:175], v[72:75], 0
ds_read_b128 v[124:127], v19 offset:2048
v_mfma_f32_16x16x32_bf16 v[52:55], v[172:175], v[76:79], 0
ds_read_b128 v[128:131], v19 offset:4096
v_mfma_f32_16x16x32_bf16 v[56:59], v[172:175], v[80:83], 0
ds_read_b128 v[132:135], v19 offset:6144
v_mfma_f32_16x16x32_bf16 v[60:63], v[172:175], v[84:87], 0
s_add_u32 m0, s33, 2048
s_add_u32 s36, s32, 6144
buffer_load_dwordx4 v15, s[16:19], s36 offen  lds
v_mfma_f32_16x16x32_bf16 v[64:67], v[172:175], v[88:91], 0
ds_read_b128 v[136:139], v19 offset:8192
v_mfma_f32_16x16x32_bf16 v[68:71], v[172:175], v[92:95], 0
ds_read_b128 v[140:143], v19 offset:10240
v_mfma_f32_16x16x32_bf16 v[24:27], v[176:179], v[96:99], v[24:27]
ds_read_b64_tr_b16 v[192:193], v18 offset:8448
v_mfma_f32_16x16x32_bf16 v[28:31], v[176:179], v[100:103], v[28:31]
ds_read_b64_tr_b16 v[194:195], v18 offset:8960
v_mfma_f32_16x16x32_bf16 v[32:35], v[176:179], v[104:107], v[32:35]
s_add_u32 m0, s35, 0
s_add_u32 s36, s34, 245760
buffer_load_dwordx4 v10, s[12:15], s36 offen  lds
v_mfma_f32_16x16x32_bf16 v[36:39], v[176:179], v[108:111], v[36:39]
ds_read_b64_tr_b16 v[196:197], v18 offset:8480
v_mfma_f32_16x16x32_bf16 v[40:43], v[176:179], v[112:115], v[40:43]
ds_read_b64_tr_b16 v[198:199], v18 offset:8992
v_mfma_f32_16x16x32_bf16 v[44:47], v[176:179], v[116:119], v[44:47]
ds_read_b128 v[144:147], v19 offset:1024
v_mfma_f32_16x16x32_bf16 v[48:51], v[180:183], v[96:99], v[48:51]
ds_read_b128 v[148:151], v19 offset:3072
v_mfma_f32_16x16x32_bf16 v[52:55], v[180:183], v[100:103], v[52:55]
s_add_u32 m0, s35, 1056
s_add_u32 s36, s34, 247040
buffer_load_dwordx4 v10, s[12:15], s36 offen  lds
v_mfma_f32_16x16x32_bf16 v[56:59], v[180:183], v[104:107], v[56:59]
ds_read_b128 v[152:155], v19 offset:5120
v_mfma_f32_16x16x32_bf16 v[60:63], v[180:183], v[108:111], v[60:63]
ds_read_b128 v[156:159], v19 offset:7168
v_mfma_f32_16x16x32_bf16 v[64:67], v[180:183], v[112:115], v[64:67]
ds_read_b128 v[160:163], v19 offset:9216
v_mfma_f32_16x16x32_bf16 v[68:71], v[180:183], v[116:119], v[68:71]
ds_read_b128 v[164:167], v19 offset:11264
s_waitcnt vmcnt(5) lgkmcnt(0)
s_barrier
v_mfma_f32_16x16x32_bf16 v[24:27], v[184:187], v[120:123], v[24:27]
s_add_u32 m0, s33, 41472
s_add_u32 s36, s30, 8192
buffer_load_dwordx4 v15, s[16:19], s36 offen  lds
ds_read_b64_tr_b16 v[168:169], v20 offset:0
v_mfma_f32_16x16x32_bf16 v[28:31], v[184:187], v[124:127], v[28:31]
ds_read_b64_tr_b16 v[170:171], v20 offset:512
v_mfma_f32_16x16x32_bf16 v[32:35], v[184:187], v[128:131], v[32:35]
ds_read_b64_tr_b16 v[172:173], v20 offset:32
v_mfma_f32_16x16x32_bf16 v[36:39], v[184:187], v[132:135], v[36:39]
ds_read_b64_tr_b16 v[174:175], v20 offset:544
v_mfma_f32_16x16x32_bf16 v[40:43], v[184:187], v[136:139], v[40:43]
s_add_u32 m0, s33, 42496
s_add_u32 s36, s31, 8192
buffer_load_dwordx4 v15, s[16:19], s36 offen  lds
v_mfma_f32_16x16x32_bf16 v[44:47], v[184:187], v[140:143], v[44:47]
ds_read_b128 v[72:75], v21 offset:0
v_mfma_f32_16x16x32_bf16 v[48:51], v[188:191], v[120:123], v[48:51]
ds_read_b128 v[76:79], v21 offset:2048
v_mfma_f32_16x16x32_bf16 v[52:55], v[188:191], v[124:127], v[52:55]
ds_read_b128 v[80:83], v21 offset:4096
v_mfma_f32_16x16x32_bf16 v[56:59], v[188:191], v[128:131], v[56:59]
ds_read_b128 v[84:87], v21 offset:6144
v_mfma_f32_16x16x32_bf16 v[60:63], v[188:191], v[132:135], v[60:63]
s_add_u32 m0, s33, 43520
s_add_u32 s36, s32, 8192
buffer_load_dwordx4 v15, s[16:19], s36 offen  lds
v_mfma_f32_16x16x32_bf16 v[64:67], v[188:191], v[136:139], v[64:67]
ds_read_b128 v[88:91], v21 offset:8192
v_mfma_f32_16x16x32_bf16 v[68:71], v[188:191], v[140:143], v[68:71]
ds_read_b128 v[92:95], v21 offset:10240
v_mfma_f32_16x16x32_bf16 v[24:27], v[192:195], v[144:147], v[24:27]
ds_read_b64_tr_b16 v[176:177], v20 offset:8448
v_mfma_f32_16x16x32_bf16 v[28:31], v[192:195], v[148:151], v[28:31]
ds_read_b64_tr_b16 v[178:179], v20 offset:8960
v_mfma_f32_16x16x32_bf16 v[32:35], v[192:195], v[152:155], v[32:35]
s_add_u32 m0, s35, 41472
s_add_u32 s36, s34, 327680
buffer_load_dwordx4 v10, s[12:15], s36 offen  lds
v_mfma_f32_16x16x32_bf16 v[36:39], v[192:195], v[156:159], v[36:39]
ds_read_b64_tr_b16 v[180:181], v20 offset:8480
v_mfma_f32_16x16x32_bf16 v[40:43], v[192:195], v[160:163], v[40:43]
ds_read_b64_tr_b16 v[182:183], v20 offset:8992
v_mfma_f32_16x16x32_bf16 v[44:47], v[192:195], v[164:167], v[44:47]
ds_read_b128 v[96:99], v21 offset:1024
v_mfma_f32_16x16x32_bf16 v[48:51], v[196:199], v[144:147], v[48:51]
ds_read_b128 v[100:103], v21 offset:3072
v_mfma_f32_16x16x32_bf16 v[52:55], v[196:199], v[148:151], v[52:55]
s_add_u32 m0, s35, 42528
s_add_u32 s36, s34, 328960
buffer_load_dwordx4 v10, s[12:15], s36 offen  lds
v_mfma_f32_16x16x32_bf16 v[56:59], v[196:199], v[152:155], v[56:59]
ds_read_b128 v[104:107], v21 offset:5120
v_mfma_f32_16x16x32_bf16 v[60:63], v[196:199], v[156:159], v[60:63]
ds_read_b128 v[108:111], v21 offset:7168
v_mfma_f32_16x16x32_bf16 v[64:67], v[196:199], v[160:163], v[64:67]
ds_read_b128 v[112:115], v21 offset:9216
v_mfma_f32_16x16x32_bf16 v[68:71], v[196:199], v[164:167], v[68:71]
ds_read_b128 v[116:119], v21 offset:11264
s_waitcnt vmcnt(5) lgkmcnt(0)
s_barrier
v_mfma_f32_16x16x32_bf16 v[24:27], v[168:171], v[72:75], v[24:27]
s_add_u32 m0, s33, 82944
s_add_u32 s36, s30, 10240
buffer_load_dwordx4 v15, s[16:19], s36 offen  lds
ds_read_b64_tr_b16 v[184:185], v16 offset:0
v_mfma_f32_16x16x32_bf16 v[28:31], v[168:171], v[76:79], v[28:31]
ds_read_b64_tr_b16 v[186:187], v16 offset:512
v_mfma_f32_16x16x32_bf16 v[32:35], v[168:171], v[80:83], v[32:35]
ds_read_b64_tr_b16 v[188:189], v16 offset:32
v_mfma_f32_16x16x32_bf16 v[36:39], v[168:171], v[84:87], v[36:39]
ds_read_b64_tr_b16 v[190:191], v16 offset:544
v_mfma_f32_16x16x32_bf16 v[40:43], v[168:171], v[88:91], v[40:43]
s_add_u32 m0, s33, 83968
s_add_u32 s36, s31, 10240
buffer_load_dwordx4 v15, s[16:19], s36 offen  lds
v_mfma_f32_16x16x32_bf16 v[44:47], v[168:171], v[92:95], v[44:47]
ds_read_b128 v[120:123], v17 offset:0
v_mfma_f32_16x16x32_bf16 v[48:51], v[172:175], v[72:75], v[48:51]
ds_read_b128 v[124:127], v17 offset:2048
v_mfma_f32_16x16x32_bf16 v[52:55], v[172:175], v[76:79], v[52:55]
ds_read_b128 v[128:131], v17 offset:4096
v_mfma_f32_16x16x32_bf16 v[56:59], v[172:175], v[80:83], v[56:59]
ds_read_b128 v[132:135], v17 offset:6144
v_mfma_f32_16x16x32_bf16 v[60:63], v[172:175], v[84:87], v[60:63]
s_add_u32 m0, s33, 84992
s_add_u32 s36, s32, 10240
buffer_load_dwordx4 v15, s[16:19], s36 offen  lds
v_mfma_f32_16x16x32_bf16 v[64:67], v[172:175], v[88:91], v[64:67]
ds_read_b128 v[136:139], v17 offset:8192
v_mfma_f32_16x16x32_bf16 v[68:71], v[172:175], v[92:95], v[68:71]
ds_read_b128 v[140:143], v17 offset:10240
v_mfma_f32_16x16x32_bf16 v[24:27], v[176:179], v[96:99], v[24:27]
ds_read_b64_tr_b16 v[192:193], v16 offset:8448
v_mfma_f32_16x16x32_bf16 v[28:31], v[176:179], v[100:103], v[28:31]
ds_read_b64_tr_b16 v[194:195], v16 offset:8960
v_mfma_f32_16x16x32_bf16 v[32:35], v[176:179], v[104:107], v[32:35]
s_add_u32 m0, s35, 82944
s_add_u32 s36, s34, 409600
buffer_load_dwordx4 v10, s[12:15], s36 offen  lds
v_mfma_f32_16x16x32_bf16 v[36:39], v[176:179], v[108:111], v[36:39]
ds_read_b64_tr_b16 v[196:197], v16 offset:8480
v_mfma_f32_16x16x32_bf16 v[40:43], v[176:179], v[112:115], v[40:43]
ds_read_b64_tr_b16 v[198:199], v16 offset:8992
v_mfma_f32_16x16x32_bf16 v[44:47], v[176:179], v[116:119], v[44:47]
ds_read_b128 v[144:147], v17 offset:1024
v_mfma_f32_16x16x32_bf16 v[48:51], v[180:183], v[96:99], v[48:51]
ds_read_b128 v[148:151], v17 offset:3072
v_mfma_f32_16x16x32_bf16 v[52:55], v[180:183], v[100:103], v[52:55]
s_add_u32 m0, s35, 84000
s_add_u32 s36, s34, 410880
buffer_load_dwordx4 v10, s[12:15], s36 offen  lds
v_mfma_f32_16x16x32_bf16 v[56:59], v[180:183], v[104:107], v[56:59]
ds_read_b128 v[152:155], v17 offset:5120
v_mfma_f32_16x16x32_bf16 v[60:63], v[180:183], v[108:111], v[60:63]
ds_read_b128 v[156:159], v17 offset:7168
v_mfma_f32_16x16x32_bf16 v[64:67], v[180:183], v[112:115], v[64:67]
ds_read_b128 v[160:163], v17 offset:9216
v_mfma_f32_16x16x32_bf16 v[68:71], v[180:183], v[116:119], v[68:71]
ds_read_b128 v[164:167], v17 offset:11264
s_waitcnt vmcnt(5) lgkmcnt(0)
s_barrier
v_mfma_f32_16x16x32_bf16 v[24:27], v[184:187], v[120:123], v[24:27]
s_add_u32 m0, s33, 0
s_add_u32 s36, s30, 12288
buffer_load_dwordx4 v15, s[16:19], s36 offen  lds
ds_read_b64_tr_b16 v[168:169], v18 offset:0
v_mfma_f32_16x16x32_bf16 v[28:31], v[184:187], v[124:127], v[28:31]
ds_read_b64_tr_b16 v[170:171], v18 offset:512
v_mfma_f32_16x16x32_bf16 v[32:35], v[184:187], v[128:131], v[32:35]
ds_read_b64_tr_b16 v[172:173], v18 offset:32
v_mfma_f32_16x16x32_bf16 v[36:39], v[184:187], v[132:135], v[36:39]
ds_read_b64_tr_b16 v[174:175], v18 offset:544
v_mfma_f32_16x16x32_bf16 v[40:43], v[184:187], v[136:139], v[40:43]
s_add_u32 m0, s33, 1024
s_add_u32 s36, s31, 12288
buffer_load_dwordx4 v15, s[16:19], s36 offen  lds
v_mfma_f32_16x16x32_bf16 v[44:47], v[184:187], v[140:143], v[44:47]
ds_read_b128 v[72:75], v19 offset:0
v_mfma_f32_16x16x32_bf16 v[48:51], v[188:191], v[120:123], v[48:51]
ds_read_b128 v[76:79], v19 offset:2048
v_mfma_f32_16x16x32_bf16 v[52:55], v[188:191], v[124:127], v[52:55]
ds_read_b128 v[80:83], v19 offset:4096
v_mfma_f32_16x16x32_bf16 v[56:59], v[188:191], v[128:131], v[56:59]
ds_read_b128 v[84:87], v19 offset:6144
v_mfma_f32_16x16x32_bf16 v[60:63], v[188:191], v[132:135], v[60:63]
s_add_u32 m0, s33, 2048
s_add_u32 s36, s32, 12288
buffer_load_dwordx4 v15, s[16:19], s36 offen  lds
v_mfma_f32_16x16x32_bf16 v[64:67], v[188:191], v[136:139], v[64:67]
ds_read_b128 v[88:91], v19 offset:8192
v_mfma_f32_16x16x32_bf16 v[68:71], v[188:191], v[140:143], v[68:71]
ds_read_b128 v[92:95], v19 offset:10240
v_mfma_f32_16x16x32_bf16 v[24:27], v[192:195], v[144:147], v[24:27]
ds_read_b64_tr_b16 v[176:177], v18 offset:8448
v_mfma_f32_16x16x32_bf16 v[28:31], v[192:195], v[148:151], v[28:31]
ds_read_b64_tr_b16 v[178:179], v18 offset:8960
v_mfma_f32_16x16x32_bf16 v[32:35], v[192:195], v[152:155], v[32:35]
s_add_u32 m0, s35, 0
s_add_u32 s36, s34, 491520
buffer_load_dwordx4 v10, s[12:15], s36 offen  lds
v_mfma_f32_16x16x32_bf16 v[36:39], v[192:195], v[156:159], v[36:39]
ds_read_b64_tr_b16 v[180:181], v18 offset:8480
v_mfma_f32_16x16x32_bf16 v[40:43], v[192:195], v[160:163], v[40:43]
ds_read_b64_tr_b16 v[182:183], v18 offset:8992
v_mfma_f32_16x16x32_bf16 v[44:47], v[192:195], v[164:167], v[44:47]
ds_read_b128 v[96:99], v19 offset:1024
v_mfma_f32_16x16x32_bf16 v[48:51], v[196:199], v[144:147], v[48:51]
ds_read_b128 v[100:103], v19 offset:3072
v_mfma_f32_16x16x32_bf16 v[52:55], v[196:199], v[148:151], v[52:55]
s_add_u32 m0, s35, 1056
s_add_u32 s36, s34, 492800
buffer_load_dwordx4 v10, s[12:15], s36 offen  lds
v_mfma_f32_16x16x32_bf16 v[56:59], v[196:199], v[152:155], v[56:59]
ds_read_b128 v[104:107], v19 offset:5120
v_mfma_f32_16x16x32_bf16 v[60:63], v[196:199], v[156:159], v[60:63]
ds_read_b128 v[108:111], v19 offset:7168
v_mfma_f32_16x16x32_bf16 v[64:67], v[196:199], v[160:163], v[64:67]
ds_read_b128 v[112:115], v19 offset:9216
v_mfma_f32_16x16x32_bf16 v[68:71], v[196:199], v[164:167], v[68:71]
ds_read_b128 v[116:119], v19 offset:11264
s_waitcnt vmcnt(5) lgkmcnt(0)
s_barrier
v_mfma_f32_16x16x32_bf16 v[24:27], v[168:171], v[72:75], v[24:27]
s_add_u32 m0, s33, 41472
s_add_u32 s36, s30, 14336
buffer_load_dwordx4 v15, s[16:19], s36 offen  lds
ds_read_b64_tr_b16 v[184:185], v20 offset:0
v_mfma_f32_16x16x32_bf16 v[28:31], v[168:171], v[76:79], v[28:31]
ds_read_b64_tr_b16 v[186:187], v20 offset:512
v_mfma_f32_16x16x32_bf16 v[32:35], v[168:171], v[80:83], v[32:35]
ds_read_b64_tr_b16 v[188:189], v20 offset:32
v_mfma_f32_16x16x32_bf16 v[36:39], v[168:171], v[84:87], v[36:39]
ds_read_b64_tr_b16 v[190:191], v20 offset:544
v_mfma_f32_16x16x32_bf16 v[40:43], v[168:171], v[88:91], v[40:43]
s_add_u32 m0, s33, 42496
s_add_u32 s36, s31, 14336
buffer_load_dwordx4 v15, s[16:19], s36 offen  lds
v_mfma_f32_16x16x32_bf16 v[44:47], v[168:171], v[92:95], v[44:47]
ds_read_b128 v[120:123], v21 offset:0
v_mfma_f32_16x16x32_bf16 v[48:51], v[172:175], v[72:75], v[48:51]
ds_read_b128 v[124:127], v21 offset:2048
v_mfma_f32_16x16x32_bf16 v[52:55], v[172:175], v[76:79], v[52:55]
ds_read_b128 v[128:131], v21 offset:4096
v_mfma_f32_16x16x32_bf16 v[56:59], v[172:175], v[80:83], v[56:59]
ds_read_b128 v[132:135], v21 offset:6144
v_mfma_f32_16x16x32_bf16 v[60:63], v[172:175], v[84:87], v[60:63]
s_add_u32 m0, s33, 43520
s_add_u32 s36, s32, 14336
buffer_load_dwordx4 v15, s[16:19], s36 offen  lds
v_mfma_f32_16x16x32_bf16 v[64:67], v[172:175], v[88:91], v[64:67]
ds_read_b128 v[136:139], v21 offset:8192
v_mfma_f32_16x16x32_bf16 v[68:71], v[172:175], v[92:95], v[68:71]
ds_read_b128 v[140:143], v21 offset:10240
v_mfma_f32_16x16x32_bf16 v[24:27], v[176:179], v[96:99], v[24:27]
ds_read_b64_tr_b16 v[192:193], v20 offset:8448
v_mfma_f32_16x16x32_bf16 v[28:31], v[176:179], v[100:103], v[28:31]
ds_read_b64_tr_b16 v[194:195], v20 offset:8960
v_mfma_f32_16x16x32_bf16 v[32:35], v[176:179], v[104:107], v[32:35]
s_add_u32 m0, s35, 41472
s_add_u32 s36, s34, 573440
buffer_load_dwordx4 v10, s[12:15], s36 offen  lds
v_mfma_f32_16x16x32_bf16 v[36:39], v[176:179], v[108:111], v[36:39]
ds_read_b64_tr_b16 v[196:197], v20 offset:8480
v_mfma_f32_16x16x32_bf16 v[40:43], v[176:179], v[112:115], v[40:43]
ds_read_b64_tr_b16 v[198:199], v20 offset:8992
v_mfma_f32_16x16x32_bf16 v[44:47], v[176:179], v[116:119], v[44:47]
ds_read_b128 v[144:147], v21 offset:1024
v_mfma_f32_16x16x32_bf16 v[48:51], v[180:183], v[96:99], v[48:51]
ds_read_b128 v[148:151], v21 offset:3072
v_mfma_f32_16x16x32_bf16 v[52:55], v[180:183], v[100:103], v[52:55]
s_add_u32 m0, s35, 42528
s_add_u32 s36, s34, 574720
buffer_load_dwordx4 v10, s[12:15], s36 offen  lds
v_mfma_f32_16x16x32_bf16 v[56:59], v[180:183], v[104:107], v[56:59]
ds_read_b128 v[152:155], v21 offset:5120
v_mfma_f32_16x16x32_bf16 v[60:63], v[180:183], v[108:111], v[60:63]
ds_read_b128 v[156:159], v21 offset:7168
v_mfma_f32_16x16x32_bf16 v[64:67], v[180:183], v[112:115], v[64:67]
ds_read_b128 v[160:163], v21 offset:9216
v_mfma_f32_16x16x32_bf16 v[68:71], v[180:183], v[116:119], v[68:71]
ds_read_b128 v[164:167], v21 offset:11264
s_waitcnt vmcnt(5) lgkmcnt(0)
s_barrier
v_mfma_f32_16x16x32_bf16 v[24:27], v[184:187], v[120:123], v[24:27]
s_add_u32 m0, s33, 82944
s_add_u32 s36, s30, 16384
buffer_load_dwordx4 v15, s[16:19], s36 offen  lds
ds_read_b64_tr_b16 v[168:169], v16 offset:0
v_mfma_f32_16x16x32_bf16 v[28:31], v[184:187], v[124:127], v[28:31]
ds_read_b64_tr_b16 v[170:171], v16 offset:512
v_mfma_f32_16x16x32_bf16 v[32:35], v[184:187], v[128:131], v[32:35]
ds_read_b64_tr_b16 v[172:173], v16 offset:32
v_mfma_f32_16x16x32_bf16 v[36:39], v[184:187], v[132:135], v[36:39]
ds_read_b64_tr_b16 v[174:175], v16 offset:544
v_mfma_f32_16x16x32_bf16 v[40:43], v[184:187], v[136:139], v[40:43]
s_add_u32 m0, s33, 83968
s_add_u32 s36, s31, 16384
buffer_load_dwordx4 v15, s[16:19], s36 offen  lds
v_mfma_f32_16x16x32_bf16 v[44:47], v[184:187], v[140:143], v[44:47]
ds_read_b128 v[72:75], v17 offset:0
v_mfma_f32_16x16x32_bf16 v[48:51], v[188:191], v[120:123], v[48:51]
ds_read_b128 v[76:79], v17 offset:2048
v_mfma_f32_16x16x32_bf16 v[52:55], v[188:191], v[124:127], v[52:55]
ds_read_b128 v[80:83], v17 offset:4096
v_mfma_f32_16x16x32_bf16 v[56:59], v[188:191], v[128:131], v[56:59]
ds_read_b128 v[84:87], v17 offset:6144
v_mfma_f32_16x16x32_bf16 v[60:63], v[188:191], v[132:135], v[60:63]
s_add_u32 m0, s33, 84992
s_add_u32 s36, s32, 16384
buffer_load_dwordx4 v15, s[16:19], s36 offen  lds
v_mfma_f32_16x16x32_bf16 v[64:67], v[188:191], v[136:139], v[64:67]
ds_read_b128 v[88:91], v17 offset:8192
v_mfma_f32_16x16x32_bf16 v[68:71], v[188:191], v[140:143], v[68:71]
ds_read_b128 v[92:95], v17 offset:10240
v_mfma_f32_16x16x32_bf16 v[24:27], v[192:195], v[144:147], v[24:27]
ds_read_b64_tr_b16 v[176:177], v16 offset:8448
v_mfma_f32_16x16x32_bf16 v[28:31], v[192:195], v[148:151], v[28:31]
ds_read_b64_tr_b16 v[178:179], v16 offset:8960
v_mfma_f32_16x16x32_bf16 v[32:35], v[192:195], v[152:155], v[32:35]
s_add_u32 m0, s35, 82944
s_add_u32 s36, s34, 655360
buffer_load_dwordx4 v10, s[12:15], s36 offen  lds
v_mfma_f32_16x16x32_bf16 v[36:39], v[192:195], v[156:159], v[36:39]
ds_read_b64_tr_b16 v[180:181], v16 offset:8480
v_mfma_f32_16x16x32_bf16 v[40:43], v[192:195], v[160:163], v[40:43]
ds_read_b64_tr_b16 v[182:183], v16 offset:8992
v_mfma_f32_16x16x32_bf16 v[44:47], v[192:195], v[164:167], v[44:47]
ds_read_b128 v[96:99], v17 offset:1024
v_mfma_f32_16x16x32_bf16 v[48:51], v[196:199], v[144:147], v[48:51]
ds_read_b128 v[100:103], v17 offset:3072
v_mfma_f32_16x16x32_bf16 v[52:55], v[196:199], v[148:151], v[52:55]
s_add_u32 m0, s35, 84000
s_add_u32 s36, s34, 656640
buffer_load_dwordx4 v10, s[12:15], s36 offen  lds
v_mfma_f32_16x16x32_bf16 v[56:59], v[196:199], v[152:155], v[56:59]
ds_read_b128 v[104:107], v17 offset:5120
v_mfma_f32_16x16x32_bf16 v[60:63], v[196:199], v[156:159], v[60:63]
ds_read_b128 v[108:111], v17 offset:7168
v_mfma_f32_16x16x32_bf16 v[64:67], v[196:199], v[160:163], v[64:67]
ds_read_b128 v[112:115], v17 offset:9216
v_mfma_f32_16x16x32_bf16 v[68:71], v[196:199], v[164:167], v[68:71]
ds_read_b128 v[116:119], v17 offset:11264
s_waitcnt vmcnt(5) lgkmcnt(0)
s_barrier
v_mfma_f32_16x16x32_bf16 v[24:27], v[168:171], v[72:75], v[24:27]
s_add_u32 m0, s33, 0
s_add_u32 s36, s30, 18432
buffer_load_dwordx4 v15, s[16:19], s36 offen  lds
ds_read_b64_tr_b16 v[184:185], v18 offset:0
v_mfma_f32_16x16x32_bf16 v[28:31], v[168:171], v[76:79], v[28:31]
ds_read_b64_tr_b16 v[186:187], v18 offset:512
v_mfma_f32_16x16x32_bf16 v[32:35], v[168:171], v[80:83], v[32:35]
ds_read_b64_tr_b16 v[188:189], v18 offset:32
v_mfma_f32_16x16x32_bf16 v[36:39], v[168:171], v[84:87], v[36:39]
ds_read_b64_tr_b16 v[190:191], v18 offset:544
v_mfma_f32_16x16x32_bf16 v[40:43], v[168:171], v[88:91], v[40:43]
s_add_u32 m0, s33, 1024
s_add_u32 s36, s31, 18432
buffer_load_dwordx4 v15, s[16:19], s36 offen  lds
v_mfma_f32_16x16x32_bf16 v[44:47], v[168:171], v[92:95], v[44:47]
ds_read_b128 v[120:123], v19 offset:0
v_mfma_f32_16x16x32_bf16 v[48:51], v[172:175], v[72:75], v[48:51]
ds_read_b128 v[124:127], v19 offset:2048
v_mfma_f32_16x16x32_bf16 v[52:55], v[172:175], v[76:79], v[52:55]
ds_read_b128 v[128:131], v19 offset:4096
v_mfma_f32_16x16x32_bf16 v[56:59], v[172:175], v[80:83], v[56:59]
ds_read_b128 v[132:135], v19 offset:6144
v_mfma_f32_16x16x32_bf16 v[60:63], v[172:175], v[84:87], v[60:63]
s_add_u32 m0, s33, 2048
s_add_u32 s36, s32, 18432
buffer_load_dwordx4 v15, s[16:19], s36 offen  lds
v_mfma_f32_16x16x32_bf16 v[64:67], v[172:175], v[88:91], v[64:67]
ds_read_b128 v[136:139], v19 offset:8192
v_mfma_f32_16x16x32_bf16 v[68:71], v[172:175], v[92:95], v[68:71]
ds_read_b128 v[140:143], v19 offset:10240
v_mfma_f32_16x16x32_bf16 v[24:27], v[176:179], v[96:99], v[24:27]
ds_read_b64_tr_b16 v[192:193], v18 offset:8448
v_mfma_f32_16x16x32_bf16 v[28:31], v[176:179], v[100:103], v[28:31]
ds_read_b64_tr_b16 v[194:195], v18 offset:8960
v_mfma_f32_16x16x32_bf16 v[32:35], v[176:179], v[104:107], v[32:35]
s_add_u32 m0, s35, 0
s_add_u32 s36, s34, 737280
buffer_load_dwordx4 v10, s[12:15], s36 offen  lds
v_mfma_f32_16x16x32_bf16 v[36:39], v[176:179], v[108:111], v[36:39]
ds_read_b64_tr_b16 v[196:197], v18 offset:8480
v_mfma_f32_16x16x32_bf16 v[40:43], v[176:179], v[112:115], v[40:43]
ds_read_b64_tr_b16 v[198:199], v18 offset:8992
v_mfma_f32_16x16x32_bf16 v[44:47], v[176:179], v[116:119], v[44:47]
ds_read_b128 v[144:147], v19 offset:1024
v_mfma_f32_16x16x32_bf16 v[48:51], v[180:183], v[96:99], v[48:51]
ds_read_b128 v[148:151], v19 offset:3072
v_mfma_f32_16x16x32_bf16 v[52:55], v[180:183], v[100:103], v[52:55]
s_add_u32 m0, s35, 1056
s_add_u32 s36, s34, 738560
buffer_load_dwordx4 v10, s[12:15], s36 offen  lds
v_mfma_f32_16x16x32_bf16 v[56:59], v[180:183], v[104:107], v[56:59]
ds_read_b128 v[152:155], v19 offset:5120
v_mfma_f32_16x16x32_bf16 v[60:63], v[180:183], v[108:111], v[60:63]
ds_read_b128 v[156:159], v19 offset:7168
v_mfma_f32_16x16x32_bf16 v[64:67], v[180:183], v[112:115], v[64:67]
ds_read_b128 v[160:163], v19 offset:9216
v_mfma_f32_16x16x32_bf16 v[68:71], v[180:183], v[116:119], v[68:71]
ds_read_b128 v[164:167], v19 offset:11264
s_waitcnt vmcnt(5) lgkmcnt(0)
s_barrier
v_mfma_f32_16x16x32_bf16 v[24:27], v[184:187], v[120:123], v[24:27]
s_add_u32 m0, s33, 41472
s_add_u32 s36, s30, 20480
buffer_load_dwordx4 v15, s[16:19], s36 offen  lds
ds_read_b64_tr_b16 v[168:169], v20 offset:0
v_mfma_f32_16x16x32_bf16 v[28:31], v[184:187], v[124:127], v[28:31]
ds_read_b64_tr_b16 v[170:171], v20 offset:512
v_mfma_f32_16x16x32_bf16 v[32:35], v[184:187], v[128:131], v[32:35]
ds_read_b64_tr_b16 v[172:173], v20 offset:32
v_mfma_f32_16x16x32_bf16 v[36:39], v[184:187], v[132:135], v[36:39]
ds_read_b64_tr_b16 v[174:175], v20 offset:544
v_mfma_f32_16x16x32_bf16 v[40:43], v[184:187], v[136:139], v[40:43]
s_add_u32 m0, s33, 42496
s_add_u32 s36, s31, 20480
buffer_load_dwordx4 v15, s[16:19], s36 offen  lds
v_mfma_f32_16x16x32_bf16 v[44:47], v[184:187], v[140:143], v[44:47]
ds_read_b128 v[72:75], v21 offset:0
v_mfma_f32_16x16x32_bf16 v[48:51], v[188:191], v[120:123], v[48:51]
ds_read_b128 v[76:79], v21 offset:2048
v_mfma_f32_16x16x32_bf16 v[52:55], v[188:191], v[124:127], v[52:55]
ds_read_b128 v[80:83], v21 offset:4096
v_mfma_f32_16x16x32_bf16 v[56:59], v[188:191], v[128:131], v[56:59]
ds_read_b128 v[84:87], v21 offset:6144
v_mfma_f32_16x16x32_bf16 v[60:63], v[188:191], v[132:135], v[60:63]
s_add_u32 m0, s33, 43520
s_add_u32 s36, s32, 20480
buffer_load_dwordx4 v15, s[16:19], s36 offen  lds
v_mfma_f32_16x16x32_bf16 v[64:67], v[188:191], v[136:139], v[64:67]
ds_read_b128 v[88:91], v21 offset:8192
v_mfma_f32_16x16x32_bf16 v[68:71], v[188:191], v[140:143], v[68:71]
ds_read_b128 v[92:95], v21 offset:10240
v_mfma_f32_16x16x32_bf16 v[24:27], v[192:195], v[144:147], v[24:27]
ds_read_b64_tr_b16 v[176:177], v20 offset:8448
v_mfma_f32_16x16x32_bf16 v[28:31], v[192:195], v[148:151], v[28:31]
ds_read_b64_tr_b16 v[178:179], v20 offset:8960
v_mfma_f32_16x16x32_bf16 v[32:35], v[192:195], v[152:155], v[32:35]
s_add_u32 m0, s35, 41472
s_add_u32 s36, s34, 819200
buffer_load_dwordx4 v10, s[12:15], s36 offen  lds
v_mfma_f32_16x16x32_bf16 v[36:39], v[192:195], v[156:159], v[36:39]
ds_read_b64_tr_b16 v[180:181], v20 offset:8480
v_mfma_f32_16x16x32_bf16 v[40:43], v[192:195], v[160:163], v[40:43]
ds_read_b64_tr_b16 v[182:183], v20 offset:8992
v_mfma_f32_16x16x32_bf16 v[44:47], v[192:195], v[164:167], v[44:47]
ds_read_b128 v[96:99], v21 offset:1024
v_mfma_f32_16x16x32_bf16 v[48:51], v[196:199], v[144:147], v[48:51]
ds_read_b128 v[100:103], v21 offset:3072
v_mfma_f32_16x16x32_bf16 v[52:55], v[196:199], v[148:151], v[52:55]
s_add_u32 m0, s35, 42528
s_add_u32 s36, s34, 820480
buffer_load_dwordx4 v10, s[12:15], s36 offen  lds
v_mfma_f32_16x16x32_bf16 v[56:59], v[196:199], v[152:155], v[56:59]
ds_read_b128 v[104:107], v21 offset:5120
v_mfma_f32_16x16x32_bf16 v[60:63], v[196:199], v[156:159], v[60:63]
ds_read_b128 v[108:111], v21 offset:7168
v_mfma_f32_16x16x32_bf16 v[64:67], v[196:199], v[160:163], v[64:67]
ds_read_b128 v[112:115], v21 offset:9216
v_mfma_f32_16x16x32_bf16 v[68:71], v[196:199], v[164:167], v[68:71]
ds_read_b128 v[116:119], v21 offset:11264
s_waitcnt vmcnt(5) lgkmcnt(0)
s_barrier
v_mfma_f32_16x16x32_bf16 v[24:27], v[168:171], v[72:75], v[24:27]
s_add_u32 m0, s33, 82944
s_add_u32 s36, s30, 22528
buffer_load_dwordx4 v15, s[16:19], s36 offen  lds
ds_read_b64_tr_b16 v[184:185], v16 offset:0
v_mfma_f32_16x16x32_bf16 v[28:31], v[168:171], v[76:79], v[28:31]
ds_read_b64_tr_b16 v[186:187], v16 offset:512
v_mfma_f32_16x16x32_bf16 v[32:35], v[168:171], v[80:83], v[32:35]
ds_read_b64_tr_b16 v[188:189], v16 offset:32
v_mfma_f32_16x16x32_bf16 v[36:39], v[168:171], v[84:87], v[36:39]
ds_read_b64_tr_b16 v[190:191], v16 offset:544
v_mfma_f32_16x16x32_bf16 v[40:43], v[168:171], v[88:91], v[40:43]
s_add_u32 m0, s33, 83968
s_add_u32 s36, s31, 22528
buffer_load_dwordx4 v15, s[16:19], s36 offen  lds
v_mfma_f32_16x16x32_bf16 v[44:47], v[168:171], v[92:95], v[44:47]
ds_read_b128 v[120:123], v17 offset:0
v_mfma_f32_16x16x32_bf16 v[48:51], v[172:175], v[72:75], v[48:51]
ds_read_b128 v[124:127], v17 offset:2048
v_mfma_f32_16x16x32_bf16 v[52:55], v[172:175], v[76:79], v[52:55]
ds_read_b128 v[128:131], v17 offset:4096
v_mfma_f32_16x16x32_bf16 v[56:59], v[172:175], v[80:83], v[56:59]
ds_read_b128 v[132:135], v17 offset:6144
v_mfma_f32_16x16x32_bf16 v[60:63], v[172:175], v[84:87], v[60:63]
s_add_u32 m0, s33, 84992
s_add_u32 s36, s32, 22528
buffer_load_dwordx4 v15, s[16:19], s36 offen  lds
v_mfma_f32_16x16x32_bf16 v[64:67], v[172:175], v[88:91], v[64:67]
ds_read_b128 v[136:139], v17 offset:8192
v_mfma_f32_16x16x32_bf16 v[68:71], v[172:175], v[92:95], v[68:71]
ds_read_b128 v[140:143], v17 offset:10240
v_mfma_f32_16x16x32_bf16 v[24:27], v[176:179], v[96:99], v[24:27]
ds_read_b64_tr_b16 v[192:193], v16 offset:8448
v_mfma_f32_16x16x32_bf16 v[28:31], v[176:179], v[100:103], v[28:31]
ds_read_b64_tr_b16 v[194:195], v16 offset:8960
v_mfma_f32_16x16x32_bf16 v[32:35], v[176:179], v[104:107], v[32:35]
s_add_u32 m0, s35, 82944
s_add_u32 s36, s34, 901120
buffer_load_dwordx4 v10, s[12:15], s36 offen  lds
v_mfma_f32_16x16x32_bf16 v[36:39], v[176:179], v[108:111], v[36:39]
ds_read_b64_tr_b16 v[196:197], v16 offset:8480
v_mfma_f32_16x16x32_bf16 v[40:43], v[176:179], v[112:115], v[40:43]
ds_read_b64_tr_b16 v[198:199], v16 offset:8992
v_mfma_f32_16x16x32_bf16 v[44:47], v[176:179], v[116:119], v[44:47]
ds_read_b128 v[144:147], v17 offset:1024
v_mfma_f32_16x16x32_bf16 v[48:51], v[180:183], v[96:99], v[48:51]
ds_read_b128 v[148:151], v17 offset:3072
v_mfma_f32_16x16x32_bf16 v[52:55], v[180:183], v[100:103], v[52:55]
s_add_u32 m0, s35, 84000
s_add_u32 s36, s34, 902400
buffer_load_dwordx4 v10, s[12:15], s36 offen  lds
v_mfma_f32_16x16x32_bf16 v[56:59], v[180:183], v[104:107], v[56:59]
ds_read_b128 v[152:155], v17 offset:5120
v_mfma_f32_16x16x32_bf16 v[60:63], v[180:183], v[108:111], v[60:63]
ds_read_b128 v[156:159], v17 offset:7168
v_mfma_f32_16x16x32_bf16 v[64:67], v[180:183], v[112:115], v[64:67]
ds_read_b128 v[160:163], v17 offset:9216
v_mfma_f32_16x16x32_bf16 v[68:71], v[180:183], v[116:119], v[68:71]
ds_read_b128 v[164:167], v17 offset:11264
s_waitcnt vmcnt(5) lgkmcnt(0)
s_barrier
v_mfma_f32_16x16x32_bf16 v[24:27], v[184:187], v[120:123], v[24:27]
s_add_u32 m0, s33, 0
s_add_u32 s36, s30, 24576
buffer_load_dwordx4 v15, s[16:19], s36 offen  lds
ds_read_b64_tr_b16 v[168:169], v18 offset:0
v_mfma_f32_16x16x32_bf16 v[28:31], v[184:187], v[124:127], v[28:31]
ds_read_b64_tr_b16 v[170:171], v18 offset:512
v_mfma_f32_16x16x32_bf16 v[32:35], v[184:187], v[128:131], v[32:35]
ds_read_b64_tr_b16 v[172:173], v18 offset:32
v_mfma_f32_16x16x32_bf16 v[36:39], v[184:187], v[132:135], v[36:39]
ds_read_b64_tr_b16 v[174:175], v18 offset:544
v_mfma_f32_16x16x32_bf16 v[40:43], v[184:187], v[136:139], v[40:43]
s_add_u32 m0, s33, 1024
s_add_u32 s36, s31, 24576
buffer_load_dwordx4 v15, s[16:19], s36 offen  lds
v_mfma_f32_16x16x32_bf16 v[44:47], v[184:187], v[140:143], v[44:47]
ds_read_b128 v[72:75], v19 offset:0
v_mfma_f32_16x16x32_bf16 v[48:51], v[188:191], v[120:123], v[48:51]
ds_read_b128 v[76:79], v19 offset:2048
v_mfma_f32_16x16x32_bf16 v[52:55], v[188:191], v[124:127], v[52:55]
ds_read_b128 v[80:83], v19 offset:4096
v_mfma_f32_16x16x32_bf16 v[56:59], v[188:191], v[128:131], v[56:59]
ds_read_b128 v[84:87], v19 offset:6144
v_mfma_f32_16x16x32_bf16 v[60:63], v[188:191], v[132:135], v[60:63]
s_add_u32 m0, s33, 2048
s_add_u32 s36, s32, 24576
buffer_load_dwordx4 v15, s[16:19], s36 offen  lds
v_mfma_f32_16x16x32_bf16 v[64:67], v[188:191], v[136:139], v[64:67]
ds_read_b128 v[88:91], v19 offset:8192
v_mfma_f32_16x16x32_bf16 v[68:71], v[188:191], v[140:143], v[68:71]
ds_read_b128 v[92:95], v19 offset:10240
v_mfma_f32_16x16x32_bf16 v[24:27], v[192:195], v[144:147], v[24:27]
ds_read_b64_tr_b16 v[176:177], v18 offset:8448
v_mfma_f32_16x16x32_bf16 v[28:31], v[192:195], v[148:151], v[28:31]
ds_read_b64_tr_b16 v[178:179], v18 offset:8960
v_mfma_f32_16x16x32_bf16 v[32:35], v[192:195], v[152:155], v[32:35]
s_add_u32 m0, s35, 0
s_add_u32 s36, s34, 983040
buffer_load_dwordx4 v10, s[12:15], s36 offen  lds
v_mfma_f32_16x16x32_bf16 v[36:39], v[192:195], v[156:159], v[36:39]
ds_read_b64_tr_b16 v[180:181], v18 offset:8480
v_mfma_f32_16x16x32_bf16 v[40:43], v[192:195], v[160:163], v[40:43]
ds_read_b64_tr_b16 v[182:183], v18 offset:8992
v_mfma_f32_16x16x32_bf16 v[44:47], v[192:195], v[164:167], v[44:47]
ds_read_b128 v[96:99], v19 offset:1024
v_mfma_f32_16x16x32_bf16 v[48:51], v[196:199], v[144:147], v[48:51]
ds_read_b128 v[100:103], v19 offset:3072
v_mfma_f32_16x16x32_bf16 v[52:55], v[196:199], v[148:151], v[52:55]
s_add_u32 m0, s35, 1056
s_add_u32 s36, s34, 984320
buffer_load_dwordx4 v10, s[12:15], s36 offen  lds
v_mfma_f32_16x16x32_bf16 v[56:59], v[196:199], v[152:155], v[56:59]
ds_read_b128 v[104:107], v19 offset:5120
v_mfma_f32_16x16x32_bf16 v[60:63], v[196:199], v[156:159], v[60:63]
ds_read_b128 v[108:111], v19 offset:7168
v_mfma_f32_16x16x32_bf16 v[64:67], v[196:199], v[160:163], v[64:67]
ds_read_b128 v[112:115], v19 offset:9216
v_mfma_f32_16x16x32_bf16 v[68:71], v[196:199], v[164:167], v[68:71]
ds_read_b128 v[116:119], v19 offset:11264
s_waitcnt vmcnt(5) lgkmcnt(0)
s_barrier
v_mfma_f32_16x16x32_bf16 v[24:27], v[168:171], v[72:75], v[24:27]
s_add_u32 m0, s33, 41472
s_add_u32 s36, s30, 26624
buffer_load_dwordx4 v15, s[16:19], s36 offen  lds
ds_read_b64_tr_b16 v[184:185], v20 offset:0
v_mfma_f32_16x16x32_bf16 v[28:31], v[168:171], v[76:79], v[28:31]
ds_read_b64_tr_b16 v[186:187], v20 offset:512
v_mfma_f32_16x16x32_bf16 v[32:35], v[168:171], v[80:83], v[32:35]
ds_read_b64_tr_b16 v[188:189], v20 offset:32
v_mfma_f32_16x16x32_bf16 v[36:39], v[168:171], v[84:87], v[36:39]
ds_read_b64_tr_b16 v[190:191], v20 offset:544
v_mfma_f32_16x16x32_bf16 v[40:43], v[168:171], v[88:91], v[40:43]
s_add_u32 m0, s33, 42496
s_add_u32 s36, s31, 26624
buffer_load_dwordx4 v15, s[16:19], s36 offen  lds
v_mfma_f32_16x16x32_bf16 v[44:47], v[168:171], v[92:95], v[44:47]
ds_read_b128 v[120:123], v21 offset:0
v_mfma_f32_16x16x32_bf16 v[48:51], v[172:175], v[72:75], v[48:51]
ds_read_b128 v[124:127], v21 offset:2048
v_mfma_f32_16x16x32_bf16 v[52:55], v[172:175], v[76:79], v[52:55]
ds_read_b128 v[128:131], v21 offset:4096
v_mfma_f32_16x16x32_bf16 v[56:59], v[172:175], v[80:83], v[56:59]
ds_read_b128 v[132:135], v21 offset:6144
v_mfma_f32_16x16x32_bf16 v[60:63], v[172:175], v[84:87], v[60:63]
s_add_u32 m0, s33, 43520
s_add_u32 s36, s32, 26624
buffer_load_dwordx4 v15, s[16:19], s36 offen  lds
v_mfma_f32_16x16x32_bf16 v[64:67], v[172:175], v[88:91], v[64:67]
ds_read_b128 v[136:139], v21 offset:8192
v_mfma_f32_16x16x32_bf16 v[68:71], v[172:175], v[92:95], v[68:71]
ds_read_b128 v[140:143], v21 offset:10240
v_mfma_f32_16x16x32_bf16 v[24:27], v[176:179], v[96:99], v[24:27]
ds_read_b64_tr_b16 v[192:193], v20 offset:8448
v_mfma_f32_16x16x32_bf16 v[28:31], v[176:179], v[100:103], v[28:31]
ds_read_b64_tr_b16 v[194:195], v20 offset:8960
v_mfma_f32_16x16x32_bf16 v[32:35], v[176:179], v[104:107], v[32:35]
s_add_u32 m0, s35, 41472
s_add_u32 s36, s34, 1064960
buffer_load_dwordx4 v10, s[12:15], s36 offen  lds
v_mfma_f32_16x16x32_bf16 v[36:39], v[176:179], v[108:111], v[36:39]
ds_read_b64_tr_b16 v[196:197], v20 offset:8480
v_mfma_f32_16x16x32_bf16 v[40:43], v[176:179], v[112:115], v[40:43]
ds_read_b64_tr_b16 v[198:199], v20 offset:8992
v_mfma_f32_16x16x32_bf16 v[44:47], v[176:179], v[116:119], v[44:47]
ds_read_b128 v[144:147], v21 offset:1024
v_mfma_f32_16x16x32_bf16 v[48:51], v[180:183], v[96:99], v[48:51]
ds_read_b128 v[148:151], v21 offset:3072
v_mfma_f32_16x16x32_bf16 v[52:55], v[180:183], v[100:103], v[52:55]
s_add_u32 m0, s35, 42528
s_add_u32 s36, s34, 1066240
buffer_load_dwordx4 v10, s[12:15], s36 offen  lds
v_mfma_f32_16x16x32_bf16 v[56:59], v[180:183], v[104:107], v[56:59]
ds_read_b128 v[152:155], v21 offset:5120
v_mfma_f32_16x16x32_bf16 v[60:63], v[180:183], v[108:111], v[60:63]
ds_read_b128 v[156:159], v21 offset:7168
v_mfma_f32_16x16x32_bf16 v[64:67], v[180:183], v[112:115], v[64:67]
ds_read_b128 v[160:163], v21 offset:9216
v_mfma_f32_16x16x32_bf16 v[68:71], v[180:183], v[116:119], v[68:71]
ds_read_b128 v[164:167], v21 offset:11264
s_waitcnt vmcnt(5) lgkmcnt(0)
s_barrier
v_mfma_f32_16x16x32_bf16 v[24:27], v[184:187], v[120:123], v[24:27]
s_add_u32 m0, s33, 82944
s_add_u32 s36, s30, 28672
buffer_load_dwordx4 v15, s[16:19], s36 offen  lds
ds_read_b64_tr_b16 v[168:169], v16 offset:0
v_mfma_f32_16x16x32_bf16 v[28:31], v[184:187], v[124:127], v[28:31]
ds_read_b64_tr_b16 v[170:171], v16 offset:512
v_mfma_f32_16x16x32_bf16 v[32:35], v[184:187], v[128:131], v[32:35]
ds_read_b64_tr_b16 v[172:173], v16 offset:32
v_mfma_f32_16x16x32_bf16 v[36:39], v[184:187], v[132:135], v[36:39]
ds_read_b64_tr_b16 v[174:175], v16 offset:544
v_mfma_f32_16x16x32_bf16 v[40:43], v[184:187], v[136:139], v[40:43]
s_add_u32 m0, s33, 83968
s_add_u32 s36, s31, 28672
buffer_load_dwordx4 v15, s[16:19], s36 offen  lds
v_mfma_f32_16x16x32_bf16 v[44:47], v[184:187], v[140:143], v[44:47]
ds_read_b128 v[72:75], v17 offset:0
v_mfma_f32_16x16x32_bf16 v[48:51], v[188:191], v[120:123], v[48:51]
ds_read_b128 v[76:79], v17 offset:2048
v_mfma_f32_16x16x32_bf16 v[52:55], v[188:191], v[124:127], v[52:55]
ds_read_b128 v[80:83], v17 offset:4096
v_mfma_f32_16x16x32_bf16 v[56:59], v[188:191], v[128:131], v[56:59]
ds_read_b128 v[84:87], v17 offset:6144
v_mfma_f32_16x16x32_bf16 v[60:63], v[188:191], v[132:135], v[60:63]
s_add_u32 m0, s33, 84992
s_add_u32 s36, s32, 28672
buffer_load_dwordx4 v15, s[16:19], s36 offen  lds
v_mfma_f32_16x16x32_bf16 v[64:67], v[188:191], v[136:139], v[64:67]
ds_read_b128 v[88:91], v17 offset:8192
v_mfma_f32_16x16x32_bf16 v[68:71], v[188:191], v[140:143], v[68:71]
ds_read_b128 v[92:95], v17 offset:10240
v_mfma_f32_16x16x32_bf16 v[24:27], v[192:195], v[144:147], v[24:27]
ds_read_b64_tr_b16 v[176:177], v16 offset:8448
v_mfma_f32_16x16x32_bf16 v[28:31], v[192:195], v[148:151], v[28:31]
ds_read_b64_tr_b16 v[178:179], v16 offset:8960
v_mfma_f32_16x16x32_bf16 v[32:35], v[192:195], v[152:155], v[32:35]
s_add_u32 m0, s35, 82944
s_add_u32 s36, s34, 1146880
buffer_load_dwordx4 v10, s[12:15], s36 offen  lds
v_mfma_f32_16x16x32_bf16 v[36:39], v[192:195], v[156:159], v[36:39]
ds_read_b64_tr_b16 v[180:181], v16 offset:8480
v_mfma_f32_16x16x32_bf16 v[40:43], v[192:195], v[160:163], v[40:43]
ds_read_b64_tr_b16 v[182:183], v16 offset:8992
v_mfma_f32_16x16x32_bf16 v[44:47], v[192:195], v[164:167], v[44:47]
ds_read_b128 v[96:99], v17 offset:1024
v_mfma_f32_16x16x32_bf16 v[48:51], v[196:199], v[144:147], v[48:51]
ds_read_b128 v[100:103], v17 offset:3072
v_mfma_f32_16x16x32_bf16 v[52:55], v[196:199], v[148:151], v[52:55]
s_add_u32 m0, s35, 84000
s_add_u32 s36, s34, 1148160
buffer_load_dwordx4 v10, s[12:15], s36 offen  lds
v_mfma_f32_16x16x32_bf16 v[56:59], v[196:199], v[152:155], v[56:59]
ds_read_b128 v[104:107], v17 offset:5120
v_mfma_f32_16x16x32_bf16 v[60:63], v[196:199], v[156:159], v[60:63]
ds_read_b128 v[108:111], v17 offset:7168
v_mfma_f32_16x16x32_bf16 v[64:67], v[196:199], v[160:163], v[64:67]
ds_read_b128 v[112:115], v17 offset:9216
v_mfma_f32_16x16x32_bf16 v[68:71], v[196:199], v[164:167], v[68:71]
ds_read_b128 v[116:119], v17 offset:11264
s_waitcnt vmcnt(5) lgkmcnt(0)
s_barrier
v_mfma_f32_16x16x32_bf16 v[24:27], v[168:171], v[72:75], v[24:27]
s_add_u32 m0, s33, 0
s_add_u32 s36, s30, 30720
buffer_load_dwordx4 v15, s[16:19], s36 offen  lds
ds_read_b64_tr_b16 v[184:185], v18 offset:0
v_mfma_f32_16x16x32_bf16 v[28:31], v[168:171], v[76:79], v[28:31]
ds_read_b64_tr_b16 v[186:187], v18 offset:512
v_mfma_f32_16x16x32_bf16 v[32:35], v[168:171], v[80:83], v[32:35]
ds_read_b64_tr_b16 v[188:189], v18 offset:32
v_mfma_f32_16x16x32_bf16 v[36:39], v[168:171], v[84:87], v[36:39]
ds_read_b64_tr_b16 v[190:191], v18 offset:544
v_mfma_f32_16x16x32_bf16 v[40:43], v[168:171], v[88:91], v[40:43]
s_add_u32 m0, s33, 1024
s_add_u32 s36, s31, 30720
buffer_load_dwordx4 v15, s[16:19], s36 offen  lds
v_mfma_f32_16x16x32_bf16 v[44:47], v[168:171], v[92:95], v[44:47]
ds_read_b128 v[120:123], v19 offset:0
v_mfma_f32_16x16x32_bf16 v[48:51], v[172:175], v[72:75], v[48:51]
ds_read_b128 v[124:127], v19 offset:2048
v_mfma_f32_16x16x32_bf16 v[52:55], v[172:175], v[76:79], v[52:55]
ds_read_b128 v[128:131], v19 offset:4096
v_mfma_f32_16x16x32_bf16 v[56:59], v[172:175], v[80:83], v[56:59]
ds_read_b128 v[132:135], v19 offset:6144
v_mfma_f32_16x16x32_bf16 v[60:63], v[172:175], v[84:87], v[60:63]
s_add_u32 m0, s33, 2048
s_add_u32 s36, s32, 30720
buffer_load_dwordx4 v15, s[16:19], s36 offen  lds
v_mfma_f32_16x16x32_bf16 v[64:67], v[172:175], v[88:91], v[64:67]
ds_read_b128 v[136:139], v19 offset:8192
v_mfma_f32_16x16x32_bf16 v[68:71], v[172:175], v[92:95], v[68:71]
ds_read_b128 v[140:143], v19 offset:10240
v_mfma_f32_16x16x32_bf16 v[24:27], v[176:179], v[96:99], v[24:27]
ds_read_b64_tr_b16 v[192:193], v18 offset:8448
v_mfma_f32_16x16x32_bf16 v[28:31], v[176:179], v[100:103], v[28:31]
ds_read_b64_tr_b16 v[194:195], v18 offset:8960
v_mfma_f32_16x16x32_bf16 v[32:35], v[176:179], v[104:107], v[32:35]
s_add_u32 m0, s35, 0
s_add_u32 s36, s34, 1228800
buffer_load_dwordx4 v10, s[12:15], s36 offen  lds
v_mfma_f32_16x16x32_bf16 v[36:39], v[176:179], v[108:111], v[36:39]
ds_read_b64_tr_b16 v[196:197], v18 offset:8480
v_mfma_f32_16x16x32_bf16 v[40:43], v[176:179], v[112:115], v[40:43]
ds_read_b64_tr_b16 v[198:199], v18 offset:8992
v_mfma_f32_16x16x32_bf16 v[44:47], v[176:179], v[116:119], v[44:47]
ds_read_b128 v[144:147], v19 offset:1024
v_mfma_f32_16x16x32_bf16 v[48:51], v[180:183], v[96:99], v[48:51]
ds_read_b128 v[148:151], v19 offset:3072
v_mfma_f32_16x16x32_bf16 v[52:55], v[180:183], v[100:103], v[52:55]
s_add_u32 m0, s35, 1056
s_add_u32 s36, s34, 1230080
buffer_load_dwordx4 v10, s[12:15], s36 offen  lds
v_mfma_f32_16x16x32_bf16 v[56:59], v[180:183], v[104:107], v[56:59]
ds_read_b128 v[152:155], v19 offset:5120
v_mfma_f32_16x16x32_bf16 v[60:63], v[180:183], v[108:111], v[60:63]
ds_read_b128 v[156:159], v19 offset:7168
v_mfma_f32_16x16x32_bf16 v[64:67], v[180:183], v[112:115], v[64:67]
ds_read_b128 v[160:163], v19 offset:9216
v_mfma_f32_16x16x32_bf16 v[68:71], v[180:183], v[116:119], v[68:71]
ds_read_b128 v[164:167], v19 offset:11264
s_waitcnt vmcnt(5) lgkmcnt(0)
s_barrier
v_mfma_f32_16x16x32_bf16 v[24:27], v[184:187], v[120:123], v[24:27]
ds_read_b64_tr_b16 v[168:169], v20 offset:0
v_mfma_f32_16x16x32_bf16 v[28:31], v[184:187], v[124:127], v[28:31]
ds_read_b64_tr_b16 v[170:171], v20 offset:512
v_mfma_f32_16x16x32_bf16 v[32:35], v[184:187], v[128:131], v[32:35]
ds_read_b64_tr_b16 v[172:173], v20 offset:32
v_mfma_f32_16x16x32_bf16 v[36:39], v[184:187], v[132:135], v[36:39]
ds_read_b64_tr_b16 v[174:175], v20 offset:544
v_mfma_f32_16x16x32_bf16 v[40:43], v[184:187], v[136:139], v[40:43]
ds_read_b128 v[72:75], v21 offset:0
v_mfma_f32_16x16x32_bf16 v[44:47], v[184:187], v[140:143], v[44:47]
v_mfma_f32_16x16x32_bf16 v[48:51], v[188:191], v[120:123], v[48:51]
ds_read_b128 v[76:79], v21 offset:2048
v_mfma_f32_16x16x32_bf16 v[52:55], v[188:191], v[124:127], v[52:55]
ds_read_b128 v[80:83], v21 offset:4096
v_mfma_f32_16x16x32_bf16 v[56:59], v[188:191], v[128:131], v[56:59]
ds_read_b128 v[84:87], v21 offset:6144
v_mfma_f32_16x16x32_bf16 v[60:63], v[188:191], v[132:135], v[60:63]
ds_read_b128 v[88:91], v21 offset:8192
v_mfma_f32_16x16x32_bf16 v[64:67], v[188:191], v[136:139], v[64:67]
ds_read_b128 v[92:95], v21 offset:10240
v_mfma_f32_16x16x32_bf16 v[68:71], v[188:191], v[140:143], v[68:71]
v_mfma_f32_16x16x32_bf16 v[24:27], v[192:195], v[144:147], v[24:27]
ds_read_b64_tr_b16 v[176:177], v20 offset:8448
v_mfma_f32_16x16x32_bf16 v[28:31], v[192:195], v[148:151], v[28:31]
ds_read_b64_tr_b16 v[178:179], v20 offset:8960
v_mfma_f32_16x16x32_bf16 v[32:35], v[192:195], v[152:155], v[32:35]
ds_read_b64_tr_b16 v[180:181], v20 offset:8480
v_mfma_f32_16x16x32_bf16 v[36:39], v[192:195], v[156:159], v[36:39]
ds_read_b64_tr_b16 v[182:183], v20 offset:8992
v_mfma_f32_16x16x32_bf16 v[40:43], v[192:195], v[160:163], v[40:43]
ds_read_b128 v[96:99], v21 offset:1024
v_mfma_f32_16x16x32_bf16 v[44:47], v[192:195], v[164:167], v[44:47]
v_mfma_f32_16x16x32_bf16 v[48:51], v[196:199], v[144:147], v[48:51]
ds_read_b128 v[100:103], v21 offset:3072
v_mfma_f32_16x16x32_bf16 v[52:55], v[196:199], v[148:151], v[52:55]
ds_read_b128 v[104:107], v21 offset:5120
v_mfma_f32_16x16x32_bf16 v[56:59], v[196:199], v[152:155], v[56:59]
ds_read_b128 v[108:111], v21 offset:7168
v_mfma_f32_16x16x32_bf16 v[60:63], v[196:199], v[156:159], v[60:63]
ds_read_b128 v[112:115], v21 offset:9216
v_mfma_f32_16x16x32_bf16 v[64:67], v[196:199], v[160:163], v[64:67]
ds_read_b128 v[116:119], v21 offset:11264
v_mfma_f32_16x16x32_bf16 v[68:71], v[196:199], v[164:167], v[68:71]
s_waitcnt vmcnt(0) lgkmcnt(0)
s_barrier
v_mfma_f32_16x16x32_bf16 v[24:27], v[168:171], v[72:75], v[24:27]
ds_read_b64_tr_b16 v[184:185], v16 offset:0
v_mfma_f32_16x16x32_bf16 v[28:31], v[168:171], v[76:79], v[28:31]
ds_read_b64_tr_b16 v[186:187], v16 offset:512
v_mfma_f32_16x16x32_bf16 v[32:35], v[168:171], v[80:83], v[32:35]
ds_read_b64_tr_b16 v[188:189], v16 offset:32
v_mfma_f32_16x16x32_bf16 v[36:39], v[168:171], v[84:87], v[36:39]
ds_read_b64_tr_b16 v[190:191], v16 offset:544
v_mfma_f32_16x16x32_bf16 v[40:43], v[168:171], v[88:91], v[40:43]
ds_read_b128 v[120:123], v17 offset:0
v_mfma_f32_16x16x32_bf16 v[44:47], v[168:171], v[92:95], v[44:47]
v_mfma_f32_16x16x32_bf16 v[48:51], v[172:175], v[72:75], v[48:51]
ds_read_b128 v[124:127], v17 offset:2048
v_mfma_f32_16x16x32_bf16 v[52:55], v[172:175], v[76:79], v[52:55]
ds_read_b128 v[128:131], v17 offset:4096
v_mfma_f32_16x16x32_bf16 v[56:59], v[172:175], v[80:83], v[56:59]
ds_read_b128 v[132:135], v17 offset:6144
v_mfma_f32_16x16x32_bf16 v[60:63], v[172:175], v[84:87], v[60:63]
ds_read_b128 v[136:139], v17 offset:8192
v_mfma_f32_16x16x32_bf16 v[64:67], v[172:175], v[88:91], v[64:67]
ds_read_b128 v[140:143], v17 offset:10240
v_mfma_f32_16x16x32_bf16 v[68:71], v[172:175], v[92:95], v[68:71]
v_mfma_f32_16x16x32_bf16 v[24:27], v[176:179], v[96:99], v[24:27]
ds_read_b64_tr_b16 v[192:193], v16 offset:8448
v_mfma_f32_16x16x32_bf16 v[28:31], v[176:179], v[100:103], v[28:31]
ds_read_b64_tr_b16 v[194:195], v16 offset:8960
v_mfma_f32_16x16x32_bf16 v[32:35], v[176:179], v[104:107], v[32:35]
ds_read_b64_tr_b16 v[196:197], v16 offset:8480
v_mfma_f32_16x16x32_bf16 v[36:39], v[176:179], v[108:111], v[36:39]
ds_read_b64_tr_b16 v[198:199], v16 offset:8992
v_mfma_f32_16x16x32_bf16 v[40:43], v[176:179], v[112:115], v[40:43]
ds_read_b128 v[144:147], v17 offset:1024
v_mfma_f32_16x16x32_bf16 v[44:47], v[176:179], v[116:119], v[44:47]
v_mfma_f32_16x16x32_bf16 v[48:51], v[180:183], v[96:99], v[48:51]
ds_read_b128 v[148:151], v17 offset:3072
v_mfma_f32_16x16x32_bf16 v[52:55], v[180:183], v[100:103], v[52:55]
ds_read_b128 v[152:155], v17 offset:5120
v_mfma_f32_16x16x32_bf16 v[56:59], v[180:183], v[104:107], v[56:59]
ds_read_b128 v[156:159], v17 offset:7168
v_mfma_f32_16x16x32_bf16 v[60:63], v[180:183], v[108:111], v[60:63]
ds_read_b128 v[160:163], v17 offset:9216
v_mfma_f32_16x16x32_bf16 v[64:67], v[180:183], v[112:115], v[64:67]
ds_read_b128 v[164:167], v17 offset:11264
v_mfma_f32_16x16x32_bf16 v[68:71], v[180:183], v[116:119], v[68:71]
s_waitcnt lgkmcnt(0)
s_barrier
v_mfma_f32_16x16x32_bf16 v[24:27], v[184:187], v[120:123], v[24:27]
v_mfma_f32_16x16x32_bf16 v[28:31], v[184:187], v[124:127], v[28:31]
v_mfma_f32_16x16x32_bf16 v[32:35], v[184:187], v[128:131], v[32:35]
v_mfma_f32_16x16x32_bf16 v[36:39], v[184:187], v[132:135], v[36:39]
v_mfma_f32_16x16x32_bf16 v[40:43], v[184:187], v[136:139], v[40:43]
v_mfma_f32_16x16x32_bf16 v[44:47], v[184:187], v[140:143], v[44:47]
v_mfma_f32_16x16x32_bf16 v[48:51], v[188:191], v[120:123], v[48:51]
v_mfma_f32_16x16x32_bf16 v[52:55], v[188:191], v[124:127], v[52:55]
v_mfma_f32_16x16x32_bf16 v[56:59], v[188:191], v[128:131], v[56:59]
v_mfma_f32_16x16x32_bf16 v[60:63], v[188:191], v[132:135], v[60:63]
v_mfma_f32_16x16x32_bf16 v[64:67], v[188:191], v[136:139], v[64:67]
v_mfma_f32_16x16x32_bf16 v[68:71], v[188:191], v[140:143], v[68:71]
v_mfma_f32_16x16x32_bf16 v[24:27], v[192:195], v[144:147], v[24:27]
v_mfma_f32_16x16x32_bf16 v[28:31], v[192:195], v[148:151], v[28:31]
v_mfma_f32_16x16x32_bf16 v[32:35], v[192:195], v[152:155], v[32:35]
v_mfma_f32_16x16x32_bf16 v[36:39], v[192:195], v[156:159], v[36:39]
v_mfma_f32_16x16x32_bf16 v[40:43], v[192:195], v[160:163], v[40:43]
v_mfma_f32_16x16x32_bf16 v[44:47], v[192:195], v[164:167], v[44:47]
v_mfma_f32_16x16x32_bf16 v[48:51], v[196:199], v[144:147], v[48:51]
v_mfma_f32_16x16x32_bf16 v[52:55], v[196:199], v[148:151], v[52:55]
v_mfma_f32_16x16x32_bf16 v[56:59], v[196:199], v[152:155], v[56:59]
v_mfma_f32_16x16x32_bf16 v[60:63], v[196:199], v[156:159], v[60:63]
v_mfma_f32_16x16x32_bf16 v[64:67], v[196:199], v[160:163], v[64:67]
v_mfma_f32_16x16x32_bf16 v[68:71], v[196:199], v[164:167], v[68:71]
s_nop 15
s_mul_i32 s36, s23, 30
s_add_u32 s36, s36, s22
s_mul_i32 s36, s36, 196608
s_add_u32 s36, s36, 83886080
s_add_u32 s12, s56, s36
s_addc_u32 s13, s57, 0
s_mov_b32 s14, 196608
s_mov_b32 s15, 0x20000
s_mul_i32 s30, s24, 49152
s_mul_i32 s31, s27, 24576
s_lshl_b32 s32, s28, 10
s_add_u32 s31, s31, s32
s_add_u32 s30, s30, s31
s_lshl_b32 s33, s27, 1
s_add_u32 s34, s33, 0
s_cmp_eq_u32 s34, s24
s_cbranch_scc1 PX_28
v_cvt_pk_bf16_f32 v72, v24, v25
v_cvt_pk_bf16_f32 v73, v26, v27
v_cvt_pk_bf16_f32 v74, v48, v49
v_cvt_pk_bf16_f32 v75, v50, v51
s_add_u32 s36, s30, 0
buffer_store_dwordx4 v[72:75], v15, s[12:15], s36 offen sc1
v_cvt_pk_bf16_f32 v76, v28, v29
v_cvt_pk_bf16_f32 v77, v30, v31
v_cvt_pk_bf16_f32 v78, v52, v53
v_cvt_pk_bf16_f32 v79, v54, v55
s_add_u32 s36, s30, 4096
buffer_store_dwordx4 v[76:79], v15, s[12:15], s36 offen sc1
v_cvt_pk_bf16_f32 v80, v32, v33
v_cvt_pk_bf16_f32 v81, v34, v35
v_cvt_pk_bf16_f32 v82, v56, v57
v_cvt_pk_bf16_f32 v83, v58, v59
s_add_u32 s36, s30, 8192
buffer_store_dwordx4 v[80:83], v15, s[12:15], s36 offen sc1
PX_28:
s_add_u32 s34, s33, 1
s_cmp_eq_u32 s34, s24
s_cbranch_scc1 PX_29
v_cvt_pk_bf16_f32 v84, v36, v37
v_cvt_pk_bf16_f32 v85, v38, v39
v_cvt_pk_bf16_f32 v86, v60, v61
v_cvt_pk_bf16_f32 v87, v62, v63
s_add_u32 s36, s30, 12288
buffer_store_dwordx4 v[84:87], v15, s[12:15], s36 offen sc1
v_cvt_pk_bf16_f32 v88, v40, v41
v_cvt_pk_bf16_f32 v89, v42, v43
v_cvt_pk_bf16_f32 v90, v64, v65
v_cvt_pk_bf16_f32 v91, v66, v67
s_add_u32 s36, s30, 16384
buffer_store_dwordx4 v[88:91], v15, s[12:15], s36 offen sc1
v_cvt_pk_bf16_f32 v92, v44, v45
v_cvt_pk_bf16_f32 v93, v46, v47
v_cvt_pk_bf16_f32 v94, v68, v69
v_cvt_pk_bf16_f32 v95, v70, v71
s_add_u32 s36, s30, 20480
buffer_store_dwordx4 v[92:95], v15, s[12:15], s36 offen sc1
PX_29:
s_waitcnt vmcnt(0)
s_barrier
s_mul_i32 s36, s23, 30
s_add_u32 s36, s36, s22
s_lshl_b32 s36, s36, 7
s_add_u32 s36, s36, 35651584
v_and_b32 v2, 3, v0
v_lshlrev_b32 v2, 2, v2
v_add_u32 v21, s36, v2
s_cmp_lg_u32 s20, 0
s_cbranch_scc1 PW_30
s_lshl_b32 s37, s24, 2
s_add_u32 s37, s37, s36
v_mov_b32 v3, s37
v_mov_b32 v4, s51
s_mov_b64 s[42:43], exec
s_mov_b64 exec, 1
global_store_dword v3, v4, s[56:57] sc1
s_mov_b64 exec, s[42:43]
PW_30:
s_lshr_b32 s36, s24, 1
s_cmp_lg_u32 s27, s36
s_cbranch_scc1 PF_31
s_mov_b32 s47, 0
s_bitcmp1_b32 s24, 0
s_cbranch_scc1 PD_32
s_add_u32 s36, s24, 1
s_and_b32 s36, s36, 3
s_bitcmp1_b32 s47, s36
s_cbranch_scc1 PO_33
s_mov_b32 s50, 0x40000
PS_34:
s_sub_u32 s50, s50, 1
s_cbranch_scc1 PO_33
global_load_dword v20, v21, s[56:57] sc1
s_waitcnt vmcnt(0)
v_cmp_eq_u32 vcc, s51, v20
s_nop 1
s_and_b32 s47, vcc_lo, 0xf
s_bitcmp1_b32 s47, s36
s_cbranch_scc1 PO_33
s_sleep 1
s_branch PS_34
PO_33:
s_mul_i32 s36, s36, 49152
s_add_u32 s36, s36, s31
s_add_u32 s37, s36, 0
buffer_load_dwordx4 v[104:107], v15, s[12:15], s37 offen sc1
s_add_u32 s37, s36, 4096
buffer_load_dwordx4 v[108:111], v15, s[12:15], s37 offen sc1
s_add_u32 s37, s36, 8192
buffer_load_dwordx4 v[112:115], v15, s[12:15], s37 offen sc1
s_add_u32 s36, s24, 2
s_and_b32 s36, s36, 3
s_bitcmp1_b32 s47, s36
s_cbranch_scc1 PO_35
s_mov_b32 s50, 0x40000
PS_36:
s_sub_u32 s50, s50, 1
s_cbranch_scc1 PO_35
global_load_dword v20, v21, s[56:57] sc1
s_waitcnt vmcnt(0)
v_cmp_eq_u32 vcc, s51, v20
s_nop 1
s_and_b32 s47, vcc_lo, 0xf
s_bitcmp1_b32 s47, s36
s_cbranch_scc1 PO_35
s_sleep 1
s_branch PS_36
PO_35:
s_mul_i32 s36, s36, 49152
s_add_u32 s36, s36, s31
s_add_u32 s37, s36, 0
buffer_load_dwordx4 v[116:119], v15, s[12:15], s37 offen sc1
s_add_u32 s37, s36, 4096
buffer_load_dwordx4 v[120:123], v15, s[12:15], s37 offen sc1
s_add_u32 s37, s36, 8192
buffer_load_dwordx4 v[124:127], v15, s[12:15], s37 offen sc1
s_add_u32 s36, s24, 3
s_and_b32 s36, s36, 3
s_bitcmp1_b32 s47, s36
s_cbranch_scc1 PO_37
s_mov_b32 s50, 0x40000
PS_38:
s_sub_u32 s50, s50, 1
s_cbranch_scc1 PO_37
global_load_dword v20, v21, s[56:57] sc1
s_waitcnt vmcnt(0)
v_cmp_eq_u32 vcc, s51, v20
s_nop 1
s_and_b32 s47, vcc_lo, 0xf
s_bitcmp1_b32 s47, s36
s_cbranch_scc1 PO_37
s_sleep 1
s_branch PS_38
PO_37:
s_mul_i32 s36, s36, 49152
s_add_u32 s36, s36, s31
s_add_u32 s37, s36, 0
buffer_load_dwordx4 v[128:131], v15, s[12:15], s37 offen sc1
s_add_u32 s37, s36, 4096
buffer_load_dwordx4 v[132:135], v15, s[12:15], s37 offen sc1
s_add_u32 s37, s36, 8192
buffer_load_dwordx4 v[136:139], v15, s[12:15], s37 offen sc1
v_and_b32 v2, 15, v0
v_lshlrev_b32 v2, 8, v2
v_lshrrev_b32 v3, 4, v0
v_lshl_add_u32 v2, v3, 3, v2
s_lshl_b32 s36, s28, 6
v_add_u32 v2, s36, v2
s_waitcnt vmcnt(0)
v_lshlrev_b32 v4, 16, v104
v_and_b32 v5, 0xffff0000, v104
v_add_f32 v24, v24, v4
v_add_f32 v25, v25, v5
v_lshlrev_b32 v4, 16, v105
v_and_b32 v5, 0xffff0000, v105
v_add_f32 v26, v26, v4
v_add_f32 v27, v27, v5
v_lshlrev_b32 v4, 16, v116
v_and_b32 v5, 0xffff0000, v116
v_add_f32 v24, v24, v4
v_add_f32 v25, v25, v5
v_lshlrev_b32 v4, 16, v117
v_and_b32 v5, 0xffff0000, v117
v_add_f32 v26, v26, v4
v_add_f32 v27, v27, v5
v_lshlrev_b32 v4, 16, v128
v_and_b32 v5, 0xffff0000, v128
v_add_f32 v24, v24, v4
v_add_f32 v25, v25, v5
v_lshlrev_b32 v4, 16, v129
v_and_b32 v5, 0xffff0000, v129
v_add_f32 v26, v26, v4
v_add_f32 v27, v27, v5
v_cvt_pk_bf16_f32 v24, v24, v25
v_cvt_pk_bf16_f32 v25, v26, v27
ds_write_b64 v2, v[24:25] offset:0
v_lshlrev_b32 v4, 16, v106
v_and_b32 v5, 0xffff0000, v106
v_add_f32 v48, v48, v4
v_add_f32 v49, v49, v5
v_lshlrev_b32 v4, 16, v107
v_and_b32 v5, 0xffff0000, v107
v_add_f32 v50, v50, v4
v_add_f32 v51, v51, v5
v_lshlrev_b32 v4, 16, v118
v_and_b32 v5, 0xffff0000, v118
v_add_f32 v48, v48, v4
v_add_f32 v49, v49, v5
v_lshlrev_b32 v4, 16, v119
v_and_b32 v5, 0xffff0000, v119
v_add_f32 v50, v50, v4
v_add_f32 v51, v51, v5
v_lshlrev_b32 v4, 16, v130
v_and_b32 v5, 0xffff0000, v130
v_add_f32 v48, v48, v4
v_add_f32 v49, v49, v5
v_lshlrev_b32 v4, 16, v131
v_and_b32 v5, 0xffff0000, v131
v_add_f32 v50, v50, v4
v_add_f32 v51, v51, v5
v_cvt_pk_bf16_f32 v48, v48, v49
v_cvt_pk_bf16_f32 v49, v50, v51
ds_write_b64 v2, v[48:49] offset:32
v_lshlrev_b32 v4, 16, v108
v_and_b32 v5, 0xffff0000, v108
v_add_f32 v28, v28, v4
v_add_f32 v29, v29, v5
v_lshlrev_b32 v4, 16, v109
v_and_b32 v5, 0xffff0000, v109
v_add_f32 v30, v30, v4
v_add_f32 v31, v31, v5
v_lshlrev_b32 v4, 16, v120
v_and_b32 v5, 0xffff0000, v120
v_add_f32 v28, v28, v4
v_add_f32 v29, v29, v5
v_lshlrev_b32 v4, 16, v121
v_and_b32 v5, 0xffff0000, v121
v_add_f32 v30, v30, v4
v_add_f32 v31, v31, v5
v_lshlrev_b32 v4, 16, v132
v_and_b32 v5, 0xffff0000, v132
v_add_f32 v28, v28, v4
v_add_f32 v29, v29, v5
v_lshlrev_b32 v4, 16, v133
v_and_b32 v5, 0xffff0000, v133
v_add_f32 v30, v30, v4
v_add_f32 v31, v31, v5
v_cvt_pk_bf16_f32 v28, v28, v29
v_cvt_pk_bf16_f32 v29, v30, v31
ds_write_b64 v2, v[28:29] offset:4096
v_lshlrev_b32 v4, 16, v110
v_and_b32 v5, 0xffff0000, v110
v_add_f32 v52, v52, v4
v_add_f32 v53, v53, v5
v_lshlrev_b32 v4, 16, v111
v_and_b32 v5, 0xffff0000, v111
v_add_f32 v54, v54, v4
v_add_f32 v55, v55, v5
v_lshlrev_b32 v4, 16, v122
v_and_b32 v5, 0xffff0000, v122
v_add_f32 v52, v52, v4
v_add_f32 v53, v53, v5
v_lshlrev_b32 v4, 16, v123
v_and_b32 v5, 0xffff0000, v123
v_add_f32 v54, v54, v4
v_add_f32 v55, v55, v5
v_lshlrev_b32 v4, 16, v134
v_and_b32 v5, 0xffff0000, v134
v_add_f32 v52, v52, v4
v_add_f32 v53, v53, v5
v_lshlrev_b32 v4, 16, v135
v_and_b32 v5, 0xffff0000, v135
v_add_f32 v54, v54, v4
v_add_f32 v55, v55, v5
v_cvt_pk_bf16_f32 v52, v52, v53
v_cvt_pk_bf16_f32 v53, v54, v55
ds_write_b64 v2, v[52:53] offset:4128
v_lshlrev_b32 v4, 16, v112
v_and_b32 v5, 0xffff0000, v112
v_add_f32 v32, v32, v4
v_add_f32 v33, v33, v5
v_lshlrev_b32 v4, 16, v113
v_and_b32 v5, 0xffff0000, v113
v_add_f32 v34, v34, v4
v_add_f32 v35, v35, v5
v_lshlrev_b32 v4, 16, v124
v_and_b32 v5, 0xffff0000, v124
v_add_f32 v32, v32, v4
v_add_f32 v33, v33, v5
v_lshlrev_b32 v4, 16, v125
v_and_b32 v5, 0xffff0000, v125
v_add_f32 v34, v34, v4
v_add_f32 v35, v35, v5
v_lshlrev_b32 v4, 16, v136
v_and_b32 v5, 0xffff0000, v136
v_add_f32 v32, v32, v4
v_add_f32 v33, v33, v5
v_lshlrev_b32 v4, 16, v137
v_and_b32 v5, 0xffff0000, v137
v_add_f32 v34, v34, v4
v_add_f32 v35, v35, v5
v_cvt_pk_bf16_f32 v32, v32, v33
v_cvt_pk_bf16_f32 v33, v34, v35
ds_write_b64 v2, v[32:33] offset:8192
v_lshlrev_b32 v4, 16, v114
v_and_b32 v5, 0xffff0000, v114
v_add_f32 v56, v56, v4
v_add_f32 v57, v57, v5
v_lshlrev_b32 v4, 16, v115
v_and_b32 v5, 0xffff0000, v115
v_add_f32 v58, v58, v4
v_add_f32 v59, v59, v5
v_lshlrev_b32 v4, 16, v126
v_and_b32 v5, 0xffff0000, v126
v_add_f32 v56, v56, v4
v_add_f32 v57, v57, v5
v_lshlrev_b32 v4, 16, v127
v_and_b32 v5, 0xffff0000, v127
v_add_f32 v58, v58, v4
v_add_f32 v59, v59, v5
v_lshlrev_b32 v4, 16, v138
v_and_b32 v5, 0xffff0000, v138
v_add_f32 v56, v56, v4
v_add_f32 v57, v57, v5
v_lshlrev_b32 v4, 16, v139
v_and_b32 v5, 0xffff0000, v139
v_add_f32 v58, v58, v4
v_add_f32 v59, v59, v5
v_cvt_pk_bf16_f32 v56, v56, v57
v_cvt_pk_bf16_f32 v57, v58, v59
ds_write_b64 v2, v[56:57] offset:8224
s_waitcnt lgkmcnt(0)
s_branch PF_31
PD_32:
s_add_u32 s36, s24, 1
s_and_b32 s36, s36, 3
s_bitcmp1_b32 s47, s36
s_cbranch_scc1 PO_39
s_mov_b32 s50, 0x40000
PS_40:
s_sub_u32 s50, s50, 1
s_cbranch_scc1 PO_39
global_load_dword v20, v21, s[56:57] sc1
s_waitcnt vmcnt(0)
v_cmp_eq_u32 vcc, s51, v20
s_nop 1
s_and_b32 s47, vcc_lo, 0xf
s_bitcmp1_b32 s47, s36
s_cbranch_scc1 PO_39
s_sleep 1
s_branch PS_40
PO_39:
s_mul_i32 s36, s36, 49152
s_add_u32 s36, s36, s31
s_add_u32 s37, s36, 12288
buffer_load_dwordx4 v[104:107], v15, s[12:15], s37 offen sc1
s_add_u32 s37, s36, 16384
buffer_load_dwordx4 v[108:111], v15, s[12:15], s37 offen sc1
s_add_u32 s37, s36, 20480
buffer_load_dwordx4 v[112:115], v15, s[12:15], s37 offen sc1
s_add_u32 s36, s24, 2
s_and_b32 s36, s36, 3
s_bitcmp1_b32 s47, s36
s_cbranch_scc1 PO_41
s_mov_b32 s50, 0x40000
PS_42:
s_sub_u32 s50, s50, 1
s_cbranch_scc1 PO_41
global_load_dword v20, v21, s[56:57] sc1
s_waitcnt vmcnt(0)
v_cmp_eq_u32 vcc, s51, v20
s_nop 1
s_and_b32 s47, vcc_lo, 0xf
s_bitcmp1_b32 s47, s36
s_cbranch_scc1 PO_41
s_sleep 1
s_branch PS_42
PO_41:
s_mul_i32 s36, s36, 49152
s_add_u32 s36, s36, s31
s_add_u32 s37, s36, 12288
buffer_load_dwordx4 v[116:119], v15, s[12:15], s37 offen sc1
s_add_u32 s37, s36, 16384
buffer_load_dwordx4 v[120:123], v15, s[12:15], s37 offen sc1
s_add_u32 s37, s36, 20480
buffer_load_dwordx4 v[124:127], v15, s[12:15], s37 offen sc1
s_add_u32 s36, s24, 3
s_and_b32 s36, s36, 3
s_bitcmp1_b32 s47, s36
s_cbranch_scc1 PO_43
s_mov_b32 s50, 0x40000
PS_44:
s_sub_u32 s50, s50, 1
s_cbranch_scc1 PO_43
global_load_dword v20, v21, s[56:57] sc1
s_waitcnt vmcnt(0)
v_cmp_eq_u32 vcc, s51, v20
s_nop 1
s_and_b32 s47, vcc_lo, 0xf
s_bitcmp1_b32 s47, s36
s_cbranch_scc1 PO_43
s_sleep 1
s_branch PS_44
PO_43:
s_mul_i32 s36, s36, 49152
s_add_u32 s36, s36, s31
s_add_u32 s37, s36, 12288
buffer_load_dwordx4 v[128:131], v15, s[12:15], s37 offen sc1
s_add_u32 s37, s36, 16384
buffer_load_dwordx4 v[132:135], v15, s[12:15], s37 offen sc1
s_add_u32 s37, s36, 20480
buffer_load_dwordx4 v[136:139], v15, s[12:15], s37 offen sc1
v_and_b32 v2, 15, v0
v_lshlrev_b32 v2, 8, v2
v_lshrrev_b32 v3, 4, v0
v_lshl_add_u32 v2, v3, 3, v2
s_lshl_b32 s36, s28, 6
v_add_u32 v2, s36, v2
s_waitcnt vmcnt(0)
v_lshlrev_b32 v4, 16, v104
v_and_b32 v5, 0xffff0000, v104
v_add_f32 v36, v36, v4
v_add_f32 v37, v37, v5
v_lshlrev_b32 v4, 16, v105
v_and_b32 v5, 0xffff0000, v105
v_add_f32 v38, v38, v4
v_add_f32 v39, v39, v5
v_lshlrev_b32 v4, 16, v116
v_and_b32 v5, 0xffff0000, v116
v_add_f32 v36, v36, v4
v_add_f32 v37, v37, v5
v_lshlrev_b32 v4, 16, v117
v_and_b32 v5, 0xffff0000, v117
v_add_f32 v38, v38, v4
v_add_f32 v39, v39, v5
v_lshlrev_b32 v4, 16, v128
v_and_b32 v5, 0xffff0000, v128
v_add_f32 v36, v36, v4
v_add_f32 v37, v37, v5
v_lshlrev_b32 v4, 16, v129
v_and_b32 v5, 0xffff0000, v129
v_add_f32 v38, v38, v4
v_add_f32 v39, v39, v5
v_cvt_pk_bf16_f32 v36, v36, v37
v_cvt_pk_bf16_f32 v37, v38, v39
ds_write_b64 v2, v[36:37] offset:0
v_lshlrev_b32 v4, 16, v106
v_and_b32 v5, 0xffff0000, v106
v_add_f32 v60, v60, v4
v_add_f32 v61, v61, v5
v_lshlrev_b32 v4, 16, v107
v_and_b32 v5, 0xffff0000, v107
v_add_f32 v62, v62, v4
v_add_f32 v63, v63, v5
v_lshlrev_b32 v4, 16, v118
v_and_b32 v5, 0xffff0000, v118
v_add_f32 v60, v60, v4
v_add_f32 v61, v61, v5
v_lshlrev_b32 v4, 16, v119
v_and_b32 v5, 0xffff0000, v119
v_add_f32 v62, v62, v4
v_add_f32 v63, v63, v5
v_lshlrev_b32 v4, 16, v130
v_and_b32 v5, 0xffff0000, v130
v_add_f32 v60, v60, v4
v_add_f32 v61, v61, v5
v_lshlrev_b32 v4, 16, v131
v_and_b32 v5, 0xffff0000, v131
v_add_f32 v62, v62, v4
v_add_f32 v63, v63, v5
v_cvt_pk_bf16_f32 v60, v60, v61
v_cvt_pk_bf16_f32 v61, v62, v63
ds_write_b64 v2, v[60:61] offset:32
v_lshlrev_b32 v4, 16, v108
v_and_b32 v5, 0xffff0000, v108
v_add_f32 v40, v40, v4
v_add_f32 v41, v41, v5
v_lshlrev_b32 v4, 16, v109
v_and_b32 v5, 0xffff0000, v109
v_add_f32 v42, v42, v4
v_add_f32 v43, v43, v5
v_lshlrev_b32 v4, 16, v120
v_and_b32 v5, 0xffff0000, v120
v_add_f32 v40, v40, v4
v_add_f32 v41, v41, v5
v_lshlrev_b32 v4, 16, v121
v_and_b32 v5, 0xffff0000, v121
v_add_f32 v42, v42, v4
v_add_f32 v43, v43, v5
v_lshlrev_b32 v4, 16, v132
v_and_b32 v5, 0xffff0000, v132
v_add_f32 v40, v40, v4
v_add_f32 v41, v41, v5
v_lshlrev_b32 v4, 16, v133
v_and_b32 v5, 0xffff0000, v133
v_add_f32 v42, v42, v4
v_add_f32 v43, v43, v5
v_cvt_pk_bf16_f32 v40, v40, v41
v_cvt_pk_bf16_f32 v41, v42, v43
ds_write_b64 v2, v[40:41] offset:4096
v_lshlrev_b32 v4, 16, v110
v_and_b32 v5, 0xffff0000, v110
v_add_f32 v64, v64, v4
v_add_f32 v65, v65, v5
v_lshlrev_b32 v4, 16, v111
v_and_b32 v5, 0xffff0000, v111
v_add_f32 v66, v66, v4
v_add_f32 v67, v67, v5
v_lshlrev_b32 v4, 16, v122
v_and_b32 v5, 0xffff0000, v122
v_add_f32 v64, v64, v4
v_add_f32 v65, v65, v5
v_lshlrev_b32 v4, 16, v123
v_and_b32 v5, 0xffff0000, v123
v_add_f32 v66, v66, v4
v_add_f32 v67, v67, v5
v_lshlrev_b32 v4, 16, v134
v_and_b32 v5, 0xffff0000, v134
v_add_f32 v64, v64, v4
v_add_f32 v65, v65, v5
v_lshlrev_b32 v4, 16, v135
v_and_b32 v5, 0xffff0000, v135
v_add_f32 v66, v66, v4
v_add_f32 v67, v67, v5
v_cvt_pk_bf16_f32 v64, v64, v65
v_cvt_pk_bf16_f32 v65, v66, v67
ds_write_b64 v2, v[64:65] offset:4128
v_lshlrev_b32 v4, 16, v112
v_and_b32 v5, 0xffff0000, v112
v_add_f32 v44, v44, v4
v_add_f32 v45, v45, v5
v_lshlrev_b32 v4, 16, v113
v_and_b32 v5, 0xffff0000, v113
v_add_f32 v46, v46, v4
v_add_f32 v47, v47, v5
v_lshlrev_b32 v4, 16, v124
v_and_b32 v5, 0xffff0000, v124
v_add_f32 v44, v44, v4
v_add_f32 v45, v45, v5
v_lshlrev_b32 v4, 16, v125
v_and_b32 v5, 0xffff0000, v125
v_add_f32 v46, v46, v4
v_add_f32 v47, v47, v5
v_lshlrev_b32 v4, 16, v136
v_and_b32 v5, 0xffff0000, v136
v_add_f32 v44, v44, v4
v_add_f32 v45, v45, v5
v_lshlrev_b32 v4, 16, v137
v_and_b32 v5, 0xffff0000, v137
v_add_f32 v46, v46, v4
v_add_f32 v47, v47, v5
v_cvt_pk_bf16_f32 v44, v44, v45
v_cvt_pk_bf16_f32 v45, v46, v47
ds_write_b64 v2, v[44:45] offset:8192
v_lshlrev_b32 v4, 16, v114
v_and_b32 v5, 0xffff0000, v114
v_add_f32 v68, v68, v4
v_add_f32 v69, v69, v5
v_lshlrev_b32 v4, 16, v115
v_and_b32 v5, 0xffff0000, v115
v_add_f32 v70, v70, v4
v_add_f32 v71, v71, v5
v_lshlrev_b32 v4, 16, v126
v_and_b32 v5, 0xffff0000, v126
v_add_f32 v68, v68, v4
v_add_f32 v69, v69, v5
v_lshlrev_b32 v4, 16, v127
v_and_b32 v5, 0xffff0000, v127
v_add_f32 v70, v70, v4
v_add_f32 v71, v71, v5
v_lshlrev_b32 v4, 16, v138
v_and_b32 v5, 0xffff0000, v138
v_add_f32 v68, v68, v4
v_add_f32 v69, v69, v5
v_lshlrev_b32 v4, 16, v139
v_and_b32 v5, 0xffff0000, v139
v_add_f32 v70, v70, v4
v_add_f32 v71, v71, v5
v_cvt_pk_bf16_f32 v68, v68, v69
v_cvt_pk_bf16_f32 v69, v70, v71
ds_write_b64 v2, v[68:69] offset:8224
s_waitcnt lgkmcnt(0)
PF_31:
s_barrier
s_mul_i32 s30, s25, 192
s_mul_i32 s31, s24, 48
s_add_u32 s30, s30, s31
s_mul_i32 s30, s30, 2560
s_mul_i32 s31, s23, 1280
s_add_u32 s30, s30, s31
s_lshl_b32 s31, s26, 8
s_add_u32 s30, s30, s31
s_add_u32 s12, s8, s30
s_addc_u32 s13, s9, 0
s_sub_u32 s14, 2949120, s30
s_mov_b32 s15, 0x20000
s_lshl_b32 s31, s20, 6
v_add_u32 v1, s31, v0
v_add_u32 v3, 0, v1
v_lshrrev_b32 v4, 4, v3
v_and_b32 v5, 15, v3
v_lshlrev_b32 v6, 8, v4
v_lshl_add_u32 v6, v5, 4, v6
ds_read_b128 v[24:27], v6
v_mul_u32_u24 v7, 2560, v4
v_lshl_add_u32 v7, v5, 4, v7
s_waitcnt lgkmcnt(0)
buffer_store_dwordx4 v[24:27], v7, s[12:15], 0 offen sc1
s_cmp_ge_u32 s20, 4
s_cbranch_scc1 RS_45
v_add_u32 v3, 512, v1
v_lshrrev_b32 v4, 4, v3
v_and_b32 v5, 15, v3
v_lshlrev_b32 v6, 8, v4
v_lshl_add_u32 v6, v5, 4, v6
ds_read_b128 v[28:31], v6
v_mul_u32_u24 v7, 2560, v4
v_lshl_add_u32 v7, v5, 4, v7
s_waitcnt lgkmcnt(0)
buffer_store_dwordx4 v[28:31], v7, s[12:15], 0 offen sc1
RS_45:
s_endpgm
.section .rodata,"a"
.p2align 6
.amdhsa_kernel concat_heads__mha_block_cached__mha_block_cached__near_ridge_kernel
  .amdhsa_next_free_vgpr 256
  .amdhsa_next_free_sgpr 102
  .amdhsa_accum_offset 256
  .amdhsa_group_segment_fixed_size 0
  .amdhsa_kernarg_size 104
  .amdhsa_user_sgpr_count 2
  .amdhsa_user_sgpr_kernarg_segment_ptr 1
  .amdhsa_system_sgpr_workgroup_id_x 1
.end_amdhsa_kernel
.text
```
